```python
import torch

def _softmax(x, axis=-1):
    return torch.softmax(x, dim=axis)
def _gelu(x):
    return torch.nn.functional.gelu(x, approximate="tanh")
def _silu(x):
    return torch.nn.functional.silu(x)
def _sigmoid(x):
    return torch.sigmoid(x)
def _layernorm(x, axis=-1, eps=1e-5):
    m = x.mean(dim=axis, keepdim=True)
    v = x.var(dim=axis, keepdim=True, unbiased=False)
    return (x - m) / torch.sqrt(v + eps)
def _scatter_add(tgt, idx, src, axis=0):
    return tgt.clone().index_add_(axis, idx, src)
def _segment_sum(src, seg, n):
    out = torch.zeros((n,) + src.shape[1:], dtype=src.dtype)
    return out.index_add_(0, seg, src)
def _pad(x, pw):
    flat = tuple(v for pair in reversed(pw) for v in pair)
    return torch.nn.functional.pad(x, flat)

kernel_name = 'standalone__mha_block_cached__near_ridge'

def setup_inputs():

    _w = (lambda a: (lambda t: t.to(torch.bfloat16) if t.is_floating_point() else t)(torch.as_tensor(a)))
    B, Sq, D = 16, 208, 1024
    H, Sk, Dh = 32, 1024, 128
    return {
        "x": _w((lambda *s: torch.randn(*s, dtype=torch.bfloat16) * 0.8)(B, Sq, D)),
        "k_cache": _w((lambda *s: torch.randn(*s, dtype=torch.bfloat16) * 0.8)(B, H, Sk, Dh)),
        "v_cache": _w((lambda *s: torch.randn(*s, dtype=torch.bfloat16) * 0.05)(B, H, Sk, Dh)),
        "wq": _w((lambda *s: torch.randn(*s, dtype=torch.bfloat16) * 0.8)(D, H * Dh) * (D ** -0.5)),
        "wo": _w((lambda *s: torch.randn(*s, dtype=torch.bfloat16) * 0.05)(H * Dh, D) * ((H * Dh) ** -0.5)),
    }

def reference(x, k_cache, v_cache, wq, wo):
    B, Sq, D = x.shape
    H, Dh = 32, 128
    q = (lambda x, *d: x.permute(*d))((x @ wq).reshape(B, Sq, H, Dh), 0, 2, 1, 3)
    scores = torch.einsum("bhqd,bhkd->bhqk", q, k_cache) * (Dh ** -0.5)
    p = _softmax(scores, axis=-1)
    o = torch.einsum("bhqk,bhkd->bhqd", p, v_cache)
    return (lambda x, *d: x.permute(*d))(o, 0, 2, 1, 3).reshape(B, Sq, H * Dh) @ wo
```

```asm
; @launch grid=(256,1,1) block=(256,1,1) lds=163840
.amdgcn_target "amdgcn-amd-amdhsa--gfx950"
.text
.globl standalone__mha_block_cached__near_ridge_kernel
.p2align 8
.type standalone__mha_block_cached__near_ridge_kernel,@function
standalone__mha_block_cached__near_ridge_kernel:
    s_cmp_ge_u32 s2, 256
    s_cbranch_scc1 L1_end
    s_load_dwordx4 s[40:43], s[0:1], 0
    s_load_dwordx4 s[44:47], s[0:1], 16
    s_load_dwordx2 s[4:5], s[0:1], 56
    s_load_dwordx2 s[6:7], s[0:1], 32
    s_load_dwordx2 s[76:77], s[0:1], 48
    s_load_dwordx2 s[88:89], s[0:1], 40
    v_lshrrev_b32 v252, 6, v0
    v_and_b32 v247, 63, v0
    v_readfirstlane_b32 s24, v252
    s_and_b32 s90, s2, 7
    s_lshr_b32 s91, s2, 3
    s_lshr_b32 s26, s91, 1
    s_lshl_b32 s27, s90, 1
    s_and_b32 s52, s91, 1
    s_add_u32 s27, s27, s52
    s_lshr_b32 s25, s24, 1
    s_and_b32 s53, s24, 1
    v_lshrrev_b32 v252, 2, v247
    v_and_b32 v252, 3, v252
    v_lshrrev_b32 v253, 4, v247
    v_and_b32 v254, 3, v247
    v_lshlrev_b32 v208, 13, v252
    v_lshl_add_u32 v208, v253, 6, v208
    v_lshl_add_u32 v208, v254, 4, v208
    s_lshl_b32 s52, s24, 16
    s_add_u32 s52, s52, 4096
    v_add_u32 v208, s52, v208
    v_add_u32 v209, 31744, v208
    v_subrev_u32 v210, 1792, v208
    v_add_u32 v211, 29952, v208
    v_lshrrev_b32 v212, 2, v247
    v_and_b32 v212, 7, v212
    v_lshrrev_b32 v255, 2, v212
    v_lshlrev_b32 v255, 1, v255
    v_xor_b32 v255, v255, v254
    v_lshlrev_b32 v212, 11, v212
    v_lshl_add_u32 v212, v255, 4, v212
    v_lshrrev_b32 v255, 5, v247
    v_lshl_add_u32 v212, v255, 6, v212
    v_add_u32 v213, 15360, v212
    v_add_u32 v214, 30720, v212
    v_add_u32 v215, 46080, v212
    s_lshl_b32 s52, s24, 2
    s_lshr_b32 s52, 0xb480, s52
    s_and_b32 s52, s52, 15
    s_lshl_b32 s30, s52, 14
    s_lshl_b32 s36, s52, 10
    s_add_u32 s36, s36, 16640
    s_mul_i32 s52, s24, 3
    s_lshl_b32 s49, s52, 14
    s_add_u32 s49, s49, 229376
    s_lshl_b32 s50, s52, 10
    s_add_u32 s50, s50, 16640
    s_mul_i32 s35, s53, 8200
    s_lshl_b32 s54, s25, 12
    s_add_u32 s35, s35, s54
    s_mov_b32 s31, 0
    s_mul_i32 s52, s26, 425984
    s_lshl_b32 s54, s27, 9
    s_mov_b32 s10, 425984
    s_mov_b32 s11, 0x20000
    s_mov_b32 s15, 0x20000
    s_sub_u32 s14, 8392704, s54
    s_waitcnt lgkmcnt(0)
    s_add_u32 s8, s40, s52
    s_addc_u32 s9, s41, 0
    s_add_u32 s12, s46, s54
    s_addc_u32 s13, s47, 0
    s_sub_u32 s12, s12, 4096
    s_subb_u32 s13, s13, 0
    s_cmp_eq_u32 s53, 1
    s_cbranch_scc1 L1_p1
L1_p0:
    s_add_u32 m0, s35, 0
    s_nop 0
    buffer_load_dwordx4 v208, s[12:15], s31 offen offset:0 nt lds
    buffer_load_dwordx4 v209, s[12:15], s31 offen offset:1024 nt lds
    buffer_load_dwordx4 v210, s[12:15], s31 offen offset:2048 nt lds
    buffer_load_dwordx4 v211, s[12:15], s31 offen offset:3072 nt lds
    s_add_u32 s31, s31, 262144
    s_add_u32 m0, s36, 0
    s_nop 0
    buffer_load_dwordx4 v212, s[8:11], s30 offen offset:0  lds
    buffer_load_dwordx4 v213, s[8:11], s30 offen offset:1024  lds
    buffer_load_dwordx4 v214, s[8:11], s30 offen offset:2048  lds
    buffer_load_dwordx4 v215, s[8:11], s30 offen offset:3072  lds
    s_add_u32 s30, s30, 128
    s_add_u32 m0, s50, 32768
    s_nop 0
    buffer_load_dwordx4 v212, s[8:11], s49 offen offset:0  lds
    buffer_load_dwordx4 v213, s[8:11], s49 offen offset:1024  lds
    buffer_load_dwordx4 v214, s[8:11], s49 offen offset:2048  lds
    s_add_u32 s49, s49, 128
    s_add_u32 m0, s35, 32768
    s_nop 0
    buffer_load_dwordx4 v208, s[12:15], s31 offen offset:0 nt lds
    buffer_load_dwordx4 v209, s[12:15], s31 offen offset:1024 nt lds
    buffer_load_dwordx4 v210, s[12:15], s31 offen offset:2048 nt lds
    buffer_load_dwordx4 v211, s[12:15], s31 offen offset:3072 nt lds
    s_add_u32 s31, s31, 262144
    s_lshl_b32 s52, s26, 5
    s_lshl_b32 s54, s27, 1
    s_add_u32 s52, s52, s54
    s_add_u32 s52, s52, s25
    s_lshr_b32 s54, s52, 5
    s_mul_i32 s54, s54, 11
    s_add_u32 s54, s54, s52
    s_and_b32 s54, s54, 31
    s_lshl_b32 s65, s54, 13
    s_lshl_b32 s54, s52, 18
    s_add_u32 s16, s42, s54
    s_addc_u32 s17, s43, 0
    s_mov_b32 s18, 262144
    s_mov_b32 s19, 0x20000
    s_mul_i32 s52, s26, 1703936
    s_add_u32 s20, s4, s52
    s_addc_u32 s21, s5, 0
    s_mov_b32 s22, 1703936
    s_mov_b32 s23, 0x20000
    s_mov_b32 s56, s6
    s_mov_b32 s57, s7
    s_mov_b32 s58, 8388608
    s_mov_b32 s59, 0x20000
    s_lshl_b32 s37, s24, 13
    s_mov_b32 s78, 256
    s_mov_b32 s79, 0x20000
    s_lshl_b32 s80, s26, 4
    v_and_b32 v216, 1, v253
    v_mul_u32_u24 v216, 8200, v216
    v_lshrrev_b32 v217, 1, v253
    v_lshl_add_u32 v216, v217, 12, v216
    v_and_b32 v217, 15, v247
    v_lshl_add_u32 v216, v217, 4, v216
    s_lshl_b32 s54, s25, 11
    v_add_u32 v216, s54, v216
    v_and_b32 v255, 1, v252
    v_lshlrev_b32 v255, 1, v255
    v_xor_b32 v255, v255, v253
    v_lshlrev_b32 v255, 4, v255
    v_and_b32 v218, 7, v247
    v_lshl_add_u32 v218, v218, 6, v255
    v_lshrrev_b32 v217, 3, v217
    v_lshl_add_u32 v217, v217, 10, v218
    v_add_u32 v217, 16640, v217
    v_add_u32 v218, 32768, v217
    v_mov_b32 v219, v216
    v_mov_b32 v220, v217
    v_lshl_add_u32 v244, v252, 10, v255
    v_lshl_add_u32 v244, v254, 6, v244
    s_lshl_b32 s54, s25, 14
    s_add_u32 s54, s54, 65536
    v_add_u32 v244, s54, v244
    v_lshlrev_b32 v245, 10, v253
    v_lshl_add_u32 v245, v252, 6, v245
    v_lshl_add_u32 v245, v254, 3, v245
    s_add_u32 s54, s54, 8192
    v_add_u32 v245, s54, v245
    v_and_b32 v255, 1, v253
    v_lshl_add_u32 v245, v255, 5, v245
    v_xor_b32 v246, 32, v245
    v_lshlrev_b32 v248, 8, v252
    v_lshl_add_u32 v248, v253, 6, v248
    v_lshl_add_u32 v248, v254, 4, v248
    v_xor_b32 v249, 32, v248
    v_lshlrev_b32 v250, 7, v247
    v_lshlrev_b32 v255, 4, v247
    v_add_u32 v255, s37, v255
    v_add_u32 v221, 65536, v255
    v_add_u32 v222, 98304, v255
    v_add_u32 v223, 131072, v255
    v_add_u32 v224, 0, v255
    s_mov_b32 s29, 0
    s_mov_b32 s39, 0
    s_mov_b32 s64, 0
    s_mov_b32 s32, s65
    s_or_b32 s33, s65, 4096
    s_mov_b32 s48, 0
    s_mov_b32 s51, 131072
    s_and_b32 s67, s2, 7
    s_lshr_b32 s68, s2, 3
    s_lshr_b32 s81, s67, 1
    s_lshl_b32 s81, s81, 2
    s_lshr_b32 s69, s68, 3
    s_add_u32 s81, s81, s69
    s_and_b32 s82, s67, 1
    s_lshl_b32 s82, s82, 2
    s_lshr_b32 s69, s68, 1
    s_and_b32 s69, s69, 3
    s_add_u32 s82, s82, s69
    s_and_b32 s83, s68, 1
    s_mul_i32 s69, s81, 1703936
    s_add_u32 s60, s4, s69
    s_addc_u32 s61, s5, 0
    s_mov_b32 s62, 1703936
    s_mov_b32 s63, 0x20000
    s_lshl_b32 s69, s82, 8
    s_add_u32 s84, s6, s69
    s_addc_u32 s85, s7, 0
    s_sub_u32 s86, 8388608, s69
    s_mov_b32 s87, 0x20000
    s_mul_i32 s69, s81, 425984
    s_add_u32 s88, s88, s69
    s_addc_u32 s89, s89, 0
    s_mov_b32 s90, 425984
    s_mov_b32 s91, 0x20000
    s_add_u32 s72, s4, 0x4000000
    s_addc_u32 s73, s5, 0
    s_mov_b32 s74, 0x80000
    s_mov_b32 s75, 0x20000
    s_lshl_b32 s69, s81, 2
    s_add_u32 s69, s69, s24
    s_mul_i32 s95, s69, 4352
    s_lshl_b32 s66, s81, 4
    s_mul_i32 s97, s24, 33792
    s_add_u32 m0, s35, 65536
    s_nop 0
    buffer_load_dwordx4 v208, s[12:15], s31 offen offset:0 nt lds
    buffer_load_dwordx4 v209, s[12:15], s31 offen offset:1024 nt lds
    buffer_load_dwordx4 v210, s[12:15], s31 offen offset:2048 nt lds
    buffer_load_dwordx4 v211, s[12:15], s31 offen offset:3072 nt lds
    s_add_u32 s31, s31, 262144
    s_add_u32 m0, s36, 65536
    s_nop 0
    buffer_load_dwordx4 v212, s[8:11], s30 offen offset:0  lds
    buffer_load_dwordx4 v213, s[8:11], s30 offen offset:1024  lds
    buffer_load_dwordx4 v214, s[8:11], s30 offen offset:2048  lds
    buffer_load_dwordx4 v215, s[8:11], s30 offen offset:3072  lds
    s_add_u32 s30, s30, 128
    s_add_u32 m0, s50, 98304
    s_nop 0
    buffer_load_dwordx4 v212, s[8:11], s49 offen offset:0  lds
    buffer_load_dwordx4 v213, s[8:11], s49 offen offset:1024  lds
    buffer_load_dwordx4 v214, s[8:11], s49 offen offset:2048  lds
    s_add_u32 s49, s49, 128
    s_lshr_b32 s55, s2, 3
    s_lshl_b32 s55, s55, 2
    s_add_u32 s55, s55, s24
    s_getpc_b64 s[46:47]
    s_sub_u32 s46, s46, .-standalone__mha_block_cached__near_ridge_kernel
    s_subb_u32 s47, s47, 0
    v_lshl_add_u32 v226, s55, 10, v248
    v_min_u32 v226, L_code_end-standalone__mha_block_cached__near_ridge_kernel-4, v226
    v_mov_b32 v227, s47
    v_add_co_u32 v226, vcc, s46, v226
    s_nop 1
    v_addc_co_u32 v227, vcc, 0, v227, vcc
    global_load_dword v255, v[226:227], off
    s_waitcnt vmcnt(16)
    s_barrier
    ds_read_b64_tr_b16 a[112:113], v216 offset:0
    ds_read_b64_tr_b16 a[114:115], v216 offset:1024
    ds_read_b128 a[144:147], v217 offset:0
    ds_read_b128 a[148:151], v217 offset:2048
    ds_read_b128 a[152:155], v217 offset:4096
    ds_read_b128 a[156:159], v217 offset:6144
    ds_read_b128 a[160:163], v217 offset:8192
    ds_read_b128 a[164:167], v217 offset:10240
    ds_read_b128 a[168:171], v218 offset:10240
    ds_read_b64_tr_b16 a[116:117], v216 offset:8
    ds_read_b64_tr_b16 a[118:119], v216 offset:1032
    ds_read_b64_tr_b16 a[120:121], v216 offset:256
    ds_read_b64_tr_b16 a[122:123], v216 offset:1280
    ds_read_b64_tr_b16 a[124:125], v216 offset:264
    ds_read_b64_tr_b16 a[126:127], v216 offset:1288
    ds_read_b64_tr_b16 a[128:129], v216 offset:512
    ds_read_b64_tr_b16 a[130:131], v216 offset:1536
    ds_read_b64_tr_b16 a[132:133], v216 offset:520
    ds_read_b64_tr_b16 a[134:135], v216 offset:1544
    ds_read_b64_tr_b16 a[136:137], v216 offset:768
    ds_read_b64_tr_b16 a[138:139], v216 offset:1792
    ds_read_b64_tr_b16 a[140:141], v216 offset:776
    ds_read_b64_tr_b16 a[142:143], v216 offset:1800
    s_add_u32 s39, s39, 32768
    s_cmp_eq_u32 s39, 163840
    s_cselect_b32 s39, 0, s39
    v_add_u32 v216, s39, v219
    s_waitcnt vmcnt(12) lgkmcnt(0)
    s_barrier
    v_mfma_f32_16x16x32_bf16 v[0:3], a[112:115], a[144:147], 0
    s_add_u32 m0, s35, 98304
    ds_read_b64_tr_b16 a[172:173], v216 offset:0
    v_mfma_f32_16x16x32_bf16 v[32:35], a[112:115], a[148:151], 0
    buffer_load_dwordx4 v208, s[12:15], s31 offen offset:0 nt lds
    ds_read_b64_tr_b16 a[174:175], v216 offset:1024
    v_mfma_f32_16x16x32_bf16 v[64:67], a[112:115], a[152:155], 0
    ds_read_b128 a[204:207], v217 offset:512
    v_mfma_f32_16x16x32_bf16 v[96:99], a[112:115], a[156:159], 0
    ds_read_b128 a[208:211], v217 offset:2560
    v_mfma_f32_16x16x32_bf16 v[128:131], a[112:115], a[160:163], 0
    buffer_load_dwordx4 v209, s[12:15], s31 offen offset:1024 nt lds
    ds_read_b128 a[212:215], v217 offset:4608
    v_mfma_f32_16x16x32_bf16 v[160:163], a[112:115], a[164:167], 0
    ds_read_b128 a[216:219], v217 offset:6656
    v_mfma_f32_16x16x32_bf16 v[192:195], a[112:115], a[168:171], 0
    ds_read_b128 a[220:223], v217 offset:8704
    v_mfma_f32_16x16x32_bf16 v[4:7], a[116:119], a[144:147], 0
    buffer_load_dwordx4 v210, s[12:15], s31 offen offset:2048 nt lds
    ds_read_b128 a[224:227], v217 offset:10752
    v_mfma_f32_16x16x32_bf16 v[36:39], a[116:119], a[148:151], 0
    ds_read_b128 a[228:231], v218 offset:10752
    v_mfma_f32_16x16x32_bf16 v[68:71], a[116:119], a[152:155], 0
    ds_read_b64_tr_b16 a[176:177], v216 offset:8
    v_mfma_f32_16x16x32_bf16 v[100:103], a[116:119], a[156:159], 0
    buffer_load_dwordx4 v211, s[12:15], s31 offen offset:3072 nt lds
    s_add_u32 s31, s31, 262144
    v_mfma_f32_16x16x32_bf16 v[132:135], a[116:119], a[160:163], 0
    s_add_u32 m0, s35, 131072
    ds_read_b64_tr_b16 a[178:179], v216 offset:1032
    v_mfma_f32_16x16x32_bf16 v[164:167], a[116:119], a[164:167], 0
    ds_read_b64_tr_b16 a[180:181], v216 offset:256
    v_mfma_f32_16x16x32_bf16 v[196:199], a[116:119], a[168:171], 0
    buffer_load_dwordx4 v208, s[12:15], s31 offen offset:0 nt lds
    ds_read_b64_tr_b16 a[182:183], v216 offset:1280
    v_mfma_f32_16x16x32_bf16 v[8:11], a[120:123], a[144:147], 0
    ds_read_b64_tr_b16 a[184:185], v216 offset:264
    v_mfma_f32_16x16x32_bf16 v[40:43], a[120:123], a[148:151], 0
    ds_read_b64_tr_b16 a[186:187], v216 offset:1288
    v_mfma_f32_16x16x32_bf16 v[72:75], a[120:123], a[152:155], 0
    buffer_load_dwordx4 v209, s[12:15], s31 offen offset:1024 nt lds
    ds_read_b64_tr_b16 a[188:189], v216 offset:512
    v_mfma_f32_16x16x32_bf16 v[104:107], a[120:123], a[156:159], 0
    ds_read_b64_tr_b16 a[190:191], v216 offset:1536
    v_mfma_f32_16x16x32_bf16 v[136:139], a[120:123], a[160:163], 0
    ds_read_b64_tr_b16 a[192:193], v216 offset:520
    v_mfma_f32_16x16x32_bf16 v[168:171], a[120:123], a[164:167], 0
    buffer_load_dwordx4 v210, s[12:15], s31 offen offset:2048 nt lds
    ds_read_b64_tr_b16 a[194:195], v216 offset:1544
    v_mfma_f32_16x16x32_bf16 v[200:203], a[120:123], a[168:171], 0
    ds_read_b64_tr_b16 a[196:197], v216 offset:768
    v_mfma_f32_16x16x32_bf16 v[12:15], a[124:127], a[144:147], 0
    ds_read_b64_tr_b16 a[198:199], v216 offset:1792
    v_mfma_f32_16x16x32_bf16 v[44:47], a[124:127], a[148:151], 0
    buffer_load_dwordx4 v211, s[12:15], s31 offen offset:3072 nt lds
    s_add_u32 s31, s31, 262144
    v_mfma_f32_16x16x32_bf16 v[76:79], a[124:127], a[152:155], 0
    s_add_u32 m0, s36, s51
    ds_read_b64_tr_b16 a[200:201], v216 offset:776
    v_mfma_f32_16x16x32_bf16 v[108:111], a[124:127], a[156:159], 0
    ds_read_b64_tr_b16 a[202:203], v216 offset:1800
    v_mfma_f32_16x16x32_bf16 v[140:143], a[124:127], a[160:163], 0
    buffer_load_dwordx4 v212, s[8:11], s30 offen offset:0  lds
    s_add_u32 s39, s39, 32768
    v_mfma_f32_16x16x32_bf16 v[172:175], a[124:127], a[164:167], 0
    s_cmp_eq_u32 s39, 163840
    s_cselect_b32 s39, 0, s39
    v_mfma_f32_16x16x32_bf16 v[204:207], a[124:127], a[168:171], 0
    v_add_u32 v216, s39, v219
    v_add_u32 v217, s39, v220
    v_mfma_f32_16x16x32_bf16 v[16:19], a[128:131], a[144:147], 0
    buffer_load_dwordx4 v213, s[8:11], s30 offen offset:1024  lds
    s_add_u32 s40, s39, 32768
    v_mfma_f32_16x16x32_bf16 v[48:51], a[128:131], a[148:151], 0
    s_cmp_eq_u32 s40, 163840
    s_cselect_b32 s40, 0, s40
    v_mfma_f32_16x16x32_bf16 v[80:83], a[128:131], a[152:155], 0
    v_add_u32 v218, s40, v220
    v_mfma_f32_16x16x32_bf16 v[112:115], a[128:131], a[156:159], 0
    buffer_load_dwordx4 v214, s[8:11], s30 offen offset:2048  lds
    v_mfma_f32_16x16x32_bf16 v[144:147], a[128:131], a[160:163], 0
    v_mfma_f32_16x16x32_bf16 v[176:179], a[128:131], a[164:167], 0
    v_mfma_f32_16x16x32_bf16 v[20:23], a[132:135], a[144:147], 0
    buffer_load_dwordx4 v215, s[8:11], s30 offen offset:3072  lds
    s_add_u32 s30, s30, 128
    v_mfma_f32_16x16x32_bf16 v[52:55], a[132:135], a[148:151], 0
    s_add_u32 m0, s35, s29
    v_mfma_f32_16x16x32_bf16 v[84:87], a[132:135], a[152:155], 0
    v_mfma_f32_16x16x32_bf16 v[116:119], a[132:135], a[156:159], 0
    buffer_load_dwordx4 v208, s[12:15], s31 offen offset:0 nt lds
    v_mfma_f32_16x16x32_bf16 v[148:151], a[132:135], a[160:163], 0
    v_mfma_f32_16x16x32_bf16 v[180:183], a[132:135], a[164:167], 0
    v_mfma_f32_16x16x32_bf16 v[24:27], a[136:139], a[144:147], 0
    buffer_load_dwordx4 v209, s[12:15], s31 offen offset:1024 nt lds
    v_mfma_f32_16x16x32_bf16 v[56:59], a[136:139], a[148:151], 0
    v_mfma_f32_16x16x32_bf16 v[88:91], a[136:139], a[152:155], 0
    v_mfma_f32_16x16x32_bf16 v[120:123], a[136:139], a[156:159], 0
    buffer_load_dwordx4 v210, s[12:15], s31 offen offset:2048 nt lds
    v_mfma_f32_16x16x32_bf16 v[152:155], a[136:139], a[160:163], 0
    v_mfma_f32_16x16x32_bf16 v[184:187], a[136:139], a[164:167], 0
    v_mfma_f32_16x16x32_bf16 v[28:31], a[140:143], a[144:147], 0
    buffer_load_dwordx4 v211, s[12:15], s31 offen offset:3072 nt lds
    s_add_u32 s31, s31, 262144
    v_mfma_f32_16x16x32_bf16 v[60:63], a[140:143], a[148:151], 0
    s_mov_b32 s51, s29
    s_add_u32 s29, s29, 32768
    v_mfma_f32_16x16x32_bf16 v[92:95], a[140:143], a[152:155], 0
    s_cmp_eq_u32 s29, 163840
    s_cselect_b32 s29, 0, s29
    v_mfma_f32_16x16x32_bf16 v[124:127], a[140:143], a[156:159], 0
    v_mfma_f32_16x16x32_bf16 v[156:159], a[140:143], a[160:163], 0
    v_mfma_f32_16x16x32_bf16 v[188:191], a[140:143], a[164:167], 0
    s_waitcnt vmcnt(17) lgkmcnt(0)
    s_barrier
    v_mfma_f32_16x16x32_bf16 v[0:3], a[172:175], a[204:207], v[0:3]
    s_add_u32 m0, s50, s51
    ds_read_b64_tr_b16 a[112:113], v216 offset:0
    v_mfma_f32_16x16x32_bf16 v[32:35], a[172:175], a[208:211], v[32:35]
    buffer_load_dwordx4 v212, s[8:11], s49 offen offset:0  lds
    ds_read_b64_tr_b16 a[114:115], v216 offset:1024
    v_mfma_f32_16x16x32_bf16 v[64:67], a[172:175], a[212:215], v[64:67]
    ds_read_b128 a[144:147], v217 offset:0
    v_mfma_f32_16x16x32_bf16 v[96:99], a[172:175], a[216:219], v[96:99]
    ds_read_b128 a[148:151], v217 offset:2048
    v_mfma_f32_16x16x32_bf16 v[128:131], a[172:175], a[220:223], v[128:131]
    ds_read_b128 a[152:155], v217 offset:4096
    v_mfma_f32_16x16x32_bf16 v[160:163], a[172:175], a[224:227], v[160:163]
    ds_read_b128 a[156:159], v217 offset:6144
    v_mfma_f32_16x16x32_bf16 v[192:195], a[172:175], a[228:231], v[192:195]
    ds_read_b128 a[160:163], v217 offset:8192
    v_mfma_f32_16x16x32_bf16 v[4:7], a[176:179], a[204:207], v[4:7]
    buffer_load_dwordx4 v213, s[8:11], s49 offen offset:1024  lds
    ds_read_b128 a[164:167], v217 offset:10240
    v_mfma_f32_16x16x32_bf16 v[36:39], a[176:179], a[208:211], v[36:39]
    ds_read_b128 a[168:171], v218 offset:10240
    v_mfma_f32_16x16x32_bf16 v[68:71], a[176:179], a[212:215], v[68:71]
    ds_read_b64_tr_b16 a[116:117], v216 offset:8
    v_mfma_f32_16x16x32_bf16 v[100:103], a[176:179], a[216:219], v[100:103]
    ds_read_b64_tr_b16 a[118:119], v216 offset:1032
    v_mfma_f32_16x16x32_bf16 v[132:135], a[176:179], a[220:223], v[132:135]
    ds_read_b64_tr_b16 a[120:121], v216 offset:256
    v_mfma_f32_16x16x32_bf16 v[164:167], a[176:179], a[224:227], v[164:167]
    ds_read_b64_tr_b16 a[122:123], v216 offset:1280
    v_mfma_f32_16x16x32_bf16 v[196:199], a[176:179], a[228:231], v[196:199]
    ds_read_b64_tr_b16 a[124:125], v216 offset:264
    v_mfma_f32_16x16x32_bf16 v[8:11], a[180:183], a[204:207], v[8:11]
    buffer_load_dwordx4 v214, s[8:11], s49 offen offset:2048  lds
    s_add_u32 s49, s49, 128
    v_mfma_f32_16x16x32_bf16 v[40:43], a[180:183], a[208:211], v[40:43]
    s_add_u32 m0, s35, s29
    ds_read_b64_tr_b16 a[126:127], v216 offset:1288
    v_mfma_f32_16x16x32_bf16 v[72:75], a[180:183], a[212:215], v[72:75]
    ds_read_b64_tr_b16 a[128:129], v216 offset:512
    v_mfma_f32_16x16x32_bf16 v[104:107], a[180:183], a[216:219], v[104:107]
    ds_read_b64_tr_b16 a[130:131], v216 offset:1536
    v_mfma_f32_16x16x32_bf16 v[136:139], a[180:183], a[220:223], v[136:139]
    ds_read_b64_tr_b16 a[132:133], v216 offset:520
    v_mfma_f32_16x16x32_bf16 v[168:171], a[180:183], a[224:227], v[168:171]
    ds_read_b64_tr_b16 a[134:135], v216 offset:1544
    v_mfma_f32_16x16x32_bf16 v[200:203], a[180:183], a[228:231], v[200:203]
    ds_read_b64_tr_b16 a[136:137], v216 offset:768
    v_mfma_f32_16x16x32_bf16 v[12:15], a[184:187], a[204:207], v[12:15]
    buffer_load_dwordx4 v208, s[12:15], s31 offen offset:0 nt lds
    ds_read_b64_tr_b16 a[138:139], v216 offset:1792
    v_mfma_f32_16x16x32_bf16 v[44:47], a[184:187], a[208:211], v[44:47]
    ds_read_b64_tr_b16 a[140:141], v216 offset:776
    v_mfma_f32_16x16x32_bf16 v[76:79], a[184:187], a[212:215], v[76:79]
    ds_read_b64_tr_b16 a[142:143], v216 offset:1800
    v_mfma_f32_16x16x32_bf16 v[108:111], a[184:187], a[216:219], v[108:111]
    s_add_u32 s39, s39, 32768
    v_mfma_f32_16x16x32_bf16 v[140:143], a[184:187], a[220:223], v[140:143]
    s_cmp_eq_u32 s39, 163840
    s_cselect_b32 s39, 0, s39
    v_mfma_f32_16x16x32_bf16 v[172:175], a[184:187], a[224:227], v[172:175]
    v_add_u32 v216, s39, v219
    v_mfma_f32_16x16x32_bf16 v[204:207], a[184:187], a[228:231], v[204:207]
    v_mfma_f32_16x16x32_bf16 v[16:19], a[188:191], a[204:207], v[16:19]
    buffer_load_dwordx4 v209, s[12:15], s31 offen offset:1024 nt lds
    v_mfma_f32_16x16x32_bf16 v[48:51], a[188:191], a[208:211], v[48:51]
    v_mfma_f32_16x16x32_bf16 v[80:83], a[188:191], a[212:215], v[80:83]
    v_mfma_f32_16x16x32_bf16 v[112:115], a[188:191], a[216:219], v[112:115]
    v_mfma_f32_16x16x32_bf16 v[144:147], a[188:191], a[220:223], v[144:147]
    v_mfma_f32_16x16x32_bf16 v[176:179], a[188:191], a[224:227], v[176:179]
    v_mfma_f32_16x16x32_bf16 v[20:23], a[192:195], a[204:207], v[20:23]
    v_mfma_f32_16x16x32_bf16 v[52:55], a[192:195], a[208:211], v[52:55]
    buffer_load_dwordx4 v210, s[12:15], s31 offen offset:2048 nt lds
    v_mfma_f32_16x16x32_bf16 v[84:87], a[192:195], a[212:215], v[84:87]
    v_mfma_f32_16x16x32_bf16 v[116:119], a[192:195], a[216:219], v[116:119]
    v_mfma_f32_16x16x32_bf16 v[148:151], a[192:195], a[220:223], v[148:151]
    v_mfma_f32_16x16x32_bf16 v[180:183], a[192:195], a[224:227], v[180:183]
    v_mfma_f32_16x16x32_bf16 v[24:27], a[196:199], a[204:207], v[24:27]
    v_mfma_f32_16x16x32_bf16 v[56:59], a[196:199], a[208:211], v[56:59]
    v_mfma_f32_16x16x32_bf16 v[88:91], a[196:199], a[212:215], v[88:91]
    buffer_load_dwordx4 v211, s[12:15], s31 offen offset:3072 nt lds
    s_add_u32 s31, s31, 262144
    v_mfma_f32_16x16x32_bf16 v[120:123], a[196:199], a[216:219], v[120:123]
    s_mov_b32 s51, s29
    s_add_u32 s29, s29, 32768
    v_mfma_f32_16x16x32_bf16 v[152:155], a[196:199], a[220:223], v[152:155]
    s_cmp_eq_u32 s29, 163840
    s_cselect_b32 s29, 0, s29
    v_mfma_f32_16x16x32_bf16 v[184:187], a[196:199], a[224:227], v[184:187]
    v_mfma_f32_16x16x32_bf16 v[28:31], a[200:203], a[204:207], v[28:31]
    v_mfma_f32_16x16x32_bf16 v[60:63], a[200:203], a[208:211], v[60:63]
    v_mfma_f32_16x16x32_bf16 v[92:95], a[200:203], a[212:215], v[92:95]
    v_mfma_f32_16x16x32_bf16 v[124:127], a[200:203], a[216:219], v[124:127]
    v_mfma_f32_16x16x32_bf16 v[156:159], a[200:203], a[220:223], v[156:159]
    v_mfma_f32_16x16x32_bf16 v[188:191], a[200:203], a[224:227], v[188:191]
    s_waitcnt vmcnt(19) lgkmcnt(0)
    s_barrier
    v_mfma_f32_16x16x32_bf16 v[0:3], a[112:115], a[144:147], v[0:3]
    s_add_u32 m0, s36, s51
    ds_read_b64_tr_b16 a[172:173], v216 offset:0
    v_mfma_f32_16x16x32_bf16 v[32:35], a[112:115], a[148:151], v[32:35]
    buffer_load_dwordx4 v212, s[8:11], s30 offen offset:0  lds
    ds_read_b64_tr_b16 a[174:175], v216 offset:1024
    v_mfma_f32_16x16x32_bf16 v[64:67], a[112:115], a[152:155], v[64:67]
    ds_read_b128 a[204:207], v217 offset:512
    v_mfma_f32_16x16x32_bf16 v[96:99], a[112:115], a[156:159], v[96:99]
    ds_read_b128 a[208:211], v217 offset:2560
    v_mfma_f32_16x16x32_bf16 v[128:131], a[112:115], a[160:163], v[128:131]
    ds_read_b128 a[212:215], v217 offset:4608
    v_mfma_f32_16x16x32_bf16 v[160:163], a[112:115], a[164:167], v[160:163]
    ds_read_b128 a[216:219], v217 offset:6656
    v_mfma_f32_16x16x32_bf16 v[192:195], a[112:115], a[168:171], v[192:195]
    ds_read_b128 a[220:223], v217 offset:8704
    v_mfma_f32_16x16x32_bf16 v[4:7], a[116:119], a[144:147], v[4:7]
    buffer_load_dwordx4 v213, s[8:11], s30 offen offset:1024  lds
    ds_read_b128 a[224:227], v217 offset:10752
    v_mfma_f32_16x16x32_bf16 v[36:39], a[116:119], a[148:151], v[36:39]
    ds_read_b128 a[228:231], v218 offset:10752
    v_mfma_f32_16x16x32_bf16 v[68:71], a[116:119], a[152:155], v[68:71]
    ds_read_b64_tr_b16 a[176:177], v216 offset:8
    v_mfma_f32_16x16x32_bf16 v[100:103], a[116:119], a[156:159], v[100:103]
    ds_read_b64_tr_b16 a[178:179], v216 offset:1032
    v_mfma_f32_16x16x32_bf16 v[132:135], a[116:119], a[160:163], v[132:135]
    ds_read_b64_tr_b16 a[180:181], v216 offset:256
    v_mfma_f32_16x16x32_bf16 v[164:167], a[116:119], a[164:167], v[164:167]
    ds_read_b64_tr_b16 a[182:183], v216 offset:1280
    v_mfma_f32_16x16x32_bf16 v[196:199], a[116:119], a[168:171], v[196:199]
    buffer_load_dwordx4 v214, s[8:11], s30 offen offset:2048  lds
    ds_read_b64_tr_b16 a[184:185], v216 offset:264
    v_mfma_f32_16x16x32_bf16 v[8:11], a[120:123], a[144:147], v[8:11]
    ds_read_b64_tr_b16 a[186:187], v216 offset:1288
    v_mfma_f32_16x16x32_bf16 v[40:43], a[120:123], a[148:151], v[40:43]
    ds_read_b64_tr_b16 a[188:189], v216 offset:512
    v_mfma_f32_16x16x32_bf16 v[72:75], a[120:123], a[152:155], v[72:75]
    ds_read_b64_tr_b16 a[190:191], v216 offset:1536
    v_mfma_f32_16x16x32_bf16 v[104:107], a[120:123], a[156:159], v[104:107]
    ds_read_b64_tr_b16 a[192:193], v216 offset:520
    v_mfma_f32_16x16x32_bf16 v[136:139], a[120:123], a[160:163], v[136:139]
    ds_read_b64_tr_b16 a[194:195], v216 offset:1544
    v_mfma_f32_16x16x32_bf16 v[168:171], a[120:123], a[164:167], v[168:171]
    buffer_load_dwordx4 v215, s[8:11], s30 offen offset:3072  lds
    s_add_u32 s30, s30, 128
    v_mfma_f32_16x16x32_bf16 v[200:203], a[120:123], a[168:171], v[200:203]
    s_add_u32 m0, s35, s29
    ds_read_b64_tr_b16 a[196:197], v216 offset:768
    v_mfma_f32_16x16x32_bf16 v[12:15], a[124:127], a[144:147], v[12:15]
    ds_read_b64_tr_b16 a[198:199], v216 offset:1792
    v_mfma_f32_16x16x32_bf16 v[44:47], a[124:127], a[148:151], v[44:47]
    ds_read_b64_tr_b16 a[200:201], v216 offset:776
    v_mfma_f32_16x16x32_bf16 v[76:79], a[124:127], a[152:155], v[76:79]
    ds_read_b64_tr_b16 a[202:203], v216 offset:1800
    v_mfma_f32_16x16x32_bf16 v[108:111], a[124:127], a[156:159], v[108:111]
    s_add_u32 s39, s39, 32768
    v_mfma_f32_16x16x32_bf16 v[140:143], a[124:127], a[160:163], v[140:143]
    buffer_load_dwordx4 v208, s[12:15], s31 offen offset:0 nt lds
    v_mfma_f32_16x16x32_bf16 v[172:175], a[124:127], a[164:167], v[172:175]
    s_cmp_eq_u32 s39, 163840
    s_cselect_b32 s39, 0, s39
    v_mfma_f32_16x16x32_bf16 v[204:207], a[124:127], a[168:171], v[204:207]
    v_add_u32 v216, s39, v219
    v_add_u32 v217, s39, v220
    v_mfma_f32_16x16x32_bf16 v[16:19], a[128:131], a[144:147], v[16:19]
    s_add_u32 s40, s39, 32768
    v_mfma_f32_16x16x32_bf16 v[48:51], a[128:131], a[148:151], v[48:51]
    s_cmp_eq_u32 s40, 163840
    s_cselect_b32 s40, 0, s40
    v_mfma_f32_16x16x32_bf16 v[80:83], a[128:131], a[152:155], v[80:83]
    v_add_u32 v218, s40, v220
    v_mfma_f32_16x16x32_bf16 v[112:115], a[128:131], a[156:159], v[112:115]
    buffer_load_dwordx4 v209, s[12:15], s31 offen offset:1024 nt lds
    v_mfma_f32_16x16x32_bf16 v[144:147], a[128:131], a[160:163], v[144:147]
    v_mfma_f32_16x16x32_bf16 v[176:179], a[128:131], a[164:167], v[176:179]
    v_mfma_f32_16x16x32_bf16 v[20:23], a[132:135], a[144:147], v[20:23]
    v_mfma_f32_16x16x32_bf16 v[52:55], a[132:135], a[148:151], v[52:55]
    v_mfma_f32_16x16x32_bf16 v[84:87], a[132:135], a[152:155], v[84:87]
    v_mfma_f32_16x16x32_bf16 v[116:119], a[132:135], a[156:159], v[116:119]
    buffer_load_dwordx4 v210, s[12:15], s31 offen offset:2048 nt lds
    v_mfma_f32_16x16x32_bf16 v[148:151], a[132:135], a[160:163], v[148:151]
    v_mfma_f32_16x16x32_bf16 v[180:183], a[132:135], a[164:167], v[180:183]
    v_mfma_f32_16x16x32_bf16 v[24:27], a[136:139], a[144:147], v[24:27]
    v_mfma_f32_16x16x32_bf16 v[56:59], a[136:139], a[148:151], v[56:59]
    v_mfma_f32_16x16x32_bf16 v[88:91], a[136:139], a[152:155], v[88:91]
    v_mfma_f32_16x16x32_bf16 v[120:123], a[136:139], a[156:159], v[120:123]
    buffer_load_dwordx4 v211, s[12:15], s31 offen offset:3072 nt lds
    s_add_u32 s31, s31, 262144
    v_mfma_f32_16x16x32_bf16 v[152:155], a[136:139], a[160:163], v[152:155]
    s_mov_b32 s51, s29
    s_add_u32 s29, s29, 32768
    v_mfma_f32_16x16x32_bf16 v[184:187], a[136:139], a[164:167], v[184:187]
    s_cmp_eq_u32 s29, 163840
    s_cselect_b32 s29, 0, s29
    v_mfma_f32_16x16x32_bf16 v[28:31], a[140:143], a[144:147], v[28:31]
    v_mfma_f32_16x16x32_bf16 v[60:63], a[140:143], a[148:151], v[60:63]
    v_mfma_f32_16x16x32_bf16 v[92:95], a[140:143], a[152:155], v[92:95]
    v_mfma_f32_16x16x32_bf16 v[124:127], a[140:143], a[156:159], v[124:127]
    v_mfma_f32_16x16x32_bf16 v[156:159], a[140:143], a[160:163], v[156:159]
    v_mfma_f32_16x16x32_bf16 v[188:191], a[140:143], a[164:167], v[188:191]
    s_waitcnt vmcnt(12) lgkmcnt(0)
    s_barrier
    v_mfma_f32_16x16x32_bf16 v[0:3], a[172:175], a[204:207], v[0:3]
    s_add_u32 m0, s50, s51
    ds_read_b64_tr_b16 a[112:113], v216 offset:0
    v_mfma_f32_16x16x32_bf16 v[32:35], a[172:175], a[208:211], v[32:35]
    buffer_load_dwordx4 v212, s[8:11], s49 offen offset:0  lds
    ds_read_b64_tr_b16 a[114:115], v216 offset:1024
    v_mfma_f32_16x16x32_bf16 v[64:67], a[172:175], a[212:215], v[64:67]
    ds_read_b128 a[144:147], v217 offset:0
    v_mfma_f32_16x16x32_bf16 v[96:99], a[172:175], a[216:219], v[96:99]
    ds_read_b128 a[148:151], v217 offset:2048
    v_mfma_f32_16x16x32_bf16 v[128:131], a[172:175], a[220:223], v[128:131]
    ds_read_b128 a[152:155], v217 offset:4096
    v_mfma_f32_16x16x32_bf16 v[160:163], a[172:175], a[224:227], v[160:163]
    ds_read_b128 a[156:159], v217 offset:6144
    v_mfma_f32_16x16x32_bf16 v[192:195], a[172:175], a[228:231], v[192:195]
    ds_read_b128 a[160:163], v217 offset:8192
    v_mfma_f32_16x16x32_bf16 v[4:7], a[176:179], a[204:207], v[4:7]
    buffer_load_dwordx4 v213, s[8:11], s49 offen offset:1024  lds
    ds_read_b128 a[164:167], v217 offset:10240
    v_mfma_f32_16x16x32_bf16 v[36:39], a[176:179], a[208:211], v[36:39]
    ds_read_b128 a[168:171], v218 offset:10240
    v_mfma_f32_16x16x32_bf16 v[68:71], a[176:179], a[212:215], v[68:71]
    ds_read_b64_tr_b16 a[116:117], v216 offset:8
    v_mfma_f32_16x16x32_bf16 v[100:103], a[176:179], a[216:219], v[100:103]
    ds_read_b64_tr_b16 a[118:119], v216 offset:1032
    v_mfma_f32_16x16x32_bf16 v[132:135], a[176:179], a[220:223], v[132:135]
    ds_read_b64_tr_b16 a[120:121], v216 offset:256
    v_mfma_f32_16x16x32_bf16 v[164:167], a[176:179], a[224:227], v[164:167]
    ds_read_b64_tr_b16 a[122:123], v216 offset:1280
    v_mfma_f32_16x16x32_bf16 v[196:199], a[176:179], a[228:231], v[196:199]
    ds_read_b64_tr_b16 a[124:125], v216 offset:264
    v_mfma_f32_16x16x32_bf16 v[8:11], a[180:183], a[204:207], v[8:11]
    buffer_load_dwordx4 v214, s[8:11], s49 offen offset:2048  lds
    s_add_u32 s49, s49, 128
    v_mfma_f32_16x16x32_bf16 v[40:43], a[180:183], a[208:211], v[40:43]
    s_add_u32 m0, s35, s29
    ds_read_b64_tr_b16 a[126:127], v216 offset:1288
    v_mfma_f32_16x16x32_bf16 v[72:75], a[180:183], a[212:215], v[72:75]
    ds_read_b64_tr_b16 a[128:129], v216 offset:512
    v_mfma_f32_16x16x32_bf16 v[104:107], a[180:183], a[216:219], v[104:107]
    ds_read_b64_tr_b16 a[130:131], v216 offset:1536
    v_mfma_f32_16x16x32_bf16 v[136:139], a[180:183], a[220:223], v[136:139]
    ds_read_b64_tr_b16 a[132:133], v216 offset:520
    v_mfma_f32_16x16x32_bf16 v[168:171], a[180:183], a[224:227], v[168:171]
    ds_read_b64_tr_b16 a[134:135], v216 offset:1544
    v_mfma_f32_16x16x32_bf16 v[200:203], a[180:183], a[228:231], v[200:203]
    ds_read_b64_tr_b16 a[136:137], v216 offset:768
    v_mfma_f32_16x16x32_bf16 v[12:15], a[184:187], a[204:207], v[12:15]
    buffer_load_dwordx4 v208, s[12:15], s31 offen offset:0 nt lds
    ds_read_b64_tr_b16 a[138:139], v216 offset:1792
    v_mfma_f32_16x16x32_bf16 v[44:47], a[184:187], a[208:211], v[44:47]
    ds_read_b64_tr_b16 a[140:141], v216 offset:776
    v_mfma_f32_16x16x32_bf16 v[76:79], a[184:187], a[212:215], v[76:79]
    ds_read_b64_tr_b16 a[142:143], v216 offset:1800
    v_mfma_f32_16x16x32_bf16 v[108:111], a[184:187], a[216:219], v[108:111]
    s_add_u32 s39, s39, 32768
    v_mfma_f32_16x16x32_bf16 v[140:143], a[184:187], a[220:223], v[140:143]
    s_cmp_eq_u32 s39, 163840
    s_cselect_b32 s39, 0, s39
    v_mfma_f32_16x16x32_bf16 v[172:175], a[184:187], a[224:227], v[172:175]
    v_add_u32 v216, s39, v219
    v_mfma_f32_16x16x32_bf16 v[204:207], a[184:187], a[228:231], v[204:207]
    v_mfma_f32_16x16x32_bf16 v[16:19], a[188:191], a[204:207], v[16:19]
    buffer_load_dwordx4 v209, s[12:15], s31 offen offset:1024 nt lds
    v_mfma_f32_16x16x32_bf16 v[48:51], a[188:191], a[208:211], v[48:51]
    v_mfma_f32_16x16x32_bf16 v[80:83], a[188:191], a[212:215], v[80:83]
    v_mfma_f32_16x16x32_bf16 v[112:115], a[188:191], a[216:219], v[112:115]
    v_mfma_f32_16x16x32_bf16 v[144:147], a[188:191], a[220:223], v[144:147]
    v_mfma_f32_16x16x32_bf16 v[176:179], a[188:191], a[224:227], v[176:179]
    v_mfma_f32_16x16x32_bf16 v[20:23], a[192:195], a[204:207], v[20:23]
    v_mfma_f32_16x16x32_bf16 v[52:55], a[192:195], a[208:211], v[52:55]
    buffer_load_dwordx4 v210, s[12:15], s31 offen offset:2048 nt lds
    v_mfma_f32_16x16x32_bf16 v[84:87], a[192:195], a[212:215], v[84:87]
    v_mfma_f32_16x16x32_bf16 v[116:119], a[192:195], a[216:219], v[116:119]
    v_mfma_f32_16x16x32_bf16 v[148:151], a[192:195], a[220:223], v[148:151]
    v_mfma_f32_16x16x32_bf16 v[180:183], a[192:195], a[224:227], v[180:183]
    v_mfma_f32_16x16x32_bf16 v[24:27], a[196:199], a[204:207], v[24:27]
    v_mfma_f32_16x16x32_bf16 v[56:59], a[196:199], a[208:211], v[56:59]
    v_mfma_f32_16x16x32_bf16 v[88:91], a[196:199], a[212:215], v[88:91]
    buffer_load_dwordx4 v211, s[12:15], s31 offen offset:3072 nt lds
    s_add_u32 s31, s31, 262144
    v_mfma_f32_16x16x32_bf16 v[120:123], a[196:199], a[216:219], v[120:123]
    s_mov_b32 s51, s29
    s_add_u32 s29, s29, 32768
    v_mfma_f32_16x16x32_bf16 v[152:155], a[196:199], a[220:223], v[152:155]
    s_cmp_eq_u32 s29, 163840
    s_cselect_b32 s29, 0, s29
    v_mfma_f32_16x16x32_bf16 v[184:187], a[196:199], a[224:227], v[184:187]
    v_mfma_f32_16x16x32_bf16 v[28:31], a[200:203], a[204:207], v[28:31]
    v_mfma_f32_16x16x32_bf16 v[60:63], a[200:203], a[208:211], v[60:63]
    v_mfma_f32_16x16x32_bf16 v[92:95], a[200:203], a[212:215], v[92:95]
    v_mfma_f32_16x16x32_bf16 v[124:127], a[200:203], a[216:219], v[124:127]
    v_mfma_f32_16x16x32_bf16 v[156:159], a[200:203], a[220:223], v[156:159]
    v_mfma_f32_16x16x32_bf16 v[188:191], a[200:203], a[224:227], v[188:191]
    s_mov_b32 s28, 11
.p2align 6
L1_q0:
    s_waitcnt vmcnt(19) lgkmcnt(0)
    s_barrier
    v_mfma_f32_16x16x32_bf16 v[0:3], a[112:115], a[144:147], v[0:3]
    s_add_u32 m0, s36, s51
    ds_read_b64_tr_b16 a[172:173], v216 offset:0
    v_mfma_f32_16x16x32_bf16 v[32:35], a[112:115], a[148:151], v[32:35]
    buffer_load_dwordx4 v212, s[8:11], s30 offen offset:0  lds
    ds_read_b64_tr_b16 a[174:175], v216 offset:1024
    v_mfma_f32_16x16x32_bf16 v[64:67], a[112:115], a[152:155], v[64:67]
    ds_read_b128 a[204:207], v217 offset:512
    v_mfma_f32_16x16x32_bf16 v[96:99], a[112:115], a[156:159], v[96:99]
    ds_read_b128 a[208:211], v217 offset:2560
    v_mfma_f32_16x16x32_bf16 v[128:131], a[112:115], a[160:163], v[128:131]
    ds_read_b128 a[212:215], v217 offset:4608
    v_mfma_f32_16x16x32_bf16 v[160:163], a[112:115], a[164:167], v[160:163]
    ds_read_b128 a[216:219], v217 offset:6656
    v_mfma_f32_16x16x32_bf16 v[192:195], a[112:115], a[168:171], v[192:195]
    ds_read_b128 a[220:223], v217 offset:8704
    v_mfma_f32_16x16x32_bf16 v[4:7], a[116:119], a[144:147], v[4:7]
    buffer_load_dwordx4 v213, s[8:11], s30 offen offset:1024  lds
    ds_read_b128 a[224:227], v217 offset:10752
    v_mfma_f32_16x16x32_bf16 v[36:39], a[116:119], a[148:151], v[36:39]
    ds_read_b128 a[228:231], v218 offset:10752
    v_mfma_f32_16x16x32_bf16 v[68:71], a[116:119], a[152:155], v[68:71]
    ds_read_b64_tr_b16 a[176:177], v216 offset:8
    v_mfma_f32_16x16x32_bf16 v[100:103], a[116:119], a[156:159], v[100:103]
    ds_read_b64_tr_b16 a[178:179], v216 offset:1032
    v_mfma_f32_16x16x32_bf16 v[132:135], a[116:119], a[160:163], v[132:135]
    ds_read_b64_tr_b16 a[180:181], v216 offset:256
    v_mfma_f32_16x16x32_bf16 v[164:167], a[116:119], a[164:167], v[164:167]
    ds_read_b64_tr_b16 a[182:183], v216 offset:1280
    v_mfma_f32_16x16x32_bf16 v[196:199], a[116:119], a[168:171], v[196:199]
    buffer_load_dwordx4 v214, s[8:11], s30 offen offset:2048  lds
    ds_read_b64_tr_b16 a[184:185], v216 offset:264
    v_mfma_f32_16x16x32_bf16 v[8:11], a[120:123], a[144:147], v[8:11]
    ds_read_b64_tr_b16 a[186:187], v216 offset:1288
    v_mfma_f32_16x16x32_bf16 v[40:43], a[120:123], a[148:151], v[40:43]
    ds_read_b64_tr_b16 a[188:189], v216 offset:512
    v_mfma_f32_16x16x32_bf16 v[72:75], a[120:123], a[152:155], v[72:75]
    ds_read_b64_tr_b16 a[190:191], v216 offset:1536
    v_mfma_f32_16x16x32_bf16 v[104:107], a[120:123], a[156:159], v[104:107]
    ds_read_b64_tr_b16 a[192:193], v216 offset:520
    v_mfma_f32_16x16x32_bf16 v[136:139], a[120:123], a[160:163], v[136:139]
    ds_read_b64_tr_b16 a[194:195], v216 offset:1544
    v_mfma_f32_16x16x32_bf16 v[168:171], a[120:123], a[164:167], v[168:171]
    buffer_load_dwordx4 v215, s[8:11], s30 offen offset:3072  lds
    s_add_u32 s30, s30, 128
    v_mfma_f32_16x16x32_bf16 v[200:203], a[120:123], a[168:171], v[200:203]
    s_add_u32 m0, s35, s29
    ds_read_b64_tr_b16 a[196:197], v216 offset:768
    v_mfma_f32_16x16x32_bf16 v[12:15], a[124:127], a[144:147], v[12:15]
    ds_read_b64_tr_b16 a[198:199], v216 offset:1792
    v_mfma_f32_16x16x32_bf16 v[44:47], a[124:127], a[148:151], v[44:47]
    ds_read_b64_tr_b16 a[200:201], v216 offset:776
    v_mfma_f32_16x16x32_bf16 v[76:79], a[124:127], a[152:155], v[76:79]
    ds_read_b64_tr_b16 a[202:203], v216 offset:1800
    v_mfma_f32_16x16x32_bf16 v[108:111], a[124:127], a[156:159], v[108:111]
    s_add_u32 s39, s39, 32768
    v_mfma_f32_16x16x32_bf16 v[140:143], a[124:127], a[160:163], v[140:143]
    buffer_load_dwordx4 v208, s[12:15], s31 offen offset:0 nt lds
    v_mfma_f32_16x16x32_bf16 v[172:175], a[124:127], a[164:167], v[172:175]
    s_cmp_eq_u32 s39, 163840
    s_cselect_b32 s39, 0, s39
    v_mfma_f32_16x16x32_bf16 v[204:207], a[124:127], a[168:171], v[204:207]
    v_add_u32 v216, s39, v219
    v_add_u32 v217, s39, v220
    v_mfma_f32_16x16x32_bf16 v[16:19], a[128:131], a[144:147], v[16:19]
    s_add_u32 s40, s39, 32768
    v_mfma_f32_16x16x32_bf16 v[48:51], a[128:131], a[148:151], v[48:51]
    s_cmp_eq_u32 s40, 163840
    s_cselect_b32 s40, 0, s40
    v_mfma_f32_16x16x32_bf16 v[80:83], a[128:131], a[152:155], v[80:83]
    v_add_u32 v218, s40, v220
    v_mfma_f32_16x16x32_bf16 v[112:115], a[128:131], a[156:159], v[112:115]
    buffer_load_dwordx4 v209, s[12:15], s31 offen offset:1024 nt lds
    v_mfma_f32_16x16x32_bf16 v[144:147], a[128:131], a[160:163], v[144:147]
    v_mfma_f32_16x16x32_bf16 v[176:179], a[128:131], a[164:167], v[176:179]
    v_mfma_f32_16x16x32_bf16 v[20:23], a[132:135], a[144:147], v[20:23]
    v_mfma_f32_16x16x32_bf16 v[52:55], a[132:135], a[148:151], v[52:55]
    v_mfma_f32_16x16x32_bf16 v[84:87], a[132:135], a[152:155], v[84:87]
    v_mfma_f32_16x16x32_bf16 v[116:119], a[132:135], a[156:159], v[116:119]
    buffer_load_dwordx4 v210, s[12:15], s31 offen offset:2048 nt lds
    v_mfma_f32_16x16x32_bf16 v[148:151], a[132:135], a[160:163], v[148:151]
    v_mfma_f32_16x16x32_bf16 v[180:183], a[132:135], a[164:167], v[180:183]
    v_mfma_f32_16x16x32_bf16 v[24:27], a[136:139], a[144:147], v[24:27]
    v_mfma_f32_16x16x32_bf16 v[56:59], a[136:139], a[148:151], v[56:59]
    v_mfma_f32_16x16x32_bf16 v[88:91], a[136:139], a[152:155], v[88:91]
    v_mfma_f32_16x16x32_bf16 v[120:123], a[136:139], a[156:159], v[120:123]
    buffer_load_dwordx4 v211, s[12:15], s31 offen offset:3072 nt lds
    s_add_u32 s31, s31, 262144
    v_mfma_f32_16x16x32_bf16 v[152:155], a[136:139], a[160:163], v[152:155]
    s_mov_b32 s51, s29
    s_add_u32 s29, s29, 32768
    v_mfma_f32_16x16x32_bf16 v[184:187], a[136:139], a[164:167], v[184:187]
    s_cmp_eq_u32 s29, 163840
    s_cselect_b32 s29, 0, s29
    v_mfma_f32_16x16x32_bf16 v[28:31], a[140:143], a[144:147], v[28:31]
    v_mfma_f32_16x16x32_bf16 v[60:63], a[140:143], a[148:151], v[60:63]
    v_mfma_f32_16x16x32_bf16 v[92:95], a[140:143], a[152:155], v[92:95]
    v_mfma_f32_16x16x32_bf16 v[124:127], a[140:143], a[156:159], v[124:127]
    v_mfma_f32_16x16x32_bf16 v[156:159], a[140:143], a[160:163], v[156:159]
    v_mfma_f32_16x16x32_bf16 v[188:191], a[140:143], a[164:167], v[188:191]
    s_waitcnt vmcnt(12) lgkmcnt(0)
    s_barrier
    v_mfma_f32_16x16x32_bf16 v[0:3], a[172:175], a[204:207], v[0:3]
    s_add_u32 m0, s50, s51
    ds_read_b64_tr_b16 a[112:113], v216 offset:0
    v_mfma_f32_16x16x32_bf16 v[32:35], a[172:175], a[208:211], v[32:35]
    buffer_load_dwordx4 v212, s[8:11], s49 offen offset:0  lds
    ds_read_b64_tr_b16 a[114:115], v216 offset:1024
    v_mfma_f32_16x16x32_bf16 v[64:67], a[172:175], a[212:215], v[64:67]
    ds_read_b128 a[144:147], v217 offset:0
    v_mfma_f32_16x16x32_bf16 v[96:99], a[172:175], a[216:219], v[96:99]
    ds_read_b128 a[148:151], v217 offset:2048
    v_mfma_f32_16x16x32_bf16 v[128:131], a[172:175], a[220:223], v[128:131]
    ds_read_b128 a[152:155], v217 offset:4096
    v_mfma_f32_16x16x32_bf16 v[160:163], a[172:175], a[224:227], v[160:163]
    ds_read_b128 a[156:159], v217 offset:6144
    v_mfma_f32_16x16x32_bf16 v[192:195], a[172:175], a[228:231], v[192:195]
    ds_read_b128 a[160:163], v217 offset:8192
    v_mfma_f32_16x16x32_bf16 v[4:7], a[176:179], a[204:207], v[4:7]
    buffer_load_dwordx4 v213, s[8:11], s49 offen offset:1024  lds
    ds_read_b128 a[164:167], v217 offset:10240
    v_mfma_f32_16x16x32_bf16 v[36:39], a[176:179], a[208:211], v[36:39]
    ds_read_b128 a[168:171], v218 offset:10240
    v_mfma_f32_16x16x32_bf16 v[68:71], a[176:179], a[212:215], v[68:71]
    ds_read_b64_tr_b16 a[116:117], v216 offset:8
    v_mfma_f32_16x16x32_bf16 v[100:103], a[176:179], a[216:219], v[100:103]
    ds_read_b64_tr_b16 a[118:119], v216 offset:1032
    v_mfma_f32_16x16x32_bf16 v[132:135], a[176:179], a[220:223], v[132:135]
    ds_read_b64_tr_b16 a[120:121], v216 offset:256
    v_mfma_f32_16x16x32_bf16 v[164:167], a[176:179], a[224:227], v[164:167]
    ds_read_b64_tr_b16 a[122:123], v216 offset:1280
    v_mfma_f32_16x16x32_bf16 v[196:199], a[176:179], a[228:231], v[196:199]
    ds_read_b64_tr_b16 a[124:125], v216 offset:264
    v_mfma_f32_16x16x32_bf16 v[8:11], a[180:183], a[204:207], v[8:11]
    buffer_load_dwordx4 v214, s[8:11], s49 offen offset:2048  lds
    s_add_u32 s49, s49, 128
    v_mfma_f32_16x16x32_bf16 v[40:43], a[180:183], a[208:211], v[40:43]
    s_add_u32 m0, s35, s29
    ds_read_b64_tr_b16 a[126:127], v216 offset:1288
    v_mfma_f32_16x16x32_bf16 v[72:75], a[180:183], a[212:215], v[72:75]
    ds_read_b64_tr_b16 a[128:129], v216 offset:512
    v_mfma_f32_16x16x32_bf16 v[104:107], a[180:183], a[216:219], v[104:107]
    ds_read_b64_tr_b16 a[130:131], v216 offset:1536
    v_mfma_f32_16x16x32_bf16 v[136:139], a[180:183], a[220:223], v[136:139]
    ds_read_b64_tr_b16 a[132:133], v216 offset:520
    v_mfma_f32_16x16x32_bf16 v[168:171], a[180:183], a[224:227], v[168:171]
    ds_read_b64_tr_b16 a[134:135], v216 offset:1544
    v_mfma_f32_16x16x32_bf16 v[200:203], a[180:183], a[228:231], v[200:203]
    ds_read_b64_tr_b16 a[136:137], v216 offset:768
    v_mfma_f32_16x16x32_bf16 v[12:15], a[184:187], a[204:207], v[12:15]
    buffer_load_dwordx4 v208, s[12:15], s31 offen offset:0 nt lds
    ds_read_b64_tr_b16 a[138:139], v216 offset:1792
    v_mfma_f32_16x16x32_bf16 v[44:47], a[184:187], a[208:211], v[44:47]
    ds_read_b64_tr_b16 a[140:141], v216 offset:776
    v_mfma_f32_16x16x32_bf16 v[76:79], a[184:187], a[212:215], v[76:79]
    ds_read_b64_tr_b16 a[142:143], v216 offset:1800
    v_mfma_f32_16x16x32_bf16 v[108:111], a[184:187], a[216:219], v[108:111]
    s_add_u32 s39, s39, 32768
    v_mfma_f32_16x16x32_bf16 v[140:143], a[184:187], a[220:223], v[140:143]
    s_cmp_eq_u32 s39, 163840
    s_cselect_b32 s39, 0, s39
    v_mfma_f32_16x16x32_bf16 v[172:175], a[184:187], a[224:227], v[172:175]
    v_add_u32 v216, s39, v219
    v_mfma_f32_16x16x32_bf16 v[204:207], a[184:187], a[228:231], v[204:207]
    v_mfma_f32_16x16x32_bf16 v[16:19], a[188:191], a[204:207], v[16:19]
    buffer_load_dwordx4 v209, s[12:15], s31 offen offset:1024 nt lds
    v_mfma_f32_16x16x32_bf16 v[48:51], a[188:191], a[208:211], v[48:51]
    v_mfma_f32_16x16x32_bf16 v[80:83], a[188:191], a[212:215], v[80:83]
    v_mfma_f32_16x16x32_bf16 v[112:115], a[188:191], a[216:219], v[112:115]
    v_mfma_f32_16x16x32_bf16 v[144:147], a[188:191], a[220:223], v[144:147]
    v_mfma_f32_16x16x32_bf16 v[176:179], a[188:191], a[224:227], v[176:179]
    v_mfma_f32_16x16x32_bf16 v[20:23], a[192:195], a[204:207], v[20:23]
    v_mfma_f32_16x16x32_bf16 v[52:55], a[192:195], a[208:211], v[52:55]
    buffer_load_dwordx4 v210, s[12:15], s31 offen offset:2048 nt lds
    v_mfma_f32_16x16x32_bf16 v[84:87], a[192:195], a[212:215], v[84:87]
    v_mfma_f32_16x16x32_bf16 v[116:119], a[192:195], a[216:219], v[116:119]
    v_mfma_f32_16x16x32_bf16 v[148:151], a[192:195], a[220:223], v[148:151]
    v_mfma_f32_16x16x32_bf16 v[180:183], a[192:195], a[224:227], v[180:183]
    v_mfma_f32_16x16x32_bf16 v[24:27], a[196:199], a[204:207], v[24:27]
    v_mfma_f32_16x16x32_bf16 v[56:59], a[196:199], a[208:211], v[56:59]
    v_mfma_f32_16x16x32_bf16 v[88:91], a[196:199], a[212:215], v[88:91]
    buffer_load_dwordx4 v211, s[12:15], s31 offen offset:3072 nt lds
    s_add_u32 s31, s31, 262144
    v_mfma_f32_16x16x32_bf16 v[120:123], a[196:199], a[216:219], v[120:123]
    s_mov_b32 s51, s29
    s_add_u32 s29, s29, 32768
    v_mfma_f32_16x16x32_bf16 v[152:155], a[196:199], a[220:223], v[152:155]
    s_cmp_eq_u32 s29, 163840
    s_cselect_b32 s29, 0, s29
    v_mfma_f32_16x16x32_bf16 v[184:187], a[196:199], a[224:227], v[184:187]
    v_mfma_f32_16x16x32_bf16 v[28:31], a[200:203], a[204:207], v[28:31]
    v_mfma_f32_16x16x32_bf16 v[60:63], a[200:203], a[208:211], v[60:63]
    v_mfma_f32_16x16x32_bf16 v[92:95], a[200:203], a[212:215], v[92:95]
    v_mfma_f32_16x16x32_bf16 v[124:127], a[200:203], a[216:219], v[124:127]
    v_mfma_f32_16x16x32_bf16 v[156:159], a[200:203], a[220:223], v[156:159]
    v_mfma_f32_16x16x32_bf16 v[188:191], a[200:203], a[224:227], v[188:191]
    s_sub_u32 s28, s28, 1
    s_cmp_lg_u32 s28, 0
    s_cbranch_scc1 L1_q0
    s_waitcnt vmcnt(19) lgkmcnt(0)
    s_barrier
    v_mfma_f32_16x16x32_bf16 v[0:3], a[112:115], a[144:147], v[0:3]
    s_add_u32 m0, s36, s51
    ds_read_b64_tr_b16 a[172:173], v216 offset:0
    v_mfma_f32_16x16x32_bf16 v[32:35], a[112:115], a[148:151], v[32:35]
    buffer_load_dwordx4 v212, s[8:11], s30 offen offset:0  lds
    ds_read_b64_tr_b16 a[174:175], v216 offset:1024
    v_mfma_f32_16x16x32_bf16 v[64:67], a[112:115], a[152:155], v[64:67]
    ds_read_b128 a[204:207], v217 offset:512
    v_mfma_f32_16x16x32_bf16 v[96:99], a[112:115], a[156:159], v[96:99]
    ds_read_b128 a[208:211], v217 offset:2560
    v_mfma_f32_16x16x32_bf16 v[128:131], a[112:115], a[160:163], v[128:131]
    ds_read_b128 a[212:215], v217 offset:4608
    v_mfma_f32_16x16x32_bf16 v[160:163], a[112:115], a[164:167], v[160:163]
    ds_read_b128 a[216:219], v217 offset:6656
    v_mfma_f32_16x16x32_bf16 v[192:195], a[112:115], a[168:171], v[192:195]
    buffer_load_dwordx4 v213, s[8:11], s30 offen offset:1024  lds
    ds_read_b128 a[220:223], v217 offset:8704
    v_mfma_f32_16x16x32_bf16 v[4:7], a[116:119], a[144:147], v[4:7]
    ds_read_b128 a[224:227], v217 offset:10752
    v_mfma_f32_16x16x32_bf16 v[36:39], a[116:119], a[148:151], v[36:39]
    ds_read_b128 a[228:231], v218 offset:10752
    v_mfma_f32_16x16x32_bf16 v[68:71], a[116:119], a[152:155], v[68:71]
    ds_read_b64_tr_b16 a[176:177], v216 offset:8
    v_mfma_f32_16x16x32_bf16 v[100:103], a[116:119], a[156:159], v[100:103]
    ds_read_b64_tr_b16 a[178:179], v216 offset:1032
    v_mfma_f32_16x16x32_bf16 v[132:135], a[116:119], a[160:163], v[132:135]
    buffer_load_dwordx4 v214, s[8:11], s30 offen offset:2048  lds
    ds_read_b64_tr_b16 a[180:181], v216 offset:256
    v_mfma_f32_16x16x32_bf16 v[164:167], a[116:119], a[164:167], v[164:167]
    ds_read_b64_tr_b16 a[182:183], v216 offset:1280
    v_mfma_f32_16x16x32_bf16 v[196:199], a[116:119], a[168:171], v[196:199]
    ds_read_b64_tr_b16 a[184:185], v216 offset:264
    v_mfma_f32_16x16x32_bf16 v[8:11], a[120:123], a[144:147], v[8:11]
    ds_read_b64_tr_b16 a[186:187], v216 offset:1288
    v_mfma_f32_16x16x32_bf16 v[40:43], a[120:123], a[148:151], v[40:43]
    ds_read_b64_tr_b16 a[188:189], v216 offset:512
    v_mfma_f32_16x16x32_bf16 v[72:75], a[120:123], a[152:155], v[72:75]
    ds_read_b64_tr_b16 a[190:191], v216 offset:1536
    v_mfma_f32_16x16x32_bf16 v[104:107], a[120:123], a[156:159], v[104:107]
    buffer_load_dwordx4 v215, s[8:11], s30 offen offset:3072  lds
    s_add_u32 s30, s30, 128
    v_mfma_f32_16x16x32_bf16 v[136:139], a[120:123], a[160:163], v[136:139]
    s_add_u32 m0, s35, s29
    ds_read_b64_tr_b16 a[192:193], v216 offset:520
    v_mfma_f32_16x16x32_bf16 v[168:171], a[120:123], a[164:167], v[168:171]
    ds_read_b64_tr_b16 a[194:195], v216 offset:1544
    v_mfma_f32_16x16x32_bf16 v[200:203], a[120:123], a[168:171], v[200:203]
    ds_read_b64_tr_b16 a[196:197], v216 offset:768
    v_mfma_f32_16x16x32_bf16 v[12:15], a[124:127], a[144:147], v[12:15]
    ds_read_b64_tr_b16 a[198:199], v216 offset:1792
    v_mfma_f32_16x16x32_bf16 v[44:47], a[124:127], a[148:151], v[44:47]
    buffer_load_dwordx4 v208, s[12:15], s31 offen offset:0 nt lds
    ds_read_b64_tr_b16 a[200:201], v216 offset:776
    v_mfma_f32_16x16x32_bf16 v[76:79], a[124:127], a[152:155], v[76:79]
    ds_read_b64_tr_b16 a[202:203], v216 offset:1800
    v_mfma_f32_16x16x32_bf16 v[108:111], a[124:127], a[156:159], v[108:111]
    s_add_u32 s39, s39, 32768
    v_mfma_f32_16x16x32_bf16 v[140:143], a[124:127], a[160:163], v[140:143]
    s_cmp_eq_u32 s39, 163840
    s_cselect_b32 s39, 0, s39
    v_mfma_f32_16x16x32_bf16 v[172:175], a[124:127], a[164:167], v[172:175]
    v_add_u32 v216, s39, v219
    v_add_u32 v217, s39, v220
    v_mfma_f32_16x16x32_bf16 v[204:207], a[124:127], a[168:171], v[204:207]
    buffer_load_dwordx4 v209, s[12:15], s31 offen offset:1024 nt lds
    s_add_u32 s40, s39, 32768
    v_mfma_f32_16x16x32_bf16 v[16:19], a[128:131], a[144:147], v[16:19]
    s_cmp_eq_u32 s40, 163840
    s_cselect_b32 s40, 0, s40
    v_mfma_f32_16x16x32_bf16 v[48:51], a[128:131], a[148:151], v[48:51]
    v_add_u32 v218, s40, v220
    v_mfma_f32_16x16x32_bf16 v[80:83], a[128:131], a[152:155], v[80:83]
    v_mfma_f32_16x16x32_bf16 v[112:115], a[128:131], a[156:159], v[112:115]
    v_mfma_f32_16x16x32_bf16 v[144:147], a[128:131], a[160:163], v[144:147]
    v_mfma_f32_16x16x32_bf16 v[176:179], a[128:131], a[164:167], v[176:179]
    buffer_load_dwordx4 v210, s[12:15], s31 offen offset:2048 nt lds
    v_mfma_f32_16x16x32_bf16 v[20:23], a[132:135], a[144:147], v[20:23]
    v_mfma_f32_16x16x32_bf16 v[52:55], a[132:135], a[148:151], v[52:55]
    v_mfma_f32_16x16x32_bf16 v[84:87], a[132:135], a[152:155], v[84:87]
    v_mfma_f32_16x16x32_bf16 v[116:119], a[132:135], a[156:159], v[116:119]
    v_mfma_f32_16x16x32_bf16 v[148:151], a[132:135], a[160:163], v[148:151]
    buffer_load_dwordx4 v211, s[12:15], s31 offen offset:3072 nt lds
    s_add_u32 s31, s31, 262144
    v_mfma_f32_16x16x32_bf16 v[180:183], a[132:135], a[164:167], v[180:183]
    v_mfma_f32_16x16x32_bf16 v[24:27], a[136:139], a[144:147], v[24:27]
    v_mfma_f32_16x16x32_bf16 v[56:59], a[136:139], a[148:151], v[56:59]
    v_mfma_f32_16x16x32_bf16 v[88:91], a[136:139], a[152:155], v[88:91]
    v_mfma_f32_16x16x32_bf16 v[120:123], a[136:139], a[156:159], v[120:123]
    global_load_dword v255, v[226:227], off
    s_mov_b32 s51, s29
    v_mfma_f32_16x16x32_bf16 v[152:155], a[136:139], a[160:163], v[152:155]
    s_add_u32 s29, s29, 32768
    v_mfma_f32_16x16x32_bf16 v[184:187], a[136:139], a[164:167], v[184:187]
    s_cmp_eq_u32 s29, 163840
    s_cselect_b32 s29, 0, s29
    v_mfma_f32_16x16x32_bf16 v[28:31], a[140:143], a[144:147], v[28:31]
    v_mfma_f32_16x16x32_bf16 v[60:63], a[140:143], a[148:151], v[60:63]
    v_mfma_f32_16x16x32_bf16 v[92:95], a[140:143], a[152:155], v[92:95]
    v_mfma_f32_16x16x32_bf16 v[124:127], a[140:143], a[156:159], v[124:127]
    v_mfma_f32_16x16x32_bf16 v[156:159], a[140:143], a[160:163], v[156:159]
    v_mfma_f32_16x16x32_bf16 v[188:191], a[140:143], a[164:167], v[188:191]
    s_waitcnt vmcnt(13) lgkmcnt(0)
    s_barrier
    v_mfma_f32_16x16x32_bf16 v[0:3], a[172:175], a[204:207], v[0:3]
    s_add_u32 m0, s50, s51
    ds_read_b64_tr_b16 a[112:113], v216 offset:0
    v_mfma_f32_16x16x32_bf16 v[32:35], a[172:175], a[208:211], v[32:35]
    buffer_load_dwordx4 v212, s[8:11], s49 offen offset:0  lds
    ds_read_b64_tr_b16 a[114:115], v216 offset:1024
    v_mfma_f32_16x16x32_bf16 v[64:67], a[172:175], a[212:215], v[64:67]
    ds_read_b128 a[144:147], v217 offset:0
    v_mfma_f32_16x16x32_bf16 v[96:99], a[172:175], a[216:219], v[96:99]
    ds_read_b128 a[148:151], v217 offset:2048
    v_mfma_f32_16x16x32_bf16 v[128:131], a[172:175], a[220:223], v[128:131]
    ds_read_b128 a[152:155], v217 offset:4096
    v_mfma_f32_16x16x32_bf16 v[160:163], a[172:175], a[224:227], v[160:163]
    ds_read_b128 a[156:159], v217 offset:6144
    v_mfma_f32_16x16x32_bf16 v[192:195], a[172:175], a[228:231], v[192:195]
    ds_read_b128 a[160:163], v217 offset:8192
    v_mfma_f32_16x16x32_bf16 v[4:7], a[176:179], a[204:207], v[4:7]
    ds_read_b128 a[164:167], v217 offset:10240
    v_mfma_f32_16x16x32_bf16 v[36:39], a[176:179], a[208:211], v[36:39]
    ds_read_b128 a[168:171], v218 offset:10240
    v_mfma_f32_16x16x32_bf16 v[68:71], a[176:179], a[212:215], v[68:71]
    ds_read_b64_tr_b16 a[116:117], v216 offset:8
    v_mfma_f32_16x16x32_bf16 v[100:103], a[176:179], a[216:219], v[100:103]
    ds_read_b64_tr_b16 a[118:119], v216 offset:1032
    v_mfma_f32_16x16x32_bf16 v[132:135], a[176:179], a[220:223], v[132:135]
    ds_read_b64_tr_b16 a[120:121], v216 offset:256
    v_mfma_f32_16x16x32_bf16 v[164:167], a[176:179], a[224:227], v[164:167]
    ds_read_b64_tr_b16 a[122:123], v216 offset:1280
    v_mfma_f32_16x16x32_bf16 v[196:199], a[176:179], a[228:231], v[196:199]
    ds_read_b64_tr_b16 a[124:125], v216 offset:264
    v_mfma_f32_16x16x32_bf16 v[8:11], a[180:183], a[204:207], v[8:11]
    ds_read_b64_tr_b16 a[126:127], v216 offset:1288
    v_mfma_f32_16x16x32_bf16 v[40:43], a[180:183], a[208:211], v[40:43]
    ds_read_b64_tr_b16 a[128:129], v216 offset:512
    v_mfma_f32_16x16x32_bf16 v[72:75], a[180:183], a[212:215], v[72:75]
    ds_read_b64_tr_b16 a[130:131], v216 offset:1536
    v_mfma_f32_16x16x32_bf16 v[104:107], a[180:183], a[216:219], v[104:107]
    buffer_load_dwordx4 v213, s[8:11], s49 offen offset:1024  lds
    ds_read_b64_tr_b16 a[132:133], v216 offset:520
    v_mfma_f32_16x16x32_bf16 v[136:139], a[180:183], a[220:223], v[136:139]
    ds_read_b64_tr_b16 a[134:135], v216 offset:1544
    v_mfma_f32_16x16x32_bf16 v[168:171], a[180:183], a[224:227], v[168:171]
    ds_read_b64_tr_b16 a[136:137], v216 offset:768
    v_mfma_f32_16x16x32_bf16 v[200:203], a[180:183], a[228:231], v[200:203]
    ds_read_b64_tr_b16 a[138:139], v216 offset:1792
    v_mfma_f32_16x16x32_bf16 v[12:15], a[184:187], a[204:207], v[12:15]
    ds_read_b64_tr_b16 a[140:141], v216 offset:776
    v_mfma_f32_16x16x32_bf16 v[44:47], a[184:187], a[208:211], v[44:47]
    ds_read_b64_tr_b16 a[142:143], v216 offset:1800
    v_mfma_f32_16x16x32_bf16 v[76:79], a[184:187], a[212:215], v[76:79]
    s_add_u32 s39, s39, 32768
    v_mfma_f32_16x16x32_bf16 v[108:111], a[184:187], a[216:219], v[108:111]
    s_cmp_eq_u32 s39, 163840
    s_cselect_b32 s39, 0, s39
    v_mfma_f32_16x16x32_bf16 v[140:143], a[184:187], a[220:223], v[140:143]
    v_add_u32 v216, s39, v219
    v_mfma_f32_16x16x32_bf16 v[172:175], a[184:187], a[224:227], v[172:175]
    v_mfma_f32_16x16x32_bf16 v[204:207], a[184:187], a[228:231], v[204:207]
    v_mfma_f32_16x16x32_bf16 v[16:19], a[188:191], a[204:207], v[16:19]
    v_mfma_f32_16x16x32_bf16 v[48:51], a[188:191], a[208:211], v[48:51]
    v_mfma_f32_16x16x32_bf16 v[80:83], a[188:191], a[212:215], v[80:83]
    v_mfma_f32_16x16x32_bf16 v[112:115], a[188:191], a[216:219], v[112:115]
    v_mfma_f32_16x16x32_bf16 v[144:147], a[188:191], a[220:223], v[144:147]
    v_mfma_f32_16x16x32_bf16 v[176:179], a[188:191], a[224:227], v[176:179]
    buffer_load_dwordx4 v214, s[8:11], s49 offen offset:2048  lds
    s_add_u32 s49, s49, 128
    v_mfma_f32_16x16x32_bf16 v[20:23], a[192:195], a[204:207], v[20:23]
    s_mov_b32 s51, s29
    s_add_u32 s29, s29, 32768
    v_mfma_f32_16x16x32_bf16 v[52:55], a[192:195], a[208:211], v[52:55]
    s_cmp_eq_u32 s29, 163840
    s_cselect_b32 s29, 0, s29
    v_mfma_f32_16x16x32_bf16 v[84:87], a[192:195], a[212:215], v[84:87]
    v_mfma_f32_16x16x32_bf16 v[116:119], a[192:195], a[216:219], v[116:119]
    v_mfma_f32_16x16x32_bf16 v[148:151], a[192:195], a[220:223], v[148:151]
    v_mfma_f32_16x16x32_bf16 v[180:183], a[192:195], a[224:227], v[180:183]
    v_mfma_f32_16x16x32_bf16 v[24:27], a[196:199], a[204:207], v[24:27]
    v_mfma_f32_16x16x32_bf16 v[56:59], a[196:199], a[208:211], v[56:59]
    v_mfma_f32_16x16x32_bf16 v[88:91], a[196:199], a[212:215], v[88:91]
    v_mfma_f32_16x16x32_bf16 v[120:123], a[196:199], a[216:219], v[120:123]
    v_mfma_f32_16x16x32_bf16 v[152:155], a[196:199], a[220:223], v[152:155]
    v_mfma_f32_16x16x32_bf16 v[184:187], a[196:199], a[224:227], v[184:187]
    v_mfma_f32_16x16x32_bf16 v[28:31], a[200:203], a[204:207], v[28:31]
    v_mfma_f32_16x16x32_bf16 v[60:63], a[200:203], a[208:211], v[60:63]
    v_mfma_f32_16x16x32_bf16 v[92:95], a[200:203], a[212:215], v[92:95]
    v_mfma_f32_16x16x32_bf16 v[124:127], a[200:203], a[216:219], v[124:127]
    v_mfma_f32_16x16x32_bf16 v[156:159], a[200:203], a[220:223], v[156:159]
    v_mfma_f32_16x16x32_bf16 v[188:191], a[200:203], a[224:227], v[188:191]
    s_waitcnt vmcnt(16) lgkmcnt(0)
    s_barrier
    v_mfma_f32_16x16x32_bf16 v[0:3], a[112:115], a[144:147], v[0:3]
    s_add_u32 m0, s37, 65536
    ds_read_b64_tr_b16 a[172:173], v216 offset:0
    v_mfma_f32_16x16x32_bf16 v[32:35], a[112:115], a[148:151], v[32:35]
    buffer_load_dwordx4 v248, s[16:19], s32 offen offset:0 nt lds
    ds_read_b64_tr_b16 a[174:175], v216 offset:1024
    v_mfma_f32_16x16x32_bf16 v[64:67], a[112:115], a[152:155], v[64:67]
    ds_read_b128 a[204:207], v217 offset:512
    v_mfma_f32_16x16x32_bf16 v[96:99], a[112:115], a[156:159], v[96:99]
    ds_read_b128 a[208:211], v217 offset:2560
    v_mfma_f32_16x16x32_bf16 v[128:131], a[112:115], a[160:163], v[128:131]
    ds_read_b128 a[212:215], v217 offset:4608
    v_mfma_f32_16x16x32_bf16 v[160:163], a[112:115], a[164:167], v[160:163]
    ds_read_b128 a[216:219], v217 offset:6656
    v_mfma_f32_16x16x32_bf16 v[192:195], a[112:115], a[168:171], v[192:195]
    ds_read_b128 a[220:223], v217 offset:8704
    v_mfma_f32_16x16x32_bf16 v[4:7], a[116:119], a[144:147], v[4:7]
    buffer_load_dwordx4 v249, s[16:19], s32 offen offset:1024 nt lds
    ds_read_b128 a[224:227], v217 offset:10752
    v_mfma_f32_16x16x32_bf16 v[36:39], a[116:119], a[148:151], v[36:39]
    ds_read_b128 a[228:231], v218 offset:10752
    v_mfma_f32_16x16x32_bf16 v[68:71], a[116:119], a[152:155], v[68:71]
    ds_read_b64_tr_b16 a[176:177], v216 offset:8
    v_mfma_f32_16x16x32_bf16 v[100:103], a[116:119], a[156:159], v[100:103]
    ds_read_b64_tr_b16 a[178:179], v216 offset:1032
    v_mfma_f32_16x16x32_bf16 v[132:135], a[116:119], a[160:163], v[132:135]
    ds_read_b64_tr_b16 a[180:181], v216 offset:256
    v_mfma_f32_16x16x32_bf16 v[164:167], a[116:119], a[164:167], v[164:167]
    ds_read_b64_tr_b16 a[182:183], v216 offset:1280
    v_mfma_f32_16x16x32_bf16 v[196:199], a[116:119], a[168:171], v[196:199]
    buffer_load_dwordx4 v248, s[16:19], s32 offen offset:2048 nt lds
    ds_read_b64_tr_b16 a[184:185], v216 offset:264
    v_mfma_f32_16x16x32_bf16 v[8:11], a[120:123], a[144:147], v[8:11]
    ds_read_b64_tr_b16 a[186:187], v216 offset:1288
    v_mfma_f32_16x16x32_bf16 v[40:43], a[120:123], a[148:151], v[40:43]
    ds_read_b64_tr_b16 a[188:189], v216 offset:512
    v_mfma_f32_16x16x32_bf16 v[72:75], a[120:123], a[152:155], v[72:75]
    ds_read_b64_tr_b16 a[190:191], v216 offset:1536
    v_mfma_f32_16x16x32_bf16 v[104:107], a[120:123], a[156:159], v[104:107]
    ds_read_b64_tr_b16 a[192:193], v216 offset:520
    v_mfma_f32_16x16x32_bf16 v[136:139], a[120:123], a[160:163], v[136:139]
    ds_read_b64_tr_b16 a[194:195], v216 offset:1544
    v_mfma_f32_16x16x32_bf16 v[168:171], a[120:123], a[164:167], v[168:171]
    buffer_load_dwordx4 v249, s[16:19], s32 offen offset:3072 nt lds
    s_add_u32 m0, m0, 4096
    v_mfma_f32_16x16x32_bf16 v[200:203], a[120:123], a[168:171], v[200:203]
    ds_read_b64_tr_b16 a[196:197], v216 offset:768
    v_mfma_f32_16x16x32_bf16 v[12:15], a[124:127], a[144:147], v[12:15]
    ds_read_b64_tr_b16 a[198:199], v216 offset:1792
    v_mfma_f32_16x16x32_bf16 v[44:47], a[124:127], a[148:151], v[44:47]
    ds_read_b64_tr_b16 a[200:201], v216 offset:776
    v_mfma_f32_16x16x32_bf16 v[76:79], a[124:127], a[152:155], v[76:79]
    ds_read_b64_tr_b16 a[202:203], v216 offset:1800
    v_mfma_f32_16x16x32_bf16 v[108:111], a[124:127], a[156:159], v[108:111]
    s_add_u32 s39, s39, 32768
    v_mfma_f32_16x16x32_bf16 v[140:143], a[124:127], a[160:163], v[140:143]
    buffer_load_dwordx4 v248, s[16:19], s33 offen offset:0 nt lds
    v_mfma_f32_16x16x32_bf16 v[172:175], a[124:127], a[164:167], v[172:175]
    s_cmp_eq_u32 s39, 163840
    s_cselect_b32 s39, 0, s39
    v_mfma_f32_16x16x32_bf16 v[204:207], a[124:127], a[168:171], v[204:207]
    v_add_u32 v216, s39, v219
    v_add_u32 v217, s39, v220
    v_mfma_f32_16x16x32_bf16 v[16:19], a[128:131], a[144:147], v[16:19]
    s_add_u32 s40, s39, 32768
    v_mfma_f32_16x16x32_bf16 v[48:51], a[128:131], a[148:151], v[48:51]
    s_cmp_eq_u32 s40, 163840
    s_cselect_b32 s40, 0, s40
    v_mfma_f32_16x16x32_bf16 v[80:83], a[128:131], a[152:155], v[80:83]
    v_add_u32 v218, s40, v220
    v_mfma_f32_16x16x32_bf16 v[112:115], a[128:131], a[156:159], v[112:115]
    buffer_load_dwordx4 v249, s[16:19], s33 offen offset:1024 nt lds
    v_mfma_f32_16x16x32_bf16 v[144:147], a[128:131], a[160:163], v[144:147]
    v_mfma_f32_16x16x32_bf16 v[176:179], a[128:131], a[164:167], v[176:179]
    v_mfma_f32_16x16x32_bf16 v[20:23], a[132:135], a[144:147], v[20:23]
    v_mfma_f32_16x16x32_bf16 v[52:55], a[132:135], a[148:151], v[52:55]
    v_mfma_f32_16x16x32_bf16 v[84:87], a[132:135], a[152:155], v[84:87]
    v_mfma_f32_16x16x32_bf16 v[116:119], a[132:135], a[156:159], v[116:119]
    buffer_load_dwordx4 v248, s[16:19], s33 offen offset:2048 nt lds
    v_mfma_f32_16x16x32_bf16 v[148:151], a[132:135], a[160:163], v[148:151]
    v_mfma_f32_16x16x32_bf16 v[180:183], a[132:135], a[164:167], v[180:183]
    v_mfma_f32_16x16x32_bf16 v[24:27], a[136:139], a[144:147], v[24:27]
    v_mfma_f32_16x16x32_bf16 v[56:59], a[136:139], a[148:151], v[56:59]
    v_mfma_f32_16x16x32_bf16 v[88:91], a[136:139], a[152:155], v[88:91]
    v_mfma_f32_16x16x32_bf16 v[120:123], a[136:139], a[156:159], v[120:123]
    buffer_load_dwordx4 v249, s[16:19], s33 offen offset:3072 nt lds
    s_add_u32 s64, s64, 8192
    v_mfma_f32_16x16x32_bf16 v[152:155], a[136:139], a[160:163], v[152:155]
    s_xor_b32 s32, s64, s65
    s_or_b32 s33, s32, 4096
    v_mfma_f32_16x16x32_bf16 v[184:187], a[136:139], a[164:167], v[184:187]
    s_mov_b32 s51, s29
    s_add_u32 s29, s29, 32768
    v_mfma_f32_16x16x32_bf16 v[28:31], a[140:143], a[144:147], v[28:31]
    s_cmp_eq_u32 s29, 163840
    s_cselect_b32 s29, 0, s29
    v_mfma_f32_16x16x32_bf16 v[60:63], a[140:143], a[148:151], v[60:63]
    v_mfma_f32_16x16x32_bf16 v[92:95], a[140:143], a[152:155], v[92:95]
    v_mfma_f32_16x16x32_bf16 v[124:127], a[140:143], a[156:159], v[124:127]
    v_mfma_f32_16x16x32_bf16 v[156:159], a[140:143], a[160:163], v[156:159]
    v_mfma_f32_16x16x32_bf16 v[188:191], a[140:143], a[164:167], v[188:191]
    s_waitcnt vmcnt(8) lgkmcnt(0)
    s_barrier
    v_mfma_f32_16x16x32_bf16 v[0:3], a[172:175], a[204:207], v[0:3]
    ds_read_b64_tr_b16 a[112:113], v216 offset:0
    v_mfma_f32_16x16x32_bf16 v[32:35], a[172:175], a[208:211], v[32:35]
    ds_read_b64_tr_b16 a[114:115], v216 offset:1024
    v_mfma_f32_16x16x32_bf16 v[64:67], a[172:175], a[212:215], v[64:67]
    ds_read_b128 a[144:147], v217 offset:0
    v_mfma_f32_16x16x32_bf16 v[96:99], a[172:175], a[216:219], v[96:99]
    ds_read_b128 a[148:151], v217 offset:2048
    v_mfma_f32_16x16x32_bf16 v[128:131], a[172:175], a[220:223], v[128:131]
    ds_read_b128 a[152:155], v217 offset:4096
    v_mfma_f32_16x16x32_bf16 v[160:163], a[172:175], a[224:227], v[160:163]
    ds_read_b128 a[156:159], v217 offset:6144
    v_mfma_f32_16x16x32_bf16 v[192:195], a[172:175], a[228:231], v[192:195]
    ds_read_b128 a[160:163], v217 offset:8192
    v_mfma_f32_16x16x32_bf16 v[4:7], a[176:179], a[204:207], v[4:7]
    ds_read_b128 a[164:167], v217 offset:10240
    v_mfma_f32_16x16x32_bf16 v[36:39], a[176:179], a[208:211], v[36:39]
    ds_read_b128 a[168:171], v218 offset:10240
    v_mfma_f32_16x16x32_bf16 v[68:71], a[176:179], a[212:215], v[68:71]
    ds_read_b64_tr_b16 a[116:117], v216 offset:8
    v_mfma_f32_16x16x32_bf16 v[100:103], a[176:179], a[216:219], v[100:103]
    ds_read_b64_tr_b16 a[118:119], v216 offset:1032
    v_mfma_f32_16x16x32_bf16 v[132:135], a[176:179], a[220:223], v[132:135]
    ds_read_b64_tr_b16 a[120:121], v216 offset:256
    v_mfma_f32_16x16x32_bf16 v[164:167], a[176:179], a[224:227], v[164:167]
    ds_read_b64_tr_b16 a[122:123], v216 offset:1280
    v_mfma_f32_16x16x32_bf16 v[196:199], a[176:179], a[228:231], v[196:199]
    ds_read_b64_tr_b16 a[124:125], v216 offset:264
    v_mfma_f32_16x16x32_bf16 v[8:11], a[180:183], a[204:207], v[8:11]
    ds_read_b64_tr_b16 a[126:127], v216 offset:1288
    v_mfma_f32_16x16x32_bf16 v[40:43], a[180:183], a[208:211], v[40:43]
    ds_read_b64_tr_b16 a[128:129], v216 offset:512
    v_mfma_f32_16x16x32_bf16 v[72:75], a[180:183], a[212:215], v[72:75]
    ds_read_b64_tr_b16 a[130:131], v216 offset:1536
    v_mfma_f32_16x16x32_bf16 v[104:107], a[180:183], a[216:219], v[104:107]
    ds_read_b64_tr_b16 a[132:133], v216 offset:520
    v_mfma_f32_16x16x32_bf16 v[136:139], a[180:183], a[220:223], v[136:139]
    ds_read_b64_tr_b16 a[134:135], v216 offset:1544
    v_mfma_f32_16x16x32_bf16 v[168:171], a[180:183], a[224:227], v[168:171]
    ds_read_b64_tr_b16 a[136:137], v216 offset:768
    v_mfma_f32_16x16x32_bf16 v[200:203], a[180:183], a[228:231], v[200:203]
    ds_read_b64_tr_b16 a[138:139], v216 offset:1792
    v_mfma_f32_16x16x32_bf16 v[12:15], a[184:187], a[204:207], v[12:15]
    ds_read_b64_tr_b16 a[140:141], v216 offset:776
    v_mfma_f32_16x16x32_bf16 v[44:47], a[184:187], a[208:211], v[44:47]
    ds_read_b64_tr_b16 a[142:143], v216 offset:1800
    v_mfma_f32_16x16x32_bf16 v[76:79], a[184:187], a[212:215], v[76:79]
    s_add_u32 s39, s39, 32768
    v_mfma_f32_16x16x32_bf16 v[108:111], a[184:187], a[216:219], v[108:111]
    s_cmp_eq_u32 s39, 163840
    s_cselect_b32 s39, 0, s39
    v_mfma_f32_16x16x32_bf16 v[140:143], a[184:187], a[220:223], v[140:143]
    v_add_u32 v216, s39, v219
    v_mfma_f32_16x16x32_bf16 v[172:175], a[184:187], a[224:227], v[172:175]
    v_mfma_f32_16x16x32_bf16 v[204:207], a[184:187], a[228:231], v[204:207]
    v_mfma_f32_16x16x32_bf16 v[16:19], a[188:191], a[204:207], v[16:19]
    v_mfma_f32_16x16x32_bf16 v[48:51], a[188:191], a[208:211], v[48:51]
    v_mfma_f32_16x16x32_bf16 v[80:83], a[188:191], a[212:215], v[80:83]
    v_mfma_f32_16x16x32_bf16 v[112:115], a[188:191], a[216:219], v[112:115]
    v_mfma_f32_16x16x32_bf16 v[144:147], a[188:191], a[220:223], v[144:147]
    v_mfma_f32_16x16x32_bf16 v[176:179], a[188:191], a[224:227], v[176:179]
    v_mfma_f32_16x16x32_bf16 v[20:23], a[192:195], a[204:207], v[20:23]
    v_mfma_f32_16x16x32_bf16 v[52:55], a[192:195], a[208:211], v[52:55]
    v_mfma_f32_16x16x32_bf16 v[84:87], a[192:195], a[212:215], v[84:87]
    v_mfma_f32_16x16x32_bf16 v[116:119], a[192:195], a[216:219], v[116:119]
    v_mfma_f32_16x16x32_bf16 v[148:151], a[192:195], a[220:223], v[148:151]
    v_mfma_f32_16x16x32_bf16 v[180:183], a[192:195], a[224:227], v[180:183]
    s_mov_b32 s51, s29
    s_add_u32 s29, s29, 32768
    v_mfma_f32_16x16x32_bf16 v[24:27], a[196:199], a[204:207], v[24:27]
    s_cmp_eq_u32 s29, 163840
    s_cselect_b32 s29, 0, s29
    v_mfma_f32_16x16x32_bf16 v[56:59], a[196:199], a[208:211], v[56:59]
    v_mfma_f32_16x16x32_bf16 v[88:91], a[196:199], a[212:215], v[88:91]
    v_mfma_f32_16x16x32_bf16 v[120:123], a[196:199], a[216:219], v[120:123]
    v_mfma_f32_16x16x32_bf16 v[152:155], a[196:199], a[220:223], v[152:155]
    v_mfma_f32_16x16x32_bf16 v[184:187], a[196:199], a[224:227], v[184:187]
    v_mfma_f32_16x16x32_bf16 v[28:31], a[200:203], a[204:207], v[28:31]
    v_mfma_f32_16x16x32_bf16 v[60:63], a[200:203], a[208:211], v[60:63]
    v_mfma_f32_16x16x32_bf16 v[92:95], a[200:203], a[212:215], v[92:95]
    v_mfma_f32_16x16x32_bf16 v[124:127], a[200:203], a[216:219], v[124:127]
    v_mfma_f32_16x16x32_bf16 v[156:159], a[200:203], a[220:223], v[156:159]
    v_mfma_f32_16x16x32_bf16 v[188:191], a[200:203], a[224:227], v[188:191]
    s_waitcnt vmcnt(8) lgkmcnt(0)
    s_barrier
    v_mfma_f32_16x16x32_bf16 v[0:3], a[112:115], a[144:147], v[0:3]
    s_add_u32 m0, s37, 98304
    ds_read_b64_tr_b16 a[172:173], v216 offset:0
    v_mfma_f32_16x16x32_bf16 v[32:35], a[112:115], a[148:151], v[32:35]
    buffer_load_dwordx4 v248, s[16:19], s32 offen offset:0 nt lds
    ds_read_b64_tr_b16 a[174:175], v216 offset:1024
    v_mfma_f32_16x16x32_bf16 v[64:67], a[112:115], a[152:155], v[64:67]
    ds_read_b128 a[204:207], v217 offset:512
    v_mfma_f32_16x16x32_bf16 v[96:99], a[112:115], a[156:159], v[96:99]
    ds_read_b128 a[208:211], v217 offset:2560
    v_mfma_f32_16x16x32_bf16 v[128:131], a[112:115], a[160:163], v[128:131]
    ds_read_b128 a[212:215], v217 offset:4608
    v_mfma_f32_16x16x32_bf16 v[160:163], a[112:115], a[164:167], v[160:163]
    ds_read_b128 a[216:219], v217 offset:6656
    v_mfma_f32_16x16x32_bf16 v[192:195], a[112:115], a[168:171], v[192:195]
    ds_read_b128 a[220:223], v217 offset:8704
    v_mfma_f32_16x16x32_bf16 v[4:7], a[116:119], a[144:147], v[4:7]
    buffer_load_dwordx4 v249, s[16:19], s32 offen offset:1024 nt lds
    ds_read_b128 a[224:227], v217 offset:10752
    v_mfma_f32_16x16x32_bf16 v[36:39], a[116:119], a[148:151], v[36:39]
    ds_read_b128 a[228:231], v218 offset:10752
    v_mfma_f32_16x16x32_bf16 v[68:71], a[116:119], a[152:155], v[68:71]
    ds_read_b64_tr_b16 a[176:177], v216 offset:8
    v_mfma_f32_16x16x32_bf16 v[100:103], a[116:119], a[156:159], v[100:103]
    ds_read_b64_tr_b16 a[178:179], v216 offset:1032
    v_mfma_f32_16x16x32_bf16 v[132:135], a[116:119], a[160:163], v[132:135]
    ds_read_b64_tr_b16 a[180:181], v216 offset:256
    v_mfma_f32_16x16x32_bf16 v[164:167], a[116:119], a[164:167], v[164:167]
    ds_read_b64_tr_b16 a[182:183], v216 offset:1280
    v_mfma_f32_16x16x32_bf16 v[196:199], a[116:119], a[168:171], v[196:199]
    buffer_load_dwordx4 v248, s[16:19], s32 offen offset:2048 nt lds
    ds_read_b64_tr_b16 a[184:185], v216 offset:264
    v_mfma_f32_16x16x32_bf16 v[8:11], a[120:123], a[144:147], v[8:11]
    ds_read_b64_tr_b16 a[186:187], v216 offset:1288
    v_mfma_f32_16x16x32_bf16 v[40:43], a[120:123], a[148:151], v[40:43]
    ds_read_b64_tr_b16 a[188:189], v216 offset:512
    v_mfma_f32_16x16x32_bf16 v[72:75], a[120:123], a[152:155], v[72:75]
    ds_read_b64_tr_b16 a[190:191], v216 offset:1536
    v_mfma_f32_16x16x32_bf16 v[104:107], a[120:123], a[156:159], v[104:107]
    ds_read_b64_tr_b16 a[192:193], v216 offset:520
    v_mfma_f32_16x16x32_bf16 v[136:139], a[120:123], a[160:163], v[136:139]
    ds_read_b64_tr_b16 a[194:195], v216 offset:1544
    v_mfma_f32_16x16x32_bf16 v[168:171], a[120:123], a[164:167], v[168:171]
    buffer_load_dwordx4 v249, s[16:19], s32 offen offset:3072 nt lds
    s_add_u32 m0, m0, 4096
    v_mfma_f32_16x16x32_bf16 v[200:203], a[120:123], a[168:171], v[200:203]
    ds_read_b64_tr_b16 a[196:197], v216 offset:768
    v_mfma_f32_16x16x32_bf16 v[12:15], a[124:127], a[144:147], v[12:15]
    ds_read_b64_tr_b16 a[198:199], v216 offset:1792
    v_mfma_f32_16x16x32_bf16 v[44:47], a[124:127], a[148:151], v[44:47]
    ds_read_b64_tr_b16 a[200:201], v216 offset:776
    v_mfma_f32_16x16x32_bf16 v[76:79], a[124:127], a[152:155], v[76:79]
    ds_read_b64_tr_b16 a[202:203], v216 offset:1800
    v_mfma_f32_16x16x32_bf16 v[108:111], a[124:127], a[156:159], v[108:111]
    s_add_u32 s39, s39, 32768
    v_mfma_f32_16x16x32_bf16 v[140:143], a[124:127], a[160:163], v[140:143]
    buffer_load_dwordx4 v248, s[16:19], s33 offen offset:0 nt lds
    v_mfma_f32_16x16x32_bf16 v[172:175], a[124:127], a[164:167], v[172:175]
    s_cmp_eq_u32 s39, 163840
    s_cselect_b32 s39, 0, s39
    v_mfma_f32_16x16x32_bf16 v[204:207], a[124:127], a[168:171], v[204:207]
    v_add_u32 v216, s39, v219
    v_add_u32 v217, s39, v220
    v_mfma_f32_16x16x32_bf16 v[16:19], a[128:131], a[144:147], v[16:19]
    s_add_u32 s40, s39, 32768
    v_mfma_f32_16x16x32_bf16 v[48:51], a[128:131], a[148:151], v[48:51]
    s_cmp_eq_u32 s40, 163840
    s_cselect_b32 s40, 0, s40
    v_mfma_f32_16x16x32_bf16 v[80:83], a[128:131], a[152:155], v[80:83]
    v_add_u32 v218, s40, v220
    v_mfma_f32_16x16x32_bf16 v[112:115], a[128:131], a[156:159], v[112:115]
    buffer_load_dwordx4 v249, s[16:19], s33 offen offset:1024 nt lds
    v_mfma_f32_16x16x32_bf16 v[144:147], a[128:131], a[160:163], v[144:147]
    v_mfma_f32_16x16x32_bf16 v[176:179], a[128:131], a[164:167], v[176:179]
    v_mfma_f32_16x16x32_bf16 v[20:23], a[132:135], a[144:147], v[20:23]
    v_mfma_f32_16x16x32_bf16 v[52:55], a[132:135], a[148:151], v[52:55]
    v_mfma_f32_16x16x32_bf16 v[84:87], a[132:135], a[152:155], v[84:87]
    v_mfma_f32_16x16x32_bf16 v[116:119], a[132:135], a[156:159], v[116:119]
    buffer_load_dwordx4 v248, s[16:19], s33 offen offset:2048 nt lds
    v_mfma_f32_16x16x32_bf16 v[148:151], a[132:135], a[160:163], v[148:151]
    v_mfma_f32_16x16x32_bf16 v[180:183], a[132:135], a[164:167], v[180:183]
    v_mfma_f32_16x16x32_bf16 v[24:27], a[136:139], a[144:147], v[24:27]
    v_mfma_f32_16x16x32_bf16 v[56:59], a[136:139], a[148:151], v[56:59]
    v_mfma_f32_16x16x32_bf16 v[88:91], a[136:139], a[152:155], v[88:91]
    v_mfma_f32_16x16x32_bf16 v[120:123], a[136:139], a[156:159], v[120:123]
    buffer_load_dwordx4 v249, s[16:19], s33 offen offset:3072 nt lds
    s_add_u32 s64, s64, 8192
    v_mfma_f32_16x16x32_bf16 v[152:155], a[136:139], a[160:163], v[152:155]
    s_xor_b32 s32, s64, s65
    s_or_b32 s33, s32, 4096
    v_mfma_f32_16x16x32_bf16 v[184:187], a[136:139], a[164:167], v[184:187]
    s_mov_b32 s51, s29
    s_add_u32 s29, s29, 32768
    v_mfma_f32_16x16x32_bf16 v[28:31], a[140:143], a[144:147], v[28:31]
    s_cmp_eq_u32 s29, 163840
    s_cselect_b32 s29, 0, s29
    v_mfma_f32_16x16x32_bf16 v[60:63], a[140:143], a[148:151], v[60:63]
    v_mfma_f32_16x16x32_bf16 v[92:95], a[140:143], a[152:155], v[92:95]
    v_mfma_f32_16x16x32_bf16 v[124:127], a[140:143], a[156:159], v[124:127]
    v_mfma_f32_16x16x32_bf16 v[156:159], a[140:143], a[160:163], v[156:159]
    v_mfma_f32_16x16x32_bf16 v[188:191], a[140:143], a[164:167], v[188:191]
    s_waitcnt vmcnt(63) lgkmcnt(0)
    s_barrier
    v_mfma_f32_16x16x32_bf16 v[0:3], a[172:175], a[204:207], v[0:3]
    v_mfma_f32_16x16x32_bf16 v[32:35], a[172:175], a[208:211], v[32:35]
    v_mfma_f32_16x16x32_bf16 v[64:67], a[172:175], a[212:215], v[64:67]
    v_mfma_f32_16x16x32_bf16 v[96:99], a[172:175], a[216:219], v[96:99]
    v_mfma_f32_16x16x32_bf16 v[128:131], a[172:175], a[220:223], v[128:131]
    v_mfma_f32_16x16x32_bf16 v[160:163], a[172:175], a[224:227], v[160:163]
    v_mfma_f32_16x16x32_bf16 v[192:195], a[172:175], a[228:231], v[192:195]
    v_mfma_f32_16x16x32_bf16 v[4:7], a[176:179], a[204:207], v[4:7]
    v_mfma_f32_16x16x32_bf16 v[36:39], a[176:179], a[208:211], v[36:39]
    v_mfma_f32_16x16x32_bf16 v[68:71], a[176:179], a[212:215], v[68:71]
    v_mfma_f32_16x16x32_bf16 v[100:103], a[176:179], a[216:219], v[100:103]
    v_mfma_f32_16x16x32_bf16 v[132:135], a[176:179], a[220:223], v[132:135]
    v_mfma_f32_16x16x32_bf16 v[164:167], a[176:179], a[224:227], v[164:167]
    v_mfma_f32_16x16x32_bf16 v[196:199], a[176:179], a[228:231], v[196:199]
    v_mfma_f32_16x16x32_bf16 v[8:11], a[180:183], a[204:207], v[8:11]
    v_mfma_f32_16x16x32_bf16 v[40:43], a[180:183], a[208:211], v[40:43]
    v_mfma_f32_16x16x32_bf16 v[72:75], a[180:183], a[212:215], v[72:75]
    v_mfma_f32_16x16x32_bf16 v[104:107], a[180:183], a[216:219], v[104:107]
    v_mfma_f32_16x16x32_bf16 v[136:139], a[180:183], a[220:223], v[136:139]
    v_mfma_f32_16x16x32_bf16 v[168:171], a[180:183], a[224:227], v[168:171]
    v_mfma_f32_16x16x32_bf16 v[200:203], a[180:183], a[228:231], v[200:203]
    v_mfma_f32_16x16x32_bf16 v[12:15], a[184:187], a[204:207], v[12:15]
    v_mfma_f32_16x16x32_bf16 v[44:47], a[184:187], a[208:211], v[44:47]
    v_mfma_f32_16x16x32_bf16 v[76:79], a[184:187], a[212:215], v[76:79]
    v_mfma_f32_16x16x32_bf16 v[108:111], a[184:187], a[216:219], v[108:111]
    v_mfma_f32_16x16x32_bf16 v[140:143], a[184:187], a[220:223], v[140:143]
    v_mfma_f32_16x16x32_bf16 v[172:175], a[184:187], a[224:227], v[172:175]
    v_mfma_f32_16x16x32_bf16 v[204:207], a[184:187], a[228:231], v[204:207]
    v_mfma_f32_16x16x32_bf16 v[16:19], a[188:191], a[204:207], v[16:19]
    v_mfma_f32_16x16x32_bf16 v[48:51], a[188:191], a[208:211], v[48:51]
    v_mfma_f32_16x16x32_bf16 v[80:83], a[188:191], a[212:215], v[80:83]
    v_mfma_f32_16x16x32_bf16 v[112:115], a[188:191], a[216:219], v[112:115]
    v_mfma_f32_16x16x32_bf16 v[144:147], a[188:191], a[220:223], v[144:147]
    v_mfma_f32_16x16x32_bf16 v[176:179], a[188:191], a[224:227], v[176:179]
    v_mfma_f32_16x16x32_bf16 v[20:23], a[192:195], a[204:207], v[20:23]
    v_mfma_f32_16x16x32_bf16 v[52:55], a[192:195], a[208:211], v[52:55]
    v_mfma_f32_16x16x32_bf16 v[84:87], a[192:195], a[212:215], v[84:87]
    v_mfma_f32_16x16x32_bf16 v[116:119], a[192:195], a[216:219], v[116:119]
    v_mfma_f32_16x16x32_bf16 v[148:151], a[192:195], a[220:223], v[148:151]
    v_mfma_f32_16x16x32_bf16 v[180:183], a[192:195], a[224:227], v[180:183]
    s_mov_b32 s51, s29
    s_add_u32 s29, s29, 32768
    v_mfma_f32_16x16x32_bf16 v[24:27], a[196:199], a[204:207], v[24:27]
    s_cmp_eq_u32 s29, 163840
    s_cselect_b32 s29, 0, s29
    v_mfma_f32_16x16x32_bf16 v[56:59], a[196:199], a[208:211], v[56:59]
    v_mfma_f32_16x16x32_bf16 v[88:91], a[196:199], a[212:215], v[88:91]
    v_mfma_f32_16x16x32_bf16 v[120:123], a[196:199], a[216:219], v[120:123]
    v_mfma_f32_16x16x32_bf16 v[152:155], a[196:199], a[220:223], v[152:155]
    v_mfma_f32_16x16x32_bf16 v[184:187], a[196:199], a[224:227], v[184:187]
    v_mfma_f32_16x16x32_bf16 v[28:31], a[200:203], a[204:207], v[28:31]
    v_mfma_f32_16x16x32_bf16 v[60:63], a[200:203], a[208:211], v[60:63]
    v_mfma_f32_16x16x32_bf16 v[92:95], a[200:203], a[212:215], v[92:95]
    v_mfma_f32_16x16x32_bf16 v[124:127], a[200:203], a[216:219], v[124:127]
    v_mfma_f32_16x16x32_bf16 v[156:159], a[200:203], a[220:223], v[156:159]
    v_mfma_f32_16x16x32_bf16 v[188:191], a[200:203], a[224:227], v[188:191]
    s_mov_b32 s40, 0x3e0293ee
    s_mov_b32 s41, 0x3e0293ee
    v_mov_b32 v230, 0
    s_mov_b64 exec, 1
    buffer_load_dword v253, v230, s[72:75], s95 offen sc1 nt
    s_mov_b64 exec, -1
    v_subrev_u32 v252, 32768, v221
    v_pk_mul_f32 v[192:193], v[192:193], s[40:41]
    v_pk_mul_f32 v[194:195], v[194:195], s[40:41]
    v_pk_mul_f32 v[196:197], v[196:197], s[40:41]
    v_pk_mul_f32 v[198:199], v[198:199], s[40:41]
    v_cvt_pk_bf16_f32 v192, v192, v193
    v_cvt_pk_bf16_f32 v193, v194, v195
    v_cvt_pk_bf16_f32 v194, v196, v197
    v_cvt_pk_bf16_f32 v195, v198, v199
    v_accvgpr_write_b32 a96, v192
    v_accvgpr_write_b32 a97, v193
    v_accvgpr_write_b32 a98, v194
    v_accvgpr_write_b32 a99, v195
    v_pk_mul_f32 v[200:201], v[200:201], s[40:41]
    v_pk_mul_f32 v[202:203], v[202:203], s[40:41]
    v_pk_mul_f32 v[204:205], v[204:205], s[40:41]
    v_pk_mul_f32 v[206:207], v[206:207], s[40:41]
    v_cvt_pk_bf16_f32 v200, v200, v201
    v_cvt_pk_bf16_f32 v201, v202, v203
    v_cvt_pk_bf16_f32 v202, v204, v205
    v_cvt_pk_bf16_f32 v203, v206, v207
    v_accvgpr_write_b32 a100, v200
    v_accvgpr_write_b32 a101, v201
    v_accvgpr_write_b32 a102, v202
    v_accvgpr_write_b32 a103, v203
    s_waitcnt vmcnt(9) lgkmcnt(0)
    s_barrier
    v_pk_mul_f32 v[0:1], v[0:1], s[40:41]
    v_pk_mul_f32 v[2:3], v[2:3], s[40:41]
    v_pk_mul_f32 v[4:5], v[4:5], s[40:41]
    v_pk_mul_f32 v[6:7], v[6:7], s[40:41]
    ds_read_b128 a[104:107], v252 offset:0
    ds_read_b128 a[108:111], v252 offset:1024
    ds_read_b128 a[112:115], v244 offset:0
    ds_read_b128 a[116:119], v244 offset:256
    ds_read_b128 a[120:123], v244 offset:512
    ds_read_b128 a[124:127], v244 offset:768
    ds_read_b128 a[128:131], v244 offset:4096
    ds_read_b128 a[132:135], v244 offset:4352
    ds_read_b128 a[136:139], v244 offset:4608
    ds_read_b128 a[140:143], v244 offset:4864
    v_cvt_pk_bf16_f32 v0, v0, v1
    v_cvt_pk_bf16_f32 v1, v2, v3
    v_cvt_pk_bf16_f32 v2, v4, v5
    v_cvt_pk_bf16_f32 v3, v6, v7
    v_accvgpr_write_b32 a0, v0
    v_accvgpr_write_b32 a1, v1
    v_accvgpr_write_b32 a2, v2
    v_accvgpr_write_b32 a3, v3
    v_pk_mul_f32 v[8:9], v[8:9], s[40:41]
    v_pk_mul_f32 v[10:11], v[10:11], s[40:41]
    v_pk_mul_f32 v[12:13], v[12:13], s[40:41]
    v_pk_mul_f32 v[14:15], v[14:15], s[40:41]
    ds_read_b64_tr_b16 a[144:145], v245 offset:0
    ds_read_b64_tr_b16 a[146:147], v245 offset:4096
    ds_read_b64_tr_b16 a[148:149], v246 offset:0
    v_cvt_pk_bf16_f32 v8, v8, v9
    v_cvt_pk_bf16_f32 v9, v10, v11
    v_cvt_pk_bf16_f32 v10, v12, v13
    v_cvt_pk_bf16_f32 v11, v14, v15
    v_accvgpr_write_b32 a4, v8
    v_accvgpr_write_b32 a5, v9
    v_accvgpr_write_b32 a6, v10
    v_accvgpr_write_b32 a7, v11
    v_pk_mul_f32 v[16:17], v[16:17], s[40:41]
    v_pk_mul_f32 v[18:19], v[18:19], s[40:41]
    v_pk_mul_f32 v[20:21], v[20:21], s[40:41]
    v_pk_mul_f32 v[22:23], v[22:23], s[40:41]
    ds_read_b64_tr_b16 a[150:151], v246 offset:4096
    ds_read_b64_tr_b16 a[152:153], v245 offset:256
    ds_read_b64_tr_b16 a[154:155], v245 offset:4352
    v_cvt_pk_bf16_f32 v16, v16, v17
    v_cvt_pk_bf16_f32 v17, v18, v19
    v_cvt_pk_bf16_f32 v18, v20, v21
    v_cvt_pk_bf16_f32 v19, v22, v23
    v_accvgpr_write_b32 a8, v16
    v_accvgpr_write_b32 a9, v17
    v_accvgpr_write_b32 a10, v18
    v_accvgpr_write_b32 a11, v19
    v_pk_mul_f32 v[24:25], v[24:25], s[40:41]
    v_pk_mul_f32 v[26:27], v[26:27], s[40:41]
    v_pk_mul_f32 v[28:29], v[28:29], s[40:41]
    v_pk_mul_f32 v[30:31], v[30:31], s[40:41]
    ds_read_b64_tr_b16 a[156:157], v246 offset:256
    ds_read_b64_tr_b16 a[158:159], v246 offset:4352
    ds_read_b64_tr_b16 a[160:161], v245 offset:512
    v_cvt_pk_bf16_f32 v24, v24, v25
    v_cvt_pk_bf16_f32 v25, v26, v27
    v_cvt_pk_bf16_f32 v26, v28, v29
    v_cvt_pk_bf16_f32 v27, v30, v31
    v_accvgpr_write_b32 a12, v24
    v_accvgpr_write_b32 a13, v25
    v_accvgpr_write_b32 a14, v26
    v_accvgpr_write_b32 a15, v27
    v_pk_mul_f32 v[32:33], v[32:33], s[40:41]
    v_pk_mul_f32 v[34:35], v[34:35], s[40:41]
    v_pk_mul_f32 v[36:37], v[36:37], s[40:41]
    v_pk_mul_f32 v[38:39], v[38:39], s[40:41]
    s_waitcnt lgkmcnt(15)
    v_mfma_f32_16x16x32_bf16 v[8:11], a[112:115], a[0:3], 0
    ds_read_b64_tr_b16 a[162:163], v245 offset:4608
    ds_read_b64_tr_b16 a[164:165], v246 offset:512
    ds_read_b64_tr_b16 a[166:167], v246 offset:4608
    v_cvt_pk_bf16_f32 v32, v32, v33
    v_cvt_pk_bf16_f32 v33, v34, v35
    v_cvt_pk_bf16_f32 v34, v36, v37
    v_cvt_pk_bf16_f32 v35, v38, v39
    v_mfma_f32_16x16x32_bf16 v[8:11], a[116:119], a[4:7], v[8:11]
    v_accvgpr_write_b32 a16, v32
    v_accvgpr_write_b32 a17, v33
    v_accvgpr_write_b32 a18, v34
    v_accvgpr_write_b32 a19, v35
    v_pk_mul_f32 v[40:41], v[40:41], s[40:41]
    v_pk_mul_f32 v[42:43], v[42:43], s[40:41]
    v_pk_mul_f32 v[44:45], v[44:45], s[40:41]
    v_pk_mul_f32 v[46:47], v[46:47], s[40:41]
    s_waitcnt lgkmcnt(15)
    v_mfma_f32_16x16x32_bf16 v[8:11], a[120:123], a[8:11], v[8:11]
    ds_read_b64_tr_b16 a[168:169], v245 offset:768
    ds_read_b64_tr_b16 a[170:171], v245 offset:4864
    ds_read_b64_tr_b16 a[172:173], v246 offset:768
    v_cvt_pk_bf16_f32 v40, v40, v41
    v_cvt_pk_bf16_f32 v41, v42, v43
    v_cvt_pk_bf16_f32 v42, v44, v45
    v_cvt_pk_bf16_f32 v43, v46, v47
    v_mfma_f32_16x16x32_bf16 v[8:11], a[124:127], a[12:15], v[8:11]
    v_accvgpr_write_b32 a20, v40
    v_accvgpr_write_b32 a21, v41
    v_accvgpr_write_b32 a22, v42
    v_accvgpr_write_b32 a23, v43
    v_pk_mul_f32 v[48:49], v[48:49], s[40:41]
    v_pk_mul_f32 v[50:51], v[50:51], s[40:41]
    v_pk_mul_f32 v[52:53], v[52:53], s[40:41]
    v_pk_mul_f32 v[54:55], v[54:55], s[40:41]
    v_mfma_f32_16x16x32_bf16 v[16:19], a[112:115], a[96:99], 0
    ds_read_b64_tr_b16 a[174:175], v246 offset:4864
    s_add_u32 m0, s37, 131072
    s_nop 0
    buffer_load_dwordx4 v248, s[16:19], s32 offen offset:0 nt lds
    v_cvt_pk_bf16_f32 v48, v48, v49
    v_cvt_pk_bf16_f32 v49, v50, v51
    v_cvt_pk_bf16_f32 v50, v52, v53
    v_cvt_pk_bf16_f32 v51, v54, v55
    v_mfma_f32_16x16x32_bf16 v[16:19], a[116:119], a[100:103], v[16:19]
    v_accvgpr_write_b32 a24, v48
    v_accvgpr_write_b32 a25, v49
    v_accvgpr_write_b32 a26, v50
    v_accvgpr_write_b32 a27, v51
    v_pk_mul_f32 v[56:57], v[56:57], s[40:41]
    v_pk_mul_f32 v[58:59], v[58:59], s[40:41]
    v_pk_mul_f32 v[60:61], v[60:61], s[40:41]
    v_pk_mul_f32 v[62:63], v[62:63], s[40:41]
    v_mfma_f32_16x16x32_bf16 v[16:19], a[120:123], a[104:107], v[16:19]
    buffer_load_dwordx4 v249, s[16:19], s32 offen offset:1024 nt lds
    buffer_load_dwordx4 v248, s[16:19], s32 offen offset:2048 nt lds
    buffer_load_dwordx4 v249, s[16:19], s32 offen offset:3072 nt lds
    v_cvt_pk_bf16_f32 v56, v56, v57
    v_cvt_pk_bf16_f32 v57, v58, v59
    v_cvt_pk_bf16_f32 v58, v60, v61
    v_cvt_pk_bf16_f32 v59, v62, v63
    v_mfma_f32_16x16x32_bf16 v[16:19], a[124:127], a[108:111], v[16:19]
    v_accvgpr_write_b32 a28, v56
    v_accvgpr_write_b32 a29, v57
    v_accvgpr_write_b32 a30, v58
    v_accvgpr_write_b32 a31, v59
    v_pk_mul_f32 v[64:65], v[64:65], s[40:41]
    v_pk_mul_f32 v[66:67], v[66:67], s[40:41]
    v_pk_mul_f32 v[68:69], v[68:69], s[40:41]
    v_pk_mul_f32 v[70:71], v[70:71], s[40:41]
    v_mfma_f32_16x16x32_bf16 v[40:43], a[112:115], a[16:19], 0
    s_add_u32 m0, m0, 4096
    s_nop 0
    buffer_load_dwordx4 v248, s[16:19], s33 offen offset:0 nt lds
    buffer_load_dwordx4 v249, s[16:19], s33 offen offset:1024 nt lds
    v_cvt_pk_bf16_f32 v64, v64, v65
    v_cvt_pk_bf16_f32 v65, v66, v67
    v_cvt_pk_bf16_f32 v66, v68, v69
    v_cvt_pk_bf16_f32 v67, v70, v71
    v_accvgpr_write_b32 a32, v64
    v_accvgpr_write_b32 a33, v65
    v_accvgpr_write_b32 a34, v66
    v_accvgpr_write_b32 a35, v67
    v_pk_mul_f32 v[72:73], v[72:73], s[40:41]
    v_pk_mul_f32 v[74:75], v[74:75], s[40:41]
    v_pk_mul_f32 v[76:77], v[76:77], s[40:41]
    v_pk_mul_f32 v[78:79], v[78:79], s[40:41]
    v_mfma_f32_16x16x32_bf16 v[40:43], a[116:119], a[20:23], v[40:43]
    buffer_load_dwordx4 v248, s[16:19], s33 offen offset:2048 nt lds
    buffer_load_dwordx4 v249, s[16:19], s33 offen offset:3072 nt lds
    s_add_u32 s64, s64, 8192
    v_cvt_pk_bf16_f32 v72, v72, v73
    v_cvt_pk_bf16_f32 v73, v74, v75
    v_cvt_pk_bf16_f32 v74, v76, v77
    v_cvt_pk_bf16_f32 v75, v78, v79
    v_accvgpr_write_b32 a36, v72
    v_accvgpr_write_b32 a37, v73
    v_accvgpr_write_b32 a38, v74
    v_accvgpr_write_b32 a39, v75
    v_pk_mul_f32 v[80:81], v[80:81], s[40:41]
    v_pk_mul_f32 v[82:83], v[82:83], s[40:41]
    v_pk_mul_f32 v[84:85], v[84:85], s[40:41]
    v_pk_mul_f32 v[86:87], v[86:87], s[40:41]
    v_mfma_f32_16x16x32_bf16 v[40:43], a[120:123], a[24:27], v[40:43]
    s_xor_b32 s32, s64, s65
    s_or_b32 s33, s32, 4096
    s_lshl_b32 s55, s2, 2
    s_add_u32 s55, s55, s24
    v_cvt_pk_bf16_f32 v80, v80, v81
    v_cvt_pk_bf16_f32 v81, v82, v83
    v_cvt_pk_bf16_f32 v82, v84, v85
    v_cvt_pk_bf16_f32 v83, v86, v87
    v_accvgpr_write_b32 a40, v80
    v_accvgpr_write_b32 a41, v81
    v_accvgpr_write_b32 a42, v82
    v_accvgpr_write_b32 a43, v83
    v_pk_mul_f32 v[88:89], v[88:89], s[40:41]
    v_pk_mul_f32 v[90:91], v[90:91], s[40:41]
    v_pk_mul_f32 v[92:93], v[92:93], s[40:41]
    v_pk_mul_f32 v[94:95], v[94:95], s[40:41]
    v_mfma_f32_16x16x32_bf16 v[40:43], a[124:127], a[28:31], v[40:43]
    s_lshl_b32 s55, s55, 13
    v_and_b32 v254, 3, v247
    v_cmp_eq_u32 vcc, 0, v254
    v_mov_b32 v254, 0x3f803f80
    s_nop 0
    v_cndmask_b32 v254, 0, v254, vcc
    v_cvt_pk_bf16_f32 v88, v88, v89
    v_cvt_pk_bf16_f32 v89, v90, v91
    v_cvt_pk_bf16_f32 v90, v92, v93
    v_cvt_pk_bf16_f32 v91, v94, v95
    v_accvgpr_write_b32 a44, v88
    v_accvgpr_write_b32 a45, v89
    v_accvgpr_write_b32 a46, v90
    v_accvgpr_write_b32 a47, v91
    v_pk_mul_f32 v[96:97], v[96:97], s[40:41]
    v_pk_mul_f32 v[98:99], v[98:99], s[40:41]
    v_pk_mul_f32 v[100:101], v[100:101], s[40:41]
    v_pk_mul_f32 v[102:103], v[102:103], s[40:41]
    v_mfma_f32_16x16x32_bf16 v[72:75], a[112:115], a[32:35], 0
    v_accvgpr_write_b32 a204, v254
    v_accvgpr_write_b32 a205, v254
    v_accvgpr_write_b32 a206, v254
    v_cvt_pk_bf16_f32 v96, v96, v97
    v_cvt_pk_bf16_f32 v97, v98, v99
    v_cvt_pk_bf16_f32 v98, v100, v101
    v_cvt_pk_bf16_f32 v99, v102, v103
    v_accvgpr_write_b32 a48, v96
    v_accvgpr_write_b32 a49, v97
    v_accvgpr_write_b32 a50, v98
    v_accvgpr_write_b32 a51, v99
    v_pk_mul_f32 v[104:105], v[104:105], s[40:41]
    v_pk_mul_f32 v[106:107], v[106:107], s[40:41]
    v_pk_mul_f32 v[108:109], v[108:109], s[40:41]
    v_pk_mul_f32 v[110:111], v[110:111], s[40:41]
    v_mfma_f32_16x16x32_bf16 v[72:75], a[116:119], a[36:39], v[72:75]
    v_accvgpr_write_b32 a207, v254
    v_cvt_pk_bf16_f32 v104, v104, v105
    v_cvt_pk_bf16_f32 v105, v106, v107
    v_cvt_pk_bf16_f32 v106, v108, v109
    v_cvt_pk_bf16_f32 v107, v110, v111
    v_accvgpr_write_b32 a52, v104
    v_accvgpr_write_b32 a53, v105
    v_accvgpr_write_b32 a54, v106
    v_accvgpr_write_b32 a55, v107
    v_pk_mul_f32 v[112:113], v[112:113], s[40:41]
    v_pk_mul_f32 v[114:115], v[114:115], s[40:41]
    v_pk_mul_f32 v[116:117], v[116:117], s[40:41]
    v_pk_mul_f32 v[118:119], v[118:119], s[40:41]
    v_mfma_f32_16x16x32_bf16 v[72:75], a[120:123], a[40:43], v[72:75]
    v_cvt_pk_bf16_f32 v112, v112, v113
    v_cvt_pk_bf16_f32 v113, v114, v115
    v_cvt_pk_bf16_f32 v114, v116, v117
    v_cvt_pk_bf16_f32 v115, v118, v119
    v_accvgpr_write_b32 a56, v112
    v_accvgpr_write_b32 a57, v113
    v_accvgpr_write_b32 a58, v114
    v_accvgpr_write_b32 a59, v115
    v_pk_mul_f32 v[120:121], v[120:121], s[40:41]
    v_pk_mul_f32 v[122:123], v[122:123], s[40:41]
    v_pk_mul_f32 v[124:125], v[124:125], s[40:41]
    v_pk_mul_f32 v[126:127], v[126:127], s[40:41]
    v_mfma_f32_16x16x32_bf16 v[72:75], a[124:127], a[44:47], v[72:75]
    v_cvt_pk_bf16_f32 v120, v120, v121
    v_cvt_pk_bf16_f32 v121, v122, v123
    v_cvt_pk_bf16_f32 v122, v124, v125
    v_cvt_pk_bf16_f32 v123, v126, v127
    v_accvgpr_write_b32 a60, v120
    v_accvgpr_write_b32 a61, v121
    v_accvgpr_write_b32 a62, v122
    v_accvgpr_write_b32 a63, v123
    v_pk_mul_f32 v[128:129], v[128:129], s[40:41]
    v_pk_mul_f32 v[130:131], v[130:131], s[40:41]
    v_pk_mul_f32 v[132:133], v[132:133], s[40:41]
    v_pk_mul_f32 v[134:135], v[134:135], s[40:41]
    v_mfma_f32_16x16x32_bf16 v[104:107], a[112:115], a[48:51], 0
    v_cvt_pk_bf16_f32 v128, v128, v129
    v_cvt_pk_bf16_f32 v129, v130, v131
    v_cvt_pk_bf16_f32 v130, v132, v133
    v_cvt_pk_bf16_f32 v131, v134, v135
    v_accvgpr_write_b32 a64, v128
    v_accvgpr_write_b32 a65, v129
    v_accvgpr_write_b32 a66, v130
    v_accvgpr_write_b32 a67, v131
    v_pk_mul_f32 v[136:137], v[136:137], s[40:41]
    v_pk_mul_f32 v[138:139], v[138:139], s[40:41]
    v_pk_mul_f32 v[140:141], v[140:141], s[40:41]
    v_pk_mul_f32 v[142:143], v[142:143], s[40:41]
    v_mfma_f32_16x16x32_bf16 v[104:107], a[116:119], a[52:55], v[104:107]
    v_cvt_pk_bf16_f32 v136, v136, v137
    v_cvt_pk_bf16_f32 v137, v138, v139
    v_cvt_pk_bf16_f32 v138, v140, v141
    v_cvt_pk_bf16_f32 v139, v142, v143
    v_accvgpr_write_b32 a68, v136
    v_accvgpr_write_b32 a69, v137
    v_accvgpr_write_b32 a70, v138
    v_accvgpr_write_b32 a71, v139
    v_pk_mul_f32 v[144:145], v[144:145], s[40:41]
    v_pk_mul_f32 v[146:147], v[146:147], s[40:41]
    v_pk_mul_f32 v[148:149], v[148:149], s[40:41]
    v_pk_mul_f32 v[150:151], v[150:151], s[40:41]
    v_mfma_f32_16x16x32_bf16 v[104:107], a[120:123], a[56:59], v[104:107]
    v_cvt_pk_bf16_f32 v144, v144, v145
    v_cvt_pk_bf16_f32 v145, v146, v147
    v_cvt_pk_bf16_f32 v146, v148, v149
    v_cvt_pk_bf16_f32 v147, v150, v151
    v_accvgpr_write_b32 a72, v144
    v_accvgpr_write_b32 a73, v145
    v_accvgpr_write_b32 a74, v146
    v_accvgpr_write_b32 a75, v147
    v_pk_mul_f32 v[152:153], v[152:153], s[40:41]
    v_pk_mul_f32 v[154:155], v[154:155], s[40:41]
    v_pk_mul_f32 v[156:157], v[156:157], s[40:41]
    v_pk_mul_f32 v[158:159], v[158:159], s[40:41]
    v_mfma_f32_16x16x32_bf16 v[104:107], a[124:127], a[60:63], v[104:107]
    v_cvt_pk_bf16_f32 v152, v152, v153
    v_cvt_pk_bf16_f32 v153, v154, v155
    v_cvt_pk_bf16_f32 v154, v156, v157
    v_cvt_pk_bf16_f32 v155, v158, v159
    v_accvgpr_write_b32 a76, v152
    v_accvgpr_write_b32 a77, v153
    v_accvgpr_write_b32 a78, v154
    v_accvgpr_write_b32 a79, v155
    v_pk_mul_f32 v[160:161], v[160:161], s[40:41]
    v_pk_mul_f32 v[162:163], v[162:163], s[40:41]
    v_pk_mul_f32 v[164:165], v[164:165], s[40:41]
    v_pk_mul_f32 v[166:167], v[166:167], s[40:41]
    v_mfma_f32_16x16x32_bf16 v[136:139], a[112:115], a[64:67], 0
    v_cvt_pk_bf16_f32 v160, v160, v161
    v_cvt_pk_bf16_f32 v161, v162, v163
    v_cvt_pk_bf16_f32 v162, v164, v165
    v_cvt_pk_bf16_f32 v163, v166, v167
    v_accvgpr_write_b32 a80, v160
    v_accvgpr_write_b32 a81, v161
    v_accvgpr_write_b32 a82, v162
    v_accvgpr_write_b32 a83, v163
    v_pk_mul_f32 v[168:169], v[168:169], s[40:41]
    v_pk_mul_f32 v[170:171], v[170:171], s[40:41]
    v_pk_mul_f32 v[172:173], v[172:173], s[40:41]
    v_pk_mul_f32 v[174:175], v[174:175], s[40:41]
    v_mfma_f32_16x16x32_bf16 v[136:139], a[116:119], a[68:71], v[136:139]
    v_cvt_pk_bf16_f32 v168, v168, v169
    v_cvt_pk_bf16_f32 v169, v170, v171
    v_cvt_pk_bf16_f32 v170, v172, v173
    v_cvt_pk_bf16_f32 v171, v174, v175
    v_accvgpr_write_b32 a84, v168
    v_accvgpr_write_b32 a85, v169
    v_accvgpr_write_b32 a86, v170
    v_accvgpr_write_b32 a87, v171
    v_pk_mul_f32 v[176:177], v[176:177], s[40:41]
    v_pk_mul_f32 v[178:179], v[178:179], s[40:41]
    v_pk_mul_f32 v[180:181], v[180:181], s[40:41]
    v_pk_mul_f32 v[182:183], v[182:183], s[40:41]
    v_mfma_f32_16x16x32_bf16 v[136:139], a[120:123], a[72:75], v[136:139]
    v_cvt_pk_bf16_f32 v176, v176, v177
    v_cvt_pk_bf16_f32 v177, v178, v179
    v_cvt_pk_bf16_f32 v178, v180, v181
    v_cvt_pk_bf16_f32 v179, v182, v183
    v_accvgpr_write_b32 a88, v176
    v_accvgpr_write_b32 a89, v177
    v_accvgpr_write_b32 a90, v178
    v_accvgpr_write_b32 a91, v179
    v_pk_mul_f32 v[184:185], v[184:185], s[40:41]
    v_pk_mul_f32 v[186:187], v[186:187], s[40:41]
    v_pk_mul_f32 v[188:189], v[188:189], s[40:41]
    v_pk_mul_f32 v[190:191], v[190:191], s[40:41]
    v_mfma_f32_16x16x32_bf16 v[136:139], a[124:127], a[76:79], v[136:139]
    v_cvt_pk_bf16_f32 v184, v184, v185
    v_cvt_pk_bf16_f32 v185, v186, v187
    v_cvt_pk_bf16_f32 v186, v188, v189
    v_cvt_pk_bf16_f32 v187, v190, v191
    v_accvgpr_write_b32 a92, v184
    v_accvgpr_write_b32 a93, v185
    v_accvgpr_write_b32 a94, v186
    v_accvgpr_write_b32 a95, v187
    v_mfma_f32_16x16x32_bf16 v[168:171], a[112:115], a[80:83], 0
    v_mfma_f32_16x16x32_bf16 v[168:171], a[116:119], a[84:87], v[168:171]
    v_mfma_f32_16x16x32_bf16 v[168:171], a[120:123], a[88:91], v[168:171]
    v_mfma_f32_16x16x32_bf16 v[168:171], a[124:127], a[92:95], v[168:171]
    v_max3_f32 v16, v16, v17, v18
    v_max_f32 v16, v16, v19
    v_max3_f32 v8, v8, v9, v10
    v_max_f32 v8, v8, v11
    v_max3_f32 v40, v40, v41, v42
    v_max_f32 v40, v40, v43
    v_max3_f32 v72, v72, v73, v74
    v_max_f32 v72, v72, v75
    v_max3_f32 v104, v104, v105, v106
    v_max_f32 v104, v104, v107
    v_max3_f32 v136, v136, v137, v138
    v_max_f32 v136, v136, v139
    v_max3_f32 v168, v168, v169, v170
    v_max_f32 v168, v168, v171
L1_m0:
    s_waitcnt lgkmcnt(0)
    v_mov_b32 v17, v16
    v_mov_b32 v9, v8
    v_mov_b32 v41, v40
    v_mov_b32 v73, v72
    v_mov_b32 v105, v104
    v_mov_b32 v137, v136
    v_mov_b32 v169, v168
    v_permlane32_swap_b32 v16, v17
    v_permlane32_swap_b32 v8, v9
    v_permlane32_swap_b32 v40, v41
    v_permlane32_swap_b32 v72, v73
    v_permlane32_swap_b32 v104, v105
    v_permlane32_swap_b32 v136, v137
    v_permlane32_swap_b32 v168, v169
    v_max_f32 v16, v16, v17
    v_mov_b32 v17, v16
    v_max_f32 v8, v8, v9
    v_mov_b32 v9, v8
    v_max_f32 v40, v40, v41
    v_mov_b32 v41, v40
    v_max_f32 v72, v72, v73
    v_mov_b32 v73, v72
    v_max_f32 v104, v104, v105
    v_mov_b32 v105, v104
    v_max_f32 v136, v136, v137
    v_mov_b32 v137, v136
    v_max_f32 v168, v168, v169
    v_mov_b32 v169, v168
    v_permlane16_swap_b32 v16, v17
    v_permlane16_swap_b32 v8, v9
    v_permlane16_swap_b32 v40, v41
    v_permlane16_swap_b32 v72, v73
    v_permlane16_swap_b32 v104, v105
    v_permlane16_swap_b32 v136, v137
    v_permlane16_swap_b32 v168, v169
    v_max_f32 v16, v16, v17
    v_max_f32 v8, v8, v9
    v_max_f32 v40, v40, v41
    v_max_f32 v72, v72, v73
    v_max_f32 v104, v104, v105
    v_max_f32 v136, v136, v137
    v_max_f32 v168, v168, v169
    v_sub_f32 v216, 0, v16
    v_sub_f32 v217, 0, v16
    v_sub_f32 v218, 0, v16
    v_sub_f32 v219, 0, v16
    v_sub_f32 v192, 0, v8
    v_sub_f32 v193, 0, v8
    v_sub_f32 v194, 0, v8
    v_sub_f32 v195, 0, v8
    v_sub_f32 v196, 0, v40
    v_sub_f32 v197, 0, v40
    v_sub_f32 v198, 0, v40
    v_sub_f32 v199, 0, v40
    v_sub_f32 v200, 0, v72
    v_sub_f32 v201, 0, v72
    v_sub_f32 v202, 0, v72
    v_sub_f32 v203, 0, v72
    v_sub_f32 v204, 0, v104
    v_sub_f32 v205, 0, v104
    v_sub_f32 v206, 0, v104
    v_sub_f32 v207, 0, v104
    v_sub_f32 v208, 0, v136
    v_sub_f32 v209, 0, v136
    v_sub_f32 v210, 0, v136
    v_sub_f32 v211, 0, v136
    v_sub_f32 v212, 0, v168
    v_sub_f32 v213, 0, v168
    v_sub_f32 v214, 0, v168
    v_sub_f32 v215, 0, v168
    s_mov_b32 s29, 0
    s_mov_b32 s39, 65536
    v_mfma_f32_16x16x32_bf16 v[220:223], a[112:115], a[96:99], v[216:219]
    v_mfma_f32_16x16x32_bf16 v[220:223], a[116:119], a[100:103], v[220:223]
    v_mfma_f32_16x16x32_bf16 v[220:223], a[120:123], a[104:107], v[220:223]
    v_mfma_f32_16x16x32_bf16 v[220:223], a[124:127], a[108:111], v[220:223]
    v_mfma_f32_16x16x32_bf16 v[224:227], a[128:131], a[96:99], v[216:219]
    v_mfma_f32_16x16x32_bf16 v[224:227], a[132:135], a[100:103], v[224:227]
    v_mfma_f32_16x16x32_bf16 v[224:227], a[136:139], a[104:107], v[224:227]
    v_mfma_f32_16x16x32_bf16 v[224:227], a[140:143], a[108:111], v[224:227]
    v_mfma_f32_16x16x32_bf16 v[228:231], a[112:115], a[0:3], v[192:195]
    s_nop 2
    v_exp_f32 v220, v220
    v_mfma_f32_16x16x32_bf16 v[228:231], a[116:119], a[4:7], v[228:231]
    v_exp_f32 v221, v221
    v_mfma_f32_16x16x32_bf16 v[228:231], a[120:123], a[8:11], v[228:231]
    v_exp_f32 v222, v222
    v_mfma_f32_16x16x32_bf16 v[228:231], a[124:127], a[12:15], v[228:231]
    v_exp_f32 v223, v223
    v_cvt_pk_bf16_f32 v236, v220, v221
    v_cvt_pk_bf16_f32 v237, v222, v223
    v_mfma_f32_16x16x32_bf16 v[232:235], a[128:131], a[0:3], v[192:195]
    v_exp_f32 v224, v224
    v_mfma_f32_16x16x32_bf16 v[232:235], a[132:135], a[4:7], v[232:235]
    v_exp_f32 v225, v225
    v_mfma_f32_16x16x32_bf16 v[232:235], a[136:139], a[8:11], v[232:235]
    v_exp_f32 v226, v226
    v_mfma_f32_16x16x32_bf16 v[232:235], a[140:143], a[12:15], v[232:235]
    v_exp_f32 v227, v227
    v_cvt_pk_bf16_f32 v238, v224, v225
    v_cvt_pk_bf16_f32 v239, v226, v227
    v_mfma_f32_16x16x32_bf16 v[220:223], a[112:115], a[16:19], v[196:199]
    v_exp_f32 v228, v228
    v_mfma_f32_16x16x32_bf16 v[220:223], a[116:119], a[20:23], v[220:223]
    v_exp_f32 v229, v229
    v_mfma_f32_16x16x32_bf16 v[220:223], a[120:123], a[24:27], v[220:223]
    v_exp_f32 v230, v230
    v_mfma_f32_16x16x32_bf16 v[220:223], a[124:127], a[28:31], v[220:223]
    v_exp_f32 v231, v231
    v_mfma_f32_16x16x32_bf16 a[208:211], a[144:147], v[236:239], 0
    v_cvt_pk_bf16_f32 v240, v228, v229
    v_mfma_f32_16x16x32_bf16 a[212:215], a[148:151], v[236:239], 0
    v_cvt_pk_bf16_f32 v241, v230, v231
    v_mfma_f32_16x16x32_bf16 a[216:219], a[152:155], v[236:239], 0
    v_mfma_f32_16x16x32_bf16 a[220:223], a[156:159], v[236:239], 0
    v_mfma_f32_16x16x32_bf16 v[224:227], a[128:131], a[16:19], v[196:199]
    v_exp_f32 v232, v232
    v_mfma_f32_16x16x32_bf16 v[224:227], a[132:135], a[20:23], v[224:227]
    v_exp_f32 v233, v233
    v_mfma_f32_16x16x32_bf16 v[224:227], a[136:139], a[24:27], v[224:227]
    v_exp_f32 v234, v234
    v_mfma_f32_16x16x32_bf16 v[224:227], a[140:143], a[28:31], v[224:227]
    v_exp_f32 v235, v235
    v_mfma_f32_16x16x32_bf16 a[224:227], a[160:163], v[236:239], 0
    v_cvt_pk_bf16_f32 v242, v232, v233
    v_mfma_f32_16x16x32_bf16 a[228:231], a[164:167], v[236:239], 0
    v_cvt_pk_bf16_f32 v243, v234, v235
    v_mfma_f32_16x16x32_bf16 a[232:235], a[168:171], v[236:239], 0
    v_mfma_f32_16x16x32_bf16 a[236:239], a[172:175], v[236:239], 0
    v_mfma_f32_16x16x32_bf16 a[200:203], a[204:207], v[236:239], 0
    s_waitcnt vmcnt(8)
    s_barrier
    v_mfma_f32_16x16x32_bf16 v[228:231], a[112:115], a[32:35], v[200:203]
    v_exp_f32 v220, v220
    v_mfma_f32_16x16x32_bf16 v[228:231], a[116:119], a[36:39], v[228:231]
    v_exp_f32 v221, v221
    v_mfma_f32_16x16x32_bf16 v[228:231], a[120:123], a[40:43], v[228:231]
    v_exp_f32 v222, v222
    v_mfma_f32_16x16x32_bf16 v[228:231], a[124:127], a[44:47], v[228:231]
    v_exp_f32 v223, v223
    v_mfma_f32_16x16x32_bf16 v[0:3], a[144:147], v[240:243], 0
    v_cvt_pk_bf16_f32 v236, v220, v221
    s_add_u32 m0, s37, s29
    v_mfma_f32_16x16x32_bf16 v[4:7], a[148:151], v[240:243], 0
    v_cvt_pk_bf16_f32 v237, v222, v223
    v_mfma_f32_16x16x32_bf16 v[8:11], a[152:155], v[240:243], 0
    buffer_load_dwordx4 v248, s[16:19], s32 offen offset:0 nt lds
    v_mfma_f32_16x16x32_bf16 v[12:15], a[156:159], v[240:243], 0
    buffer_load_dwordx4 v249, s[16:19], s32 offen offset:1024 nt lds
    v_mfma_f32_16x16x32_bf16 v[232:235], a[128:131], a[32:35], v[200:203]
    v_exp_f32 v224, v224
    v_mfma_f32_16x16x32_bf16 v[232:235], a[132:135], a[36:39], v[232:235]
    v_exp_f32 v225, v225
    v_mfma_f32_16x16x32_bf16 v[232:235], a[136:139], a[40:43], v[232:235]
    v_exp_f32 v226, v226
    v_mfma_f32_16x16x32_bf16 v[232:235], a[140:143], a[44:47], v[232:235]
    v_exp_f32 v227, v227
    v_mfma_f32_16x16x32_bf16 v[16:19], a[160:163], v[240:243], 0
    v_cvt_pk_bf16_f32 v238, v224, v225
    v_mfma_f32_16x16x32_bf16 v[20:23], a[164:167], v[240:243], 0
    v_cvt_pk_bf16_f32 v239, v226, v227
    v_mfma_f32_16x16x32_bf16 v[24:27], a[168:171], v[240:243], 0
    buffer_load_dwordx4 v248, s[16:19], s32 offen offset:2048 nt lds
    v_mfma_f32_16x16x32_bf16 v[28:31], a[172:175], v[240:243], 0
    buffer_load_dwordx4 v249, s[16:19], s32 offen offset:3072 nt lds
    s_add_u32 m0, m0, 4096
    v_mfma_f32_16x16x32_bf16 a[176:179], a[204:207], v[240:243], 0
    buffer_load_dwordx4 v248, s[16:19], s33 offen offset:0 nt lds
    v_mfma_f32_16x16x32_bf16 v[220:223], a[112:115], a[48:51], v[204:207]
    v_exp_f32 v228, v228
    v_mfma_f32_16x16x32_bf16 v[220:223], a[116:119], a[52:55], v[220:223]
    v_exp_f32 v229, v229
    v_mfma_f32_16x16x32_bf16 v[220:223], a[120:123], a[56:59], v[220:223]
    v_exp_f32 v230, v230
    v_mfma_f32_16x16x32_bf16 v[220:223], a[124:127], a[60:63], v[220:223]
    v_exp_f32 v231, v231
    v_mfma_f32_16x16x32_bf16 v[32:35], a[144:147], v[236:239], 0
    v_cvt_pk_bf16_f32 v240, v228, v229
    v_mfma_f32_16x16x32_bf16 v[36:39], a[148:151], v[236:239], 0
    v_cvt_pk_bf16_f32 v241, v230, v231
    v_mfma_f32_16x16x32_bf16 v[40:43], a[152:155], v[236:239], 0
    buffer_load_dwordx4 v249, s[16:19], s33 offen offset:1024 nt lds
    v_mfma_f32_16x16x32_bf16 v[44:47], a[156:159], v[236:239], 0
    buffer_load_dwordx4 v248, s[16:19], s33 offen offset:2048 nt lds
    v_mfma_f32_16x16x32_bf16 v[224:227], a[128:131], a[48:51], v[204:207]
    v_exp_f32 v232, v232
    v_mfma_f32_16x16x32_bf16 v[224:227], a[132:135], a[52:55], v[224:227]
    v_exp_f32 v233, v233
    v_mfma_f32_16x16x32_bf16 v[224:227], a[136:139], a[56:59], v[224:227]
    v_exp_f32 v234, v234
    v_mfma_f32_16x16x32_bf16 v[224:227], a[140:143], a[60:63], v[224:227]
    v_exp_f32 v235, v235
    v_mfma_f32_16x16x32_bf16 v[48:51], a[160:163], v[236:239], 0
    v_cvt_pk_bf16_f32 v242, v232, v233
    v_mfma_f32_16x16x32_bf16 v[52:55], a[164:167], v[236:239], 0
    v_cvt_pk_bf16_f32 v243, v234, v235
    v_mfma_f32_16x16x32_bf16 v[56:59], a[168:171], v[236:239], 0
    buffer_load_dwordx4 v249, s[16:19], s33 offen offset:3072 nt lds
    v_mfma_f32_16x16x32_bf16 v[60:63], a[172:175], v[236:239], 0
    s_add_u32 s64, s64, 8192
    s_xor_b32 s32, s64, s65
    v_mfma_f32_16x16x32_bf16 a[180:183], a[204:207], v[236:239], 0
    s_or_b32 s33, s32, 4096
    s_add_u32 s29, s29, 32768
    v_mfma_f32_16x16x32_bf16 v[228:231], a[112:115], a[64:67], v[208:211]
    v_exp_f32 v220, v220
    v_mfma_f32_16x16x32_bf16 v[228:231], a[116:119], a[68:71], v[228:231]
    v_exp_f32 v221, v221
    v_mfma_f32_16x16x32_bf16 v[228:231], a[120:123], a[72:75], v[228:231]
    v_exp_f32 v222, v222
    v_mfma_f32_16x16x32_bf16 v[228:231], a[124:127], a[76:79], v[228:231]
    v_exp_f32 v223, v223
    v_mfma_f32_16x16x32_bf16 v[64:67], a[144:147], v[240:243], 0
    v_cvt_pk_bf16_f32 v236, v220, v221
    s_add_u32 s44, s39, 32768
    v_mfma_f32_16x16x32_bf16 v[68:71], a[148:151], v[240:243], 0
    v_cvt_pk_bf16_f32 v237, v222, v223
    v_mfma_f32_16x16x32_bf16 v[72:75], a[152:155], v[240:243], 0
    s_cmp_eq_u32 s44, 163840
    s_cselect_b32 s44, 0, s44
    v_mfma_f32_16x16x32_bf16 v[76:79], a[156:159], v[240:243], 0
    s_cmp_eq_u32 s29, 163840
    s_cselect_b32 s29, 0, s29
    v_mfma_f32_16x16x32_bf16 v[232:235], a[128:131], a[64:67], v[208:211]
    v_exp_f32 v224, v224
    v_mfma_f32_16x16x32_bf16 v[232:235], a[132:135], a[68:71], v[232:235]
    v_exp_f32 v225, v225
    v_mfma_f32_16x16x32_bf16 v[232:235], a[136:139], a[72:75], v[232:235]
    v_exp_f32 v226, v226
    v_mfma_f32_16x16x32_bf16 v[232:235], a[140:143], a[76:79], v[232:235]
    v_exp_f32 v227, v227
    v_mfma_f32_16x16x32_bf16 v[80:83], a[160:163], v[240:243], 0
    v_cvt_pk_bf16_f32 v238, v224, v225
    s_sub_u32 s34, s44, s39
    v_mfma_f32_16x16x32_bf16 v[84:87], a[164:167], v[240:243], 0
    v_cvt_pk_bf16_f32 v239, v226, v227
    s_mov_b32 s39, s44
    v_mfma_f32_16x16x32_bf16 v[88:91], a[168:171], v[240:243], 0
    v_mfma_f32_16x16x32_bf16 v[92:95], a[172:175], v[240:243], 0
    v_mfma_f32_16x16x32_bf16 a[184:187], a[204:207], v[240:243], 0
    v_mfma_f32_16x16x32_bf16 v[220:223], a[112:115], a[80:83], v[212:215]
    v_exp_f32 v228, v228
    v_mfma_f32_16x16x32_bf16 v[220:223], a[116:119], a[84:87], v[220:223]
    v_exp_f32 v229, v229
    v_mfma_f32_16x16x32_bf16 v[220:223], a[120:123], a[88:91], v[220:223]
    v_exp_f32 v230, v230
    v_mfma_f32_16x16x32_bf16 v[220:223], a[124:127], a[92:95], v[220:223]
    v_exp_f32 v231, v231
    v_mfma_f32_16x16x32_bf16 v[96:99], a[144:147], v[236:239], 0
    v_cvt_pk_bf16_f32 v240, v228, v229
    v_add_u32 v244, s34, v244
    v_mfma_f32_16x16x32_bf16 v[100:103], a[148:151], v[236:239], 0
    v_cvt_pk_bf16_f32 v241, v230, v231
    v_mfma_f32_16x16x32_bf16 v[104:107], a[152:155], v[236:239], 0
    v_mfma_f32_16x16x32_bf16 v[108:111], a[156:159], v[236:239], 0
    v_mfma_f32_16x16x32_bf16 v[224:227], a[128:131], a[80:83], v[212:215]
    v_exp_f32 v232, v232
    v_mfma_f32_16x16x32_bf16 v[224:227], a[132:135], a[84:87], v[224:227]
    v_exp_f32 v233, v233
    v_mfma_f32_16x16x32_bf16 v[224:227], a[136:139], a[88:91], v[224:227]
    v_exp_f32 v234, v234
    v_mfma_f32_16x16x32_bf16 v[224:227], a[140:143], a[92:95], v[224:227]
    v_exp_f32 v235, v235
    v_mfma_f32_16x16x32_bf16 v[112:115], a[160:163], v[236:239], 0
    v_cvt_pk_bf16_f32 v242, v232, v233
    v_mfma_f32_16x16x32_bf16 v[116:119], a[164:167], v[236:239], 0
    v_cvt_pk_bf16_f32 v243, v234, v235
    v_mfma_f32_16x16x32_bf16 v[120:123], a[168:171], v[236:239], 0
    v_mfma_f32_16x16x32_bf16 v[124:127], a[172:175], v[236:239], 0
    v_mfma_f32_16x16x32_bf16 a[188:191], a[204:207], v[236:239], 0
    ds_read_b128 a[112:115], v244 offset:0
    ds_read_b128 a[116:119], v244 offset:256
    ds_read_b128 a[120:123], v244 offset:512
    ds_read_b128 a[124:127], v244 offset:768
    ds_read_b128 a[128:131], v244 offset:4096
    ds_read_b128 a[132:135], v244 offset:4352
    ds_read_b128 a[136:139], v244 offset:4608
    ds_read_b128 a[140:143], v244 offset:4864
    s_waitcnt lgkmcnt(0)
    v_mfma_f32_16x16x32_bf16 v[228:231], a[112:115], a[96:99], v[216:219]
    v_exp_f32 v220, v220
    v_mfma_f32_16x16x32_bf16 v[228:231], a[116:119], a[100:103], v[228:231]
    v_exp_f32 v221, v221
    v_mfma_f32_16x16x32_bf16 v[228:231], a[120:123], a[104:107], v[228:231]
    v_exp_f32 v222, v222
    v_mfma_f32_16x16x32_bf16 v[228:231], a[124:127], a[108:111], v[228:231]
    v_exp_f32 v223, v223
    v_mfma_f32_16x16x32_bf16 v[128:131], a[144:147], v[240:243], 0
    v_cvt_pk_bf16_f32 v236, v220, v221
    v_mfma_f32_16x16x32_bf16 v[132:135], a[148:151], v[240:243], 0
    v_cvt_pk_bf16_f32 v237, v222, v223
    v_mfma_f32_16x16x32_bf16 v[136:139], a[152:155], v[240:243], 0
    v_mfma_f32_16x16x32_bf16 v[140:143], a[156:159], v[240:243], 0
    v_mfma_f32_16x16x32_bf16 v[232:235], a[128:131], a[96:99], v[216:219]
    v_exp_f32 v224, v224
    v_mfma_f32_16x16x32_bf16 v[232:235], a[132:135], a[100:103], v[232:235]
    v_exp_f32 v225, v225
    v_mfma_f32_16x16x32_bf16 v[232:235], a[136:139], a[104:107], v[232:235]
    v_exp_f32 v226, v226
    v_mfma_f32_16x16x32_bf16 v[232:235], a[140:143], a[108:111], v[232:235]
    v_exp_f32 v227, v227
    v_mfma_f32_16x16x32_bf16 v[144:147], a[160:163], v[240:243], 0
    v_cvt_pk_bf16_f32 v238, v224, v225
    v_add_u32 v245, s34, v245
    v_mfma_f32_16x16x32_bf16 v[148:151], a[164:167], v[240:243], 0
    v_cvt_pk_bf16_f32 v239, v226, v227
    v_add_u32 v246, s34, v246
    v_mfma_f32_16x16x32_bf16 v[152:155], a[168:171], v[240:243], 0
    v_mfma_f32_16x16x32_bf16 v[156:159], a[172:175], v[240:243], 0
    v_mfma_f32_16x16x32_bf16 a[192:195], a[204:207], v[240:243], 0
    v_mfma_f32_16x16x32_bf16 v[220:223], a[112:115], a[0:3], v[192:195]
    v_exp_f32 v228, v228
    v_mfma_f32_16x16x32_bf16 v[220:223], a[116:119], a[4:7], v[220:223]
    v_exp_f32 v229, v229
    v_mfma_f32_16x16x32_bf16 v[220:223], a[120:123], a[8:11], v[220:223]
    v_exp_f32 v230, v230
    v_mfma_f32_16x16x32_bf16 v[220:223], a[124:127], a[12:15], v[220:223]
    v_exp_f32 v231, v231
    v_mfma_f32_16x16x32_bf16 v[160:163], a[144:147], v[236:239], 0
    v_cvt_pk_bf16_f32 v240, v228, v229
    v_mfma_f32_16x16x32_bf16 v[164:167], a[148:151], v[236:239], 0
    v_cvt_pk_bf16_f32 v241, v230, v231
    v_mfma_f32_16x16x32_bf16 v[168:171], a[152:155], v[236:239], 0
    v_mfma_f32_16x16x32_bf16 v[172:175], a[156:159], v[236:239], 0
    v_mfma_f32_16x16x32_bf16 v[224:227], a[128:131], a[0:3], v[192:195]
    v_exp_f32 v232, v232
    v_mfma_f32_16x16x32_bf16 v[224:227], a[132:135], a[4:7], v[224:227]
    v_exp_f32 v233, v233
    v_mfma_f32_16x16x32_bf16 v[224:227], a[136:139], a[8:11], v[224:227]
    v_exp_f32 v234, v234
    v_mfma_f32_16x16x32_bf16 v[224:227], a[140:143], a[12:15], v[224:227]
    v_exp_f32 v235, v235
    v_mfma_f32_16x16x32_bf16 v[176:179], a[160:163], v[236:239], 0
    v_cvt_pk_bf16_f32 v242, v232, v233
    v_mfma_f32_16x16x32_bf16 v[180:183], a[164:167], v[236:239], 0
    v_cvt_pk_bf16_f32 v243, v234, v235
    v_mfma_f32_16x16x32_bf16 v[184:187], a[168:171], v[236:239], 0
    v_mfma_f32_16x16x32_bf16 v[188:191], a[172:175], v[236:239], 0
    v_mfma_f32_16x16x32_bf16 a[196:199], a[204:207], v[236:239], 0
    v_mfma_f32_16x16x32_bf16 v[228:231], a[112:115], a[16:19], v[196:199]
    v_exp_f32 v220, v220
    v_mfma_f32_16x16x32_bf16 v[228:231], a[116:119], a[20:23], v[228:231]
    v_exp_f32 v221, v221
    v_mfma_f32_16x16x32_bf16 v[228:231], a[120:123], a[24:27], v[228:231]
    v_exp_f32 v222, v222
    v_mfma_f32_16x16x32_bf16 v[228:231], a[124:127], a[28:31], v[228:231]
    v_exp_f32 v223, v223
    ds_read_b64_tr_b16 a[144:145], v245 offset:0
    ds_read_b64_tr_b16 a[146:147], v245 offset:4096
    ds_read_b64_tr_b16 a[148:149], v246 offset:0
    ds_read_b64_tr_b16 a[150:151], v246 offset:4096
    ds_read_b64_tr_b16 a[152:153], v245 offset:256
    ds_read_b64_tr_b16 a[154:155], v245 offset:4352
    ds_read_b64_tr_b16 a[156:157], v246 offset:256
    ds_read_b64_tr_b16 a[158:159], v246 offset:4352
    ds_read_b64_tr_b16 a[160:161], v245 offset:512
    ds_read_b64_tr_b16 a[162:163], v245 offset:4608
    ds_read_b64_tr_b16 a[164:165], v246 offset:512
    ds_read_b64_tr_b16 a[166:167], v246 offset:4608
    ds_read_b64_tr_b16 a[168:169], v245 offset:768
    ds_read_b64_tr_b16 a[170:171], v245 offset:4864
    ds_read_b64_tr_b16 a[172:173], v246 offset:768
    ds_read_b64_tr_b16 a[174:175], v246 offset:4864
    s_waitcnt lgkmcnt(0)
    v_mfma_f32_16x16x32_bf16 a[208:211], a[144:147], v[240:243], a[208:211]
    v_cvt_pk_bf16_f32 v236, v220, v221
    v_mfma_f32_16x16x32_bf16 a[212:215], a[148:151], v[240:243], a[212:215]
    v_cvt_pk_bf16_f32 v237, v222, v223
    v_mfma_f32_16x16x32_bf16 a[216:219], a[152:155], v[240:243], a[216:219]
    v_mfma_f32_16x16x32_bf16 a[220:223], a[156:159], v[240:243], a[220:223]
    v_mfma_f32_16x16x32_bf16 v[232:235], a[128:131], a[16:19], v[196:199]
    v_exp_f32 v224, v224
    v_mfma_f32_16x16x32_bf16 v[232:235], a[132:135], a[20:23], v[232:235]
    v_exp_f32 v225, v225
    v_mfma_f32_16x16x32_bf16 v[232:235], a[136:139], a[24:27], v[232:235]
    v_exp_f32 v226, v226
    v_mfma_f32_16x16x32_bf16 v[232:235], a[140:143], a[28:31], v[232:235]
    v_exp_f32 v227, v227
    v_mfma_f32_16x16x32_bf16 a[224:227], a[160:163], v[240:243], a[224:227]
    v_cvt_pk_bf16_f32 v238, v224, v225
    v_mfma_f32_16x16x32_bf16 a[228:231], a[164:167], v[240:243], a[228:231]
    v_cvt_pk_bf16_f32 v239, v226, v227
    v_mfma_f32_16x16x32_bf16 a[232:235], a[168:171], v[240:243], a[232:235]
    v_mfma_f32_16x16x32_bf16 a[236:239], a[172:175], v[240:243], a[236:239]
    v_mfma_f32_16x16x32_bf16 a[200:203], a[204:207], v[240:243], a[200:203]
    s_waitcnt vmcnt(8)
    s_barrier
    v_mfma_f32_16x16x32_bf16 v[220:223], a[112:115], a[32:35], v[200:203]
    v_exp_f32 v228, v228
    v_mfma_f32_16x16x32_bf16 v[220:223], a[116:119], a[36:39], v[220:223]
    v_exp_f32 v229, v229
    v_mfma_f32_16x16x32_bf16 v[220:223], a[120:123], a[40:43], v[220:223]
    v_exp_f32 v230, v230
    v_mfma_f32_16x16x32_bf16 v[220:223], a[124:127], a[44:47], v[220:223]
    v_exp_f32 v231, v231
    v_mfma_f32_16x16x32_bf16 v[0:3], a[144:147], v[236:239], v[0:3]
    v_cvt_pk_bf16_f32 v240, v228, v229
    s_add_u32 m0, s37, s29
    v_mfma_f32_16x16x32_bf16 v[4:7], a[148:151], v[236:239], v[4:7]
    v_cvt_pk_bf16_f32 v241, v230, v231
    v_mfma_f32_16x16x32_bf16 v[8:11], a[152:155], v[236:239], v[8:11]
    buffer_load_dwordx4 v248, s[16:19], s32 offen offset:0 nt lds
    v_mfma_f32_16x16x32_bf16 v[12:15], a[156:159], v[236:239], v[12:15]
    buffer_load_dwordx4 v249, s[16:19], s32 offen offset:1024 nt lds
    v_mfma_f32_16x16x32_bf16 v[224:227], a[128:131], a[32:35], v[200:203]
    v_exp_f32 v232, v232
    v_mfma_f32_16x16x32_bf16 v[224:227], a[132:135], a[36:39], v[224:227]
    v_exp_f32 v233, v233
    v_mfma_f32_16x16x32_bf16 v[224:227], a[136:139], a[40:43], v[224:227]
    v_exp_f32 v234, v234
    v_mfma_f32_16x16x32_bf16 v[224:227], a[140:143], a[44:47], v[224:227]
    v_exp_f32 v235, v235
    v_mfma_f32_16x16x32_bf16 v[16:19], a[160:163], v[236:239], v[16:19]
    v_cvt_pk_bf16_f32 v242, v232, v233
    v_mfma_f32_16x16x32_bf16 v[20:23], a[164:167], v[236:239], v[20:23]
    v_cvt_pk_bf16_f32 v243, v234, v235
    v_mfma_f32_16x16x32_bf16 v[24:27], a[168:171], v[236:239], v[24:27]
    buffer_load_dwordx4 v248, s[16:19], s32 offen offset:2048 nt lds
    v_mfma_f32_16x16x32_bf16 v[28:31], a[172:175], v[236:239], v[28:31]
    buffer_load_dwordx4 v249, s[16:19], s32 offen offset:3072 nt lds
    s_add_u32 m0, m0, 4096
    v_mfma_f32_16x16x32_bf16 a[176:179], a[204:207], v[236:239], a[176:179]
    buffer_load_dwordx4 v248, s[16:19], s33 offen offset:0 nt lds
    v_mfma_f32_16x16x32_bf16 v[228:231], a[112:115], a[48:51], v[204:207]
    v_exp_f32 v220, v220
    v_mfma_f32_16x16x32_bf16 v[228:231], a[116:119], a[52:55], v[228:231]
    v_exp_f32 v221, v221
    v_mfma_f32_16x16x32_bf16 v[228:231], a[120:123], a[56:59], v[228:231]
    v_exp_f32 v222, v222
    v_mfma_f32_16x16x32_bf16 v[228:231], a[124:127], a[60:63], v[228:231]
    v_exp_f32 v223, v223
    v_mfma_f32_16x16x32_bf16 v[32:35], a[144:147], v[240:243], v[32:35]
    v_cvt_pk_bf16_f32 v236, v220, v221
    v_mfma_f32_16x16x32_bf16 v[36:39], a[148:151], v[240:243], v[36:39]
    v_cvt_pk_bf16_f32 v237, v222, v223
    v_mfma_f32_16x16x32_bf16 v[40:43], a[152:155], v[240:243], v[40:43]
    buffer_load_dwordx4 v249, s[16:19], s33 offen offset:1024 nt lds
    v_mfma_f32_16x16x32_bf16 v[44:47], a[156:159], v[240:243], v[44:47]
    buffer_load_dwordx4 v248, s[16:19], s33 offen offset:2048 nt lds
    v_mfma_f32_16x16x32_bf16 v[232:235], a[128:131], a[48:51], v[204:207]
    v_exp_f32 v224, v224
    v_mfma_f32_16x16x32_bf16 v[232:235], a[132:135], a[52:55], v[232:235]
    v_exp_f32 v225, v225
    v_mfma_f32_16x16x32_bf16 v[232:235], a[136:139], a[56:59], v[232:235]
    v_exp_f32 v226, v226
    v_mfma_f32_16x16x32_bf16 v[232:235], a[140:143], a[60:63], v[232:235]
    v_exp_f32 v227, v227
    v_mfma_f32_16x16x32_bf16 v[48:51], a[160:163], v[240:243], v[48:51]
    v_cvt_pk_bf16_f32 v238, v224, v225
    v_mfma_f32_16x16x32_bf16 v[52:55], a[164:167], v[240:243], v[52:55]
    v_cvt_pk_bf16_f32 v239, v226, v227
    v_mfma_f32_16x16x32_bf16 v[56:59], a[168:171], v[240:243], v[56:59]
    buffer_load_dwordx4 v249, s[16:19], s33 offen offset:3072 nt lds
    v_mfma_f32_16x16x32_bf16 v[60:63], a[172:175], v[240:243], v[60:63]
    s_add_u32 s64, s64, 8192
    s_xor_b32 s32, s64, s65
    v_mfma_f32_16x16x32_bf16 a[180:183], a[204:207], v[240:243], a[180:183]
    s_or_b32 s33, s32, 4096
    s_add_u32 s29, s29, 32768
    v_mfma_f32_16x16x32_bf16 v[220:223], a[112:115], a[64:67], v[208:211]
    v_exp_f32 v228, v228
    v_mfma_f32_16x16x32_bf16 v[220:223], a[116:119], a[68:71], v[220:223]
    v_exp_f32 v229, v229
    v_mfma_f32_16x16x32_bf16 v[220:223], a[120:123], a[72:75], v[220:223]
    v_exp_f32 v230, v230
    v_mfma_f32_16x16x32_bf16 v[220:223], a[124:127], a[76:79], v[220:223]
    v_exp_f32 v231, v231
    v_mfma_f32_16x16x32_bf16 v[64:67], a[144:147], v[236:239], v[64:67]
    v_cvt_pk_bf16_f32 v240, v228, v229
    s_add_u32 s44, s39, 32768
    v_mfma_f32_16x16x32_bf16 v[68:71], a[148:151], v[236:239], v[68:71]
    v_cvt_pk_bf16_f32 v241, v230, v231
    v_mfma_f32_16x16x32_bf16 v[72:75], a[152:155], v[236:239], v[72:75]
    s_cmp_eq_u32 s44, 163840
    s_cselect_b32 s44, 0, s44
    v_mfma_f32_16x16x32_bf16 v[76:79], a[156:159], v[236:239], v[76:79]
    s_cmp_eq_u32 s29, 163840
    s_cselect_b32 s29, 0, s29
    v_mfma_f32_16x16x32_bf16 v[224:227], a[128:131], a[64:67], v[208:211]
    v_exp_f32 v232, v232
    v_mfma_f32_16x16x32_bf16 v[224:227], a[132:135], a[68:71], v[224:227]
    v_exp_f32 v233, v233
    v_mfma_f32_16x16x32_bf16 v[224:227], a[136:139], a[72:75], v[224:227]
    v_exp_f32 v234, v234
    v_mfma_f32_16x16x32_bf16 v[224:227], a[140:143], a[76:79], v[224:227]
    v_exp_f32 v235, v235
    v_mfma_f32_16x16x32_bf16 v[80:83], a[160:163], v[236:239], v[80:83]
    v_cvt_pk_bf16_f32 v242, v232, v233
    s_sub_u32 s34, s44, s39
    v_mfma_f32_16x16x32_bf16 v[84:87], a[164:167], v[236:239], v[84:87]
    v_cvt_pk_bf16_f32 v243, v234, v235
    s_mov_b32 s39, s44
    v_mfma_f32_16x16x32_bf16 v[88:91], a[168:171], v[236:239], v[88:91]
    v_mfma_f32_16x16x32_bf16 v[92:95], a[172:175], v[236:239], v[92:95]
    v_mfma_f32_16x16x32_bf16 a[184:187], a[204:207], v[236:239], a[184:187]
    v_mfma_f32_16x16x32_bf16 v[228:231], a[112:115], a[80:83], v[212:215]
    v_exp_f32 v220, v220
    v_mfma_f32_16x16x32_bf16 v[228:231], a[116:119], a[84:87], v[228:231]
    v_exp_f32 v221, v221
    v_mfma_f32_16x16x32_bf16 v[228:231], a[120:123], a[88:91], v[228:231]
    v_exp_f32 v222, v222
    v_mfma_f32_16x16x32_bf16 v[228:231], a[124:127], a[92:95], v[228:231]
    v_exp_f32 v223, v223
    v_mfma_f32_16x16x32_bf16 v[96:99], a[144:147], v[240:243], v[96:99]
    v_cvt_pk_bf16_f32 v236, v220, v221
    v_add_u32 v244, s34, v244
    v_mfma_f32_16x16x32_bf16 v[100:103], a[148:151], v[240:243], v[100:103]
    v_cvt_pk_bf16_f32 v237, v222, v223
    v_mfma_f32_16x16x32_bf16 v[104:107], a[152:155], v[240:243], v[104:107]
    v_mfma_f32_16x16x32_bf16 v[108:111], a[156:159], v[240:243], v[108:111]
    v_mfma_f32_16x16x32_bf16 v[232:235], a[128:131], a[80:83], v[212:215]
    v_exp_f32 v224, v224
    v_mfma_f32_16x16x32_bf16 v[232:235], a[132:135], a[84:87], v[232:235]
    v_exp_f32 v225, v225
    v_mfma_f32_16x16x32_bf16 v[232:235], a[136:139], a[88:91], v[232:235]
    v_exp_f32 v226, v226
    v_mfma_f32_16x16x32_bf16 v[232:235], a[140:143], a[92:95], v[232:235]
    v_exp_f32 v227, v227
    v_mfma_f32_16x16x32_bf16 v[112:115], a[160:163], v[240:243], v[112:115]
    v_cvt_pk_bf16_f32 v238, v224, v225
    v_mfma_f32_16x16x32_bf16 v[116:119], a[164:167], v[240:243], v[116:119]
    v_cvt_pk_bf16_f32 v239, v226, v227
    v_mfma_f32_16x16x32_bf16 v[120:123], a[168:171], v[240:243], v[120:123]
    v_mfma_f32_16x16x32_bf16 v[124:127], a[172:175], v[240:243], v[124:127]
    v_mfma_f32_16x16x32_bf16 a[188:191], a[204:207], v[240:243], a[188:191]
    s_cmp_lg_u32 s48, 0
    s_cbranch_scc1 L1_nb0
    v_readfirstlane_b32 s96, v253
L1_nb0:
    s_mov_b32 s28, 6
.p2align 6
L1_a0:
    ds_read_b128 a[112:115], v244 offset:0
    ds_read_b128 a[116:119], v244 offset:256
    ds_read_b128 a[120:123], v244 offset:512
    ds_read_b128 a[124:127], v244 offset:768
    ds_read_b128 a[128:131], v244 offset:4096
    ds_read_b128 a[132:135], v244 offset:4352
    ds_read_b128 a[136:139], v244 offset:4608
    ds_read_b128 a[140:143], v244 offset:4864
    s_waitcnt lgkmcnt(0)
    v_mfma_f32_16x16x32_bf16 v[220:223], a[112:115], a[96:99], v[216:219]
    v_exp_f32 v228, v228
    v_mfma_f32_16x16x32_bf16 v[220:223], a[116:119], a[100:103], v[220:223]
    v_exp_f32 v229, v229
    v_mfma_f32_16x16x32_bf16 v[220:223], a[120:123], a[104:107], v[220:223]
    v_exp_f32 v230, v230
    v_mfma_f32_16x16x32_bf16 v[220:223], a[124:127], a[108:111], v[220:223]
    v_exp_f32 v231, v231
    v_mfma_f32_16x16x32_bf16 v[128:131], a[144:147], v[236:239], v[128:131]
    v_cvt_pk_bf16_f32 v240, v228, v229
    v_mfma_f32_16x16x32_bf16 v[132:135], a[148:151], v[236:239], v[132:135]
    v_cvt_pk_bf16_f32 v241, v230, v231
    v_mfma_f32_16x16x32_bf16 v[136:139], a[152:155], v[236:239], v[136:139]
    v_mfma_f32_16x16x32_bf16 v[140:143], a[156:159], v[236:239], v[140:143]
    v_mfma_f32_16x16x32_bf16 v[224:227], a[128:131], a[96:99], v[216:219]
    v_exp_f32 v232, v232
    v_mfma_f32_16x16x32_bf16 v[224:227], a[132:135], a[100:103], v[224:227]
    v_exp_f32 v233, v233
    v_mfma_f32_16x16x32_bf16 v[224:227], a[136:139], a[104:107], v[224:227]
    v_exp_f32 v234, v234
    v_mfma_f32_16x16x32_bf16 v[224:227], a[140:143], a[108:111], v[224:227]
    v_exp_f32 v235, v235
    v_mfma_f32_16x16x32_bf16 v[144:147], a[160:163], v[236:239], v[144:147]
    v_cvt_pk_bf16_f32 v242, v232, v233
    v_add_u32 v245, s34, v245
    v_mfma_f32_16x16x32_bf16 v[148:151], a[164:167], v[236:239], v[148:151]
    v_cvt_pk_bf16_f32 v243, v234, v235
    v_add_u32 v246, s34, v246
    v_mfma_f32_16x16x32_bf16 v[152:155], a[168:171], v[236:239], v[152:155]
    v_mfma_f32_16x16x32_bf16 v[156:159], a[172:175], v[236:239], v[156:159]
    v_mfma_f32_16x16x32_bf16 a[192:195], a[204:207], v[236:239], a[192:195]
    v_mfma_f32_16x16x32_bf16 v[228:231], a[112:115], a[0:3], v[192:195]
    v_exp_f32 v220, v220
    v_mfma_f32_16x16x32_bf16 v[228:231], a[116:119], a[4:7], v[228:231]
    v_exp_f32 v221, v221
    v_mfma_f32_16x16x32_bf16 v[228:231], a[120:123], a[8:11], v[228:231]
    v_exp_f32 v222, v222
    v_mfma_f32_16x16x32_bf16 v[228:231], a[124:127], a[12:15], v[228:231]
    v_exp_f32 v223, v223
    v_mfma_f32_16x16x32_bf16 v[160:163], a[144:147], v[240:243], v[160:163]
    v_cvt_pk_bf16_f32 v236, v220, v221
    v_mfma_f32_16x16x32_bf16 v[164:167], a[148:151], v[240:243], v[164:167]
    v_cvt_pk_bf16_f32 v237, v222, v223
    v_mfma_f32_16x16x32_bf16 v[168:171], a[152:155], v[240:243], v[168:171]
    v_mfma_f32_16x16x32_bf16 v[172:175], a[156:159], v[240:243], v[172:175]
    v_mfma_f32_16x16x32_bf16 v[232:235], a[128:131], a[0:3], v[192:195]
    v_exp_f32 v224, v224
    v_mfma_f32_16x16x32_bf16 v[232:235], a[132:135], a[4:7], v[232:235]
    v_exp_f32 v225, v225
    v_mfma_f32_16x16x32_bf16 v[232:235], a[136:139], a[8:11], v[232:235]
    v_exp_f32 v226, v226
    v_mfma_f32_16x16x32_bf16 v[232:235], a[140:143], a[12:15], v[232:235]
    v_exp_f32 v227, v227
    v_mfma_f32_16x16x32_bf16 v[176:179], a[160:163], v[240:243], v[176:179]
    v_cvt_pk_bf16_f32 v238, v224, v225
    v_mfma_f32_16x16x32_bf16 v[180:183], a[164:167], v[240:243], v[180:183]
    v_cvt_pk_bf16_f32 v239, v226, v227
    v_mfma_f32_16x16x32_bf16 v[184:187], a[168:171], v[240:243], v[184:187]
    v_mfma_f32_16x16x32_bf16 v[188:191], a[172:175], v[240:243], v[188:191]
    v_mfma_f32_16x16x32_bf16 a[196:199], a[204:207], v[240:243], a[196:199]
    v_mfma_f32_16x16x32_bf16 v[220:223], a[112:115], a[16:19], v[196:199]
    v_exp_f32 v228, v228
    v_mfma_f32_16x16x32_bf16 v[220:223], a[116:119], a[20:23], v[220:223]
    v_exp_f32 v229, v229
    v_mfma_f32_16x16x32_bf16 v[220:223], a[120:123], a[24:27], v[220:223]
    v_exp_f32 v230, v230
    v_mfma_f32_16x16x32_bf16 v[220:223], a[124:127], a[28:31], v[220:223]
    v_exp_f32 v231, v231
    ds_read_b64_tr_b16 a[144:145], v245 offset:0
    ds_read_b64_tr_b16 a[146:147], v245 offset:4096
    ds_read_b64_tr_b16 a[148:149], v246 offset:0
    ds_read_b64_tr_b16 a[150:151], v246 offset:4096
    ds_read_b64_tr_b16 a[152:153], v245 offset:256
    ds_read_b64_tr_b16 a[154:155], v245 offset:4352
    ds_read_b64_tr_b16 a[156:157], v246 offset:256
    ds_read_b64_tr_b16 a[158:159], v246 offset:4352
    ds_read_b64_tr_b16 a[160:161], v245 offset:512
    ds_read_b64_tr_b16 a[162:163], v245 offset:4608
    ds_read_b64_tr_b16 a[164:165], v246 offset:512
    ds_read_b64_tr_b16 a[166:167], v246 offset:4608
    ds_read_b64_tr_b16 a[168:169], v245 offset:768
    ds_read_b64_tr_b16 a[170:171], v245 offset:4864
    ds_read_b64_tr_b16 a[172:173], v246 offset:768
    ds_read_b64_tr_b16 a[174:175], v246 offset:4864
    s_waitcnt lgkmcnt(0)
    v_mfma_f32_16x16x32_bf16 a[208:211], a[144:147], v[236:239], a[208:211]
    v_cvt_pk_bf16_f32 v240, v228, v229
    v_mfma_f32_16x16x32_bf16 a[212:215], a[148:151], v[236:239], a[212:215]
    v_cvt_pk_bf16_f32 v241, v230, v231
    v_mfma_f32_16x16x32_bf16 a[216:219], a[152:155], v[236:239], a[216:219]
    v_mfma_f32_16x16x32_bf16 a[220:223], a[156:159], v[236:239], a[220:223]
    v_mfma_f32_16x16x32_bf16 v[224:227], a[128:131], a[16:19], v[196:199]
    v_exp_f32 v232, v232
    v_mfma_f32_16x16x32_bf16 v[224:227], a[132:135], a[20:23], v[224:227]
    v_exp_f32 v233, v233
    v_mfma_f32_16x16x32_bf16 v[224:227], a[136:139], a[24:27], v[224:227]
    v_exp_f32 v234, v234
    v_mfma_f32_16x16x32_bf16 v[224:227], a[140:143], a[28:31], v[224:227]
    v_exp_f32 v235, v235
    v_mfma_f32_16x16x32_bf16 a[224:227], a[160:163], v[236:239], a[224:227]
    v_cvt_pk_bf16_f32 v242, v232, v233
    v_mfma_f32_16x16x32_bf16 a[228:231], a[164:167], v[236:239], a[228:231]
    v_cvt_pk_bf16_f32 v243, v234, v235
    v_mfma_f32_16x16x32_bf16 a[232:235], a[168:171], v[236:239], a[232:235]
    v_mfma_f32_16x16x32_bf16 a[236:239], a[172:175], v[236:239], a[236:239]
    v_mfma_f32_16x16x32_bf16 a[200:203], a[204:207], v[236:239], a[200:203]
    s_waitcnt vmcnt(8)
    s_barrier
    v_mfma_f32_16x16x32_bf16 v[228:231], a[112:115], a[32:35], v[200:203]
    v_exp_f32 v220, v220
    v_mfma_f32_16x16x32_bf16 v[228:231], a[116:119], a[36:39], v[228:231]
    v_exp_f32 v221, v221
    v_mfma_f32_16x16x32_bf16 v[228:231], a[120:123], a[40:43], v[228:231]
    v_exp_f32 v222, v222
    v_mfma_f32_16x16x32_bf16 v[228:231], a[124:127], a[44:47], v[228:231]
    v_exp_f32 v223, v223
    v_mfma_f32_16x16x32_bf16 v[0:3], a[144:147], v[240:243], v[0:3]
    v_cvt_pk_bf16_f32 v236, v220, v221
    s_add_u32 m0, s37, s29
    v_mfma_f32_16x16x32_bf16 v[4:7], a[148:151], v[240:243], v[4:7]
    v_cvt_pk_bf16_f32 v237, v222, v223
    v_mfma_f32_16x16x32_bf16 v[8:11], a[152:155], v[240:243], v[8:11]
    buffer_load_dwordx4 v248, s[16:19], s32 offen offset:0 nt lds
    v_mfma_f32_16x16x32_bf16 v[12:15], a[156:159], v[240:243], v[12:15]
    buffer_load_dwordx4 v249, s[16:19], s32 offen offset:1024 nt lds
    v_mfma_f32_16x16x32_bf16 v[232:235], a[128:131], a[32:35], v[200:203]
    v_exp_f32 v224, v224
    v_mfma_f32_16x16x32_bf16 v[232:235], a[132:135], a[36:39], v[232:235]
    v_exp_f32 v225, v225
    v_mfma_f32_16x16x32_bf16 v[232:235], a[136:139], a[40:43], v[232:235]
    v_exp_f32 v226, v226
    v_mfma_f32_16x16x32_bf16 v[232:235], a[140:143], a[44:47], v[232:235]
    v_exp_f32 v227, v227
    v_mfma_f32_16x16x32_bf16 v[16:19], a[160:163], v[240:243], v[16:19]
    v_cvt_pk_bf16_f32 v238, v224, v225
    v_mfma_f32_16x16x32_bf16 v[20:23], a[164:167], v[240:243], v[20:23]
    v_cvt_pk_bf16_f32 v239, v226, v227
    v_mfma_f32_16x16x32_bf16 v[24:27], a[168:171], v[240:243], v[24:27]
    buffer_load_dwordx4 v248, s[16:19], s32 offen offset:2048 nt lds
    v_mfma_f32_16x16x32_bf16 v[28:31], a[172:175], v[240:243], v[28:31]
    buffer_load_dwordx4 v249, s[16:19], s32 offen offset:3072 nt lds
    s_add_u32 m0, m0, 4096
    v_mfma_f32_16x16x32_bf16 a[176:179], a[204:207], v[240:243], a[176:179]
    buffer_load_dwordx4 v248, s[16:19], s33 offen offset:0 nt lds
    v_mfma_f32_16x16x32_bf16 v[220:223], a[112:115], a[48:51], v[204:207]
    v_exp_f32 v228, v228
    v_mfma_f32_16x16x32_bf16 v[220:223], a[116:119], a[52:55], v[220:223]
    v_exp_f32 v229, v229
    v_mfma_f32_16x16x32_bf16 v[220:223], a[120:123], a[56:59], v[220:223]
    v_exp_f32 v230, v230
    v_mfma_f32_16x16x32_bf16 v[220:223], a[124:127], a[60:63], v[220:223]
    v_exp_f32 v231, v231
    v_mfma_f32_16x16x32_bf16 v[32:35], a[144:147], v[236:239], v[32:35]
    v_cvt_pk_bf16_f32 v240, v228, v229
    v_mfma_f32_16x16x32_bf16 v[36:39], a[148:151], v[236:239], v[36:39]
    v_cvt_pk_bf16_f32 v241, v230, v231
    v_mfma_f32_16x16x32_bf16 v[40:43], a[152:155], v[236:239], v[40:43]
    buffer_load_dwordx4 v249, s[16:19], s33 offen offset:1024 nt lds
    v_mfma_f32_16x16x32_bf16 v[44:47], a[156:159], v[236:239], v[44:47]
    buffer_load_dwordx4 v248, s[16:19], s33 offen offset:2048 nt lds
    v_mfma_f32_16x16x32_bf16 v[224:227], a[128:131], a[48:51], v[204:207]
    v_exp_f32 v232, v232
    v_mfma_f32_16x16x32_bf16 v[224:227], a[132:135], a[52:55], v[224:227]
    v_exp_f32 v233, v233
    v_mfma_f32_16x16x32_bf16 v[224:227], a[136:139], a[56:59], v[224:227]
    v_exp_f32 v234, v234
    v_mfma_f32_16x16x32_bf16 v[224:227], a[140:143], a[60:63], v[224:227]
    v_exp_f32 v235, v235
    v_mfma_f32_16x16x32_bf16 v[48:51], a[160:163], v[236:239], v[48:51]
    v_cvt_pk_bf16_f32 v242, v232, v233
    v_mfma_f32_16x16x32_bf16 v[52:55], a[164:167], v[236:239], v[52:55]
    v_cvt_pk_bf16_f32 v243, v234, v235
    v_mfma_f32_16x16x32_bf16 v[56:59], a[168:171], v[236:239], v[56:59]
    buffer_load_dwordx4 v249, s[16:19], s33 offen offset:3072 nt lds
    v_mfma_f32_16x16x32_bf16 v[60:63], a[172:175], v[236:239], v[60:63]
    s_add_u32 s64, s64, 8192
    s_xor_b32 s32, s64, s65
    v_mfma_f32_16x16x32_bf16 a[180:183], a[204:207], v[236:239], a[180:183]
    s_or_b32 s33, s32, 4096
    s_add_u32 s29, s29, 32768
    v_mfma_f32_16x16x32_bf16 v[228:231], a[112:115], a[64:67], v[208:211]
    v_exp_f32 v220, v220
    v_mfma_f32_16x16x32_bf16 v[228:231], a[116:119], a[68:71], v[228:231]
    v_exp_f32 v221, v221
    v_mfma_f32_16x16x32_bf16 v[228:231], a[120:123], a[72:75], v[228:231]
    v_exp_f32 v222, v222
    v_mfma_f32_16x16x32_bf16 v[228:231], a[124:127], a[76:79], v[228:231]
    v_exp_f32 v223, v223
    v_mfma_f32_16x16x32_bf16 v[64:67], a[144:147], v[240:243], v[64:67]
    v_cvt_pk_bf16_f32 v236, v220, v221
    s_add_u32 s44, s39, 32768
    v_mfma_f32_16x16x32_bf16 v[68:71], a[148:151], v[240:243], v[68:71]
    v_cvt_pk_bf16_f32 v237, v222, v223
    v_mfma_f32_16x16x32_bf16 v[72:75], a[152:155], v[240:243], v[72:75]
    s_cmp_eq_u32 s44, 163840
    s_cselect_b32 s44, 0, s44
    v_mfma_f32_16x16x32_bf16 v[76:79], a[156:159], v[240:243], v[76:79]
    s_cmp_eq_u32 s29, 163840
    s_cselect_b32 s29, 0, s29
    v_mfma_f32_16x16x32_bf16 v[232:235], a[128:131], a[64:67], v[208:211]
    v_exp_f32 v224, v224
    v_mfma_f32_16x16x32_bf16 v[232:235], a[132:135], a[68:71], v[232:235]
    v_exp_f32 v225, v225
    v_mfma_f32_16x16x32_bf16 v[232:235], a[136:139], a[72:75], v[232:235]
    v_exp_f32 v226, v226
    v_mfma_f32_16x16x32_bf16 v[232:235], a[140:143], a[76:79], v[232:235]
    v_exp_f32 v227, v227
    v_mfma_f32_16x16x32_bf16 v[80:83], a[160:163], v[240:243], v[80:83]
    v_cvt_pk_bf16_f32 v238, v224, v225
    s_sub_u32 s34, s44, s39
    v_mfma_f32_16x16x32_bf16 v[84:87], a[164:167], v[240:243], v[84:87]
    v_cvt_pk_bf16_f32 v239, v226, v227
    s_mov_b32 s39, s44
    v_mfma_f32_16x16x32_bf16 v[88:91], a[168:171], v[240:243], v[88:91]
    v_mfma_f32_16x16x32_bf16 v[92:95], a[172:175], v[240:243], v[92:95]
    v_mfma_f32_16x16x32_bf16 a[184:187], a[204:207], v[240:243], a[184:187]
    v_mfma_f32_16x16x32_bf16 v[220:223], a[112:115], a[80:83], v[212:215]
    v_exp_f32 v228, v228
    v_mfma_f32_16x16x32_bf16 v[220:223], a[116:119], a[84:87], v[220:223]
    v_exp_f32 v229, v229
    v_mfma_f32_16x16x32_bf16 v[220:223], a[120:123], a[88:91], v[220:223]
    v_exp_f32 v230, v230
    v_mfma_f32_16x16x32_bf16 v[220:223], a[124:127], a[92:95], v[220:223]
    v_exp_f32 v231, v231
    v_mfma_f32_16x16x32_bf16 v[96:99], a[144:147], v[236:239], v[96:99]
    v_cvt_pk_bf16_f32 v240, v228, v229
    v_add_u32 v244, s34, v244
    v_mfma_f32_16x16x32_bf16 v[100:103], a[148:151], v[236:239], v[100:103]
    v_cvt_pk_bf16_f32 v241, v230, v231
    v_mfma_f32_16x16x32_bf16 v[104:107], a[152:155], v[236:239], v[104:107]
    v_mfma_f32_16x16x32_bf16 v[108:111], a[156:159], v[236:239], v[108:111]
    v_mfma_f32_16x16x32_bf16 v[224:227], a[128:131], a[80:83], v[212:215]
    v_exp_f32 v232, v232
    v_mfma_f32_16x16x32_bf16 v[224:227], a[132:135], a[84:87], v[224:227]
    v_exp_f32 v233, v233
    v_mfma_f32_16x16x32_bf16 v[224:227], a[136:139], a[88:91], v[224:227]
    v_exp_f32 v234, v234
    v_mfma_f32_16x16x32_bf16 v[224:227], a[140:143], a[92:95], v[224:227]
    v_exp_f32 v235, v235
    v_mfma_f32_16x16x32_bf16 v[112:115], a[160:163], v[236:239], v[112:115]
    v_cvt_pk_bf16_f32 v242, v232, v233
    v_mfma_f32_16x16x32_bf16 v[116:119], a[164:167], v[236:239], v[116:119]
    v_cvt_pk_bf16_f32 v243, v234, v235
    v_mfma_f32_16x16x32_bf16 v[120:123], a[168:171], v[236:239], v[120:123]
    v_mfma_f32_16x16x32_bf16 v[124:127], a[172:175], v[236:239], v[124:127]
    v_mfma_f32_16x16x32_bf16 a[188:191], a[204:207], v[236:239], a[188:191]
    ds_read_b128 a[112:115], v244 offset:0
    ds_read_b128 a[116:119], v244 offset:256
    ds_read_b128 a[120:123], v244 offset:512
    ds_read_b128 a[124:127], v244 offset:768
    ds_read_b128 a[128:131], v244 offset:4096
    ds_read_b128 a[132:135], v244 offset:4352
    ds_read_b128 a[136:139], v244 offset:4608
    ds_read_b128 a[140:143], v244 offset:4864
    s_waitcnt lgkmcnt(0)
    v_mfma_f32_16x16x32_bf16 v[228:231], a[112:115], a[96:99], v[216:219]
    v_exp_f32 v220, v220
    v_mfma_f32_16x16x32_bf16 v[228:231], a[116:119], a[100:103], v[228:231]
    v_exp_f32 v221, v221
    v_mfma_f32_16x16x32_bf16 v[228:231], a[120:123], a[104:107], v[228:231]
    v_exp_f32 v222, v222
    v_mfma_f32_16x16x32_bf16 v[228:231], a[124:127], a[108:111], v[228:231]
    v_exp_f32 v223, v223
    v_mfma_f32_16x16x32_bf16 v[128:131], a[144:147], v[240:243], v[128:131]
    v_cvt_pk_bf16_f32 v236, v220, v221
    v_mfma_f32_16x16x32_bf16 v[132:135], a[148:151], v[240:243], v[132:135]
    v_cvt_pk_bf16_f32 v237, v222, v223
    v_mfma_f32_16x16x32_bf16 v[136:139], a[152:155], v[240:243], v[136:139]
    v_mfma_f32_16x16x32_bf16 v[140:143], a[156:159], v[240:243], v[140:143]
    v_mfma_f32_16x16x32_bf16 v[232:235], a[128:131], a[96:99], v[216:219]
    v_exp_f32 v224, v224
    v_mfma_f32_16x16x32_bf16 v[232:235], a[132:135], a[100:103], v[232:235]
    v_exp_f32 v225, v225
    v_mfma_f32_16x16x32_bf16 v[232:235], a[136:139], a[104:107], v[232:235]
    v_exp_f32 v226, v226
    v_mfma_f32_16x16x32_bf16 v[232:235], a[140:143], a[108:111], v[232:235]
    v_exp_f32 v227, v227
    v_mfma_f32_16x16x32_bf16 v[144:147], a[160:163], v[240:243], v[144:147]
    v_cvt_pk_bf16_f32 v238, v224, v225
    v_add_u32 v245, s34, v245
    v_mfma_f32_16x16x32_bf16 v[148:151], a[164:167], v[240:243], v[148:151]
    v_cvt_pk_bf16_f32 v239, v226, v227
    v_add_u32 v246, s34, v246
    v_mfma_f32_16x16x32_bf16 v[152:155], a[168:171], v[240:243], v[152:155]
    v_mfma_f32_16x16x32_bf16 v[156:159], a[172:175], v[240:243], v[156:159]
    v_mfma_f32_16x16x32_bf16 a[192:195], a[204:207], v[240:243], a[192:195]
    v_mfma_f32_16x16x32_bf16 v[220:223], a[112:115], a[0:3], v[192:195]
    v_exp_f32 v228, v228
    v_mfma_f32_16x16x32_bf16 v[220:223], a[116:119], a[4:7], v[220:223]
    v_exp_f32 v229, v229
    v_mfma_f32_16x16x32_bf16 v[220:223], a[120:123], a[8:11], v[220:223]
    v_exp_f32 v230, v230
    v_mfma_f32_16x16x32_bf16 v[220:223], a[124:127], a[12:15], v[220:223]
    v_exp_f32 v231, v231
    v_mfma_f32_16x16x32_bf16 v[160:163], a[144:147], v[236:239], v[160:163]
    v_cvt_pk_bf16_f32 v240, v228, v229
    v_mfma_f32_16x16x32_bf16 v[164:167], a[148:151], v[236:239], v[164:167]
    v_cvt_pk_bf16_f32 v241, v230, v231
    v_mfma_f32_16x16x32_bf16 v[168:171], a[152:155], v[236:239], v[168:171]
    v_mfma_f32_16x16x32_bf16 v[172:175], a[156:159], v[236:239], v[172:175]
    v_mfma_f32_16x16x32_bf16 v[224:227], a[128:131], a[0:3], v[192:195]
    v_exp_f32 v232, v232
    v_mfma_f32_16x16x32_bf16 v[224:227], a[132:135], a[4:7], v[224:227]
    v_exp_f32 v233, v233
    v_mfma_f32_16x16x32_bf16 v[224:227], a[136:139], a[8:11], v[224:227]
    v_exp_f32 v234, v234
    v_mfma_f32_16x16x32_bf16 v[224:227], a[140:143], a[12:15], v[224:227]
    v_exp_f32 v235, v235
    v_mfma_f32_16x16x32_bf16 v[176:179], a[160:163], v[236:239], v[176:179]
    v_cvt_pk_bf16_f32 v242, v232, v233
    v_mfma_f32_16x16x32_bf16 v[180:183], a[164:167], v[236:239], v[180:183]
    v_cvt_pk_bf16_f32 v243, v234, v235
    v_mfma_f32_16x16x32_bf16 v[184:187], a[168:171], v[236:239], v[184:187]
    v_mfma_f32_16x16x32_bf16 v[188:191], a[172:175], v[236:239], v[188:191]
    v_mfma_f32_16x16x32_bf16 a[196:199], a[204:207], v[236:239], a[196:199]
    v_mfma_f32_16x16x32_bf16 v[228:231], a[112:115], a[16:19], v[196:199]
    v_exp_f32 v220, v220
    v_mfma_f32_16x16x32_bf16 v[228:231], a[116:119], a[20:23], v[228:231]
    v_exp_f32 v221, v221
    v_mfma_f32_16x16x32_bf16 v[228:231], a[120:123], a[24:27], v[228:231]
    v_exp_f32 v222, v222
    v_mfma_f32_16x16x32_bf16 v[228:231], a[124:127], a[28:31], v[228:231]
    v_exp_f32 v223, v223
    ds_read_b64_tr_b16 a[144:145], v245 offset:0
    ds_read_b64_tr_b16 a[146:147], v245 offset:4096
    ds_read_b64_tr_b16 a[148:149], v246 offset:0
    ds_read_b64_tr_b16 a[150:151], v246 offset:4096
    ds_read_b64_tr_b16 a[152:153], v245 offset:256
    ds_read_b64_tr_b16 a[154:155], v245 offset:4352
    ds_read_b64_tr_b16 a[156:157], v246 offset:256
    ds_read_b64_tr_b16 a[158:159], v246 offset:4352
    ds_read_b64_tr_b16 a[160:161], v245 offset:512
    ds_read_b64_tr_b16 a[162:163], v245 offset:4608
    ds_read_b64_tr_b16 a[164:165], v246 offset:512
    ds_read_b64_tr_b16 a[166:167], v246 offset:4608
    ds_read_b64_tr_b16 a[168:169], v245 offset:768
    ds_read_b64_tr_b16 a[170:171], v245 offset:4864
    ds_read_b64_tr_b16 a[172:173], v246 offset:768
    ds_read_b64_tr_b16 a[174:175], v246 offset:4864
    s_waitcnt lgkmcnt(0)
    v_mfma_f32_16x16x32_bf16 a[208:211], a[144:147], v[240:243], a[208:211]
    v_cvt_pk_bf16_f32 v236, v220, v221
    v_mfma_f32_16x16x32_bf16 a[212:215], a[148:151], v[240:243], a[212:215]
    v_cvt_pk_bf16_f32 v237, v222, v223
    v_mfma_f32_16x16x32_bf16 a[216:219], a[152:155], v[240:243], a[216:219]
    v_mfma_f32_16x16x32_bf16 a[220:223], a[156:159], v[240:243], a[220:223]
    v_mfma_f32_16x16x32_bf16 v[232:235], a[128:131], a[16:19], v[196:199]
    v_exp_f32 v224, v224
    v_mfma_f32_16x16x32_bf16 v[232:235], a[132:135], a[20:23], v[232:235]
    v_exp_f32 v225, v225
    v_mfma_f32_16x16x32_bf16 v[232:235], a[136:139], a[24:27], v[232:235]
    v_exp_f32 v226, v226
    v_mfma_f32_16x16x32_bf16 v[232:235], a[140:143], a[28:31], v[232:235]
    v_exp_f32 v227, v227
    v_mfma_f32_16x16x32_bf16 a[224:227], a[160:163], v[240:243], a[224:227]
    v_cvt_pk_bf16_f32 v238, v224, v225
    v_mfma_f32_16x16x32_bf16 a[228:231], a[164:167], v[240:243], a[228:231]
    v_cvt_pk_bf16_f32 v239, v226, v227
    v_mfma_f32_16x16x32_bf16 a[232:235], a[168:171], v[240:243], a[232:235]
    v_mfma_f32_16x16x32_bf16 a[236:239], a[172:175], v[240:243], a[236:239]
    v_mfma_f32_16x16x32_bf16 a[200:203], a[204:207], v[240:243], a[200:203]
    s_waitcnt vmcnt(8)
    s_barrier
    v_mfma_f32_16x16x32_bf16 v[220:223], a[112:115], a[32:35], v[200:203]
    v_exp_f32 v228, v228
    v_mfma_f32_16x16x32_bf16 v[220:223], a[116:119], a[36:39], v[220:223]
    v_exp_f32 v229, v229
    v_mfma_f32_16x16x32_bf16 v[220:223], a[120:123], a[40:43], v[220:223]
    v_exp_f32 v230, v230
    v_mfma_f32_16x16x32_bf16 v[220:223], a[124:127], a[44:47], v[220:223]
    v_exp_f32 v231, v231
    v_mfma_f32_16x16x32_bf16 v[0:3], a[144:147], v[236:239], v[0:3]
    v_cvt_pk_bf16_f32 v240, v228, v229
    s_add_u32 m0, s37, s29
    v_mfma_f32_16x16x32_bf16 v[4:7], a[148:151], v[236:239], v[4:7]
    v_cvt_pk_bf16_f32 v241, v230, v231
    v_mfma_f32_16x16x32_bf16 v[8:11], a[152:155], v[236:239], v[8:11]
    buffer_load_dwordx4 v248, s[16:19], s32 offen offset:0 nt lds
    v_mfma_f32_16x16x32_bf16 v[12:15], a[156:159], v[236:239], v[12:15]
    buffer_load_dwordx4 v249, s[16:19], s32 offen offset:1024 nt lds
    v_mfma_f32_16x16x32_bf16 v[224:227], a[128:131], a[32:35], v[200:203]
    v_exp_f32 v232, v232
    v_mfma_f32_16x16x32_bf16 v[224:227], a[132:135], a[36:39], v[224:227]
    v_exp_f32 v233, v233
    v_mfma_f32_16x16x32_bf16 v[224:227], a[136:139], a[40:43], v[224:227]
    v_exp_f32 v234, v234
    v_mfma_f32_16x16x32_bf16 v[224:227], a[140:143], a[44:47], v[224:227]
    v_exp_f32 v235, v235
    v_mfma_f32_16x16x32_bf16 v[16:19], a[160:163], v[236:239], v[16:19]
    v_cvt_pk_bf16_f32 v242, v232, v233
    v_mfma_f32_16x16x32_bf16 v[20:23], a[164:167], v[236:239], v[20:23]
    v_cvt_pk_bf16_f32 v243, v234, v235
    v_mfma_f32_16x16x32_bf16 v[24:27], a[168:171], v[236:239], v[24:27]
    buffer_load_dwordx4 v248, s[16:19], s32 offen offset:2048 nt lds
    v_mfma_f32_16x16x32_bf16 v[28:31], a[172:175], v[236:239], v[28:31]
    buffer_load_dwordx4 v249, s[16:19], s32 offen offset:3072 nt lds
    s_add_u32 m0, m0, 4096
    v_mfma_f32_16x16x32_bf16 a[176:179], a[204:207], v[236:239], a[176:179]
    buffer_load_dwordx4 v248, s[16:19], s33 offen offset:0 nt lds
    v_mfma_f32_16x16x32_bf16 v[228:231], a[112:115], a[48:51], v[204:207]
    v_exp_f32 v220, v220
    v_mfma_f32_16x16x32_bf16 v[228:231], a[116:119], a[52:55], v[228:231]
    v_exp_f32 v221, v221
    v_mfma_f32_16x16x32_bf16 v[228:231], a[120:123], a[56:59], v[228:231]
    v_exp_f32 v222, v222
    v_mfma_f32_16x16x32_bf16 v[228:231], a[124:127], a[60:63], v[228:231]
    v_exp_f32 v223, v223
    v_mfma_f32_16x16x32_bf16 v[32:35], a[144:147], v[240:243], v[32:35]
    v_cvt_pk_bf16_f32 v236, v220, v221
    v_mfma_f32_16x16x32_bf16 v[36:39], a[148:151], v[240:243], v[36:39]
    v_cvt_pk_bf16_f32 v237, v222, v223
    v_mfma_f32_16x16x32_bf16 v[40:43], a[152:155], v[240:243], v[40:43]
    buffer_load_dwordx4 v249, s[16:19], s33 offen offset:1024 nt lds
    v_mfma_f32_16x16x32_bf16 v[44:47], a[156:159], v[240:243], v[44:47]
    buffer_load_dwordx4 v248, s[16:19], s33 offen offset:2048 nt lds
    v_mfma_f32_16x16x32_bf16 v[232:235], a[128:131], a[48:51], v[204:207]
    v_exp_f32 v224, v224
    v_mfma_f32_16x16x32_bf16 v[232:235], a[132:135], a[52:55], v[232:235]
    v_exp_f32 v225, v225
    v_mfma_f32_16x16x32_bf16 v[232:235], a[136:139], a[56:59], v[232:235]
    v_exp_f32 v226, v226
    v_mfma_f32_16x16x32_bf16 v[232:235], a[140:143], a[60:63], v[232:235]
    v_exp_f32 v227, v227
    v_mfma_f32_16x16x32_bf16 v[48:51], a[160:163], v[240:243], v[48:51]
    v_cvt_pk_bf16_f32 v238, v224, v225
    v_mfma_f32_16x16x32_bf16 v[52:55], a[164:167], v[240:243], v[52:55]
    v_cvt_pk_bf16_f32 v239, v226, v227
    v_mfma_f32_16x16x32_bf16 v[56:59], a[168:171], v[240:243], v[56:59]
    buffer_load_dwordx4 v249, s[16:19], s33 offen offset:3072 nt lds
    v_mfma_f32_16x16x32_bf16 v[60:63], a[172:175], v[240:243], v[60:63]
    s_add_u32 s64, s64, 8192
    s_xor_b32 s32, s64, s65
    v_mfma_f32_16x16x32_bf16 a[180:183], a[204:207], v[240:243], a[180:183]
    s_or_b32 s33, s32, 4096
    s_add_u32 s29, s29, 32768
    v_mfma_f32_16x16x32_bf16 v[220:223], a[112:115], a[64:67], v[208:211]
    v_exp_f32 v228, v228
    v_mfma_f32_16x16x32_bf16 v[220:223], a[116:119], a[68:71], v[220:223]
    v_exp_f32 v229, v229
    v_mfma_f32_16x16x32_bf16 v[220:223], a[120:123], a[72:75], v[220:223]
    v_exp_f32 v230, v230
    v_mfma_f32_16x16x32_bf16 v[220:223], a[124:127], a[76:79], v[220:223]
    v_exp_f32 v231, v231
    v_mfma_f32_16x16x32_bf16 v[64:67], a[144:147], v[236:239], v[64:67]
    v_cvt_pk_bf16_f32 v240, v228, v229
    s_add_u32 s44, s39, 32768
    v_mfma_f32_16x16x32_bf16 v[68:71], a[148:151], v[236:239], v[68:71]
    v_cvt_pk_bf16_f32 v241, v230, v231
    v_mfma_f32_16x16x32_bf16 v[72:75], a[152:155], v[236:239], v[72:75]
    s_cmp_eq_u32 s44, 163840
    s_cselect_b32 s44, 0, s44
    v_mfma_f32_16x16x32_bf16 v[76:79], a[156:159], v[236:239], v[76:79]
    s_cmp_eq_u32 s29, 163840
    s_cselect_b32 s29, 0, s29
    v_mfma_f32_16x16x32_bf16 v[224:227], a[128:131], a[64:67], v[208:211]
    v_exp_f32 v232, v232
    v_mfma_f32_16x16x32_bf16 v[224:227], a[132:135], a[68:71], v[224:227]
    v_exp_f32 v233, v233
    v_mfma_f32_16x16x32_bf16 v[224:227], a[136:139], a[72:75], v[224:227]
    v_exp_f32 v234, v234
    v_mfma_f32_16x16x32_bf16 v[224:227], a[140:143], a[76:79], v[224:227]
    v_exp_f32 v235, v235
    v_mfma_f32_16x16x32_bf16 v[80:83], a[160:163], v[236:239], v[80:83]
    v_cvt_pk_bf16_f32 v242, v232, v233
    s_sub_u32 s34, s44, s39
    v_mfma_f32_16x16x32_bf16 v[84:87], a[164:167], v[236:239], v[84:87]
    v_cvt_pk_bf16_f32 v243, v234, v235
    s_mov_b32 s39, s44
    v_mfma_f32_16x16x32_bf16 v[88:91], a[168:171], v[236:239], v[88:91]
    v_mfma_f32_16x16x32_bf16 v[92:95], a[172:175], v[236:239], v[92:95]
    v_mfma_f32_16x16x32_bf16 a[184:187], a[204:207], v[236:239], a[184:187]
    v_mfma_f32_16x16x32_bf16 v[228:231], a[112:115], a[80:83], v[212:215]
    v_exp_f32 v220, v220
    v_mfma_f32_16x16x32_bf16 v[228:231], a[116:119], a[84:87], v[228:231]
    v_exp_f32 v221, v221
    v_mfma_f32_16x16x32_bf16 v[228:231], a[120:123], a[88:91], v[228:231]
    v_exp_f32 v222, v222
    v_mfma_f32_16x16x32_bf16 v[228:231], a[124:127], a[92:95], v[228:231]
    v_exp_f32 v223, v223
    v_mfma_f32_16x16x32_bf16 v[96:99], a[144:147], v[240:243], v[96:99]
    v_cvt_pk_bf16_f32 v236, v220, v221
    v_add_u32 v244, s34, v244
    v_mfma_f32_16x16x32_bf16 v[100:103], a[148:151], v[240:243], v[100:103]
    v_cvt_pk_bf16_f32 v237, v222, v223
    v_mfma_f32_16x16x32_bf16 v[104:107], a[152:155], v[240:243], v[104:107]
    v_mfma_f32_16x16x32_bf16 v[108:111], a[156:159], v[240:243], v[108:111]
    v_mfma_f32_16x16x32_bf16 v[232:235], a[128:131], a[80:83], v[212:215]
    v_exp_f32 v224, v224
    v_mfma_f32_16x16x32_bf16 v[232:235], a[132:135], a[84:87], v[232:235]
    v_exp_f32 v225, v225
    v_mfma_f32_16x16x32_bf16 v[232:235], a[136:139], a[88:91], v[232:235]
    v_exp_f32 v226, v226
    v_mfma_f32_16x16x32_bf16 v[232:235], a[140:143], a[92:95], v[232:235]
    v_exp_f32 v227, v227
    v_mfma_f32_16x16x32_bf16 v[112:115], a[160:163], v[240:243], v[112:115]
    v_cvt_pk_bf16_f32 v238, v224, v225
    v_mfma_f32_16x16x32_bf16 v[116:119], a[164:167], v[240:243], v[116:119]
    v_cvt_pk_bf16_f32 v239, v226, v227
    v_mfma_f32_16x16x32_bf16 v[120:123], a[168:171], v[240:243], v[120:123]
    v_mfma_f32_16x16x32_bf16 v[124:127], a[172:175], v[240:243], v[124:127]
    v_mfma_f32_16x16x32_bf16 a[188:191], a[204:207], v[240:243], a[188:191]
    s_sub_u32 s28, s28, 1
    s_cmp_lg_u32 s28, 0
    s_cbranch_scc1 L1_a0
    s_mov_b32 s28, 8
.p2align 6
L1_a0_1:
    ds_read_b128 a[112:115], v244 offset:0
    ds_read_b128 a[116:119], v244 offset:256
    ds_read_b128 a[120:123], v244 offset:512
    ds_read_b128 a[124:127], v244 offset:768
    ds_read_b128 a[128:131], v244 offset:4096
    ds_read_b128 a[132:135], v244 offset:4352
    ds_read_b128 a[136:139], v244 offset:4608
    ds_read_b128 a[140:143], v244 offset:4864
    s_waitcnt lgkmcnt(4)
    v_mfma_f32_16x16x32_bf16 v[220:223], a[112:115], a[96:99], v[216:219]
    v_exp_f32 v228, v228
    v_mfma_f32_16x16x32_bf16 v[220:223], a[116:119], a[100:103], v[220:223]
    v_exp_f32 v229, v229
    v_mfma_f32_16x16x32_bf16 v[220:223], a[120:123], a[104:107], v[220:223]
    v_exp_f32 v230, v230
    v_mfma_f32_16x16x32_bf16 v[220:223], a[124:127], a[108:111], v[220:223]
    v_exp_f32 v231, v231
    v_mfma_f32_16x16x32_bf16 v[128:131], a[144:147], v[236:239], v[128:131]
    v_cvt_pk_bf16_f32 v240, v228, v229
    v_mfma_f32_16x16x32_bf16 v[132:135], a[148:151], v[236:239], v[132:135]
    v_cvt_pk_bf16_f32 v241, v230, v231
    v_mfma_f32_16x16x32_bf16 v[136:139], a[152:155], v[236:239], v[136:139]
    v_mfma_f32_16x16x32_bf16 v[140:143], a[156:159], v[236:239], v[140:143]
    s_waitcnt lgkmcnt(0)
    v_mfma_f32_16x16x32_bf16 v[224:227], a[128:131], a[96:99], v[216:219]
    v_exp_f32 v232, v232
    v_mfma_f32_16x16x32_bf16 v[224:227], a[132:135], a[100:103], v[224:227]
    v_exp_f32 v233, v233
    v_mfma_f32_16x16x32_bf16 v[224:227], a[136:139], a[104:107], v[224:227]
    v_exp_f32 v234, v234
    v_mfma_f32_16x16x32_bf16 v[224:227], a[140:143], a[108:111], v[224:227]
    v_exp_f32 v235, v235
    v_mfma_f32_16x16x32_bf16 v[144:147], a[160:163], v[236:239], v[144:147]
    v_cvt_pk_bf16_f32 v242, v232, v233
    v_add_u32 v245, s34, v245
    v_mfma_f32_16x16x32_bf16 v[148:151], a[164:167], v[236:239], v[148:151]
    v_cvt_pk_bf16_f32 v243, v234, v235
    v_add_u32 v246, s34, v246
    v_mfma_f32_16x16x32_bf16 v[152:155], a[168:171], v[236:239], v[152:155]
    v_mfma_f32_16x16x32_bf16 v[156:159], a[172:175], v[236:239], v[156:159]
    v_mfma_f32_16x16x32_bf16 a[192:195], a[204:207], v[236:239], a[192:195]
    v_mfma_f32_16x16x32_bf16 v[228:231], a[112:115], a[0:3], v[192:195]
    v_exp_f32 v220, v220
    v_mfma_f32_16x16x32_bf16 v[228:231], a[116:119], a[4:7], v[228:231]
    v_exp_f32 v221, v221
    v_mfma_f32_16x16x32_bf16 v[228:231], a[120:123], a[8:11], v[228:231]
    v_exp_f32 v222, v222
    v_mfma_f32_16x16x32_bf16 v[228:231], a[124:127], a[12:15], v[228:231]
    v_exp_f32 v223, v223
    v_mfma_f32_16x16x32_bf16 v[160:163], a[144:147], v[240:243], v[160:163]
    v_cvt_pk_bf16_f32 v236, v220, v221
    ds_read_b64_tr_b16 a[144:145], v245 offset:0
    v_mfma_f32_16x16x32_bf16 v[164:167], a[148:151], v[240:243], v[164:167]
    v_cvt_pk_bf16_f32 v237, v222, v223
    ds_read_b64_tr_b16 a[146:147], v245 offset:4096
    v_mfma_f32_16x16x32_bf16 v[168:171], a[152:155], v[240:243], v[168:171]
    ds_read_b64_tr_b16 a[148:149], v246 offset:0
    ds_read_b64_tr_b16 a[150:151], v246 offset:4096
    v_mfma_f32_16x16x32_bf16 v[172:175], a[156:159], v[240:243], v[172:175]
    ds_read_b64_tr_b16 a[152:153], v245 offset:256
    ds_read_b64_tr_b16 a[154:155], v245 offset:4352
    v_mfma_f32_16x16x32_bf16 v[232:235], a[128:131], a[0:3], v[192:195]
    v_exp_f32 v224, v224
    v_mfma_f32_16x16x32_bf16 v[232:235], a[132:135], a[4:7], v[232:235]
    v_exp_f32 v225, v225
    v_mfma_f32_16x16x32_bf16 v[232:235], a[136:139], a[8:11], v[232:235]
    v_exp_f32 v226, v226
    v_mfma_f32_16x16x32_bf16 v[232:235], a[140:143], a[12:15], v[232:235]
    v_exp_f32 v227, v227
    v_mfma_f32_16x16x32_bf16 v[176:179], a[160:163], v[240:243], v[176:179]
    v_cvt_pk_bf16_f32 v238, v224, v225
    ds_read_b64_tr_b16 a[156:157], v246 offset:256
    v_mfma_f32_16x16x32_bf16 v[180:183], a[164:167], v[240:243], v[180:183]
    v_cvt_pk_bf16_f32 v239, v226, v227
    ds_read_b64_tr_b16 a[158:159], v246 offset:4352
    v_mfma_f32_16x16x32_bf16 v[184:187], a[168:171], v[240:243], v[184:187]
    ds_read_b64_tr_b16 a[160:161], v245 offset:512
    ds_read_b64_tr_b16 a[162:163], v245 offset:4608
    v_mfma_f32_16x16x32_bf16 v[188:191], a[172:175], v[240:243], v[188:191]
    ds_read_b64_tr_b16 a[164:165], v246 offset:512
    ds_read_b64_tr_b16 a[166:167], v246 offset:4608
    v_mfma_f32_16x16x32_bf16 a[196:199], a[204:207], v[240:243], a[196:199]
    ds_read_b64_tr_b16 a[168:169], v245 offset:768
    ds_read_b64_tr_b16 a[170:171], v245 offset:4864
    v_mfma_f32_16x16x32_bf16 v[220:223], a[112:115], a[16:19], v[196:199]
    v_exp_f32 v228, v228
    v_mfma_f32_16x16x32_bf16 v[220:223], a[116:119], a[20:23], v[220:223]
    v_exp_f32 v229, v229
    v_mfma_f32_16x16x32_bf16 v[220:223], a[120:123], a[24:27], v[220:223]
    v_exp_f32 v230, v230
    v_mfma_f32_16x16x32_bf16 v[220:223], a[124:127], a[28:31], v[220:223]
    v_exp_f32 v231, v231
    s_waitcnt lgkmcnt(6)
    v_mfma_f32_16x16x32_bf16 a[208:211], a[144:147], v[236:239], a[208:211]
    v_cvt_pk_bf16_f32 v240, v228, v229
    ds_read_b64_tr_b16 a[172:173], v246 offset:768
    v_mfma_f32_16x16x32_bf16 a[212:215], a[148:151], v[236:239], a[212:215]
    v_cvt_pk_bf16_f32 v241, v230, v231
    ds_read_b64_tr_b16 a[174:175], v246 offset:4864
    v_mfma_f32_16x16x32_bf16 a[216:219], a[152:155], v[236:239], a[216:219]
    v_mfma_f32_16x16x32_bf16 a[220:223], a[156:159], v[236:239], a[220:223]
    s_waitcnt lgkmcnt(2)
    v_mfma_f32_16x16x32_bf16 v[224:227], a[128:131], a[16:19], v[196:199]
    v_exp_f32 v232, v232
    v_mfma_f32_16x16x32_bf16 v[224:227], a[132:135], a[20:23], v[224:227]
    v_exp_f32 v233, v233
    v_mfma_f32_16x16x32_bf16 v[224:227], a[136:139], a[24:27], v[224:227]
    v_exp_f32 v234, v234
    v_mfma_f32_16x16x32_bf16 v[224:227], a[140:143], a[28:31], v[224:227]
    v_exp_f32 v235, v235
    v_mfma_f32_16x16x32_bf16 a[224:227], a[160:163], v[236:239], a[224:227]
    v_cvt_pk_bf16_f32 v242, v232, v233
    v_mfma_f32_16x16x32_bf16 a[228:231], a[164:167], v[236:239], a[228:231]
    v_cvt_pk_bf16_f32 v243, v234, v235
    v_mfma_f32_16x16x32_bf16 a[232:235], a[168:171], v[236:239], a[232:235]
    s_waitcnt lgkmcnt(0)
    v_mfma_f32_16x16x32_bf16 a[236:239], a[172:175], v[236:239], a[236:239]
    v_mfma_f32_16x16x32_bf16 a[200:203], a[204:207], v[236:239], a[200:203]
    s_waitcnt vmcnt(8)
    s_barrier
    v_mfma_f32_16x16x32_bf16 v[228:231], a[112:115], a[32:35], v[200:203]
    v_exp_f32 v220, v220
    v_mfma_f32_16x16x32_bf16 v[228:231], a[116:119], a[36:39], v[228:231]
    v_exp_f32 v221, v221
    v_mfma_f32_16x16x32_bf16 v[228:231], a[120:123], a[40:43], v[228:231]
    v_exp_f32 v222, v222
    v_mfma_f32_16x16x32_bf16 v[228:231], a[124:127], a[44:47], v[228:231]
    v_exp_f32 v223, v223
    v_mfma_f32_16x16x32_bf16 v[0:3], a[144:147], v[240:243], v[0:3]
    v_cvt_pk_bf16_f32 v236, v220, v221
    s_add_u32 m0, s37, s29
    v_mfma_f32_16x16x32_bf16 v[4:7], a[148:151], v[240:243], v[4:7]
    v_cvt_pk_bf16_f32 v237, v222, v223
    v_mfma_f32_16x16x32_bf16 v[8:11], a[152:155], v[240:243], v[8:11]
    buffer_load_dwordx4 v248, s[16:19], s32 offen offset:0 nt lds
    v_mfma_f32_16x16x32_bf16 v[12:15], a[156:159], v[240:243], v[12:15]
    buffer_load_dwordx4 v249, s[16:19], s32 offen offset:1024 nt lds
    v_mfma_f32_16x16x32_bf16 v[232:235], a[128:131], a[32:35], v[200:203]
    v_exp_f32 v224, v224
    v_mfma_f32_16x16x32_bf16 v[232:235], a[132:135], a[36:39], v[232:235]
    v_exp_f32 v225, v225
    v_mfma_f32_16x16x32_bf16 v[232:235], a[136:139], a[40:43], v[232:235]
    v_exp_f32 v226, v226
    v_mfma_f32_16x16x32_bf16 v[232:235], a[140:143], a[44:47], v[232:235]
    v_exp_f32 v227, v227
    v_mfma_f32_16x16x32_bf16 v[16:19], a[160:163], v[240:243], v[16:19]
    v_cvt_pk_bf16_f32 v238, v224, v225
    v_mfma_f32_16x16x32_bf16 v[20:23], a[164:167], v[240:243], v[20:23]
    v_cvt_pk_bf16_f32 v239, v226, v227
    v_mfma_f32_16x16x32_bf16 v[24:27], a[168:171], v[240:243], v[24:27]
    buffer_load_dwordx4 v248, s[16:19], s32 offen offset:2048 nt lds
    v_mfma_f32_16x16x32_bf16 v[28:31], a[172:175], v[240:243], v[28:31]
    buffer_load_dwordx4 v249, s[16:19], s32 offen offset:3072 nt lds
    s_add_u32 m0, m0, 4096
    v_mfma_f32_16x16x32_bf16 a[176:179], a[204:207], v[240:243], a[176:179]
    buffer_load_dwordx4 v248, s[16:19], s33 offen offset:0 nt lds
    v_mfma_f32_16x16x32_bf16 v[220:223], a[112:115], a[48:51], v[204:207]
    v_exp_f32 v228, v228
    v_mfma_f32_16x16x32_bf16 v[220:223], a[116:119], a[52:55], v[220:223]
    v_exp_f32 v229, v229
    v_mfma_f32_16x16x32_bf16 v[220:223], a[120:123], a[56:59], v[220:223]
    v_exp_f32 v230, v230
    v_mfma_f32_16x16x32_bf16 v[220:223], a[124:127], a[60:63], v[220:223]
    v_exp_f32 v231, v231
    v_mfma_f32_16x16x32_bf16 v[32:35], a[144:147], v[236:239], v[32:35]
    v_cvt_pk_bf16_f32 v240, v228, v229
    v_mfma_f32_16x16x32_bf16 v[36:39], a[148:151], v[236:239], v[36:39]
    v_cvt_pk_bf16_f32 v241, v230, v231
    v_mfma_f32_16x16x32_bf16 v[40:43], a[152:155], v[236:239], v[40:43]
    buffer_load_dwordx4 v249, s[16:19], s33 offen offset:1024 nt lds
    v_mfma_f32_16x16x32_bf16 v[44:47], a[156:159], v[236:239], v[44:47]
    buffer_load_dwordx4 v248, s[16:19], s33 offen offset:2048 nt lds
    v_mfma_f32_16x16x32_bf16 v[224:227], a[128:131], a[48:51], v[204:207]
    v_exp_f32 v232, v232
    v_mfma_f32_16x16x32_bf16 v[224:227], a[132:135], a[52:55], v[224:227]
    v_exp_f32 v233, v233
    v_mfma_f32_16x16x32_bf16 v[224:227], a[136:139], a[56:59], v[224:227]
    v_exp_f32 v234, v234
    v_mfma_f32_16x16x32_bf16 v[224:227], a[140:143], a[60:63], v[224:227]
    v_exp_f32 v235, v235
    v_mfma_f32_16x16x32_bf16 v[48:51], a[160:163], v[236:239], v[48:51]
    v_cvt_pk_bf16_f32 v242, v232, v233
    v_mfma_f32_16x16x32_bf16 v[52:55], a[164:167], v[236:239], v[52:55]
    v_cvt_pk_bf16_f32 v243, v234, v235
    v_mfma_f32_16x16x32_bf16 v[56:59], a[168:171], v[236:239], v[56:59]
    buffer_load_dwordx4 v249, s[16:19], s33 offen offset:3072 nt lds
    v_mfma_f32_16x16x32_bf16 v[60:63], a[172:175], v[236:239], v[60:63]
    s_add_u32 s64, s64, 8192
    s_xor_b32 s32, s64, s65
    v_mfma_f32_16x16x32_bf16 a[180:183], a[204:207], v[236:239], a[180:183]
    s_or_b32 s33, s32, 4096
    s_add_u32 s29, s29, 32768
    v_mfma_f32_16x16x32_bf16 v[228:231], a[112:115], a[64:67], v[208:211]
    v_exp_f32 v220, v220
    v_mfma_f32_16x16x32_bf16 v[228:231], a[116:119], a[68:71], v[228:231]
    v_exp_f32 v221, v221
    v_mfma_f32_16x16x32_bf16 v[228:231], a[120:123], a[72:75], v[228:231]
    v_exp_f32 v222, v222
    v_mfma_f32_16x16x32_bf16 v[228:231], a[124:127], a[76:79], v[228:231]
    v_exp_f32 v223, v223
    v_mfma_f32_16x16x32_bf16 v[64:67], a[144:147], v[240:243], v[64:67]
    v_cvt_pk_bf16_f32 v236, v220, v221
    s_add_u32 s44, s39, 32768
    v_mfma_f32_16x16x32_bf16 v[68:71], a[148:151], v[240:243], v[68:71]
    v_cvt_pk_bf16_f32 v237, v222, v223
    v_mfma_f32_16x16x32_bf16 v[72:75], a[152:155], v[240:243], v[72:75]
    s_cmp_eq_u32 s44, 163840
    s_cselect_b32 s44, 0, s44
    v_mfma_f32_16x16x32_bf16 v[76:79], a[156:159], v[240:243], v[76:79]
    s_cmp_eq_u32 s29, 163840
    s_cselect_b32 s29, 0, s29
    v_mfma_f32_16x16x32_bf16 v[232:235], a[128:131], a[64:67], v[208:211]
    v_exp_f32 v224, v224
    v_mfma_f32_16x16x32_bf16 v[232:235], a[132:135], a[68:71], v[232:235]
    v_exp_f32 v225, v225
    v_mfma_f32_16x16x32_bf16 v[232:235], a[136:139], a[72:75], v[232:235]
    v_exp_f32 v226, v226
    v_mfma_f32_16x16x32_bf16 v[232:235], a[140:143], a[76:79], v[232:235]
    v_exp_f32 v227, v227
    v_mfma_f32_16x16x32_bf16 v[80:83], a[160:163], v[240:243], v[80:83]
    v_cvt_pk_bf16_f32 v238, v224, v225
    s_sub_u32 s34, s44, s39
    v_mfma_f32_16x16x32_bf16 v[84:87], a[164:167], v[240:243], v[84:87]
    v_cvt_pk_bf16_f32 v239, v226, v227
    s_mov_b32 s39, s44
    v_mfma_f32_16x16x32_bf16 v[88:91], a[168:171], v[240:243], v[88:91]
    v_mfma_f32_16x16x32_bf16 v[92:95], a[172:175], v[240:243], v[92:95]
    v_mfma_f32_16x16x32_bf16 a[184:187], a[204:207], v[240:243], a[184:187]
    v_mfma_f32_16x16x32_bf16 v[220:223], a[112:115], a[80:83], v[212:215]
    v_exp_f32 v228, v228
    v_mfma_f32_16x16x32_bf16 v[220:223], a[116:119], a[84:87], v[220:223]
    v_exp_f32 v229, v229
    v_mfma_f32_16x16x32_bf16 v[220:223], a[120:123], a[88:91], v[220:223]
    v_exp_f32 v230, v230
    v_mfma_f32_16x16x32_bf16 v[220:223], a[124:127], a[92:95], v[220:223]
    v_exp_f32 v231, v231
    v_mfma_f32_16x16x32_bf16 v[96:99], a[144:147], v[236:239], v[96:99]
    v_cvt_pk_bf16_f32 v240, v228, v229
    v_add_u32 v244, s34, v244
    v_mfma_f32_16x16x32_bf16 v[100:103], a[148:151], v[236:239], v[100:103]
    v_cvt_pk_bf16_f32 v241, v230, v231
    v_mfma_f32_16x16x32_bf16 v[104:107], a[152:155], v[236:239], v[104:107]
    v_mfma_f32_16x16x32_bf16 v[108:111], a[156:159], v[236:239], v[108:111]
    v_mfma_f32_16x16x32_bf16 v[224:227], a[128:131], a[80:83], v[212:215]
    v_exp_f32 v232, v232
    v_mfma_f32_16x16x32_bf16 v[224:227], a[132:135], a[84:87], v[224:227]
    v_exp_f32 v233, v233
    v_mfma_f32_16x16x32_bf16 v[224:227], a[136:139], a[88:91], v[224:227]
    v_exp_f32 v234, v234
    v_mfma_f32_16x16x32_bf16 v[224:227], a[140:143], a[92:95], v[224:227]
    v_exp_f32 v235, v235
    v_mfma_f32_16x16x32_bf16 v[112:115], a[160:163], v[236:239], v[112:115]
    v_cvt_pk_bf16_f32 v242, v232, v233
    v_mfma_f32_16x16x32_bf16 v[116:119], a[164:167], v[236:239], v[116:119]
    v_cvt_pk_bf16_f32 v243, v234, v235
    v_mfma_f32_16x16x32_bf16 v[120:123], a[168:171], v[236:239], v[120:123]
    v_mfma_f32_16x16x32_bf16 v[124:127], a[172:175], v[236:239], v[124:127]
    v_mfma_f32_16x16x32_bf16 a[188:191], a[204:207], v[236:239], a[188:191]
    ds_read_b128 a[112:115], v244 offset:0
    ds_read_b128 a[116:119], v244 offset:256
    ds_read_b128 a[120:123], v244 offset:512
    ds_read_b128 a[124:127], v244 offset:768
    ds_read_b128 a[128:131], v244 offset:4096
    ds_read_b128 a[132:135], v244 offset:4352
    ds_read_b128 a[136:139], v244 offset:4608
    ds_read_b128 a[140:143], v244 offset:4864
    s_waitcnt lgkmcnt(4)
    v_mfma_f32_16x16x32_bf16 v[228:231], a[112:115], a[96:99], v[216:219]
    v_exp_f32 v220, v220
    v_mfma_f32_16x16x32_bf16 v[228:231], a[116:119], a[100:103], v[228:231]
    v_exp_f32 v221, v221
    v_mfma_f32_16x16x32_bf16 v[228:231], a[120:123], a[104:107], v[228:231]
    v_exp_f32 v222, v222
    v_mfma_f32_16x16x32_bf16 v[228:231], a[124:127], a[108:111], v[228:231]
    v_exp_f32 v223, v223
    v_mfma_f32_16x16x32_bf16 v[128:131], a[144:147], v[240:243], v[128:131]
    v_cvt_pk_bf16_f32 v236, v220, v221
    v_mfma_f32_16x16x32_bf16 v[132:135], a[148:151], v[240:243], v[132:135]
    v_cvt_pk_bf16_f32 v237, v222, v223
    v_mfma_f32_16x16x32_bf16 v[136:139], a[152:155], v[240:243], v[136:139]
    v_mfma_f32_16x16x32_bf16 v[140:143], a[156:159], v[240:243], v[140:143]
    s_waitcnt lgkmcnt(0)
    v_mfma_f32_16x16x32_bf16 v[232:235], a[128:131], a[96:99], v[216:219]
    v_exp_f32 v224, v224
    v_mfma_f32_16x16x32_bf16 v[232:235], a[132:135], a[100:103], v[232:235]
    v_exp_f32 v225, v225
    v_mfma_f32_16x16x32_bf16 v[232:235], a[136:139], a[104:107], v[232:235]
    v_exp_f32 v226, v226
    v_mfma_f32_16x16x32_bf16 v[232:235], a[140:143], a[108:111], v[232:235]
    v_exp_f32 v227, v227
    v_mfma_f32_16x16x32_bf16 v[144:147], a[160:163], v[240:243], v[144:147]
    v_cvt_pk_bf16_f32 v238, v224, v225
    v_add_u32 v245, s34, v245
    v_mfma_f32_16x16x32_bf16 v[148:151], a[164:167], v[240:243], v[148:151]
    v_cvt_pk_bf16_f32 v239, v226, v227
    v_add_u32 v246, s34, v246
    v_mfma_f32_16x16x32_bf16 v[152:155], a[168:171], v[240:243], v[152:155]
    v_mfma_f32_16x16x32_bf16 v[156:159], a[172:175], v[240:243], v[156:159]
    v_mfma_f32_16x16x32_bf16 a[192:195], a[204:207], v[240:243], a[192:195]
    v_mfma_f32_16x16x32_bf16 v[220:223], a[112:115], a[0:3], v[192:195]
    v_exp_f32 v228, v228
    v_mfma_f32_16x16x32_bf16 v[220:223], a[116:119], a[4:7], v[220:223]
    v_exp_f32 v229, v229
    v_mfma_f32_16x16x32_bf16 v[220:223], a[120:123], a[8:11], v[220:223]
    v_exp_f32 v230, v230
    v_mfma_f32_16x16x32_bf16 v[220:223], a[124:127], a[12:15], v[220:223]
    v_exp_f32 v231, v231
    v_mfma_f32_16x16x32_bf16 v[160:163], a[144:147], v[236:239], v[160:163]
    v_cvt_pk_bf16_f32 v240, v228, v229
    ds_read_b64_tr_b16 a[144:145], v245 offset:0
    v_mfma_f32_16x16x32_bf16 v[164:167], a[148:151], v[236:239], v[164:167]
    v_cvt_pk_bf16_f32 v241, v230, v231
    ds_read_b64_tr_b16 a[146:147], v245 offset:4096
    v_mfma_f32_16x16x32_bf16 v[168:171], a[152:155], v[236:239], v[168:171]
    ds_read_b64_tr_b16 a[148:149], v246 offset:0
    ds_read_b64_tr_b16 a[150:151], v246 offset:4096
    v_mfma_f32_16x16x32_bf16 v[172:175], a[156:159], v[236:239], v[172:175]
    ds_read_b64_tr_b16 a[152:153], v245 offset:256
    ds_read_b64_tr_b16 a[154:155], v245 offset:4352
    v_mfma_f32_16x16x32_bf16 v[224:227], a[128:131], a[0:3], v[192:195]
    v_exp_f32 v232, v232
    v_mfma_f32_16x16x32_bf16 v[224:227], a[132:135], a[4:7], v[224:227]
    v_exp_f32 v233, v233
    v_mfma_f32_16x16x32_bf16 v[224:227], a[136:139], a[8:11], v[224:227]
    v_exp_f32 v234, v234
    v_mfma_f32_16x16x32_bf16 v[224:227], a[140:143], a[12:15], v[224:227]
    v_exp_f32 v235, v235
    v_mfma_f32_16x16x32_bf16 v[176:179], a[160:163], v[236:239], v[176:179]
    v_cvt_pk_bf16_f32 v242, v232, v233
    ds_read_b64_tr_b16 a[156:157], v246 offset:256
    v_mfma_f32_16x16x32_bf16 v[180:183], a[164:167], v[236:239], v[180:183]
    v_cvt_pk_bf16_f32 v243, v234, v235
    ds_read_b64_tr_b16 a[158:159], v246 offset:4352
    v_mfma_f32_16x16x32_bf16 v[184:187], a[168:171], v[236:239], v[184:187]
    ds_read_b64_tr_b16 a[160:161], v245 offset:512
    ds_read_b64_tr_b16 a[162:163], v245 offset:4608
    v_mfma_f32_16x16x32_bf16 v[188:191], a[172:175], v[236:239], v[188:191]
    ds_read_b64_tr_b16 a[164:165], v246 offset:512
    ds_read_b64_tr_b16 a[166:167], v246 offset:4608
    v_mfma_f32_16x16x32_bf16 a[196:199], a[204:207], v[236:239], a[196:199]
    ds_read_b64_tr_b16 a[168:169], v245 offset:768
    ds_read_b64_tr_b16 a[170:171], v245 offset:4864
    v_mfma_f32_16x16x32_bf16 v[228:231], a[112:115], a[16:19], v[196:199]
    v_exp_f32 v220, v220
    v_mfma_f32_16x16x32_bf16 v[228:231], a[116:119], a[20:23], v[228:231]
    v_exp_f32 v221, v221
    v_mfma_f32_16x16x32_bf16 v[228:231], a[120:123], a[24:27], v[228:231]
    v_exp_f32 v222, v222
    v_mfma_f32_16x16x32_bf16 v[228:231], a[124:127], a[28:31], v[228:231]
    v_exp_f32 v223, v223
    s_waitcnt lgkmcnt(6)
    v_mfma_f32_16x16x32_bf16 a[208:211], a[144:147], v[240:243], a[208:211]
    v_cvt_pk_bf16_f32 v236, v220, v221
    ds_read_b64_tr_b16 a[172:173], v246 offset:768
    v_mfma_f32_16x16x32_bf16 a[212:215], a[148:151], v[240:243], a[212:215]
    v_cvt_pk_bf16_f32 v237, v222, v223
    ds_read_b64_tr_b16 a[174:175], v246 offset:4864
    v_mfma_f32_16x16x32_bf16 a[216:219], a[152:155], v[240:243], a[216:219]
    v_mfma_f32_16x16x32_bf16 a[220:223], a[156:159], v[240:243], a[220:223]
    s_waitcnt lgkmcnt(2)
    v_mfma_f32_16x16x32_bf16 v[232:235], a[128:131], a[16:19], v[196:199]
    v_exp_f32 v224, v224
    v_mfma_f32_16x16x32_bf16 v[232:235], a[132:135], a[20:23], v[232:235]
    v_exp_f32 v225, v225
    v_mfma_f32_16x16x32_bf16 v[232:235], a[136:139], a[24:27], v[232:235]
    v_exp_f32 v226, v226
    v_mfma_f32_16x16x32_bf16 v[232:235], a[140:143], a[28:31], v[232:235]
    v_exp_f32 v227, v227
    v_mfma_f32_16x16x32_bf16 a[224:227], a[160:163], v[240:243], a[224:227]
    v_cvt_pk_bf16_f32 v238, v224, v225
    v_mfma_f32_16x16x32_bf16 a[228:231], a[164:167], v[240:243], a[228:231]
    v_cvt_pk_bf16_f32 v239, v226, v227
    v_mfma_f32_16x16x32_bf16 a[232:235], a[168:171], v[240:243], a[232:235]
    s_waitcnt lgkmcnt(0)
    v_mfma_f32_16x16x32_bf16 a[236:239], a[172:175], v[240:243], a[236:239]
    v_mfma_f32_16x16x32_bf16 a[200:203], a[204:207], v[240:243], a[200:203]
    s_waitcnt vmcnt(8)
    s_barrier
    v_mfma_f32_16x16x32_bf16 v[220:223], a[112:115], a[32:35], v[200:203]
    v_exp_f32 v228, v228
    v_mfma_f32_16x16x32_bf16 v[220:223], a[116:119], a[36:39], v[220:223]
    v_exp_f32 v229, v229
    v_mfma_f32_16x16x32_bf16 v[220:223], a[120:123], a[40:43], v[220:223]
    v_exp_f32 v230, v230
    v_mfma_f32_16x16x32_bf16 v[220:223], a[124:127], a[44:47], v[220:223]
    v_exp_f32 v231, v231
    v_mfma_f32_16x16x32_bf16 v[0:3], a[144:147], v[236:239], v[0:3]
    v_cvt_pk_bf16_f32 v240, v228, v229
    s_add_u32 m0, s37, s29
    v_mfma_f32_16x16x32_bf16 v[4:7], a[148:151], v[236:239], v[4:7]
    v_cvt_pk_bf16_f32 v241, v230, v231
    v_mfma_f32_16x16x32_bf16 v[8:11], a[152:155], v[236:239], v[8:11]
    buffer_load_dwordx4 v248, s[16:19], s32 offen offset:0 nt lds
    v_mfma_f32_16x16x32_bf16 v[12:15], a[156:159], v[236:239], v[12:15]
    buffer_load_dwordx4 v249, s[16:19], s32 offen offset:1024 nt lds
    v_mfma_f32_16x16x32_bf16 v[224:227], a[128:131], a[32:35], v[200:203]
    v_exp_f32 v232, v232
    v_mfma_f32_16x16x32_bf16 v[224:227], a[132:135], a[36:39], v[224:227]
    v_exp_f32 v233, v233
    v_mfma_f32_16x16x32_bf16 v[224:227], a[136:139], a[40:43], v[224:227]
    v_exp_f32 v234, v234
    v_mfma_f32_16x16x32_bf16 v[224:227], a[140:143], a[44:47], v[224:227]
    v_exp_f32 v235, v235
    v_mfma_f32_16x16x32_bf16 v[16:19], a[160:163], v[236:239], v[16:19]
    v_cvt_pk_bf16_f32 v242, v232, v233
    v_mfma_f32_16x16x32_bf16 v[20:23], a[164:167], v[236:239], v[20:23]
    v_cvt_pk_bf16_f32 v243, v234, v235
    v_mfma_f32_16x16x32_bf16 v[24:27], a[168:171], v[236:239], v[24:27]
    buffer_load_dwordx4 v248, s[16:19], s32 offen offset:2048 nt lds
    v_mfma_f32_16x16x32_bf16 v[28:31], a[172:175], v[236:239], v[28:31]
    buffer_load_dwordx4 v249, s[16:19], s32 offen offset:3072 nt lds
    s_add_u32 m0, m0, 4096
    v_mfma_f32_16x16x32_bf16 a[176:179], a[204:207], v[236:239], a[176:179]
    buffer_load_dwordx4 v248, s[16:19], s33 offen offset:0 nt lds
    v_mfma_f32_16x16x32_bf16 v[228:231], a[112:115], a[48:51], v[204:207]
    v_exp_f32 v220, v220
    v_mfma_f32_16x16x32_bf16 v[228:231], a[116:119], a[52:55], v[228:231]
    v_exp_f32 v221, v221
    v_mfma_f32_16x16x32_bf16 v[228:231], a[120:123], a[56:59], v[228:231]
    v_exp_f32 v222, v222
    v_mfma_f32_16x16x32_bf16 v[228:231], a[124:127], a[60:63], v[228:231]
    v_exp_f32 v223, v223
    v_mfma_f32_16x16x32_bf16 v[32:35], a[144:147], v[240:243], v[32:35]
    v_cvt_pk_bf16_f32 v236, v220, v221
    v_mfma_f32_16x16x32_bf16 v[36:39], a[148:151], v[240:243], v[36:39]
    v_cvt_pk_bf16_f32 v237, v222, v223
    v_mfma_f32_16x16x32_bf16 v[40:43], a[152:155], v[240:243], v[40:43]
    buffer_load_dwordx4 v249, s[16:19], s33 offen offset:1024 nt lds
    v_mfma_f32_16x16x32_bf16 v[44:47], a[156:159], v[240:243], v[44:47]
    buffer_load_dwordx4 v248, s[16:19], s33 offen offset:2048 nt lds
    v_mfma_f32_16x16x32_bf16 v[232:235], a[128:131], a[48:51], v[204:207]
    v_exp_f32 v224, v224
    v_mfma_f32_16x16x32_bf16 v[232:235], a[132:135], a[52:55], v[232:235]
    v_exp_f32 v225, v225
    v_mfma_f32_16x16x32_bf16 v[232:235], a[136:139], a[56:59], v[232:235]
    v_exp_f32 v226, v226
    v_mfma_f32_16x16x32_bf16 v[232:235], a[140:143], a[60:63], v[232:235]
    v_exp_f32 v227, v227
    v_mfma_f32_16x16x32_bf16 v[48:51], a[160:163], v[240:243], v[48:51]
    v_cvt_pk_bf16_f32 v238, v224, v225
    v_mfma_f32_16x16x32_bf16 v[52:55], a[164:167], v[240:243], v[52:55]
    v_cvt_pk_bf16_f32 v239, v226, v227
    v_mfma_f32_16x16x32_bf16 v[56:59], a[168:171], v[240:243], v[56:59]
    buffer_load_dwordx4 v249, s[16:19], s33 offen offset:3072 nt lds
    v_mfma_f32_16x16x32_bf16 v[60:63], a[172:175], v[240:243], v[60:63]
    s_add_u32 s64, s64, 8192
    s_xor_b32 s32, s64, s65
    v_mfma_f32_16x16x32_bf16 a[180:183], a[204:207], v[240:243], a[180:183]
    s_or_b32 s33, s32, 4096
    s_add_u32 s29, s29, 32768
    v_mfma_f32_16x16x32_bf16 v[220:223], a[112:115], a[64:67], v[208:211]
    v_exp_f32 v228, v228
    v_mfma_f32_16x16x32_bf16 v[220:223], a[116:119], a[68:71], v[220:223]
    v_exp_f32 v229, v229
    v_mfma_f32_16x16x32_bf16 v[220:223], a[120:123], a[72:75], v[220:223]
    v_exp_f32 v230, v230
    v_mfma_f32_16x16x32_bf16 v[220:223], a[124:127], a[76:79], v[220:223]
    v_exp_f32 v231, v231
    v_mfma_f32_16x16x32_bf16 v[64:67], a[144:147], v[236:239], v[64:67]
    v_cvt_pk_bf16_f32 v240, v228, v229
    s_add_u32 s44, s39, 32768
    v_mfma_f32_16x16x32_bf16 v[68:71], a[148:151], v[236:239], v[68:71]
    v_cvt_pk_bf16_f32 v241, v230, v231
    v_mfma_f32_16x16x32_bf16 v[72:75], a[152:155], v[236:239], v[72:75]
    s_cmp_eq_u32 s44, 163840
    s_cselect_b32 s44, 0, s44
    v_mfma_f32_16x16x32_bf16 v[76:79], a[156:159], v[236:239], v[76:79]
    s_cmp_eq_u32 s29, 163840
    s_cselect_b32 s29, 0, s29
    v_mfma_f32_16x16x32_bf16 v[224:227], a[128:131], a[64:67], v[208:211]
    v_exp_f32 v232, v232
    v_mfma_f32_16x16x32_bf16 v[224:227], a[132:135], a[68:71], v[224:227]
    v_exp_f32 v233, v233
    v_mfma_f32_16x16x32_bf16 v[224:227], a[136:139], a[72:75], v[224:227]
    v_exp_f32 v234, v234
    v_mfma_f32_16x16x32_bf16 v[224:227], a[140:143], a[76:79], v[224:227]
    v_exp_f32 v235, v235
    v_mfma_f32_16x16x32_bf16 v[80:83], a[160:163], v[236:239], v[80:83]
    v_cvt_pk_bf16_f32 v242, v232, v233
    s_sub_u32 s34, s44, s39
    v_mfma_f32_16x16x32_bf16 v[84:87], a[164:167], v[236:239], v[84:87]
    v_cvt_pk_bf16_f32 v243, v234, v235
    s_mov_b32 s39, s44
    v_mfma_f32_16x16x32_bf16 v[88:91], a[168:171], v[236:239], v[88:91]
    v_mfma_f32_16x16x32_bf16 v[92:95], a[172:175], v[236:239], v[92:95]
    v_mfma_f32_16x16x32_bf16 a[184:187], a[204:207], v[236:239], a[184:187]
    v_mfma_f32_16x16x32_bf16 v[228:231], a[112:115], a[80:83], v[212:215]
    v_exp_f32 v220, v220
    v_mfma_f32_16x16x32_bf16 v[228:231], a[116:119], a[84:87], v[228:231]
    v_exp_f32 v221, v221
    v_mfma_f32_16x16x32_bf16 v[228:231], a[120:123], a[88:91], v[228:231]
    v_exp_f32 v222, v222
    v_mfma_f32_16x16x32_bf16 v[228:231], a[124:127], a[92:95], v[228:231]
    v_exp_f32 v223, v223
    v_mfma_f32_16x16x32_bf16 v[96:99], a[144:147], v[240:243], v[96:99]
    v_cvt_pk_bf16_f32 v236, v220, v221
    v_add_u32 v244, s34, v244
    v_mfma_f32_16x16x32_bf16 v[100:103], a[148:151], v[240:243], v[100:103]
    v_cvt_pk_bf16_f32 v237, v222, v223
    v_mfma_f32_16x16x32_bf16 v[104:107], a[152:155], v[240:243], v[104:107]
    v_mfma_f32_16x16x32_bf16 v[108:111], a[156:159], v[240:243], v[108:111]
    v_mfma_f32_16x16x32_bf16 v[232:235], a[128:131], a[80:83], v[212:215]
    v_exp_f32 v224, v224
    v_mfma_f32_16x16x32_bf16 v[232:235], a[132:135], a[84:87], v[232:235]
    v_exp_f32 v225, v225
    v_mfma_f32_16x16x32_bf16 v[232:235], a[136:139], a[88:91], v[232:235]
    v_exp_f32 v226, v226
    v_mfma_f32_16x16x32_bf16 v[232:235], a[140:143], a[92:95], v[232:235]
    v_exp_f32 v227, v227
    v_mfma_f32_16x16x32_bf16 v[112:115], a[160:163], v[240:243], v[112:115]
    v_cvt_pk_bf16_f32 v238, v224, v225
    v_mfma_f32_16x16x32_bf16 v[116:119], a[164:167], v[240:243], v[116:119]
    v_cvt_pk_bf16_f32 v239, v226, v227
    v_mfma_f32_16x16x32_bf16 v[120:123], a[168:171], v[240:243], v[120:123]
    v_mfma_f32_16x16x32_bf16 v[124:127], a[172:175], v[240:243], v[124:127]
    v_mfma_f32_16x16x32_bf16 a[188:191], a[204:207], v[240:243], a[188:191]
    s_sub_u32 s28, s28, 1
    s_cmp_lg_u32 s28, 0
    s_cbranch_scc1 L1_a0_1
    ds_read_b128 a[112:115], v244 offset:0
    ds_read_b128 a[116:119], v244 offset:256
    ds_read_b128 a[120:123], v244 offset:512
    ds_read_b128 a[124:127], v244 offset:768
    ds_read_b128 a[128:131], v244 offset:4096
    ds_read_b128 a[132:135], v244 offset:4352
    ds_read_b128 a[136:139], v244 offset:4608
    ds_read_b128 a[140:143], v244 offset:4864
    s_waitcnt lgkmcnt(4)
    v_mfma_f32_16x16x32_bf16 v[220:223], a[112:115], a[0:3], v[192:195]
    v_exp_f32 v228, v228
    v_mfma_f32_16x16x32_bf16 v[220:223], a[116:119], a[4:7], v[220:223]
    v_exp_f32 v229, v229
    v_mfma_f32_16x16x32_bf16 v[220:223], a[120:123], a[8:11], v[220:223]
    v_exp_f32 v230, v230
    v_mfma_f32_16x16x32_bf16 v[220:223], a[124:127], a[12:15], v[220:223]
    v_exp_f32 v231, v231
    v_mfma_f32_16x16x32_bf16 v[128:131], a[144:147], v[236:239], v[128:131]
    v_cvt_pk_bf16_f32 v240, v228, v229
    buffer_load_dword v255, v250, s[56:59], s55 offen
    v_mfma_f32_16x16x32_bf16 v[132:135], a[148:151], v[236:239], v[132:135]
    v_cvt_pk_bf16_f32 v241, v230, v231
    s_xor_b32 s54, s55, 32768
    v_mfma_f32_16x16x32_bf16 v[136:139], a[152:155], v[236:239], v[136:139]
    buffer_load_dword v255, v250, s[56:59], s54 offen
    v_lshlrev_b32 v253, 4, v247
    s_lshl_b32 s43, s27, 1
    v_mfma_f32_16x16x32_bf16 v[140:143], a[156:159], v[236:239], v[140:143]
    s_waitcnt lgkmcnt(0)
    s_add_u32 s43, s43, s25
    s_mul_i32 s43, s43, 53248
    v_mfma_f32_16x16x32_bf16 v[224:227], a[128:131], a[0:3], v[192:195]
    v_exp_f32 v232, v232
    v_mfma_f32_16x16x32_bf16 v[224:227], a[132:135], a[4:7], v[224:227]
    v_exp_f32 v233, v233
    v_mfma_f32_16x16x32_bf16 v[224:227], a[136:139], a[8:11], v[224:227]
    v_exp_f32 v234, v234
    v_mfma_f32_16x16x32_bf16 v[224:227], a[140:143], a[12:15], v[224:227]
    v_exp_f32 v235, v235
    v_mfma_f32_16x16x32_bf16 v[144:147], a[160:163], v[236:239], v[144:147]
    v_cvt_pk_bf16_f32 v242, v232, v233
    v_add_u32 v245, s34, v245
    v_mfma_f32_16x16x32_bf16 v[148:151], a[164:167], v[236:239], v[148:151]
    v_cvt_pk_bf16_f32 v243, v234, v235
    v_add_u32 v246, s34, v246
    v_mfma_f32_16x16x32_bf16 v[152:155], a[168:171], v[236:239], v[152:155]
    v_mfma_f32_16x16x32_bf16 v[156:159], a[172:175], v[236:239], v[156:159]
    v_mfma_f32_16x16x32_bf16 a[192:195], a[204:207], v[236:239], a[192:195]
    v_mfma_f32_16x16x32_bf16 v[228:231], a[112:115], a[16:19], v[196:199]
    v_exp_f32 v220, v220
    v_mfma_f32_16x16x32_bf16 v[228:231], a[116:119], a[20:23], v[228:231]
    v_exp_f32 v221, v221
    v_mfma_f32_16x16x32_bf16 v[228:231], a[120:123], a[24:27], v[228:231]
    v_exp_f32 v222, v222
    v_mfma_f32_16x16x32_bf16 v[228:231], a[124:127], a[28:31], v[228:231]
    v_exp_f32 v223, v223
    v_mfma_f32_16x16x32_bf16 v[160:163], a[144:147], v[240:243], v[160:163]
    v_cvt_pk_bf16_f32 v236, v220, v221
    ds_read_b64_tr_b16 a[144:145], v245 offset:0
    v_mfma_f32_16x16x32_bf16 v[164:167], a[148:151], v[240:243], v[164:167]
    v_cvt_pk_bf16_f32 v237, v222, v223
    ds_read_b64_tr_b16 a[146:147], v245 offset:4096
    v_mfma_f32_16x16x32_bf16 v[168:171], a[152:155], v[240:243], v[168:171]
    ds_read_b64_tr_b16 a[148:149], v246 offset:0
    ds_read_b64_tr_b16 a[150:151], v246 offset:4096
    v_mfma_f32_16x16x32_bf16 v[172:175], a[156:159], v[240:243], v[172:175]
    ds_read_b64_tr_b16 a[152:153], v245 offset:256
    ds_read_b64_tr_b16 a[154:155], v245 offset:4352
    v_mfma_f32_16x16x32_bf16 v[232:235], a[128:131], a[16:19], v[196:199]
    v_exp_f32 v224, v224
    v_mfma_f32_16x16x32_bf16 v[232:235], a[132:135], a[20:23], v[232:235]
    v_exp_f32 v225, v225
    v_mfma_f32_16x16x32_bf16 v[232:235], a[136:139], a[24:27], v[232:235]
    v_exp_f32 v226, v226
    v_mfma_f32_16x16x32_bf16 v[232:235], a[140:143], a[28:31], v[232:235]
    v_exp_f32 v227, v227
    v_mfma_f32_16x16x32_bf16 v[176:179], a[160:163], v[240:243], v[176:179]
    v_cvt_pk_bf16_f32 v238, v224, v225
    ds_read_b64_tr_b16 a[156:157], v246 offset:256
    v_mfma_f32_16x16x32_bf16 v[180:183], a[164:167], v[240:243], v[180:183]
    v_cvt_pk_bf16_f32 v239, v226, v227
    ds_read_b64_tr_b16 a[158:159], v246 offset:4352
    v_mfma_f32_16x16x32_bf16 v[184:187], a[168:171], v[240:243], v[184:187]
    ds_read_b64_tr_b16 a[160:161], v245 offset:512
    ds_read_b64_tr_b16 a[162:163], v245 offset:4608
    v_mfma_f32_16x16x32_bf16 v[188:191], a[172:175], v[240:243], v[188:191]
    ds_read_b64_tr_b16 a[164:165], v246 offset:512
    ds_read_b64_tr_b16 a[166:167], v246 offset:4608
    v_mfma_f32_16x16x32_bf16 a[196:199], a[204:207], v[240:243], a[196:199]
    ds_read_b64_tr_b16 a[168:169], v245 offset:768
    ds_read_b64_tr_b16 a[170:171], v245 offset:4864
    v_mfma_f32_16x16x32_bf16 v[220:223], a[112:115], a[32:35], v[200:203]
    v_exp_f32 v228, v228
    v_mfma_f32_16x16x32_bf16 v[220:223], a[116:119], a[36:39], v[220:223]
    v_exp_f32 v229, v229
    v_mfma_f32_16x16x32_bf16 v[220:223], a[120:123], a[40:43], v[220:223]
    v_exp_f32 v230, v230
    v_mfma_f32_16x16x32_bf16 v[220:223], a[124:127], a[44:47], v[220:223]
    v_exp_f32 v231, v231
    s_waitcnt lgkmcnt(6)
    v_mfma_f32_16x16x32_bf16 v[0:3], a[144:147], v[236:239], v[0:3]
    v_cvt_pk_bf16_f32 v240, v228, v229
    ds_read_b64_tr_b16 a[172:173], v246 offset:768
    v_mfma_f32_16x16x32_bf16 v[4:7], a[148:151], v[236:239], v[4:7]
    v_cvt_pk_bf16_f32 v241, v230, v231
    ds_read_b64_tr_b16 a[174:175], v246 offset:4864
    v_mfma_f32_16x16x32_bf16 v[8:11], a[152:155], v[236:239], v[8:11]
    v_mfma_f32_16x16x32_bf16 v[12:15], a[156:159], v[236:239], v[12:15]
    s_waitcnt lgkmcnt(2)
    v_mfma_f32_16x16x32_bf16 v[224:227], a[128:131], a[32:35], v[200:203]
    v_exp_f32 v232, v232
    v_mfma_f32_16x16x32_bf16 v[224:227], a[132:135], a[36:39], v[224:227]
    v_exp_f32 v233, v233
    v_mfma_f32_16x16x32_bf16 v[224:227], a[136:139], a[40:43], v[224:227]
    v_exp_f32 v234, v234
    v_mfma_f32_16x16x32_bf16 v[224:227], a[140:143], a[44:47], v[224:227]
    v_exp_f32 v235, v235
    v_mfma_f32_16x16x32_bf16 v[16:19], a[160:163], v[236:239], v[16:19]
    v_cvt_pk_bf16_f32 v242, v232, v233
    v_mfma_f32_16x16x32_bf16 v[20:23], a[164:167], v[236:239], v[20:23]
    v_cvt_pk_bf16_f32 v243, v234, v235
    v_mfma_f32_16x16x32_bf16 v[24:27], a[168:171], v[236:239], v[24:27]
    s_waitcnt lgkmcnt(0)
    v_mfma_f32_16x16x32_bf16 v[28:31], a[172:175], v[236:239], v[28:31]
    v_mfma_f32_16x16x32_bf16 a[176:179], a[204:207], v[236:239], a[176:179]
    s_waitcnt vmcnt(2)
    s_barrier
    v_mfma_f32_16x16x32_bf16 v[228:231], a[112:115], a[96:99], v[216:219]
    v_exp_f32 v220, v220
    v_mfma_f32_16x16x32_bf16 v[228:231], a[116:119], a[100:103], v[228:231]
    v_exp_f32 v221, v221
    v_mfma_f32_16x16x32_bf16 v[228:231], a[120:123], a[104:107], v[228:231]
    v_exp_f32 v222, v222
    v_mfma_f32_16x16x32_bf16 v[228:231], a[124:127], a[108:111], v[228:231]
    v_exp_f32 v223, v223
    v_mfma_f32_16x16x32_bf16 v[32:35], a[144:147], v[240:243], v[32:35]
    v_cvt_pk_bf16_f32 v236, v220, v221
    v_add_u32 v244, 32768, v244
    v_mfma_f32_16x16x32_bf16 v[36:39], a[148:151], v[240:243], v[36:39]
    v_cvt_pk_bf16_f32 v237, v222, v223
    v_mfma_f32_16x16x32_bf16 v[40:43], a[152:155], v[240:243], v[40:43]
    ds_read_b128 a[112:115], v244 offset:0
    ds_read_b128 a[116:119], v244 offset:256
    v_mfma_f32_16x16x32_bf16 v[44:47], a[156:159], v[240:243], v[44:47]
    ds_read_b128 a[120:123], v244 offset:512
    ds_read_b128 a[124:127], v244 offset:768
    v_mfma_f32_16x16x32_bf16 v[232:235], a[128:131], a[96:99], v[216:219]
    v_exp_f32 v224, v224
    v_mfma_f32_16x16x32_bf16 v[232:235], a[132:135], a[100:103], v[232:235]
    v_exp_f32 v225, v225
    v_mfma_f32_16x16x32_bf16 v[232:235], a[136:139], a[104:107], v[232:235]
    v_exp_f32 v226, v226
    v_mfma_f32_16x16x32_bf16 v[232:235], a[140:143], a[108:111], v[232:235]
    v_exp_f32 v227, v227
    v_mfma_f32_16x16x32_bf16 v[48:51], a[160:163], v[240:243], v[48:51]
    v_cvt_pk_bf16_f32 v238, v224, v225
    v_mfma_f32_16x16x32_bf16 v[52:55], a[164:167], v[240:243], v[52:55]
    v_cvt_pk_bf16_f32 v239, v226, v227
    v_mfma_f32_16x16x32_bf16 v[56:59], a[168:171], v[240:243], v[56:59]
    ds_read_b128 a[128:131], v244 offset:4096
    ds_read_b128 a[132:135], v244 offset:4352
    v_mfma_f32_16x16x32_bf16 v[60:63], a[172:175], v[240:243], v[60:63]
    ds_read_b128 a[136:139], v244 offset:4608
    ds_read_b128 a[140:143], v244 offset:4864
    v_mfma_f32_16x16x32_bf16 a[180:183], a[204:207], v[240:243], a[180:183]
    s_waitcnt lgkmcnt(7)
    v_mfma_f32_16x16x32_bf16 v[220:223], a[112:115], a[0:3], v[192:195]
    v_exp_f32 v228, v228
    s_waitcnt lgkmcnt(6)
    v_mfma_f32_16x16x32_bf16 v[220:223], a[116:119], a[4:7], v[220:223]
    v_exp_f32 v229, v229
    s_waitcnt lgkmcnt(5)
    v_mfma_f32_16x16x32_bf16 v[220:223], a[120:123], a[8:11], v[220:223]
    v_exp_f32 v230, v230
    s_waitcnt lgkmcnt(4)
    v_mfma_f32_16x16x32_bf16 v[220:223], a[124:127], a[12:15], v[220:223]
    v_exp_f32 v231, v231
    v_mfma_f32_16x16x32_bf16 v[64:67], a[144:147], v[236:239], v[64:67]
    v_cvt_pk_bf16_f32 v240, v228, v229
    v_mfma_f32_16x16x32_bf16 v[68:71], a[148:151], v[236:239], v[68:71]
    v_cvt_pk_bf16_f32 v241, v230, v231
    v_mfma_f32_16x16x32_bf16 v[72:75], a[152:155], v[236:239], v[72:75]
    v_mfma_f32_16x16x32_bf16 v[76:79], a[156:159], v[236:239], v[76:79]
    s_waitcnt lgkmcnt(3)
    v_mfma_f32_16x16x32_bf16 v[224:227], a[128:131], a[0:3], v[192:195]
    v_exp_f32 v232, v232
    s_waitcnt lgkmcnt(2)
    v_mfma_f32_16x16x32_bf16 v[224:227], a[132:135], a[4:7], v[224:227]
    v_exp_f32 v233, v233
    s_waitcnt lgkmcnt(1)
    v_mfma_f32_16x16x32_bf16 v[224:227], a[136:139], a[8:11], v[224:227]
    v_exp_f32 v234, v234
    s_waitcnt lgkmcnt(0)
    v_mfma_f32_16x16x32_bf16 v[224:227], a[140:143], a[12:15], v[224:227]
    v_exp_f32 v235, v235
    v_mfma_f32_16x16x32_bf16 v[80:83], a[160:163], v[236:239], v[80:83]
    v_cvt_pk_bf16_f32 v242, v232, v233
    v_add_u32 v245, 32768, v245
    v_mfma_f32_16x16x32_bf16 v[84:87], a[164:167], v[236:239], v[84:87]
    v_cvt_pk_bf16_f32 v243, v234, v235
    v_add_u32 v246, 32768, v246
    v_mfma_f32_16x16x32_bf16 v[88:91], a[168:171], v[236:239], v[88:91]
    v_mfma_f32_16x16x32_bf16 v[92:95], a[172:175], v[236:239], v[92:95]
    v_mfma_f32_16x16x32_bf16 a[184:187], a[204:207], v[236:239], a[184:187]
    v_mfma_f32_16x16x32_bf16 v[228:231], a[112:115], a[16:19], v[196:199]
    v_exp_f32 v220, v220
    v_mfma_f32_16x16x32_bf16 v[228:231], a[116:119], a[20:23], v[228:231]
    v_exp_f32 v221, v221
    v_mfma_f32_16x16x32_bf16 v[228:231], a[120:123], a[24:27], v[228:231]
    v_exp_f32 v222, v222
    v_mfma_f32_16x16x32_bf16 v[228:231], a[124:127], a[28:31], v[228:231]
    v_exp_f32 v223, v223
    v_mfma_f32_16x16x32_bf16 a[208:211], a[144:147], v[240:243], a[208:211]
    v_cvt_pk_bf16_f32 v236, v220, v221
    ds_read_b64_tr_b16 a[144:145], v245 offset:0
    v_mfma_f32_16x16x32_bf16 a[212:215], a[148:151], v[240:243], a[212:215]
    v_cvt_pk_bf16_f32 v237, v222, v223
    ds_read_b64_tr_b16 a[146:147], v245 offset:4096
    v_mfma_f32_16x16x32_bf16 a[216:219], a[152:155], v[240:243], a[216:219]
    ds_read_b64_tr_b16 a[148:149], v246 offset:0
    ds_read_b64_tr_b16 a[150:151], v246 offset:4096
    v_mfma_f32_16x16x32_bf16 a[220:223], a[156:159], v[240:243], a[220:223]
    ds_read_b64_tr_b16 a[152:153], v245 offset:256
    ds_read_b64_tr_b16 a[154:155], v245 offset:4352
    v_mfma_f32_16x16x32_bf16 v[232:235], a[128:131], a[16:19], v[196:199]
    v_exp_f32 v224, v224
    v_mfma_f32_16x16x32_bf16 v[232:235], a[132:135], a[20:23], v[232:235]
    v_exp_f32 v225, v225
    v_mfma_f32_16x16x32_bf16 v[232:235], a[136:139], a[24:27], v[232:235]
    v_exp_f32 v226, v226
    v_mfma_f32_16x16x32_bf16 v[232:235], a[140:143], a[28:31], v[232:235]
    v_exp_f32 v227, v227
    v_mfma_f32_16x16x32_bf16 a[224:227], a[160:163], v[240:243], a[224:227]
    v_cvt_pk_bf16_f32 v238, v224, v225
    ds_read_b64_tr_b16 a[156:157], v246 offset:256
    v_mfma_f32_16x16x32_bf16 a[228:231], a[164:167], v[240:243], a[228:231]
    v_cvt_pk_bf16_f32 v239, v226, v227
    ds_read_b64_tr_b16 a[158:159], v246 offset:4352
    v_mfma_f32_16x16x32_bf16 a[232:235], a[168:171], v[240:243], a[232:235]
    ds_read_b64_tr_b16 a[160:161], v245 offset:512
    ds_read_b64_tr_b16 a[162:163], v245 offset:4608
    v_mfma_f32_16x16x32_bf16 a[236:239], a[172:175], v[240:243], a[236:239]
    ds_read_b64_tr_b16 a[164:165], v246 offset:512
    ds_read_b64_tr_b16 a[166:167], v246 offset:4608
    v_mfma_f32_16x16x32_bf16 a[200:203], a[204:207], v[240:243], a[200:203]
    ds_read_b64_tr_b16 a[168:169], v245 offset:768
    ds_read_b64_tr_b16 a[170:171], v245 offset:4864
    v_mfma_f32_16x16x32_bf16 v[220:223], a[112:115], a[32:35], v[200:203]
    v_exp_f32 v228, v228
    v_mfma_f32_16x16x32_bf16 v[220:223], a[116:119], a[36:39], v[220:223]
    v_exp_f32 v229, v229
    v_mfma_f32_16x16x32_bf16 v[220:223], a[120:123], a[40:43], v[220:223]
    v_exp_f32 v230, v230
    v_mfma_f32_16x16x32_bf16 v[220:223], a[124:127], a[44:47], v[220:223]
    v_exp_f32 v231, v231
    s_waitcnt lgkmcnt(12)
    v_mfma_f32_16x16x32_bf16 v[0:3], a[144:147], v[236:239], v[0:3]
    v_cvt_pk_bf16_f32 v240, v228, v229
    ds_read_b64_tr_b16 a[172:173], v246 offset:768
    s_waitcnt lgkmcnt(11)
    v_mfma_f32_16x16x32_bf16 v[4:7], a[148:151], v[236:239], v[4:7]
    v_cvt_pk_bf16_f32 v241, v230, v231
    ds_read_b64_tr_b16 a[174:175], v246 offset:4864
    s_waitcnt lgkmcnt(10)
    v_mfma_f32_16x16x32_bf16 v[8:11], a[152:155], v[236:239], v[8:11]
    s_waitcnt lgkmcnt(8)
    v_mfma_f32_16x16x32_bf16 v[12:15], a[156:159], v[236:239], v[12:15]
    v_mfma_f32_16x16x32_bf16 v[224:227], a[128:131], a[32:35], v[200:203]
    v_exp_f32 v232, v232
    v_mfma_f32_16x16x32_bf16 v[224:227], a[132:135], a[36:39], v[224:227]
    v_exp_f32 v233, v233
    v_mfma_f32_16x16x32_bf16 v[224:227], a[136:139], a[40:43], v[224:227]
    v_exp_f32 v234, v234
    v_mfma_f32_16x16x32_bf16 v[224:227], a[140:143], a[44:47], v[224:227]
    v_exp_f32 v235, v235
    s_waitcnt lgkmcnt(6)
    v_mfma_f32_16x16x32_bf16 v[16:19], a[160:163], v[236:239], v[16:19]
    v_cvt_pk_bf16_f32 v242, v232, v233
    s_waitcnt lgkmcnt(4)
    v_mfma_f32_16x16x32_bf16 v[20:23], a[164:167], v[236:239], v[20:23]
    v_cvt_pk_bf16_f32 v243, v234, v235
    s_waitcnt lgkmcnt(2)
    v_mfma_f32_16x16x32_bf16 v[24:27], a[168:171], v[236:239], v[24:27]
    s_waitcnt lgkmcnt(0)
    v_mfma_f32_16x16x32_bf16 v[28:31], a[172:175], v[236:239], v[28:31]
    v_mfma_f32_16x16x32_bf16 a[176:179], a[204:207], v[236:239], a[176:179]
    v_mfma_f32_16x16x32_bf16 v[228:231], a[112:115], a[96:99], v[216:219]
    v_exp_f32 v220, v220
    s_nop 5
    v_accvgpr_read_b32 v194, a176
    v_mfma_f32_16x16x32_bf16 v[228:231], a[116:119], a[100:103], v[228:231]
    v_exp_f32 v221, v221
    v_rcp_f32 v192, v194
    v_mfma_f32_16x16x32_bf16 v[228:231], a[120:123], a[104:107], v[228:231]
    v_exp_f32 v222, v222
    v_mov_b32 v254, v194
    v_mfma_f32_16x16x32_bf16 v[228:231], a[124:127], a[108:111], v[228:231]
    v_exp_f32 v223, v223
    v_mul_f32 v0, v0, v192
    v_mfma_f32_16x16x32_bf16 v[32:35], a[144:147], v[240:243], v[32:35]
    v_cvt_pk_bf16_f32 v236, v220, v221
    v_subrev_u32 v244, 32768, v244
    v_mul_f32 v1, v1, v192
    v_mfma_f32_16x16x32_bf16 v[36:39], a[148:151], v[240:243], v[36:39]
    v_cvt_pk_bf16_f32 v237, v222, v223
    v_mul_f32 v2, v2, v192
    v_mul_f32 v3, v3, v192
    v_mfma_f32_16x16x32_bf16 v[40:43], a[152:155], v[240:243], v[40:43]
    ds_read_b128 a[112:115], v244 offset:0
    ds_read_b128 a[116:119], v244 offset:256
    v_mul_f32 v4, v4, v192
    v_mfma_f32_16x16x32_bf16 v[44:47], a[156:159], v[240:243], v[44:47]
    ds_read_b128 a[120:123], v244 offset:512
    ds_read_b128 a[124:127], v244 offset:768
    v_mul_f32 v5, v5, v192
    v_mfma_f32_16x16x32_bf16 v[232:235], a[128:131], a[96:99], v[216:219]
    v_exp_f32 v224, v224
    v_mul_f32 v6, v6, v192
    v_mfma_f32_16x16x32_bf16 v[232:235], a[132:135], a[100:103], v[232:235]
    v_exp_f32 v225, v225
    v_mul_f32 v7, v7, v192
    v_mfma_f32_16x16x32_bf16 v[232:235], a[136:139], a[104:107], v[232:235]
    v_exp_f32 v226, v226
    v_cvt_pk_bf16_f32 v0, v0, v1
    v_mfma_f32_16x16x32_bf16 v[232:235], a[140:143], a[108:111], v[232:235]
    v_exp_f32 v227, v227
    v_cvt_pk_bf16_f32 v1, v2, v3
    v_mfma_f32_16x16x32_bf16 v[48:51], a[160:163], v[240:243], v[48:51]
    v_cvt_pk_bf16_f32 v238, v224, v225
    v_cvt_pk_bf16_f32 v2, v4, v5
    v_cvt_pk_bf16_f32 v3, v6, v7
    v_mfma_f32_16x16x32_bf16 v[52:55], a[164:167], v[240:243], v[52:55]
    v_cvt_pk_bf16_f32 v239, v226, v227
    s_add_u32 s45, s43, 0
    buffer_store_dwordx4 v[0:3], v253, s[20:23], s45 offen sc1
    v_mfma_f32_16x16x32_bf16 v[56:59], a[168:171], v[240:243], v[56:59]
    ds_read_b128 a[128:131], v244 offset:4096
    ds_read_b128 a[132:135], v244 offset:4352
    v_mul_f32 v8, v8, v192
    v_mfma_f32_16x16x32_bf16 v[60:63], a[172:175], v[240:243], v[60:63]
    ds_read_b128 a[136:139], v244 offset:4608
    ds_read_b128 a[140:143], v244 offset:4864
    v_mul_f32 v9, v9, v192
    v_mfma_f32_16x16x32_bf16 a[180:183], a[204:207], v[240:243], a[180:183]
    v_mul_f32 v10, v10, v192
    v_mul_f32 v11, v11, v192
    v_mul_f32 v12, v12, v192
    s_waitcnt lgkmcnt(7)
    v_mfma_f32_16x16x32_bf16 v[220:223], a[112:115], a[48:51], v[204:207]
    v_exp_f32 v228, v228
    v_mul_f32 v13, v13, v192
    s_waitcnt lgkmcnt(6)
    v_mfma_f32_16x16x32_bf16 v[220:223], a[116:119], a[52:55], v[220:223]
    v_exp_f32 v229, v229
    v_mul_f32 v14, v14, v192
    s_waitcnt lgkmcnt(5)
    v_mfma_f32_16x16x32_bf16 v[220:223], a[120:123], a[56:59], v[220:223]
    v_exp_f32 v230, v230
    v_mul_f32 v15, v15, v192
    s_waitcnt lgkmcnt(4)
    v_mfma_f32_16x16x32_bf16 v[220:223], a[124:127], a[60:63], v[220:223]
    v_exp_f32 v231, v231
    v_cvt_pk_bf16_f32 v8, v8, v9
    v_mfma_f32_16x16x32_bf16 v[64:67], a[144:147], v[236:239], v[64:67]
    v_cvt_pk_bf16_f32 v240, v228, v229
    v_cvt_pk_bf16_f32 v9, v10, v11
    v_cvt_pk_bf16_f32 v10, v12, v13
    v_mfma_f32_16x16x32_bf16 v[68:71], a[148:151], v[236:239], v[68:71]
    v_cvt_pk_bf16_f32 v241, v230, v231
    v_cvt_pk_bf16_f32 v11, v14, v15
    s_add_u32 s45, s43, 13312
    v_mfma_f32_16x16x32_bf16 v[72:75], a[152:155], v[236:239], v[72:75]
    buffer_store_dwordx4 v[8:11], v253, s[20:23], s45 offen sc1
    v_mul_f32 v16, v16, v192
    v_mul_f32 v17, v17, v192
    v_mfma_f32_16x16x32_bf16 v[76:79], a[156:159], v[236:239], v[76:79]
    v_mul_f32 v18, v18, v192
    v_mul_f32 v19, v19, v192
    v_mul_f32 v20, v20, v192
    s_waitcnt lgkmcnt(3)
    v_mfma_f32_16x16x32_bf16 v[224:227], a[128:131], a[48:51], v[204:207]
    v_exp_f32 v232, v232
    v_mul_f32 v21, v21, v192
    s_waitcnt lgkmcnt(2)
    v_mfma_f32_16x16x32_bf16 v[224:227], a[132:135], a[52:55], v[224:227]
    v_exp_f32 v233, v233
    v_mul_f32 v22, v22, v192
    s_waitcnt lgkmcnt(1)
    v_mfma_f32_16x16x32_bf16 v[224:227], a[136:139], a[56:59], v[224:227]
    v_exp_f32 v234, v234
    v_mul_f32 v23, v23, v192
    s_waitcnt lgkmcnt(0)
    v_mfma_f32_16x16x32_bf16 v[224:227], a[140:143], a[60:63], v[224:227]
    v_exp_f32 v235, v235
    v_cvt_pk_bf16_f32 v16, v16, v17
    v_mfma_f32_16x16x32_bf16 v[80:83], a[160:163], v[236:239], v[80:83]
    v_cvt_pk_bf16_f32 v242, v232, v233
    v_subrev_u32 v245, 32768, v245
    v_cvt_pk_bf16_f32 v17, v18, v19
    v_mfma_f32_16x16x32_bf16 v[84:87], a[164:167], v[236:239], v[84:87]
    v_cvt_pk_bf16_f32 v243, v234, v235
    v_subrev_u32 v246, 32768, v246
    v_cvt_pk_bf16_f32 v18, v20, v21
    v_mfma_f32_16x16x32_bf16 v[88:91], a[168:171], v[236:239], v[88:91]
    v_cvt_pk_bf16_f32 v19, v22, v23
    s_add_u32 s45, s43, 26624
    buffer_store_dwordx4 v[16:19], v253, s[20:23], s45 offen sc1
    v_mfma_f32_16x16x32_bf16 v[92:95], a[172:175], v[236:239], v[92:95]
    v_mul_f32 v24, v24, v192
    v_mul_f32 v25, v25, v192
    v_mul_f32 v26, v26, v192
    v_mfma_f32_16x16x32_bf16 a[184:187], a[204:207], v[236:239], a[184:187]
    v_mul_f32 v27, v27, v192
    v_mul_f32 v28, v28, v192
    v_mul_f32 v29, v29, v192
    v_mfma_f32_16x16x32_bf16 v[228:231], a[112:115], a[64:67], v[208:211]
    v_exp_f32 v220, v220
    v_mul_f32 v30, v30, v192
    v_mfma_f32_16x16x32_bf16 v[228:231], a[116:119], a[68:71], v[228:231]
    v_exp_f32 v221, v221
    v_mul_f32 v31, v31, v192
    v_mfma_f32_16x16x32_bf16 v[228:231], a[120:123], a[72:75], v[228:231]
    v_exp_f32 v222, v222
    v_cvt_pk_bf16_f32 v24, v24, v25
    v_mfma_f32_16x16x32_bf16 v[228:231], a[124:127], a[76:79], v[228:231]
    v_exp_f32 v223, v223
    v_cvt_pk_bf16_f32 v25, v26, v27
    v_mfma_f32_16x16x32_bf16 a[208:211], a[144:147], v[240:243], a[208:211]
    v_cvt_pk_bf16_f32 v236, v220, v221
    ds_read_b64_tr_b16 a[144:145], v245 offset:0
    v_cvt_pk_bf16_f32 v26, v28, v29
    v_mfma_f32_16x16x32_bf16 a[212:215], a[148:151], v[240:243], a[212:215]
    v_cvt_pk_bf16_f32 v237, v222, v223
    ds_read_b64_tr_b16 a[146:147], v245 offset:4096
    v_cvt_pk_bf16_f32 v27, v30, v31
    v_mfma_f32_16x16x32_bf16 a[216:219], a[152:155], v[240:243], a[216:219]
    ds_read_b64_tr_b16 a[148:149], v246 offset:0
    ds_read_b64_tr_b16 a[150:151], v246 offset:4096
    s_add_u32 s45, s43, 39936
    v_mfma_f32_16x16x32_bf16 a[220:223], a[156:159], v[240:243], a[220:223]
    ds_read_b64_tr_b16 a[152:153], v245 offset:256
    ds_read_b64_tr_b16 a[154:155], v245 offset:4352
    buffer_store_dwordx4 v[24:27], v253, s[20:23], s45 offen sc1
    v_mfma_f32_16x16x32_bf16 v[232:235], a[128:131], a[64:67], v[208:211]
    v_exp_f32 v224, v224
    v_accvgpr_read_b32 v198, a180
    v_mfma_f32_16x16x32_bf16 v[232:235], a[132:135], a[68:71], v[232:235]
    v_exp_f32 v225, v225
    v_rcp_f32 v196, v198
    v_mfma_f32_16x16x32_bf16 v[232:235], a[136:139], a[72:75], v[232:235]
    v_exp_f32 v226, v226
    v_add_f32 v254, v254, v198
    v_mfma_f32_16x16x32_bf16 v[232:235], a[140:143], a[76:79], v[232:235]
    v_exp_f32 v227, v227
    v_mul_f32 v32, v32, v196
    v_mfma_f32_16x16x32_bf16 a[224:227], a[160:163], v[240:243], a[224:227]
    v_cvt_pk_bf16_f32 v238, v224, v225
    ds_read_b64_tr_b16 a[156:157], v246 offset:256
    v_mul_f32 v33, v33, v196
    v_mfma_f32_16x16x32_bf16 a[228:231], a[164:167], v[240:243], a[228:231]
    v_cvt_pk_bf16_f32 v239, v226, v227
    ds_read_b64_tr_b16 a[158:159], v246 offset:4352
    v_mul_f32 v34, v34, v196
    v_mfma_f32_16x16x32_bf16 a[232:235], a[168:171], v[240:243], a[232:235]
    ds_read_b64_tr_b16 a[160:161], v245 offset:512
    ds_read_b64_tr_b16 a[162:163], v245 offset:4608
    v_mul_f32 v35, v35, v196
    v_mfma_f32_16x16x32_bf16 a[236:239], a[172:175], v[240:243], a[236:239]
    ds_read_b64_tr_b16 a[164:165], v246 offset:512
    ds_read_b64_tr_b16 a[166:167], v246 offset:4608
    v_mul_f32 v36, v36, v196
    v_mfma_f32_16x16x32_bf16 a[200:203], a[204:207], v[240:243], a[200:203]
    ds_read_b64_tr_b16 a[168:169], v245 offset:768
    ds_read_b64_tr_b16 a[170:171], v245 offset:4864
    v_mul_f32 v37, v37, v196
    v_mfma_f32_16x16x32_bf16 v[220:223], a[112:115], a[80:83], v[212:215]
    v_exp_f32 v228, v228
    v_mul_f32 v38, v38, v196
    v_mfma_f32_16x16x32_bf16 v[220:223], a[116:119], a[84:87], v[220:223]
    v_exp_f32 v229, v229
    v_mul_f32 v39, v39, v196
    v_mfma_f32_16x16x32_bf16 v[220:223], a[120:123], a[88:91], v[220:223]
    v_exp_f32 v230, v230
    v_cvt_pk_bf16_f32 v32, v32, v33
    v_mfma_f32_16x16x32_bf16 v[220:223], a[124:127], a[92:95], v[220:223]
    v_exp_f32 v231, v231
    v_cvt_pk_bf16_f32 v33, v34, v35
    s_waitcnt lgkmcnt(12)
    v_mfma_f32_16x16x32_bf16 v[96:99], a[144:147], v[236:239], v[96:99]
    v_cvt_pk_bf16_f32 v240, v228, v229
    ds_read_b64_tr_b16 a[172:173], v246 offset:768
    v_add_u32 v244, 32768, v244
    v_cvt_pk_bf16_f32 v34, v36, v37
    s_waitcnt lgkmcnt(11)
    v_mfma_f32_16x16x32_bf16 v[100:103], a[148:151], v[236:239], v[100:103]
    v_cvt_pk_bf16_f32 v241, v230, v231
    ds_read_b64_tr_b16 a[174:175], v246 offset:4864
    v_cvt_pk_bf16_f32 v35, v38, v39
    s_waitcnt lgkmcnt(10)
    v_mfma_f32_16x16x32_bf16 v[104:107], a[152:155], v[236:239], v[104:107]
    ds_read_b128 a[112:115], v244 offset:0
    ds_read_b128 a[116:119], v244 offset:256
    s_add_u32 s45, s43, 1024
    s_waitcnt lgkmcnt(10)
    v_mfma_f32_16x16x32_bf16 v[108:111], a[156:159], v[236:239], v[108:111]
    ds_read_b128 a[120:123], v244 offset:512
    ds_read_b128 a[124:127], v244 offset:768
    buffer_store_dwordx4 v[32:35], v253, s[20:23], s45 offen sc1
    v_mfma_f32_16x16x32_bf16 v[224:227], a[128:131], a[80:83], v[212:215]
    v_exp_f32 v232, v232
    v_mul_f32 v40, v40, v196
    v_mfma_f32_16x16x32_bf16 v[224:227], a[132:135], a[84:87], v[224:227]
    v_exp_f32 v233, v233
    v_mul_f32 v41, v41, v196
    v_mfma_f32_16x16x32_bf16 v[224:227], a[136:139], a[88:91], v[224:227]
    v_exp_f32 v234, v234
    v_mul_f32 v42, v42, v196
    v_mfma_f32_16x16x32_bf16 v[224:227], a[140:143], a[92:95], v[224:227]
    v_exp_f32 v235, v235
    v_mul_f32 v43, v43, v196
    s_waitcnt lgkmcnt(10)
    v_mfma_f32_16x16x32_bf16 v[112:115], a[160:163], v[236:239], v[112:115]
    v_cvt_pk_bf16_f32 v242, v232, v233
    v_mul_f32 v44, v44, v196
    v_mul_f32 v45, v45, v196
    s_waitcnt lgkmcnt(8)
    v_mfma_f32_16x16x32_bf16 v[116:119], a[164:167], v[236:239], v[116:119]
    v_cvt_pk_bf16_f32 v243, v234, v235
    v_mul_f32 v46, v46, v196
    v_mul_f32 v47, v47, v196
    s_waitcnt lgkmcnt(6)
    v_mfma_f32_16x16x32_bf16 v[120:123], a[168:171], v[236:239], v[120:123]
    ds_read_b128 a[128:131], v244 offset:4096
    ds_read_b128 a[132:135], v244 offset:4352
    v_cvt_pk_bf16_f32 v40, v40, v41
    s_waitcnt lgkmcnt(6)
    v_mfma_f32_16x16x32_bf16 v[124:127], a[172:175], v[236:239], v[124:127]
    ds_read_b128 a[136:139], v244 offset:4608
    ds_read_b128 a[140:143], v244 offset:4864
    v_cvt_pk_bf16_f32 v41, v42, v43
    v_mfma_f32_16x16x32_bf16 a[188:191], a[204:207], v[236:239], a[188:191]
    v_cvt_pk_bf16_f32 v42, v44, v45
    v_cvt_pk_bf16_f32 v43, v46, v47
    s_add_u32 s45, s43, 14336
    s_waitcnt lgkmcnt(7)
    v_mfma_f32_16x16x32_bf16 v[228:231], a[112:115], a[48:51], v[204:207]
    v_exp_f32 v220, v220
    buffer_store_dwordx4 v[40:43], v253, s[20:23], s45 offen sc1
    s_waitcnt lgkmcnt(6)
    v_mfma_f32_16x16x32_bf16 v[228:231], a[116:119], a[52:55], v[228:231]
    v_exp_f32 v221, v221
    v_mul_f32 v48, v48, v196
    s_waitcnt lgkmcnt(5)
    v_mfma_f32_16x16x32_bf16 v[228:231], a[120:123], a[56:59], v[228:231]
    v_exp_f32 v222, v222
    v_mul_f32 v49, v49, v196
    s_waitcnt lgkmcnt(4)
    v_mfma_f32_16x16x32_bf16 v[228:231], a[124:127], a[60:63], v[228:231]
    v_exp_f32 v223, v223
    v_mul_f32 v50, v50, v196
    v_mfma_f32_16x16x32_bf16 v[128:131], a[144:147], v[240:243], v[128:131]
    v_cvt_pk_bf16_f32 v236, v220, v221
    v_mul_f32 v51, v51, v196
    v_mul_f32 v52, v52, v196
    v_mfma_f32_16x16x32_bf16 v[132:135], a[148:151], v[240:243], v[132:135]
    v_cvt_pk_bf16_f32 v237, v222, v223
    v_mul_f32 v53, v53, v196
    v_mul_f32 v54, v54, v196
    v_mfma_f32_16x16x32_bf16 v[136:139], a[152:155], v[240:243], v[136:139]
    v_mul_f32 v55, v55, v196
    v_cvt_pk_bf16_f32 v48, v48, v49
    v_cvt_pk_bf16_f32 v49, v50, v51
    v_mfma_f32_16x16x32_bf16 v[140:143], a[156:159], v[240:243], v[140:143]
    v_cvt_pk_bf16_f32 v50, v52, v53
    v_cvt_pk_bf16_f32 v51, v54, v55
    s_add_u32 s45, s43, 27648
    s_waitcnt lgkmcnt(3)
    v_mfma_f32_16x16x32_bf16 v[232:235], a[128:131], a[48:51], v[204:207]
    v_exp_f32 v224, v224
    buffer_store_dwordx4 v[48:51], v253, s[20:23], s45 offen sc1
    s_waitcnt lgkmcnt(2)
    v_mfma_f32_16x16x32_bf16 v[232:235], a[132:135], a[52:55], v[232:235]
    v_exp_f32 v225, v225
    v_mul_f32 v56, v56, v196
    s_waitcnt lgkmcnt(1)
    v_mfma_f32_16x16x32_bf16 v[232:235], a[136:139], a[56:59], v[232:235]
    v_exp_f32 v226, v226
    v_mul_f32 v57, v57, v196
    s_waitcnt lgkmcnt(0)
    v_mfma_f32_16x16x32_bf16 v[232:235], a[140:143], a[60:63], v[232:235]
    v_exp_f32 v227, v227
    v_mul_f32 v58, v58, v196
    v_mfma_f32_16x16x32_bf16 v[144:147], a[160:163], v[240:243], v[144:147]
    v_cvt_pk_bf16_f32 v238, v224, v225
    v_add_u32 v245, 32768, v245
    v_mul_f32 v59, v59, v196
    v_mfma_f32_16x16x32_bf16 v[148:151], a[164:167], v[240:243], v[148:151]
    v_cvt_pk_bf16_f32 v239, v226, v227
    v_add_u32 v246, 32768, v246
    v_mul_f32 v60, v60, v196
    v_mfma_f32_16x16x32_bf16 v[152:155], a[168:171], v[240:243], v[152:155]
    v_mul_f32 v61, v61, v196
    v_mul_f32 v62, v62, v196
    v_mul_f32 v63, v63, v196
    v_mfma_f32_16x16x32_bf16 v[156:159], a[172:175], v[240:243], v[156:159]
    v_cvt_pk_bf16_f32 v56, v56, v57
    v_cvt_pk_bf16_f32 v57, v58, v59
    v_cvt_pk_bf16_f32 v58, v60, v61
    v_mfma_f32_16x16x32_bf16 a[192:195], a[204:207], v[240:243], a[192:195]
    v_cvt_pk_bf16_f32 v59, v62, v63
    s_add_u32 s45, s43, 40960
    buffer_store_dwordx4 v[56:59], v253, s[20:23], s45 offen sc1
    v_mfma_f32_16x16x32_bf16 v[220:223], a[112:115], a[64:67], v[208:211]
    v_exp_f32 v228, v228
    v_accvgpr_read_b32 v202, a184
    v_mfma_f32_16x16x32_bf16 v[220:223], a[116:119], a[68:71], v[220:223]
    v_exp_f32 v229, v229
    v_rcp_f32 v200, v202
    v_mfma_f32_16x16x32_bf16 v[220:223], a[120:123], a[72:75], v[220:223]
    v_exp_f32 v230, v230
    v_add_f32 v254, v254, v202
    v_mfma_f32_16x16x32_bf16 v[220:223], a[124:127], a[76:79], v[220:223]
    v_exp_f32 v231, v231
    v_mul_f32 v64, v64, v200
    v_mfma_f32_16x16x32_bf16 v[160:163], a[144:147], v[236:239], v[160:163]
    v_cvt_pk_bf16_f32 v240, v228, v229
    ds_read_b64_tr_b16 a[144:145], v245 offset:0
    v_mul_f32 v65, v65, v200
    v_mfma_f32_16x16x32_bf16 v[164:167], a[148:151], v[236:239], v[164:167]
    v_cvt_pk_bf16_f32 v241, v230, v231
    ds_read_b64_tr_b16 a[146:147], v245 offset:4096
    v_mul_f32 v66, v66, v200
    v_mfma_f32_16x16x32_bf16 v[168:171], a[152:155], v[236:239], v[168:171]
    ds_read_b64_tr_b16 a[148:149], v246 offset:0
    ds_read_b64_tr_b16 a[150:151], v246 offset:4096
    v_mul_f32 v67, v67, v200
    v_mfma_f32_16x16x32_bf16 v[172:175], a[156:159], v[236:239], v[172:175]
    ds_read_b64_tr_b16 a[152:153], v245 offset:256
    ds_read_b64_tr_b16 a[154:155], v245 offset:4352
    v_mul_f32 v68, v68, v200
    v_mfma_f32_16x16x32_bf16 v[224:227], a[128:131], a[64:67], v[208:211]
    v_exp_f32 v232, v232
    v_mul_f32 v69, v69, v200
    v_mfma_f32_16x16x32_bf16 v[224:227], a[132:135], a[68:71], v[224:227]
    v_exp_f32 v233, v233
    v_mul_f32 v70, v70, v200
    v_mfma_f32_16x16x32_bf16 v[224:227], a[136:139], a[72:75], v[224:227]
    v_exp_f32 v234, v234
    v_mul_f32 v71, v71, v200
    v_mfma_f32_16x16x32_bf16 v[224:227], a[140:143], a[76:79], v[224:227]
    v_exp_f32 v235, v235
    v_cvt_pk_bf16_f32 v64, v64, v65
    v_mfma_f32_16x16x32_bf16 v[176:179], a[160:163], v[236:239], v[176:179]
    v_cvt_pk_bf16_f32 v242, v232, v233
    ds_read_b64_tr_b16 a[156:157], v246 offset:256
    v_cvt_pk_bf16_f32 v65, v66, v67
    v_mfma_f32_16x16x32_bf16 v[180:183], a[164:167], v[236:239], v[180:183]
    v_cvt_pk_bf16_f32 v243, v234, v235
    ds_read_b64_tr_b16 a[158:159], v246 offset:4352
    v_cvt_pk_bf16_f32 v66, v68, v69
    v_mfma_f32_16x16x32_bf16 v[184:187], a[168:171], v[236:239], v[184:187]
    ds_read_b64_tr_b16 a[160:161], v245 offset:512
    ds_read_b64_tr_b16 a[162:163], v245 offset:4608
    v_cvt_pk_bf16_f32 v67, v70, v71
    v_mfma_f32_16x16x32_bf16 v[188:191], a[172:175], v[236:239], v[188:191]
    ds_read_b64_tr_b16 a[164:165], v246 offset:512
    ds_read_b64_tr_b16 a[166:167], v246 offset:4608
    s_add_u32 s45, s43, 2048
    v_mfma_f32_16x16x32_bf16 a[196:199], a[204:207], v[236:239], a[196:199]
    ds_read_b64_tr_b16 a[168:169], v245 offset:768
    ds_read_b64_tr_b16 a[170:171], v245 offset:4864
    buffer_store_dwordx4 v[64:67], v253, s[20:23], s45 offen sc1
    v_mfma_f32_16x16x32_bf16 v[228:231], a[112:115], a[80:83], v[212:215]
    v_exp_f32 v220, v220
    v_mul_f32 v72, v72, v200
    v_mfma_f32_16x16x32_bf16 v[228:231], a[116:119], a[84:87], v[228:231]
    v_exp_f32 v221, v221
    v_mul_f32 v73, v73, v200
    v_mfma_f32_16x16x32_bf16 v[228:231], a[120:123], a[88:91], v[228:231]
    v_exp_f32 v222, v222
    v_mul_f32 v74, v74, v200
    v_mfma_f32_16x16x32_bf16 v[228:231], a[124:127], a[92:95], v[228:231]
    v_exp_f32 v223, v223
    v_mul_f32 v75, v75, v200
    s_waitcnt lgkmcnt(12)
    v_mfma_f32_16x16x32_bf16 v[96:99], a[144:147], v[240:243], v[96:99]
    v_cvt_pk_bf16_f32 v236, v220, v221
    ds_read_b64_tr_b16 a[172:173], v246 offset:768
    v_mul_f32 v76, v76, v200
    s_waitcnt lgkmcnt(11)
    v_mfma_f32_16x16x32_bf16 v[100:103], a[148:151], v[240:243], v[100:103]
    v_cvt_pk_bf16_f32 v237, v222, v223
    ds_read_b64_tr_b16 a[174:175], v246 offset:4864
    v_mul_f32 v77, v77, v200
    s_waitcnt lgkmcnt(10)
    v_mfma_f32_16x16x32_bf16 v[104:107], a[152:155], v[240:243], v[104:107]
    v_mul_f32 v78, v78, v200
    v_mul_f32 v79, v79, v200
    v_cvt_pk_bf16_f32 v72, v72, v73
    s_waitcnt lgkmcnt(8)
    v_mfma_f32_16x16x32_bf16 v[108:111], a[156:159], v[240:243], v[108:111]
    v_cvt_pk_bf16_f32 v73, v74, v75
    v_cvt_pk_bf16_f32 v74, v76, v77
    v_cvt_pk_bf16_f32 v75, v78, v79
    v_mfma_f32_16x16x32_bf16 v[232:235], a[128:131], a[80:83], v[212:215]
    v_exp_f32 v224, v224
    s_add_u32 s45, s43, 15360
    v_mfma_f32_16x16x32_bf16 v[232:235], a[132:135], a[84:87], v[232:235]
    v_exp_f32 v225, v225
    buffer_store_dwordx4 v[72:75], v253, s[20:23], s45 offen sc1
    v_mfma_f32_16x16x32_bf16 v[232:235], a[136:139], a[88:91], v[232:235]
    v_exp_f32 v226, v226
    v_mul_f32 v80, v80, v200
    v_mfma_f32_16x16x32_bf16 v[232:235], a[140:143], a[92:95], v[232:235]
    v_exp_f32 v227, v227
    v_mul_f32 v81, v81, v200
    s_waitcnt lgkmcnt(6)
    v_mfma_f32_16x16x32_bf16 v[112:115], a[160:163], v[240:243], v[112:115]
    v_cvt_pk_bf16_f32 v238, v224, v225
    v_mul_f32 v82, v82, v200
    v_mul_f32 v83, v83, v200
    s_waitcnt lgkmcnt(4)
    v_mfma_f32_16x16x32_bf16 v[116:119], a[164:167], v[240:243], v[116:119]
    v_cvt_pk_bf16_f32 v239, v226, v227
    v_mul_f32 v84, v84, v200
    v_mul_f32 v85, v85, v200
    s_waitcnt lgkmcnt(2)
    v_mfma_f32_16x16x32_bf16 v[120:123], a[168:171], v[240:243], v[120:123]
    v_mul_f32 v86, v86, v200
    v_mul_f32 v87, v87, v200
    v_cvt_pk_bf16_f32 v80, v80, v81
    s_waitcnt lgkmcnt(0)
    v_mfma_f32_16x16x32_bf16 v[124:127], a[172:175], v[240:243], v[124:127]
    v_cvt_pk_bf16_f32 v81, v82, v83
    v_cvt_pk_bf16_f32 v82, v84, v85
    v_cvt_pk_bf16_f32 v83, v86, v87
    v_mfma_f32_16x16x32_bf16 a[188:191], a[204:207], v[240:243], a[188:191]
    s_add_u32 s45, s43, 28672
    buffer_store_dwordx4 v[80:83], v253, s[20:23], s45 offen sc1
    v_mul_f32 v88, v88, v200
    v_exp_f32 v228, v228
    v_exp_f32 v229, v229
    v_exp_f32 v230, v230
    v_exp_f32 v231, v231
    v_mfma_f32_16x16x32_bf16 v[128:131], a[144:147], v[236:239], v[128:131]
    v_cvt_pk_bf16_f32 v240, v228, v229
    v_mul_f32 v89, v89, v200
    v_mul_f32 v90, v90, v200
    v_mfma_f32_16x16x32_bf16 v[132:135], a[148:151], v[236:239], v[132:135]
    v_cvt_pk_bf16_f32 v241, v230, v231
    v_mul_f32 v91, v91, v200
    v_mul_f32 v92, v92, v200
    v_mfma_f32_16x16x32_bf16 v[136:139], a[152:155], v[236:239], v[136:139]
    v_mul_f32 v93, v93, v200
    v_mul_f32 v94, v94, v200
    v_mul_f32 v95, v95, v200
    v_mfma_f32_16x16x32_bf16 v[140:143], a[156:159], v[236:239], v[140:143]
    v_cvt_pk_bf16_f32 v88, v88, v89
    v_cvt_pk_bf16_f32 v89, v90, v91
    v_cvt_pk_bf16_f32 v90, v92, v93
    v_exp_f32 v232, v232
    v_exp_f32 v233, v233
    v_exp_f32 v234, v234
    v_exp_f32 v235, v235
    v_mfma_f32_16x16x32_bf16 v[144:147], a[160:163], v[236:239], v[144:147]
    v_cvt_pk_bf16_f32 v242, v232, v233
    v_cvt_pk_bf16_f32 v91, v94, v95
    s_add_u32 s45, s43, 41984
    v_mfma_f32_16x16x32_bf16 v[148:151], a[164:167], v[236:239], v[148:151]
    v_cvt_pk_bf16_f32 v243, v234, v235
    buffer_store_dwordx4 v[88:91], v253, s[20:23], s45 offen sc1
    v_mfma_f32_16x16x32_bf16 v[152:155], a[168:171], v[236:239], v[152:155]
    v_accvgpr_read_b32 v218, a200
    v_rcp_f32 v216, v218
    v_add_f32 v254, v254, v218
    v_mfma_f32_16x16x32_bf16 v[156:159], a[172:175], v[236:239], v[156:159]
    v_accvgpr_read_b32 v0, a208
    v_accvgpr_read_b32 v1, a209
    v_accvgpr_read_b32 v2, a210
    v_mfma_f32_16x16x32_bf16 a[192:195], a[204:207], v[236:239], a[192:195]
    v_accvgpr_read_b32 v3, a211
    v_accvgpr_read_b32 v4, a212
    v_accvgpr_read_b32 v5, a213
    v_mfma_f32_16x16x32_bf16 v[160:163], a[144:147], v[240:243], v[160:163]
    v_accvgpr_read_b32 v6, a214
    v_accvgpr_read_b32 v7, a215
    v_mfma_f32_16x16x32_bf16 v[164:167], a[148:151], v[240:243], v[164:167]
    v_mul_f32 v0, v0, v216
    v_mul_f32 v1, v1, v216
    v_mfma_f32_16x16x32_bf16 v[168:171], a[152:155], v[240:243], v[168:171]
    v_mul_f32 v2, v2, v216
    v_mul_f32 v3, v3, v216
    v_mul_f32 v4, v4, v216
    v_mfma_f32_16x16x32_bf16 v[172:175], a[156:159], v[240:243], v[172:175]
    v_mul_f32 v5, v5, v216
    v_mul_f32 v6, v6, v216
    v_mul_f32 v7, v7, v216
    v_mfma_f32_16x16x32_bf16 v[176:179], a[160:163], v[240:243], v[176:179]
    v_cvt_pk_bf16_f32 v0, v0, v1
    v_cvt_pk_bf16_f32 v1, v2, v3
    v_mfma_f32_16x16x32_bf16 v[180:183], a[164:167], v[240:243], v[180:183]
    v_cvt_pk_bf16_f32 v2, v4, v5
    v_cvt_pk_bf16_f32 v3, v6, v7
    v_mfma_f32_16x16x32_bf16 v[184:187], a[168:171], v[240:243], v[184:187]
    s_add_u32 s45, s43, 12288
    buffer_store_dwordx4 v[0:3], v253, s[20:23], s45 offen sc1
    v_accvgpr_read_b32 v8, a216
    v_mfma_f32_16x16x32_bf16 v[188:191], a[172:175], v[240:243], v[188:191]
    v_accvgpr_read_b32 v9, a217
    v_accvgpr_read_b32 v10, a218
    v_accvgpr_read_b32 v11, a219
    v_mfma_f32_16x16x32_bf16 a[196:199], a[204:207], v[240:243], a[196:199]
    v_accvgpr_read_b32 v12, a220
    v_accvgpr_read_b32 v13, a221
    v_accvgpr_read_b32 v14, a222
    v_accvgpr_read_b32 v15, a223
    v_mul_f32 v8, v8, v216
    v_mul_f32 v9, v9, v216
    v_mul_f32 v10, v10, v216
    v_mul_f32 v11, v11, v216
    v_mul_f32 v12, v12, v216
    v_mul_f32 v13, v13, v216
    v_mul_f32 v14, v14, v216
    v_mul_f32 v15, v15, v216
    v_cvt_pk_bf16_f32 v8, v8, v9
    v_cvt_pk_bf16_f32 v9, v10, v11
    v_cvt_pk_bf16_f32 v10, v12, v13
    v_cvt_pk_bf16_f32 v11, v14, v15
    s_add_u32 s45, s43, 25600
    buffer_store_dwordx4 v[8:11], v253, s[20:23], s45 offen sc1
    v_accvgpr_read_b32 v16, a224
    v_accvgpr_read_b32 v17, a225
    v_accvgpr_read_b32 v18, a226
    v_accvgpr_read_b32 v19, a227
    v_accvgpr_read_b32 v20, a228
    v_accvgpr_read_b32 v21, a229
    v_accvgpr_read_b32 v22, a230
    v_accvgpr_read_b32 v23, a231
    v_mul_f32 v16, v16, v216
    v_mul_f32 v17, v17, v216
    v_mul_f32 v18, v18, v216
    v_mul_f32 v19, v19, v216
    v_mul_f32 v20, v20, v216
    v_mul_f32 v21, v21, v216
    v_mul_f32 v22, v22, v216
    v_mul_f32 v23, v23, v216
    v_cvt_pk_bf16_f32 v16, v16, v17
    v_cvt_pk_bf16_f32 v17, v18, v19
    v_cvt_pk_bf16_f32 v18, v20, v21
    v_cvt_pk_bf16_f32 v19, v22, v23
    s_add_u32 s45, s43, 38912
    buffer_store_dwordx4 v[16:19], v253, s[20:23], s45 offen sc1
    v_accvgpr_read_b32 v24, a232
    v_accvgpr_read_b32 v25, a233
    v_accvgpr_read_b32 v26, a234
    v_accvgpr_read_b32 v27, a235
    v_accvgpr_read_b32 v28, a236
    v_accvgpr_read_b32 v29, a237
    v_accvgpr_read_b32 v30, a238
    v_accvgpr_read_b32 v31, a239
    v_mul_f32 v24, v24, v216
    v_mul_f32 v25, v25, v216
    v_mul_f32 v26, v26, v216
    v_mul_f32 v27, v27, v216
    v_mul_f32 v28, v28, v216
    v_mul_f32 v29, v29, v216
    v_mul_f32 v30, v30, v216
    v_mul_f32 v31, v31, v216
    v_cvt_pk_bf16_f32 v24, v24, v25
    v_cvt_pk_bf16_f32 v25, v26, v27
    v_cvt_pk_bf16_f32 v26, v28, v29
    v_cvt_pk_bf16_f32 v27, v30, v31
    s_add_u32 s45, s43, 52224
    buffer_store_dwordx4 v[24:27], v253, s[20:23], s45 offen sc1
    v_accvgpr_read_b32 v206, a188
    v_rcp_f32 v204, v206
    v_add_f32 v254, v254, v206
    v_mul_f32 v96, v96, v204
    v_mul_f32 v97, v97, v204
    v_mul_f32 v98, v98, v204
    v_mul_f32 v99, v99, v204
    v_mul_f32 v100, v100, v204
    v_mul_f32 v101, v101, v204
    v_mul_f32 v102, v102, v204
    v_mul_f32 v103, v103, v204
    v_cvt_pk_bf16_f32 v96, v96, v97
    v_cvt_pk_bf16_f32 v97, v98, v99
    v_cvt_pk_bf16_f32 v98, v100, v101
    v_cvt_pk_bf16_f32 v99, v102, v103
    s_add_u32 s45, s43, 3072
    buffer_store_dwordx4 v[96:99], v253, s[20:23], s45 offen sc1
    v_mul_f32 v104, v104, v204
    v_mul_f32 v105, v105, v204
    v_mul_f32 v106, v106, v204
    v_mul_f32 v107, v107, v204
    v_mul_f32 v108, v108, v204
    v_mul_f32 v109, v109, v204
    v_mul_f32 v110, v110, v204
    v_mul_f32 v111, v111, v204
    v_cvt_pk_bf16_f32 v104, v104, v105
    v_cvt_pk_bf16_f32 v105, v106, v107
    v_cvt_pk_bf16_f32 v106, v108, v109
    v_cvt_pk_bf16_f32 v107, v110, v111
    s_add_u32 s45, s43, 16384
    buffer_store_dwordx4 v[104:107], v253, s[20:23], s45 offen sc1
    v_mul_f32 v112, v112, v204
    v_mul_f32 v113, v113, v204
    v_mul_f32 v114, v114, v204
    v_mul_f32 v115, v115, v204
    v_mul_f32 v116, v116, v204
    v_mul_f32 v117, v117, v204
    v_mul_f32 v118, v118, v204
    v_mul_f32 v119, v119, v204
    v_cvt_pk_bf16_f32 v112, v112, v113
    v_cvt_pk_bf16_f32 v113, v114, v115
    v_cvt_pk_bf16_f32 v114, v116, v117
    v_cvt_pk_bf16_f32 v115, v118, v119
    s_add_u32 s45, s43, 29696
    buffer_store_dwordx4 v[112:115], v253, s[20:23], s45 offen sc1
    v_mul_f32 v120, v120, v204
    v_mul_f32 v121, v121, v204
    v_mul_f32 v122, v122, v204
    v_mul_f32 v123, v123, v204
    v_mul_f32 v124, v124, v204
    v_mul_f32 v125, v125, v204
    v_mul_f32 v126, v126, v204
    v_mul_f32 v127, v127, v204
    v_cvt_pk_bf16_f32 v120, v120, v121
    v_cvt_pk_bf16_f32 v121, v122, v123
    v_cvt_pk_bf16_f32 v122, v124, v125
    v_cvt_pk_bf16_f32 v123, v126, v127
    s_add_u32 s45, s43, 43008
    buffer_store_dwordx4 v[120:123], v253, s[20:23], s45 offen sc1
    v_accvgpr_read_b32 v210, a192
    v_rcp_f32 v208, v210
    v_add_f32 v254, v254, v210
    v_mul_f32 v128, v128, v208
    v_mul_f32 v129, v129, v208
    v_mul_f32 v130, v130, v208
    v_mul_f32 v131, v131, v208
    v_mul_f32 v132, v132, v208
    v_mul_f32 v133, v133, v208
    v_mul_f32 v134, v134, v208
    v_mul_f32 v135, v135, v208
    v_cvt_pk_bf16_f32 v128, v128, v129
    v_cvt_pk_bf16_f32 v129, v130, v131
    v_cvt_pk_bf16_f32 v130, v132, v133
    v_cvt_pk_bf16_f32 v131, v134, v135
    s_add_u32 s45, s43, 4096
    buffer_store_dwordx4 v[128:131], v253, s[20:23], s45 offen sc1
    v_mul_f32 v136, v136, v208
    v_mul_f32 v137, v137, v208
    v_mul_f32 v138, v138, v208
    v_mul_f32 v139, v139, v208
    v_mul_f32 v140, v140, v208
    v_mul_f32 v141, v141, v208
    v_mul_f32 v142, v142, v208
    v_mul_f32 v143, v143, v208
    v_cvt_pk_bf16_f32 v136, v136, v137
    v_cvt_pk_bf16_f32 v137, v138, v139
    v_cvt_pk_bf16_f32 v138, v140, v141
    v_cvt_pk_bf16_f32 v139, v142, v143
    s_add_u32 s45, s43, 17408
    buffer_store_dwordx4 v[136:139], v253, s[20:23], s45 offen sc1
    v_mul_f32 v144, v144, v208
    v_mul_f32 v145, v145, v208
    v_mul_f32 v146, v146, v208
    v_mul_f32 v147, v147, v208
    v_mul_f32 v148, v148, v208
    v_mul_f32 v149, v149, v208
    v_mul_f32 v150, v150, v208
    v_mul_f32 v151, v151, v208
    v_cvt_pk_bf16_f32 v144, v144, v145
    v_cvt_pk_bf16_f32 v145, v146, v147
    v_cvt_pk_bf16_f32 v146, v148, v149
    v_cvt_pk_bf16_f32 v147, v150, v151
    s_add_u32 s45, s43, 30720
    buffer_store_dwordx4 v[144:147], v253, s[20:23], s45 offen sc1
    v_mul_f32 v152, v152, v208
    v_mul_f32 v153, v153, v208
    v_mul_f32 v154, v154, v208
    v_mul_f32 v155, v155, v208
    v_mul_f32 v156, v156, v208
    v_mul_f32 v157, v157, v208
    v_mul_f32 v158, v158, v208
    v_mul_f32 v159, v159, v208
    v_cvt_pk_bf16_f32 v152, v152, v153
    v_cvt_pk_bf16_f32 v153, v154, v155
    v_cvt_pk_bf16_f32 v154, v156, v157
    v_cvt_pk_bf16_f32 v155, v158, v159
    s_add_u32 s45, s43, 44032
    buffer_store_dwordx4 v[152:155], v253, s[20:23], s45 offen sc1
L1_e0:
    v_accvgpr_read_b32 v214, a196
    v_rcp_f32 v212, v214
    v_add_f32 v254, v254, v214
    v_pk_mul_f32 v[160:161], v[160:161], v[212:213] op_sel_hi:[1,0]
    v_pk_mul_f32 v[162:163], v[162:163], v[212:213] op_sel_hi:[1,0]
    v_pk_mul_f32 v[164:165], v[164:165], v[212:213] op_sel_hi:[1,0]
    v_pk_mul_f32 v[166:167], v[166:167], v[212:213] op_sel_hi:[1,0]
    v_cvt_pk_bf16_f32 v160, v160, v161
    v_cvt_pk_bf16_f32 v161, v162, v163
    v_cvt_pk_bf16_f32 v162, v164, v165
    v_cvt_pk_bf16_f32 v163, v166, v167
    s_add_u32 s45, s43, 5120
    buffer_store_dwordx4 v[160:163], v253, s[20:23], s45 offen sc1
    v_pk_mul_f32 v[168:169], v[168:169], v[212:213] op_sel_hi:[1,0]
    v_pk_mul_f32 v[170:171], v[170:171], v[212:213] op_sel_hi:[1,0]
    v_pk_mul_f32 v[172:173], v[172:173], v[212:213] op_sel_hi:[1,0]
    v_pk_mul_f32 v[174:175], v[174:175], v[212:213] op_sel_hi:[1,0]
    v_cvt_pk_bf16_f32 v168, v168, v169
    v_cvt_pk_bf16_f32 v169, v170, v171
    v_cvt_pk_bf16_f32 v170, v172, v173
    v_cvt_pk_bf16_f32 v171, v174, v175
    s_add_u32 s45, s43, 18432
    buffer_store_dwordx4 v[168:171], v253, s[20:23], s45 offen sc1
    v_pk_mul_f32 v[176:177], v[176:177], v[212:213] op_sel_hi:[1,0]
    v_pk_mul_f32 v[178:179], v[178:179], v[212:213] op_sel_hi:[1,0]
    v_pk_mul_f32 v[180:181], v[180:181], v[212:213] op_sel_hi:[1,0]
    v_pk_mul_f32 v[182:183], v[182:183], v[212:213] op_sel_hi:[1,0]
    v_cvt_pk_bf16_f32 v176, v176, v177
    v_cvt_pk_bf16_f32 v177, v178, v179
    v_cvt_pk_bf16_f32 v178, v180, v181
    v_cvt_pk_bf16_f32 v179, v182, v183
    s_add_u32 s45, s43, 31744
    buffer_store_dwordx4 v[176:179], v253, s[20:23], s45 offen sc1
    v_pk_mul_f32 v[184:185], v[184:185], v[212:213] op_sel_hi:[1,0]
    v_pk_mul_f32 v[186:187], v[186:187], v[212:213] op_sel_hi:[1,0]
    v_pk_mul_f32 v[188:189], v[188:189], v[212:213] op_sel_hi:[1,0]
    v_pk_mul_f32 v[190:191], v[190:191], v[212:213] op_sel_hi:[1,0]
    v_cvt_pk_bf16_f32 v184, v184, v185
    v_cvt_pk_bf16_f32 v185, v186, v187
    v_cvt_pk_bf16_f32 v186, v188, v189
    v_cvt_pk_bf16_f32 v187, v190, v191
    s_add_u32 s45, s43, 45056
    buffer_store_dwordx4 v[184:187], v253, s[20:23], s45 offen sc1
    v_lshlrev_b32 v252, 2, v247
    v_add_u32 v252, 139264, v252
    s_lshl_b32 s42, s24, 8
    v_add_u32 v240, s42, v252
    ds_write_b32 v240, v254
    s_mul_i32 s67, s83, 6144
    v_lshlrev_b32 v232, 4, v247
    v_add_u32 v220, s67, v232
    v_add_u32 v221, 4096, v220
    v_add_u32 v222, 12288, v232
    v_lshrrev_b32 v232, 2, v247
    v_and_b32 v232, 3, v232
    v_lshlrev_b32 v232, 11, v232
    v_lshrrev_b32 v233, 4, v247
    v_lshl_add_u32 v232, v233, 6, v232
    v_and_b32 v234, 3, v247
    v_lshl_add_u32 v224, v234, 4, v232
    v_add_u32 v225, 15360, v224
    v_add_u32 v226, 30720, v224
    v_add_u32 v227, 46080, v224
    v_and_b32 v232, 1, v233
    v_mul_u32_u24 v232, 4104, v232
    v_lshrrev_b32 v233, 1, v233
    v_lshl_add_u32 v232, v233, 10, v232
    v_and_b32 v234, 15, v247
    v_lshl_add_u32 v232, v234, 4, v232
    s_lshl_b32 s67, s83, 9
    s_add_u32 s68, s97, s67
    v_add_u32 v228, s68, v232
    s_sub_u32 s67, 512, s67
    s_add_u32 s68, s97, s67
    v_add_u32 v229, s68, v232
    v_mov_b32 v231, 0
    s_bitcmp1_b32 s24, 0
    s_cselect_b32 s53, 12, 4
    s_and_b32 s52, s27, 12
    s_add_u32 s52, s52, s24
    s_add_u32 s52, s52, s53
    s_and_b32 s52, s52, 15
    s_mul_i32 s92, s52, 106496
    s_lshl_b32 s93, s52, 19
    s_add_u32 s94, s93, 8192
    s_lshl_b32 s46, 1, s27
    v_mov_b32 v241, s46
    s_mov_b64 exec, 1
    buffer_load_dword v230, v231, s[72:75], s95 offen sc1
    s_mov_b64 exec, -1
    s_waitcnt vmcnt(0) lgkmcnt(0)
    s_barrier
    ds_read_b32 v216, v252 offset:0
    ds_read_b32 v217, v252 offset:256
    ds_read_b32 v218, v252 offset:512
    ds_read_b32 v219, v252 offset:768
    s_mov_b32 s45, 0x4f800000
    s_waitcnt lgkmcnt(2)
    v_add_f32 v216, v216, v217
    s_waitcnt lgkmcnt(0)
    v_add_f32 v218, v218, v219
    v_add_f32 v216, v216, v218
    v_cmp_ngt_f32 vcc, s45, v216
    s_cmp_lg_u32 s48, 0
    s_cbranch_scc1 L1_ok0
    s_cbranch_vccnz L1_fb0
L1_ok0:
    s_cmp_lg_u32 s24, 0
    s_cbranch_scc1 L2_main
    s_and_b32 s46, s27, 3
    s_lshl_b32 s38, s26, 2
    s_add_u32 s38, s38, s46
    s_mul_i32 s38, s38, 4352
    s_mov_b64 exec, 1
    buffer_atomic_add v241, v231, s[72:75], s38 offen sc1
    buffer_atomic_add v241, v231, s[76:79], s80 offen sc1
    s_mov_b64 exec, -1
    s_branch L2_main
L1_fb0:
    s_waitcnt vmcnt(0) lgkmcnt(0)
    s_barrier
    v_subrev_u32 v244, 32768, v244
    v_subrev_u32 v245, 32768, v245
    v_subrev_u32 v246, 32768, v246
    v_mov_b32 v30, 0xff800000
    v_mov_b32 v24, 0xff800000
    v_mov_b32 v25, 0xff800000
    v_mov_b32 v26, 0xff800000
    v_mov_b32 v27, 0xff800000
    v_mov_b32 v28, 0xff800000
    v_mov_b32 v29, 0xff800000
    s_mov_b32 s64, 0
    s_mov_b32 s32, s65
    s_or_b32 s33, s65, 4096
    s_mov_b32 s28, 32
    s_mov_b32 s48, 1
L1_fl0:
    s_add_u32 m0, s37, 65536
    s_nop 0
    buffer_load_dwordx4 v248, s[16:19], s32 offen offset:0 nt lds
    buffer_load_dwordx4 v249, s[16:19], s32 offen offset:1024 nt lds
    buffer_load_dwordx4 v248, s[16:19], s32 offen offset:2048 nt lds
    buffer_load_dwordx4 v249, s[16:19], s32 offen offset:3072 nt lds
    s_add_u32 m0, m0, 4096
    s_nop 0
    buffer_load_dwordx4 v248, s[16:19], s33 offen offset:0 nt lds
    buffer_load_dwordx4 v249, s[16:19], s33 offen offset:1024 nt lds
    buffer_load_dwordx4 v248, s[16:19], s33 offen offset:2048 nt lds
    buffer_load_dwordx4 v249, s[16:19], s33 offen offset:3072 nt lds
    s_add_u32 s64, s64, 8192
    s_xor_b32 s32, s64, s65
    s_or_b32 s33, s32, 4096
    s_waitcnt vmcnt(0)
    s_barrier
    ds_read_b128 a[112:115], v244 offset:0
    ds_read_b128 a[116:119], v244 offset:256
    ds_read_b128 a[120:123], v244 offset:512
    ds_read_b128 a[124:127], v244 offset:768
    ds_read_b128 a[128:131], v244 offset:4096
    ds_read_b128 a[132:135], v244 offset:4352
    ds_read_b128 a[136:139], v244 offset:4608
    ds_read_b128 a[140:143], v244 offset:4864
    s_waitcnt lgkmcnt(7)
    v_mfma_f32_16x16x32_bf16 v[8:11], a[112:115], a[0:3], 0
    s_waitcnt lgkmcnt(6)
    v_mfma_f32_16x16x32_bf16 v[8:11], a[116:119], a[4:7], v[8:11]
    s_waitcnt lgkmcnt(5)
    v_mfma_f32_16x16x32_bf16 v[8:11], a[120:123], a[8:11], v[8:11]
    s_waitcnt lgkmcnt(4)
    v_mfma_f32_16x16x32_bf16 v[8:11], a[124:127], a[12:15], v[8:11]
    s_waitcnt lgkmcnt(3)
    v_mfma_f32_16x16x32_bf16 v[12:15], a[128:131], a[0:3], 0
    s_waitcnt lgkmcnt(2)
    v_mfma_f32_16x16x32_bf16 v[12:15], a[132:135], a[4:7], v[12:15]
    s_waitcnt lgkmcnt(1)
    v_mfma_f32_16x16x32_bf16 v[12:15], a[136:139], a[8:11], v[12:15]
    s_waitcnt lgkmcnt(0)
    v_mfma_f32_16x16x32_bf16 v[12:15], a[140:143], a[12:15], v[12:15]
    v_mfma_f32_16x16x32_bf16 v[40:43], a[112:115], a[16:19], 0
    v_mfma_f32_16x16x32_bf16 v[40:43], a[116:119], a[20:23], v[40:43]
    v_mfma_f32_16x16x32_bf16 v[40:43], a[120:123], a[24:27], v[40:43]
    v_mfma_f32_16x16x32_bf16 v[40:43], a[124:127], a[28:31], v[40:43]
    v_mfma_f32_16x16x32_bf16 v[44:47], a[128:131], a[16:19], 0
    v_mfma_f32_16x16x32_bf16 v[44:47], a[132:135], a[20:23], v[44:47]
    v_mfma_f32_16x16x32_bf16 v[44:47], a[136:139], a[24:27], v[44:47]
    v_mfma_f32_16x16x32_bf16 v[44:47], a[140:143], a[28:31], v[44:47]
    v_mfma_f32_16x16x32_bf16 v[72:75], a[112:115], a[32:35], 0
    v_mfma_f32_16x16x32_bf16 v[72:75], a[116:119], a[36:39], v[72:75]
    v_mfma_f32_16x16x32_bf16 v[72:75], a[120:123], a[40:43], v[72:75]
    v_mfma_f32_16x16x32_bf16 v[72:75], a[124:127], a[44:47], v[72:75]
    v_mfma_f32_16x16x32_bf16 v[76:79], a[128:131], a[32:35], 0
    v_mfma_f32_16x16x32_bf16 v[76:79], a[132:135], a[36:39], v[76:79]
    v_mfma_f32_16x16x32_bf16 v[76:79], a[136:139], a[40:43], v[76:79]
    v_mfma_f32_16x16x32_bf16 v[76:79], a[140:143], a[44:47], v[76:79]
    v_mfma_f32_16x16x32_bf16 v[104:107], a[112:115], a[48:51], 0
    v_mfma_f32_16x16x32_bf16 v[104:107], a[116:119], a[52:55], v[104:107]
    v_mfma_f32_16x16x32_bf16 v[104:107], a[120:123], a[56:59], v[104:107]
    v_mfma_f32_16x16x32_bf16 v[104:107], a[124:127], a[60:63], v[104:107]
    v_mfma_f32_16x16x32_bf16 v[108:111], a[128:131], a[48:51], 0
    v_mfma_f32_16x16x32_bf16 v[108:111], a[132:135], a[52:55], v[108:111]
    v_mfma_f32_16x16x32_bf16 v[108:111], a[136:139], a[56:59], v[108:111]
    v_mfma_f32_16x16x32_bf16 v[108:111], a[140:143], a[60:63], v[108:111]
    v_mfma_f32_16x16x32_bf16 v[136:139], a[112:115], a[64:67], 0
    v_mfma_f32_16x16x32_bf16 v[136:139], a[116:119], a[68:71], v[136:139]
    v_mfma_f32_16x16x32_bf16 v[136:139], a[120:123], a[72:75], v[136:139]
    v_mfma_f32_16x16x32_bf16 v[136:139], a[124:127], a[76:79], v[136:139]
    v_mfma_f32_16x16x32_bf16 v[140:143], a[128:131], a[64:67], 0
    v_mfma_f32_16x16x32_bf16 v[140:143], a[132:135], a[68:71], v[140:143]
    v_mfma_f32_16x16x32_bf16 v[140:143], a[136:139], a[72:75], v[140:143]
    v_mfma_f32_16x16x32_bf16 v[140:143], a[140:143], a[76:79], v[140:143]
    v_mfma_f32_16x16x32_bf16 v[168:171], a[112:115], a[80:83], 0
    v_mfma_f32_16x16x32_bf16 v[168:171], a[116:119], a[84:87], v[168:171]
    v_mfma_f32_16x16x32_bf16 v[168:171], a[120:123], a[88:91], v[168:171]
    v_mfma_f32_16x16x32_bf16 v[168:171], a[124:127], a[92:95], v[168:171]
    v_mfma_f32_16x16x32_bf16 v[172:175], a[128:131], a[80:83], 0
    v_mfma_f32_16x16x32_bf16 v[172:175], a[132:135], a[84:87], v[172:175]
    v_mfma_f32_16x16x32_bf16 v[172:175], a[136:139], a[88:91], v[172:175]
    v_mfma_f32_16x16x32_bf16 v[172:175], a[140:143], a[92:95], v[172:175]
    v_mfma_f32_16x16x32_bf16 v[16:19], a[112:115], a[96:99], 0
    v_mfma_f32_16x16x32_bf16 v[16:19], a[116:119], a[100:103], v[16:19]
    v_mfma_f32_16x16x32_bf16 v[16:19], a[120:123], a[104:107], v[16:19]
    v_mfma_f32_16x16x32_bf16 v[16:19], a[124:127], a[108:111], v[16:19]
    v_mfma_f32_16x16x32_bf16 v[20:23], a[128:131], a[96:99], 0
    v_mfma_f32_16x16x32_bf16 v[20:23], a[132:135], a[100:103], v[20:23]
    v_mfma_f32_16x16x32_bf16 v[20:23], a[136:139], a[104:107], v[20:23]
    v_mfma_f32_16x16x32_bf16 v[20:23], a[140:143], a[108:111], v[20:23]
    v_max3_f32 v8, v8, v9, v10
    v_max3_f32 v11, v11, v12, v13
    v_max3_f32 v8, v8, v14, v15
    v_max3_f32 v24, v24, v8, v11
    v_max3_f32 v40, v40, v41, v42
    v_max3_f32 v43, v43, v44, v45
    v_max3_f32 v40, v40, v46, v47
    v_max3_f32 v25, v25, v40, v43
    v_max3_f32 v72, v72, v73, v74
    v_max3_f32 v75, v75, v76, v77
    v_max3_f32 v72, v72, v78, v79
    v_max3_f32 v26, v26, v72, v75
    v_max3_f32 v104, v104, v105, v106
    v_max3_f32 v107, v107, v108, v109
    v_max3_f32 v104, v104, v110, v111
    v_max3_f32 v27, v27, v104, v107
    v_max3_f32 v136, v136, v137, v138
    v_max3_f32 v139, v139, v140, v141
    v_max3_f32 v136, v136, v142, v143
    v_max3_f32 v28, v28, v136, v139
    v_max3_f32 v168, v168, v169, v170
    v_max3_f32 v171, v171, v172, v173
    v_max3_f32 v168, v168, v174, v175
    v_max3_f32 v29, v29, v168, v171
    v_max3_f32 v16, v16, v17, v18
    v_max3_f32 v19, v19, v20, v21
    v_max3_f32 v16, v16, v22, v23
    v_max3_f32 v30, v30, v16, v19
    s_barrier
    s_sub_u32 s28, s28, 1
    s_cmp_lg_u32 s28, 0
    s_cbranch_scc1 L1_fl0
    s_mov_b32 s64, 0
    s_mov_b32 s32, s65
    s_or_b32 s33, s65, 4096
    s_add_u32 m0, s37, 65536
    s_nop 0
    buffer_load_dwordx4 v248, s[16:19], s32 offen offset:0 nt lds
    buffer_load_dwordx4 v249, s[16:19], s32 offen offset:1024 nt lds
    buffer_load_dwordx4 v248, s[16:19], s32 offen offset:2048 nt lds
    buffer_load_dwordx4 v249, s[16:19], s32 offen offset:3072 nt lds
    s_add_u32 m0, m0, 4096
    s_nop 0
    buffer_load_dwordx4 v248, s[16:19], s33 offen offset:0 nt lds
    buffer_load_dwordx4 v249, s[16:19], s33 offen offset:1024 nt lds
    buffer_load_dwordx4 v248, s[16:19], s33 offen offset:2048 nt lds
    buffer_load_dwordx4 v249, s[16:19], s33 offen offset:3072 nt lds
    s_add_u32 s64, s64, 8192
    s_xor_b32 s32, s64, s65
    s_or_b32 s33, s32, 4096
    s_add_u32 m0, s37, 98304
    s_nop 0
    buffer_load_dwordx4 v248, s[16:19], s32 offen offset:0 nt lds
    buffer_load_dwordx4 v249, s[16:19], s32 offen offset:1024 nt lds
    buffer_load_dwordx4 v248, s[16:19], s32 offen offset:2048 nt lds
    buffer_load_dwordx4 v249, s[16:19], s32 offen offset:3072 nt lds
    s_add_u32 m0, m0, 4096
    s_nop 0
    buffer_load_dwordx4 v248, s[16:19], s33 offen offset:0 nt lds
    buffer_load_dwordx4 v249, s[16:19], s33 offen offset:1024 nt lds
    buffer_load_dwordx4 v248, s[16:19], s33 offen offset:2048 nt lds
    buffer_load_dwordx4 v249, s[16:19], s33 offen offset:3072 nt lds
    s_add_u32 s64, s64, 8192
    s_xor_b32 s32, s64, s65
    s_or_b32 s33, s32, 4096
    s_add_u32 m0, s37, 131072
    s_nop 0
    buffer_load_dwordx4 v248, s[16:19], s32 offen offset:0 nt lds
    buffer_load_dwordx4 v249, s[16:19], s32 offen offset:1024 nt lds
    buffer_load_dwordx4 v248, s[16:19], s32 offen offset:2048 nt lds
    buffer_load_dwordx4 v249, s[16:19], s32 offen offset:3072 nt lds
    s_add_u32 m0, m0, 4096
    s_nop 0
    buffer_load_dwordx4 v248, s[16:19], s33 offen offset:0 nt lds
    buffer_load_dwordx4 v249, s[16:19], s33 offen offset:1024 nt lds
    buffer_load_dwordx4 v248, s[16:19], s33 offen offset:2048 nt lds
    buffer_load_dwordx4 v249, s[16:19], s33 offen offset:3072 nt lds
    s_add_u32 s64, s64, 8192
    s_xor_b32 s32, s64, s65
    s_or_b32 s33, s32, 4096
    v_mov_b32 v16, v30
    v_mov_b32 v8, v24
    v_mov_b32 v40, v25
    v_mov_b32 v72, v26
    v_mov_b32 v104, v27
    v_mov_b32 v136, v28
    v_mov_b32 v168, v29
    s_waitcnt vmcnt(0)
    s_barrier
    ds_read_b128 a[112:115], v244 offset:0
    ds_read_b128 a[116:119], v244 offset:256
    ds_read_b128 a[120:123], v244 offset:512
    ds_read_b128 a[124:127], v244 offset:768
    ds_read_b128 a[128:131], v244 offset:4096
    ds_read_b128 a[132:135], v244 offset:4352
    ds_read_b128 a[136:139], v244 offset:4608
    ds_read_b128 a[140:143], v244 offset:4864
    ds_read_b64_tr_b16 a[144:145], v245 offset:0
    ds_read_b64_tr_b16 a[146:147], v245 offset:4096
    ds_read_b64_tr_b16 a[148:149], v246 offset:0
    ds_read_b64_tr_b16 a[150:151], v246 offset:4096
    ds_read_b64_tr_b16 a[152:153], v245 offset:256
    ds_read_b64_tr_b16 a[154:155], v245 offset:4352
    ds_read_b64_tr_b16 a[156:157], v246 offset:256
    ds_read_b64_tr_b16 a[158:159], v246 offset:4352
    ds_read_b64_tr_b16 a[160:161], v245 offset:512
    ds_read_b64_tr_b16 a[162:163], v245 offset:4608
    ds_read_b64_tr_b16 a[164:165], v246 offset:512
    ds_read_b64_tr_b16 a[166:167], v246 offset:4608
    ds_read_b64_tr_b16 a[168:169], v245 offset:768
    ds_read_b64_tr_b16 a[170:171], v245 offset:4864
    ds_read_b64_tr_b16 a[172:173], v246 offset:768
    ds_read_b64_tr_b16 a[174:175], v246 offset:4864
    s_branch L1_m0
L1_p1:
    s_add_u32 m0, s35, 0
    s_nop 0
    buffer_load_dwordx4 v208, s[12:15], s31 offen offset:0 nt lds
    buffer_load_dwordx4 v209, s[12:15], s31 offen offset:1024 nt lds
    buffer_load_dwordx4 v210, s[12:15], s31 offen offset:2048 nt lds
    buffer_load_dwordx4 v211, s[12:15], s31 offen offset:3072 nt lds
    s_add_u32 s31, s31, 262144
    s_add_u32 m0, s36, 0
    s_nop 0
    buffer_load_dwordx4 v212, s[8:11], s30 offen offset:0  lds
    buffer_load_dwordx4 v213, s[8:11], s30 offen offset:1024  lds
    buffer_load_dwordx4 v214, s[8:11], s30 offen offset:2048  lds
    s_add_u32 s30, s30, 128
    s_add_u32 m0, s50, 32768
    s_nop 0
    buffer_load_dwordx4 v212, s[8:11], s49 offen offset:0  lds
    buffer_load_dwordx4 v213, s[8:11], s49 offen offset:1024  lds
    buffer_load_dwordx4 v214, s[8:11], s49 offen offset:2048  lds
    s_add_u32 s49, s49, 128
    s_add_u32 m0, s35, 32768
    s_nop 0
    buffer_load_dwordx4 v208, s[12:15], s31 offen offset:0 nt lds
    buffer_load_dwordx4 v209, s[12:15], s31 offen offset:1024 nt lds
    buffer_load_dwordx4 v210, s[12:15], s31 offen offset:2048 nt lds
    buffer_load_dwordx4 v211, s[12:15], s31 offen offset:3072 nt lds
    s_add_u32 s31, s31, 262144
    s_lshl_b32 s52, s26, 5
    s_lshl_b32 s54, s27, 1
    s_add_u32 s52, s52, s54
    s_add_u32 s52, s52, s25
    s_lshr_b32 s54, s52, 5
    s_mul_i32 s54, s54, 11
    s_add_u32 s54, s54, s52
    s_and_b32 s54, s54, 31
    s_lshl_b32 s65, s54, 13
    s_lshl_b32 s54, s52, 18
    s_add_u32 s16, s44, s54
    s_addc_u32 s17, s45, 0
    s_mov_b32 s18, 262144
    s_mov_b32 s19, 0x20000
    s_mul_i32 s52, s26, 1703936
    s_add_u32 s20, s4, s52
    s_addc_u32 s21, s5, 0
    s_mov_b32 s22, 1703936
    s_mov_b32 s23, 0x20000
    s_mov_b32 s56, s6
    s_mov_b32 s57, s7
    s_mov_b32 s58, 8388608
    s_mov_b32 s59, 0x20000
    s_lshl_b32 s37, s24, 13
    s_mov_b32 s78, 256
    s_mov_b32 s79, 0x20000
    s_lshl_b32 s80, s26, 4
    v_and_b32 v216, 1, v253
    v_mul_u32_u24 v216, 8200, v216
    v_lshrrev_b32 v217, 1, v253
    v_lshl_add_u32 v216, v217, 12, v216
    v_and_b32 v217, 15, v247
    v_lshl_add_u32 v216, v217, 4, v216
    s_lshl_b32 s54, s25, 11
    v_add_u32 v216, s54, v216
    v_and_b32 v255, 1, v252
    v_lshlrev_b32 v255, 1, v255
    v_xor_b32 v255, v255, v253
    v_lshlrev_b32 v255, 4, v255
    v_and_b32 v218, 7, v247
    v_lshl_add_u32 v218, v218, 6, v255
    v_lshrrev_b32 v217, 3, v217
    v_lshl_add_u32 v217, v217, 10, v218
    v_add_u32 v217, 16640, v217
    v_add_u32 v218, 32768, v217
    v_mov_b32 v219, v216
    v_mov_b32 v220, v217
    v_lshl_add_u32 v244, v252, 10, v255
    v_lshl_add_u32 v244, v254, 6, v244
    s_lshl_b32 s54, s25, 14
    s_add_u32 s54, s54, 65536
    v_add_u32 v244, s54, v244
    v_lshlrev_b32 v245, 10, v253
    v_lshl_add_u32 v245, v252, 6, v245
    v_lshl_add_u32 v245, v254, 3, v245
    s_add_u32 s54, s54, 8192
    v_add_u32 v245, s54, v245
    v_and_b32 v255, 1, v253
    v_lshl_add_u32 v245, v255, 5, v245
    v_xor_b32 v246, 32, v245
    v_lshlrev_b32 v248, 8, v252
    v_lshl_add_u32 v248, v253, 6, v248
    v_lshl_add_u32 v248, v254, 4, v248
    v_xor_b32 v249, 32, v248
    v_lshlrev_b32 v250, 7, v247
    v_lshlrev_b32 v255, 4, v247
    v_add_u32 v255, s37, v255
    v_add_u32 v221, 65536, v255
    v_add_u32 v222, 98304, v255
    v_add_u32 v223, 131072, v255
    v_add_u32 v224, 0, v255
    s_mov_b32 s29, 0
    s_mov_b32 s39, 0
    s_mov_b32 s64, 0
    s_mov_b32 s32, s65
    s_or_b32 s33, s65, 4096
    s_mov_b32 s48, 0
    s_mov_b32 s51, 131072
    s_and_b32 s67, s2, 7
    s_lshr_b32 s68, s2, 3
    s_lshr_b32 s81, s67, 1
    s_lshl_b32 s81, s81, 2
    s_lshr_b32 s69, s68, 3
    s_add_u32 s81, s81, s69
    s_and_b32 s82, s67, 1
    s_lshl_b32 s82, s82, 2
    s_lshr_b32 s69, s68, 1
    s_and_b32 s69, s69, 3
    s_add_u32 s82, s82, s69
    s_and_b32 s83, s68, 1
    s_mul_i32 s69, s81, 1703936
    s_add_u32 s60, s4, s69
    s_addc_u32 s61, s5, 0
    s_mov_b32 s62, 1703936
    s_mov_b32 s63, 0x20000
    s_lshl_b32 s69, s82, 8
    s_add_u32 s84, s6, s69
    s_addc_u32 s85, s7, 0
    s_sub_u32 s86, 8388608, s69
    s_mov_b32 s87, 0x20000
    s_mul_i32 s69, s81, 425984
    s_add_u32 s88, s88, s69
    s_addc_u32 s89, s89, 0
    s_mov_b32 s90, 425984
    s_mov_b32 s91, 0x20000
    s_add_u32 s72, s4, 0x4000000
    s_addc_u32 s73, s5, 0
    s_mov_b32 s74, 0x80000
    s_mov_b32 s75, 0x20000
    s_lshl_b32 s69, s81, 2
    s_add_u32 s69, s69, s24
    s_mul_i32 s95, s69, 4352
    s_lshl_b32 s66, s81, 4
    s_mul_i32 s97, s24, 33792
    s_add_u32 m0, s35, 65536
    s_nop 0
    buffer_load_dwordx4 v208, s[12:15], s31 offen offset:0 nt lds
    buffer_load_dwordx4 v209, s[12:15], s31 offen offset:1024 nt lds
    buffer_load_dwordx4 v210, s[12:15], s31 offen offset:2048 nt lds
    buffer_load_dwordx4 v211, s[12:15], s31 offen offset:3072 nt lds
    s_add_u32 s31, s31, 262144
    s_add_u32 m0, s36, 65536
    s_nop 0
    buffer_load_dwordx4 v212, s[8:11], s30 offen offset:0  lds
    buffer_load_dwordx4 v213, s[8:11], s30 offen offset:1024  lds
    buffer_load_dwordx4 v214, s[8:11], s30 offen offset:2048  lds
    s_add_u32 s30, s30, 128
    s_add_u32 m0, s50, 98304
    s_nop 0
    buffer_load_dwordx4 v212, s[8:11], s49 offen offset:0  lds
    buffer_load_dwordx4 v213, s[8:11], s49 offen offset:1024  lds
    buffer_load_dwordx4 v214, s[8:11], s49 offen offset:2048  lds
    s_add_u32 s49, s49, 128
    s_lshr_b32 s55, s2, 3
    s_lshl_b32 s55, s55, 2
    s_add_u32 s55, s55, s24
    s_getpc_b64 s[46:47]
    s_sub_u32 s46, s46, .-standalone__mha_block_cached__near_ridge_kernel
    s_subb_u32 s47, s47, 0
    v_lshl_add_u32 v226, s55, 10, v248
    v_min_u32 v226, L_code_end-standalone__mha_block_cached__near_ridge_kernel-4, v226
    v_mov_b32 v227, s47
    v_add_co_u32 v226, vcc, s46, v226
    s_nop 1
    v_addc_co_u32 v227, vcc, 0, v227, vcc
    global_load_dword v255, v[226:227], off
    s_waitcnt vmcnt(15)
    s_barrier
    ds_read_b64_tr_b16 a[112:113], v216 offset:0
    ds_read_b64_tr_b16 a[114:115], v216 offset:1024
    ds_read_b128 a[144:147], v217 offset:12288
    ds_read_b128 a[148:151], v218 offset:0
    ds_read_b128 a[152:155], v218 offset:2048
    ds_read_b128 a[156:159], v218 offset:4096
    ds_read_b128 a[160:163], v218 offset:6144
    ds_read_b128 a[164:167], v218 offset:8192
    ds_read_b128 a[168:171], v218 offset:10240
    ds_read_b64_tr_b16 a[116:117], v216 offset:8
    ds_read_b64_tr_b16 a[118:119], v216 offset:1032
    ds_read_b64_tr_b16 a[120:121], v216 offset:256
    ds_read_b64_tr_b16 a[122:123], v216 offset:1280
    ds_read_b64_tr_b16 a[124:125], v216 offset:264
    ds_read_b64_tr_b16 a[126:127], v216 offset:1288
    ds_read_b64_tr_b16 a[128:129], v216 offset:512
    ds_read_b64_tr_b16 a[130:131], v216 offset:1536
    ds_read_b64_tr_b16 a[132:133], v216 offset:520
    ds_read_b64_tr_b16 a[134:135], v216 offset:1544
    ds_read_b64_tr_b16 a[136:137], v216 offset:768
    ds_read_b64_tr_b16 a[138:139], v216 offset:1792
    ds_read_b64_tr_b16 a[140:141], v216 offset:776
    ds_read_b64_tr_b16 a[142:143], v216 offset:1800
    s_add_u32 s39, s39, 32768
    s_cmp_eq_u32 s39, 163840
    s_cselect_b32 s39, 0, s39
    v_add_u32 v216, s39, v219
    s_waitcnt vmcnt(11) lgkmcnt(0)
    s_barrier
    v_mfma_f32_16x16x32_bf16 v[0:3], a[112:115], a[144:147], 0
    s_add_u32 m0, s35, 98304
    ds_read_b64_tr_b16 a[172:173], v216 offset:0
    v_mfma_f32_16x16x32_bf16 v[32:35], a[112:115], a[148:151], 0
    buffer_load_dwordx4 v208, s[12:15], s31 offen offset:0 nt lds
    ds_read_b64_tr_b16 a[174:175], v216 offset:1024
    v_mfma_f32_16x16x32_bf16 v[64:67], a[112:115], a[152:155], 0
    ds_read_b128 a[204:207], v217 offset:12800
    v_mfma_f32_16x16x32_bf16 v[96:99], a[112:115], a[156:159], 0
    ds_read_b128 a[208:211], v218 offset:512
    v_mfma_f32_16x16x32_bf16 v[128:131], a[112:115], a[160:163], 0
    buffer_load_dwordx4 v209, s[12:15], s31 offen offset:1024 nt lds
    ds_read_b128 a[212:215], v218 offset:2560
    v_mfma_f32_16x16x32_bf16 v[160:163], a[112:115], a[164:167], 0
    ds_read_b128 a[216:219], v218 offset:4608
    v_mfma_f32_16x16x32_bf16 v[4:7], a[116:119], a[144:147], 0
    ds_read_b128 a[220:223], v218 offset:6656
    v_mfma_f32_16x16x32_bf16 v[36:39], a[116:119], a[148:151], 0
    buffer_load_dwordx4 v210, s[12:15], s31 offen offset:2048 nt lds
    ds_read_b128 a[224:227], v218 offset:8704
    v_mfma_f32_16x16x32_bf16 v[68:71], a[116:119], a[152:155], 0
    ds_read_b128 a[228:231], v218 offset:10752
    v_mfma_f32_16x16x32_bf16 v[100:103], a[116:119], a[156:159], 0
    ds_read_b64_tr_b16 a[176:177], v216 offset:8
    v_mfma_f32_16x16x32_bf16 v[132:135], a[116:119], a[160:163], 0
    buffer_load_dwordx4 v211, s[12:15], s31 offen offset:3072 nt lds
    s_add_u32 s31, s31, 262144
    v_mfma_f32_16x16x32_bf16 v[164:167], a[116:119], a[164:167], 0
    s_add_u32 m0, s35, 131072
    ds_read_b64_tr_b16 a[178:179], v216 offset:1032
    v_mfma_f32_16x16x32_bf16 v[8:11], a[120:123], a[144:147], 0
    ds_read_b64_tr_b16 a[180:181], v216 offset:256
    v_mfma_f32_16x16x32_bf16 v[40:43], a[120:123], a[148:151], 0
    buffer_load_dwordx4 v208, s[12:15], s31 offen offset:0 nt lds
    ds_read_b64_tr_b16 a[182:183], v216 offset:1280
    v_mfma_f32_16x16x32_bf16 v[72:75], a[120:123], a[152:155], 0
    ds_read_b64_tr_b16 a[184:185], v216 offset:264
    v_mfma_f32_16x16x32_bf16 v[104:107], a[120:123], a[156:159], 0
    ds_read_b64_tr_b16 a[186:187], v216 offset:1288
    v_mfma_f32_16x16x32_bf16 v[136:139], a[120:123], a[160:163], 0
    ds_read_b64_tr_b16 a[188:189], v216 offset:512
    v_mfma_f32_16x16x32_bf16 v[168:171], a[120:123], a[164:167], 0
    buffer_load_dwordx4 v209, s[12:15], s31 offen offset:1024 nt lds
    ds_read_b64_tr_b16 a[190:191], v216 offset:1536
    v_mfma_f32_16x16x32_bf16 v[12:15], a[124:127], a[144:147], 0
    ds_read_b64_tr_b16 a[192:193], v216 offset:520
    v_mfma_f32_16x16x32_bf16 v[44:47], a[124:127], a[148:151], 0
    ds_read_b64_tr_b16 a[194:195], v216 offset:1544
    v_mfma_f32_16x16x32_bf16 v[76:79], a[124:127], a[152:155], 0
    buffer_load_dwordx4 v210, s[12:15], s31 offen offset:2048 nt lds
    ds_read_b64_tr_b16 a[196:197], v216 offset:768
    v_mfma_f32_16x16x32_bf16 v[108:111], a[124:127], a[156:159], 0
    ds_read_b64_tr_b16 a[198:199], v216 offset:1792
    v_mfma_f32_16x16x32_bf16 v[140:143], a[124:127], a[160:163], 0
    ds_read_b64_tr_b16 a[200:201], v216 offset:776
    v_mfma_f32_16x16x32_bf16 v[172:175], a[124:127], a[164:167], 0
    buffer_load_dwordx4 v211, s[12:15], s31 offen offset:3072 nt lds
    s_add_u32 s31, s31, 262144
    v_mfma_f32_16x16x32_bf16 v[16:19], a[128:131], a[144:147], 0
    s_add_u32 m0, s36, s51
    ds_read_b64_tr_b16 a[202:203], v216 offset:1800
    v_mfma_f32_16x16x32_bf16 v[48:51], a[128:131], a[148:151], 0
    s_add_u32 s39, s39, 32768
    v_mfma_f32_16x16x32_bf16 v[80:83], a[128:131], a[152:155], 0
    buffer_load_dwordx4 v212, s[8:11], s30 offen offset:0  lds
    v_mfma_f32_16x16x32_bf16 v[112:115], a[128:131], a[156:159], 0
    s_cmp_eq_u32 s39, 163840
    s_cselect_b32 s39, 0, s39
    v_mfma_f32_16x16x32_bf16 v[144:147], a[128:131], a[160:163], 0
    v_add_u32 v216, s39, v219
    v_add_u32 v217, s39, v220
    v_mfma_f32_16x16x32_bf16 v[176:179], a[128:131], a[164:167], 0
    buffer_load_dwordx4 v213, s[8:11], s30 offen offset:1024  lds
    s_add_u32 s40, s39, 32768
    v_mfma_f32_16x16x32_bf16 v[192:195], a[128:131], a[168:171], 0
    s_cmp_eq_u32 s40, 163840
    s_cselect_b32 s40, 0, s40
    v_mfma_f32_16x16x32_bf16 v[20:23], a[132:135], a[144:147], 0
    v_add_u32 v218, s40, v220
    v_mfma_f32_16x16x32_bf16 v[52:55], a[132:135], a[148:151], 0
    v_mfma_f32_16x16x32_bf16 v[84:87], a[132:135], a[152:155], 0
    buffer_load_dwordx4 v214, s[8:11], s30 offen offset:2048  lds
    s_add_u32 s30, s30, 128
    v_mfma_f32_16x16x32_bf16 v[116:119], a[132:135], a[156:159], 0
    s_add_u32 m0, s35, s29
    v_mfma_f32_16x16x32_bf16 v[148:151], a[132:135], a[160:163], 0
    v_mfma_f32_16x16x32_bf16 v[180:183], a[132:135], a[164:167], 0
    buffer_load_dwordx4 v208, s[12:15], s31 offen offset:0 nt lds
    v_mfma_f32_16x16x32_bf16 v[196:199], a[132:135], a[168:171], 0
    v_mfma_f32_16x16x32_bf16 v[24:27], a[136:139], a[144:147], 0
    v_mfma_f32_16x16x32_bf16 v[56:59], a[136:139], a[148:151], 0
    buffer_load_dwordx4 v209, s[12:15], s31 offen offset:1024 nt lds
    v_mfma_f32_16x16x32_bf16 v[88:91], a[136:139], a[152:155], 0
    v_mfma_f32_16x16x32_bf16 v[120:123], a[136:139], a[156:159], 0
    v_mfma_f32_16x16x32_bf16 v[152:155], a[136:139], a[160:163], 0
    buffer_load_dwordx4 v210, s[12:15], s31 offen offset:2048 nt lds
    v_mfma_f32_16x16x32_bf16 v[184:187], a[136:139], a[164:167], 0
    v_mfma_f32_16x16x32_bf16 v[200:203], a[136:139], a[168:171], 0
    v_mfma_f32_16x16x32_bf16 v[28:31], a[140:143], a[144:147], 0
    buffer_load_dwordx4 v211, s[12:15], s31 offen offset:3072 nt lds
    s_add_u32 s31, s31, 262144
    v_mfma_f32_16x16x32_bf16 v[60:63], a[140:143], a[148:151], 0
    s_mov_b32 s51, s29
    s_add_u32 s29, s29, 32768
    v_mfma_f32_16x16x32_bf16 v[92:95], a[140:143], a[152:155], 0
    s_cmp_eq_u32 s29, 163840
    s_cselect_b32 s29, 0, s29
    v_mfma_f32_16x16x32_bf16 v[124:127], a[140:143], a[156:159], 0
    v_mfma_f32_16x16x32_bf16 v[156:159], a[140:143], a[160:163], 0
    v_mfma_f32_16x16x32_bf16 v[188:191], a[140:143], a[164:167], 0
    v_mfma_f32_16x16x32_bf16 v[204:207], a[140:143], a[168:171], 0
    s_waitcnt vmcnt(16) lgkmcnt(0)
    s_barrier
    v_mfma_f32_16x16x32_bf16 v[0:3], a[172:175], a[204:207], v[0:3]
    s_add_u32 m0, s50, s51
    ds_read_b64_tr_b16 a[112:113], v216 offset:0
    v_mfma_f32_16x16x32_bf16 v[32:35], a[172:175], a[208:211], v[32:35]
    buffer_load_dwordx4 v212, s[8:11], s49 offen offset:0  lds
    ds_read_b64_tr_b16 a[114:115], v216 offset:1024
    v_mfma_f32_16x16x32_bf16 v[64:67], a[172:175], a[212:215], v[64:67]
    ds_read_b128 a[144:147], v217 offset:12288
    v_mfma_f32_16x16x32_bf16 v[96:99], a[172:175], a[216:219], v[96:99]
    ds_read_b128 a[148:151], v218 offset:0
    v_mfma_f32_16x16x32_bf16 v[128:131], a[172:175], a[220:223], v[128:131]
    ds_read_b128 a[152:155], v218 offset:2048
    v_mfma_f32_16x16x32_bf16 v[160:163], a[172:175], a[224:227], v[160:163]
    ds_read_b128 a[156:159], v218 offset:4096
    v_mfma_f32_16x16x32_bf16 v[4:7], a[176:179], a[204:207], v[4:7]
    ds_read_b128 a[160:163], v218 offset:6144
    v_mfma_f32_16x16x32_bf16 v[36:39], a[176:179], a[208:211], v[36:39]
    buffer_load_dwordx4 v213, s[8:11], s49 offen offset:1024  lds
    ds_read_b128 a[164:167], v218 offset:8192
    v_mfma_f32_16x16x32_bf16 v[68:71], a[176:179], a[212:215], v[68:71]
    ds_read_b128 a[168:171], v218 offset:10240
    v_mfma_f32_16x16x32_bf16 v[100:103], a[176:179], a[216:219], v[100:103]
    ds_read_b64_tr_b16 a[116:117], v216 offset:8
    v_mfma_f32_16x16x32_bf16 v[132:135], a[176:179], a[220:223], v[132:135]
    ds_read_b64_tr_b16 a[118:119], v216 offset:1032
    v_mfma_f32_16x16x32_bf16 v[164:167], a[176:179], a[224:227], v[164:167]
    ds_read_b64_tr_b16 a[120:121], v216 offset:256
    v_mfma_f32_16x16x32_bf16 v[8:11], a[180:183], a[204:207], v[8:11]
    ds_read_b64_tr_b16 a[122:123], v216 offset:1280
    v_mfma_f32_16x16x32_bf16 v[40:43], a[180:183], a[208:211], v[40:43]
    ds_read_b64_tr_b16 a[124:125], v216 offset:264
    v_mfma_f32_16x16x32_bf16 v[72:75], a[180:183], a[212:215], v[72:75]
    buffer_load_dwordx4 v214, s[8:11], s49 offen offset:2048  lds
    s_add_u32 s49, s49, 128
    v_mfma_f32_16x16x32_bf16 v[104:107], a[180:183], a[216:219], v[104:107]
    s_add_u32 m0, s35, s29
    ds_read_b64_tr_b16 a[126:127], v216 offset:1288
    v_mfma_f32_16x16x32_bf16 v[136:139], a[180:183], a[220:223], v[136:139]
    ds_read_b64_tr_b16 a[128:129], v216 offset:512
    v_mfma_f32_16x16x32_bf16 v[168:171], a[180:183], a[224:227], v[168:171]
    ds_read_b64_tr_b16 a[130:131], v216 offset:1536
    v_mfma_f32_16x16x32_bf16 v[12:15], a[184:187], a[204:207], v[12:15]
    ds_read_b64_tr_b16 a[132:133], v216 offset:520
    v_mfma_f32_16x16x32_bf16 v[44:47], a[184:187], a[208:211], v[44:47]
    ds_read_b64_tr_b16 a[134:135], v216 offset:1544
    v_mfma_f32_16x16x32_bf16 v[76:79], a[184:187], a[212:215], v[76:79]
    ds_read_b64_tr_b16 a[136:137], v216 offset:768
    v_mfma_f32_16x16x32_bf16 v[108:111], a[184:187], a[216:219], v[108:111]
    buffer_load_dwordx4 v208, s[12:15], s31 offen offset:0 nt lds
    ds_read_b64_tr_b16 a[138:139], v216 offset:1792
    v_mfma_f32_16x16x32_bf16 v[140:143], a[184:187], a[220:223], v[140:143]
    ds_read_b64_tr_b16 a[140:141], v216 offset:776
    v_mfma_f32_16x16x32_bf16 v[172:175], a[184:187], a[224:227], v[172:175]
    ds_read_b64_tr_b16 a[142:143], v216 offset:1800
    v_mfma_f32_16x16x32_bf16 v[16:19], a[188:191], a[204:207], v[16:19]
    s_add_u32 s39, s39, 32768
    v_mfma_f32_16x16x32_bf16 v[48:51], a[188:191], a[208:211], v[48:51]
    s_cmp_eq_u32 s39, 163840
    s_cselect_b32 s39, 0, s39
    v_mfma_f32_16x16x32_bf16 v[80:83], a[188:191], a[212:215], v[80:83]
    v_add_u32 v216, s39, v219
    v_mfma_f32_16x16x32_bf16 v[112:115], a[188:191], a[216:219], v[112:115]
    v_mfma_f32_16x16x32_bf16 v[144:147], a[188:191], a[220:223], v[144:147]
    buffer_load_dwordx4 v209, s[12:15], s31 offen offset:1024 nt lds
    v_mfma_f32_16x16x32_bf16 v[176:179], a[188:191], a[224:227], v[176:179]
    v_mfma_f32_16x16x32_bf16 v[192:195], a[188:191], a[228:231], v[192:195]
    v_mfma_f32_16x16x32_bf16 v[20:23], a[192:195], a[204:207], v[20:23]
    v_mfma_f32_16x16x32_bf16 v[52:55], a[192:195], a[208:211], v[52:55]
    v_mfma_f32_16x16x32_bf16 v[84:87], a[192:195], a[212:215], v[84:87]
    v_mfma_f32_16x16x32_bf16 v[116:119], a[192:195], a[216:219], v[116:119]
    v_mfma_f32_16x16x32_bf16 v[148:151], a[192:195], a[220:223], v[148:151]
    buffer_load_dwordx4 v210, s[12:15], s31 offen offset:2048 nt lds
    v_mfma_f32_16x16x32_bf16 v[180:183], a[192:195], a[224:227], v[180:183]
    v_mfma_f32_16x16x32_bf16 v[196:199], a[192:195], a[228:231], v[196:199]
    v_mfma_f32_16x16x32_bf16 v[24:27], a[196:199], a[204:207], v[24:27]
    v_mfma_f32_16x16x32_bf16 v[56:59], a[196:199], a[208:211], v[56:59]
    v_mfma_f32_16x16x32_bf16 v[88:91], a[196:199], a[212:215], v[88:91]
    v_mfma_f32_16x16x32_bf16 v[120:123], a[196:199], a[216:219], v[120:123]
    v_mfma_f32_16x16x32_bf16 v[152:155], a[196:199], a[220:223], v[152:155]
    buffer_load_dwordx4 v211, s[12:15], s31 offen offset:3072 nt lds
    s_add_u32 s31, s31, 262144
    v_mfma_f32_16x16x32_bf16 v[184:187], a[196:199], a[224:227], v[184:187]
    s_mov_b32 s51, s29
    s_add_u32 s29, s29, 32768
    v_mfma_f32_16x16x32_bf16 v[200:203], a[196:199], a[228:231], v[200:203]
    s_cmp_eq_u32 s29, 163840
    s_cselect_b32 s29, 0, s29
    v_mfma_f32_16x16x32_bf16 v[28:31], a[200:203], a[204:207], v[28:31]
    v_mfma_f32_16x16x32_bf16 v[60:63], a[200:203], a[208:211], v[60:63]
    v_mfma_f32_16x16x32_bf16 v[92:95], a[200:203], a[212:215], v[92:95]
    v_mfma_f32_16x16x32_bf16 v[124:127], a[200:203], a[216:219], v[124:127]
    v_mfma_f32_16x16x32_bf16 v[156:159], a[200:203], a[220:223], v[156:159]
    v_mfma_f32_16x16x32_bf16 v[188:191], a[200:203], a[224:227], v[188:191]
    v_mfma_f32_16x16x32_bf16 v[204:207], a[200:203], a[228:231], v[204:207]
    s_waitcnt vmcnt(18) lgkmcnt(0)
    s_barrier
    v_mfma_f32_16x16x32_bf16 v[0:3], a[112:115], a[144:147], v[0:3]
    s_add_u32 m0, s36, s51
    ds_read_b64_tr_b16 a[172:173], v216 offset:0
    v_mfma_f32_16x16x32_bf16 v[32:35], a[112:115], a[148:151], v[32:35]
    buffer_load_dwordx4 v212, s[8:11], s30 offen offset:0  lds
    ds_read_b64_tr_b16 a[174:175], v216 offset:1024
    v_mfma_f32_16x16x32_bf16 v[64:67], a[112:115], a[152:155], v[64:67]
    ds_read_b128 a[204:207], v217 offset:12800
    v_mfma_f32_16x16x32_bf16 v[96:99], a[112:115], a[156:159], v[96:99]
    ds_read_b128 a[208:211], v218 offset:512
    v_mfma_f32_16x16x32_bf16 v[128:131], a[112:115], a[160:163], v[128:131]
    ds_read_b128 a[212:215], v218 offset:2560
    v_mfma_f32_16x16x32_bf16 v[160:163], a[112:115], a[164:167], v[160:163]
    ds_read_b128 a[216:219], v218 offset:4608
    v_mfma_f32_16x16x32_bf16 v[4:7], a[116:119], a[144:147], v[4:7]
    ds_read_b128 a[220:223], v218 offset:6656
    v_mfma_f32_16x16x32_bf16 v[36:39], a[116:119], a[148:151], v[36:39]
    buffer_load_dwordx4 v213, s[8:11], s30 offen offset:1024  lds
    ds_read_b128 a[224:227], v218 offset:8704
    v_mfma_f32_16x16x32_bf16 v[68:71], a[116:119], a[152:155], v[68:71]
    ds_read_b128 a[228:231], v218 offset:10752
    v_mfma_f32_16x16x32_bf16 v[100:103], a[116:119], a[156:159], v[100:103]
    ds_read_b64_tr_b16 a[176:177], v216 offset:8
    v_mfma_f32_16x16x32_bf16 v[132:135], a[116:119], a[160:163], v[132:135]
    ds_read_b64_tr_b16 a[178:179], v216 offset:1032
    v_mfma_f32_16x16x32_bf16 v[164:167], a[116:119], a[164:167], v[164:167]
    ds_read_b64_tr_b16 a[180:181], v216 offset:256
    v_mfma_f32_16x16x32_bf16 v[8:11], a[120:123], a[144:147], v[8:11]
    ds_read_b64_tr_b16 a[182:183], v216 offset:1280
    v_mfma_f32_16x16x32_bf16 v[40:43], a[120:123], a[148:151], v[40:43]
    ds_read_b64_tr_b16 a[184:185], v216 offset:264
    v_mfma_f32_16x16x32_bf16 v[72:75], a[120:123], a[152:155], v[72:75]
    buffer_load_dwordx4 v214, s[8:11], s30 offen offset:2048  lds
    s_add_u32 s30, s30, 128
    v_mfma_f32_16x16x32_bf16 v[104:107], a[120:123], a[156:159], v[104:107]
    s_add_u32 m0, s35, s29
    ds_read_b64_tr_b16 a[186:187], v216 offset:1288
    v_mfma_f32_16x16x32_bf16 v[136:139], a[120:123], a[160:163], v[136:139]
    ds_read_b64_tr_b16 a[188:189], v216 offset:512
    v_mfma_f32_16x16x32_bf16 v[168:171], a[120:123], a[164:167], v[168:171]
    ds_read_b64_tr_b16 a[190:191], v216 offset:1536
    v_mfma_f32_16x16x32_bf16 v[12:15], a[124:127], a[144:147], v[12:15]
    ds_read_b64_tr_b16 a[192:193], v216 offset:520
    v_mfma_f32_16x16x32_bf16 v[44:47], a[124:127], a[148:151], v[44:47]
    ds_read_b64_tr_b16 a[194:195], v216 offset:1544
    v_mfma_f32_16x16x32_bf16 v[76:79], a[124:127], a[152:155], v[76:79]
    ds_read_b64_tr_b16 a[196:197], v216 offset:768
    v_mfma_f32_16x16x32_bf16 v[108:111], a[124:127], a[156:159], v[108:111]
    buffer_load_dwordx4 v208, s[12:15], s31 offen offset:0 nt lds
    ds_read_b64_tr_b16 a[198:199], v216 offset:1792
    v_mfma_f32_16x16x32_bf16 v[140:143], a[124:127], a[160:163], v[140:143]
    ds_read_b64_tr_b16 a[200:201], v216 offset:776
    v_mfma_f32_16x16x32_bf16 v[172:175], a[124:127], a[164:167], v[172:175]
    ds_read_b64_tr_b16 a[202:203], v216 offset:1800
    v_mfma_f32_16x16x32_bf16 v[16:19], a[128:131], a[144:147], v[16:19]
    s_add_u32 s39, s39, 32768
    v_mfma_f32_16x16x32_bf16 v[48:51], a[128:131], a[148:151], v[48:51]
    s_cmp_eq_u32 s39, 163840
    s_cselect_b32 s39, 0, s39
    v_mfma_f32_16x16x32_bf16 v[80:83], a[128:131], a[152:155], v[80:83]
    v_add_u32 v216, s39, v219
    v_add_u32 v217, s39, v220
    v_mfma_f32_16x16x32_bf16 v[112:115], a[128:131], a[156:159], v[112:115]
    s_add_u32 s40, s39, 32768
    v_mfma_f32_16x16x32_bf16 v[144:147], a[128:131], a[160:163], v[144:147]
    buffer_load_dwordx4 v209, s[12:15], s31 offen offset:1024 nt lds
    v_mfma_f32_16x16x32_bf16 v[176:179], a[128:131], a[164:167], v[176:179]
    s_cmp_eq_u32 s40, 163840
    s_cselect_b32 s40, 0, s40
    v_mfma_f32_16x16x32_bf16 v[192:195], a[128:131], a[168:171], v[192:195]
    v_add_u32 v218, s40, v220
    v_mfma_f32_16x16x32_bf16 v[20:23], a[132:135], a[144:147], v[20:23]
    v_mfma_f32_16x16x32_bf16 v[52:55], a[132:135], a[148:151], v[52:55]
    v_mfma_f32_16x16x32_bf16 v[84:87], a[132:135], a[152:155], v[84:87]
    v_mfma_f32_16x16x32_bf16 v[116:119], a[132:135], a[156:159], v[116:119]
    v_mfma_f32_16x16x32_bf16 v[148:151], a[132:135], a[160:163], v[148:151]
    buffer_load_dwordx4 v210, s[12:15], s31 offen offset:2048 nt lds
    v_mfma_f32_16x16x32_bf16 v[180:183], a[132:135], a[164:167], v[180:183]
    v_mfma_f32_16x16x32_bf16 v[196:199], a[132:135], a[168:171], v[196:199]
    v_mfma_f32_16x16x32_bf16 v[24:27], a[136:139], a[144:147], v[24:27]
    v_mfma_f32_16x16x32_bf16 v[56:59], a[136:139], a[148:151], v[56:59]
    v_mfma_f32_16x16x32_bf16 v[88:91], a[136:139], a[152:155], v[88:91]
    v_mfma_f32_16x16x32_bf16 v[120:123], a[136:139], a[156:159], v[120:123]
    v_mfma_f32_16x16x32_bf16 v[152:155], a[136:139], a[160:163], v[152:155]
    buffer_load_dwordx4 v211, s[12:15], s31 offen offset:3072 nt lds
    s_add_u32 s31, s31, 262144
    v_mfma_f32_16x16x32_bf16 v[184:187], a[136:139], a[164:167], v[184:187]
    s_mov_b32 s51, s29
    s_add_u32 s29, s29, 32768
    v_mfma_f32_16x16x32_bf16 v[200:203], a[136:139], a[168:171], v[200:203]
    s_cmp_eq_u32 s29, 163840
    s_cselect_b32 s29, 0, s29
    v_mfma_f32_16x16x32_bf16 v[28:31], a[140:143], a[144:147], v[28:31]
    v_mfma_f32_16x16x32_bf16 v[60:63], a[140:143], a[148:151], v[60:63]
    v_mfma_f32_16x16x32_bf16 v[92:95], a[140:143], a[152:155], v[92:95]
    v_mfma_f32_16x16x32_bf16 v[124:127], a[140:143], a[156:159], v[124:127]
    v_mfma_f32_16x16x32_bf16 v[156:159], a[140:143], a[160:163], v[156:159]
    v_mfma_f32_16x16x32_bf16 v[188:191], a[140:143], a[164:167], v[188:191]
    v_mfma_f32_16x16x32_bf16 v[204:207], a[140:143], a[168:171], v[204:207]
    s_waitcnt vmcnt(11) lgkmcnt(0)
    s_barrier
    v_mfma_f32_16x16x32_bf16 v[0:3], a[172:175], a[204:207], v[0:3]
    s_add_u32 m0, s50, s51
    ds_read_b64_tr_b16 a[112:113], v216 offset:0
    v_mfma_f32_16x16x32_bf16 v[32:35], a[172:175], a[208:211], v[32:35]
    buffer_load_dwordx4 v212, s[8:11], s49 offen offset:0  lds
    ds_read_b64_tr_b16 a[114:115], v216 offset:1024
    v_mfma_f32_16x16x32_bf16 v[64:67], a[172:175], a[212:215], v[64:67]
    ds_read_b128 a[144:147], v217 offset:12288
    v_mfma_f32_16x16x32_bf16 v[96:99], a[172:175], a[216:219], v[96:99]
    ds_read_b128 a[148:151], v218 offset:0
    v_mfma_f32_16x16x32_bf16 v[128:131], a[172:175], a[220:223], v[128:131]
    ds_read_b128 a[152:155], v218 offset:2048
    v_mfma_f32_16x16x32_bf16 v[160:163], a[172:175], a[224:227], v[160:163]
    ds_read_b128 a[156:159], v218 offset:4096
    v_mfma_f32_16x16x32_bf16 v[4:7], a[176:179], a[204:207], v[4:7]
    ds_read_b128 a[160:163], v218 offset:6144
    v_mfma_f32_16x16x32_bf16 v[36:39], a[176:179], a[208:211], v[36:39]
    buffer_load_dwordx4 v213, s[8:11], s49 offen offset:1024  lds
    ds_read_b128 a[164:167], v218 offset:8192
    v_mfma_f32_16x16x32_bf16 v[68:71], a[176:179], a[212:215], v[68:71]
    ds_read_b128 a[168:171], v218 offset:10240
    v_mfma_f32_16x16x32_bf16 v[100:103], a[176:179], a[216:219], v[100:103]
    ds_read_b64_tr_b16 a[116:117], v216 offset:8
    v_mfma_f32_16x16x32_bf16 v[132:135], a[176:179], a[220:223], v[132:135]
    ds_read_b64_tr_b16 a[118:119], v216 offset:1032
    v_mfma_f32_16x16x32_bf16 v[164:167], a[176:179], a[224:227], v[164:167]
    ds_read_b64_tr_b16 a[120:121], v216 offset:256
    v_mfma_f32_16x16x32_bf16 v[8:11], a[180:183], a[204:207], v[8:11]
    ds_read_b64_tr_b16 a[122:123], v216 offset:1280
    v_mfma_f32_16x16x32_bf16 v[40:43], a[180:183], a[208:211], v[40:43]
    ds_read_b64_tr_b16 a[124:125], v216 offset:264
    v_mfma_f32_16x16x32_bf16 v[72:75], a[180:183], a[212:215], v[72:75]
    buffer_load_dwordx4 v214, s[8:11], s49 offen offset:2048  lds
    s_add_u32 s49, s49, 128
    v_mfma_f32_16x16x32_bf16 v[104:107], a[180:183], a[216:219], v[104:107]
    s_add_u32 m0, s35, s29
    ds_read_b64_tr_b16 a[126:127], v216 offset:1288
    v_mfma_f32_16x16x32_bf16 v[136:139], a[180:183], a[220:223], v[136:139]
    ds_read_b64_tr_b16 a[128:129], v216 offset:512
    v_mfma_f32_16x16x32_bf16 v[168:171], a[180:183], a[224:227], v[168:171]
    ds_read_b64_tr_b16 a[130:131], v216 offset:1536
    v_mfma_f32_16x16x32_bf16 v[12:15], a[184:187], a[204:207], v[12:15]
    ds_read_b64_tr_b16 a[132:133], v216 offset:520
    v_mfma_f32_16x16x32_bf16 v[44:47], a[184:187], a[208:211], v[44:47]
    ds_read_b64_tr_b16 a[134:135], v216 offset:1544
    v_mfma_f32_16x16x32_bf16 v[76:79], a[184:187], a[212:215], v[76:79]
    ds_read_b64_tr_b16 a[136:137], v216 offset:768
    v_mfma_f32_16x16x32_bf16 v[108:111], a[184:187], a[216:219], v[108:111]
    buffer_load_dwordx4 v208, s[12:15], s31 offen offset:0 nt lds
    ds_read_b64_tr_b16 a[138:139], v216 offset:1792
    v_mfma_f32_16x16x32_bf16 v[140:143], a[184:187], a[220:223], v[140:143]
    ds_read_b64_tr_b16 a[140:141], v216 offset:776
    v_mfma_f32_16x16x32_bf16 v[172:175], a[184:187], a[224:227], v[172:175]
    ds_read_b64_tr_b16 a[142:143], v216 offset:1800
    v_mfma_f32_16x16x32_bf16 v[16:19], a[188:191], a[204:207], v[16:19]
    s_add_u32 s39, s39, 32768
    v_mfma_f32_16x16x32_bf16 v[48:51], a[188:191], a[208:211], v[48:51]
    s_cmp_eq_u32 s39, 163840
    s_cselect_b32 s39, 0, s39
    v_mfma_f32_16x16x32_bf16 v[80:83], a[188:191], a[212:215], v[80:83]
    v_add_u32 v216, s39, v219
    v_mfma_f32_16x16x32_bf16 v[112:115], a[188:191], a[216:219], v[112:115]
    v_mfma_f32_16x16x32_bf16 v[144:147], a[188:191], a[220:223], v[144:147]
    buffer_load_dwordx4 v209, s[12:15], s31 offen offset:1024 nt lds
    v_mfma_f32_16x16x32_bf16 v[176:179], a[188:191], a[224:227], v[176:179]
    v_mfma_f32_16x16x32_bf16 v[192:195], a[188:191], a[228:231], v[192:195]
    v_mfma_f32_16x16x32_bf16 v[20:23], a[192:195], a[204:207], v[20:23]
    v_mfma_f32_16x16x32_bf16 v[52:55], a[192:195], a[208:211], v[52:55]
    v_mfma_f32_16x16x32_bf16 v[84:87], a[192:195], a[212:215], v[84:87]
    v_mfma_f32_16x16x32_bf16 v[116:119], a[192:195], a[216:219], v[116:119]
    v_mfma_f32_16x16x32_bf16 v[148:151], a[192:195], a[220:223], v[148:151]
    buffer_load_dwordx4 v210, s[12:15], s31 offen offset:2048 nt lds
    v_mfma_f32_16x16x32_bf16 v[180:183], a[192:195], a[224:227], v[180:183]
    v_mfma_f32_16x16x32_bf16 v[196:199], a[192:195], a[228:231], v[196:199]
    v_mfma_f32_16x16x32_bf16 v[24:27], a[196:199], a[204:207], v[24:27]
    v_mfma_f32_16x16x32_bf16 v[56:59], a[196:199], a[208:211], v[56:59]
    v_mfma_f32_16x16x32_bf16 v[88:91], a[196:199], a[212:215], v[88:91]
    v_mfma_f32_16x16x32_bf16 v[120:123], a[196:199], a[216:219], v[120:123]
    v_mfma_f32_16x16x32_bf16 v[152:155], a[196:199], a[220:223], v[152:155]
    buffer_load_dwordx4 v211, s[12:15], s31 offen offset:3072 nt lds
    s_add_u32 s31, s31, 262144
    v_mfma_f32_16x16x32_bf16 v[184:187], a[196:199], a[224:227], v[184:187]
    s_mov_b32 s51, s29
    s_add_u32 s29, s29, 32768
    v_mfma_f32_16x16x32_bf16 v[200:203], a[196:199], a[228:231], v[200:203]
    s_cmp_eq_u32 s29, 163840
    s_cselect_b32 s29, 0, s29
    v_mfma_f32_16x16x32_bf16 v[28:31], a[200:203], a[204:207], v[28:31]
    v_mfma_f32_16x16x32_bf16 v[60:63], a[200:203], a[208:211], v[60:63]
    v_mfma_f32_16x16x32_bf16 v[92:95], a[200:203], a[212:215], v[92:95]
    v_mfma_f32_16x16x32_bf16 v[124:127], a[200:203], a[216:219], v[124:127]
    v_mfma_f32_16x16x32_bf16 v[156:159], a[200:203], a[220:223], v[156:159]
    v_mfma_f32_16x16x32_bf16 v[188:191], a[200:203], a[224:227], v[188:191]
    v_mfma_f32_16x16x32_bf16 v[204:207], a[200:203], a[228:231], v[204:207]
    s_mov_b32 s28, 11
.p2align 6
L1_q1:
    s_waitcnt vmcnt(18) lgkmcnt(0)
    s_barrier
    v_mfma_f32_16x16x32_bf16 v[0:3], a[112:115], a[144:147], v[0:3]
    s_add_u32 m0, s36, s51
    ds_read_b64_tr_b16 a[172:173], v216 offset:0
    v_mfma_f32_16x16x32_bf16 v[32:35], a[112:115], a[148:151], v[32:35]
    buffer_load_dwordx4 v212, s[8:11], s30 offen offset:0  lds
    ds_read_b64_tr_b16 a[174:175], v216 offset:1024
    v_mfma_f32_16x16x32_bf16 v[64:67], a[112:115], a[152:155], v[64:67]
    ds_read_b128 a[204:207], v217 offset:12800
    v_mfma_f32_16x16x32_bf16 v[96:99], a[112:115], a[156:159], v[96:99]
    ds_read_b128 a[208:211], v218 offset:512
    v_mfma_f32_16x16x32_bf16 v[128:131], a[112:115], a[160:163], v[128:131]
    ds_read_b128 a[212:215], v218 offset:2560
    v_mfma_f32_16x16x32_bf16 v[160:163], a[112:115], a[164:167], v[160:163]
    ds_read_b128 a[216:219], v218 offset:4608
    v_mfma_f32_16x16x32_bf16 v[4:7], a[116:119], a[144:147], v[4:7]
    ds_read_b128 a[220:223], v218 offset:6656
    v_mfma_f32_16x16x32_bf16 v[36:39], a[116:119], a[148:151], v[36:39]
    buffer_load_dwordx4 v213, s[8:11], s30 offen offset:1024  lds
    ds_read_b128 a[224:227], v218 offset:8704
    v_mfma_f32_16x16x32_bf16 v[68:71], a[116:119], a[152:155], v[68:71]
    ds_read_b128 a[228:231], v218 offset:10752
    v_mfma_f32_16x16x32_bf16 v[100:103], a[116:119], a[156:159], v[100:103]
    ds_read_b64_tr_b16 a[176:177], v216 offset:8
    v_mfma_f32_16x16x32_bf16 v[132:135], a[116:119], a[160:163], v[132:135]
    ds_read_b64_tr_b16 a[178:179], v216 offset:1032
    v_mfma_f32_16x16x32_bf16 v[164:167], a[116:119], a[164:167], v[164:167]
    ds_read_b64_tr_b16 a[180:181], v216 offset:256
    v_mfma_f32_16x16x32_bf16 v[8:11], a[120:123], a[144:147], v[8:11]
    ds_read_b64_tr_b16 a[182:183], v216 offset:1280
    v_mfma_f32_16x16x32_bf16 v[40:43], a[120:123], a[148:151], v[40:43]
    ds_read_b64_tr_b16 a[184:185], v216 offset:264
    v_mfma_f32_16x16x32_bf16 v[72:75], a[120:123], a[152:155], v[72:75]
    buffer_load_dwordx4 v214, s[8:11], s30 offen offset:2048  lds
    s_add_u32 s30, s30, 128
    v_mfma_f32_16x16x32_bf16 v[104:107], a[120:123], a[156:159], v[104:107]
    s_add_u32 m0, s35, s29
    ds_read_b64_tr_b16 a[186:187], v216 offset:1288
    v_mfma_f32_16x16x32_bf16 v[136:139], a[120:123], a[160:163], v[136:139]
    ds_read_b64_tr_b16 a[188:189], v216 offset:512
    v_mfma_f32_16x16x32_bf16 v[168:171], a[120:123], a[164:167], v[168:171]
    ds_read_b64_tr_b16 a[190:191], v216 offset:1536
    v_mfma_f32_16x16x32_bf16 v[12:15], a[124:127], a[144:147], v[12:15]
    ds_read_b64_tr_b16 a[192:193], v216 offset:520
    v_mfma_f32_16x16x32_bf16 v[44:47], a[124:127], a[148:151], v[44:47]
    ds_read_b64_tr_b16 a[194:195], v216 offset:1544
    v_mfma_f32_16x16x32_bf16 v[76:79], a[124:127], a[152:155], v[76:79]
    ds_read_b64_tr_b16 a[196:197], v216 offset:768
    v_mfma_f32_16x16x32_bf16 v[108:111], a[124:127], a[156:159], v[108:111]
    buffer_load_dwordx4 v208, s[12:15], s31 offen offset:0 nt lds
    ds_read_b64_tr_b16 a[198:199], v216 offset:1792
    v_mfma_f32_16x16x32_bf16 v[140:143], a[124:127], a[160:163], v[140:143]
    ds_read_b64_tr_b16 a[200:201], v216 offset:776
    v_mfma_f32_16x16x32_bf16 v[172:175], a[124:127], a[164:167], v[172:175]
    ds_read_b64_tr_b16 a[202:203], v216 offset:1800
    v_mfma_f32_16x16x32_bf16 v[16:19], a[128:131], a[144:147], v[16:19]
    s_add_u32 s39, s39, 32768
    v_mfma_f32_16x16x32_bf16 v[48:51], a[128:131], a[148:151], v[48:51]
    s_cmp_eq_u32 s39, 163840
    s_cselect_b32 s39, 0, s39
    v_mfma_f32_16x16x32_bf16 v[80:83], a[128:131], a[152:155], v[80:83]
    v_add_u32 v216, s39, v219
    v_add_u32 v217, s39, v220
    v_mfma_f32_16x16x32_bf16 v[112:115], a[128:131], a[156:159], v[112:115]
    s_add_u32 s40, s39, 32768
    v_mfma_f32_16x16x32_bf16 v[144:147], a[128:131], a[160:163], v[144:147]
    buffer_load_dwordx4 v209, s[12:15], s31 offen offset:1024 nt lds
    v_mfma_f32_16x16x32_bf16 v[176:179], a[128:131], a[164:167], v[176:179]
    s_cmp_eq_u32 s40, 163840
    s_cselect_b32 s40, 0, s40
    v_mfma_f32_16x16x32_bf16 v[192:195], a[128:131], a[168:171], v[192:195]
    v_add_u32 v218, s40, v220
    v_mfma_f32_16x16x32_bf16 v[20:23], a[132:135], a[144:147], v[20:23]
    v_mfma_f32_16x16x32_bf16 v[52:55], a[132:135], a[148:151], v[52:55]
    v_mfma_f32_16x16x32_bf16 v[84:87], a[132:135], a[152:155], v[84:87]
    v_mfma_f32_16x16x32_bf16 v[116:119], a[132:135], a[156:159], v[116:119]
    v_mfma_f32_16x16x32_bf16 v[148:151], a[132:135], a[160:163], v[148:151]
    buffer_load_dwordx4 v210, s[12:15], s31 offen offset:2048 nt lds
    v_mfma_f32_16x16x32_bf16 v[180:183], a[132:135], a[164:167], v[180:183]
    v_mfma_f32_16x16x32_bf16 v[196:199], a[132:135], a[168:171], v[196:199]
    v_mfma_f32_16x16x32_bf16 v[24:27], a[136:139], a[144:147], v[24:27]
    v_mfma_f32_16x16x32_bf16 v[56:59], a[136:139], a[148:151], v[56:59]
    v_mfma_f32_16x16x32_bf16 v[88:91], a[136:139], a[152:155], v[88:91]
    v_mfma_f32_16x16x32_bf16 v[120:123], a[136:139], a[156:159], v[120:123]
    v_mfma_f32_16x16x32_bf16 v[152:155], a[136:139], a[160:163], v[152:155]
    buffer_load_dwordx4 v211, s[12:15], s31 offen offset:3072 nt lds
    s_add_u32 s31, s31, 262144
    v_mfma_f32_16x16x32_bf16 v[184:187], a[136:139], a[164:167], v[184:187]
    s_mov_b32 s51, s29
    s_add_u32 s29, s29, 32768
    v_mfma_f32_16x16x32_bf16 v[200:203], a[136:139], a[168:171], v[200:203]
    s_cmp_eq_u32 s29, 163840
    s_cselect_b32 s29, 0, s29
    v_mfma_f32_16x16x32_bf16 v[28:31], a[140:143], a[144:147], v[28:31]
    v_mfma_f32_16x16x32_bf16 v[60:63], a[140:143], a[148:151], v[60:63]
    v_mfma_f32_16x16x32_bf16 v[92:95], a[140:143], a[152:155], v[92:95]
    v_mfma_f32_16x16x32_bf16 v[124:127], a[140:143], a[156:159], v[124:127]
    v_mfma_f32_16x16x32_bf16 v[156:159], a[140:143], a[160:163], v[156:159]
    v_mfma_f32_16x16x32_bf16 v[188:191], a[140:143], a[164:167], v[188:191]
    v_mfma_f32_16x16x32_bf16 v[204:207], a[140:143], a[168:171], v[204:207]
    s_waitcnt vmcnt(11) lgkmcnt(0)
    s_barrier
    v_mfma_f32_16x16x32_bf16 v[0:3], a[172:175], a[204:207], v[0:3]
    s_add_u32 m0, s50, s51
    ds_read_b64_tr_b16 a[112:113], v216 offset:0
    v_mfma_f32_16x16x32_bf16 v[32:35], a[172:175], a[208:211], v[32:35]
    buffer_load_dwordx4 v212, s[8:11], s49 offen offset:0  lds
    ds_read_b64_tr_b16 a[114:115], v216 offset:1024
    v_mfma_f32_16x16x32_bf16 v[64:67], a[172:175], a[212:215], v[64:67]
    ds_read_b128 a[144:147], v217 offset:12288
    v_mfma_f32_16x16x32_bf16 v[96:99], a[172:175], a[216:219], v[96:99]
    ds_read_b128 a[148:151], v218 offset:0
    v_mfma_f32_16x16x32_bf16 v[128:131], a[172:175], a[220:223], v[128:131]
    ds_read_b128 a[152:155], v218 offset:2048
    v_mfma_f32_16x16x32_bf16 v[160:163], a[172:175], a[224:227], v[160:163]
    ds_read_b128 a[156:159], v218 offset:4096
    v_mfma_f32_16x16x32_bf16 v[4:7], a[176:179], a[204:207], v[4:7]
    ds_read_b128 a[160:163], v218 offset:6144
    v_mfma_f32_16x16x32_bf16 v[36:39], a[176:179], a[208:211], v[36:39]
    buffer_load_dwordx4 v213, s[8:11], s49 offen offset:1024  lds
    ds_read_b128 a[164:167], v218 offset:8192
    v_mfma_f32_16x16x32_bf16 v[68:71], a[176:179], a[212:215], v[68:71]
    ds_read_b128 a[168:171], v218 offset:10240
    v_mfma_f32_16x16x32_bf16 v[100:103], a[176:179], a[216:219], v[100:103]
    ds_read_b64_tr_b16 a[116:117], v216 offset:8
    v_mfma_f32_16x16x32_bf16 v[132:135], a[176:179], a[220:223], v[132:135]
    ds_read_b64_tr_b16 a[118:119], v216 offset:1032
    v_mfma_f32_16x16x32_bf16 v[164:167], a[176:179], a[224:227], v[164:167]
    ds_read_b64_tr_b16 a[120:121], v216 offset:256
    v_mfma_f32_16x16x32_bf16 v[8:11], a[180:183], a[204:207], v[8:11]
    ds_read_b64_tr_b16 a[122:123], v216 offset:1280
    v_mfma_f32_16x16x32_bf16 v[40:43], a[180:183], a[208:211], v[40:43]
    ds_read_b64_tr_b16 a[124:125], v216 offset:264
    v_mfma_f32_16x16x32_bf16 v[72:75], a[180:183], a[212:215], v[72:75]
    buffer_load_dwordx4 v214, s[8:11], s49 offen offset:2048  lds
    s_add_u32 s49, s49, 128
    v_mfma_f32_16x16x32_bf16 v[104:107], a[180:183], a[216:219], v[104:107]
    s_add_u32 m0, s35, s29
    ds_read_b64_tr_b16 a[126:127], v216 offset:1288
    v_mfma_f32_16x16x32_bf16 v[136:139], a[180:183], a[220:223], v[136:139]
    ds_read_b64_tr_b16 a[128:129], v216 offset:512
    v_mfma_f32_16x16x32_bf16 v[168:171], a[180:183], a[224:227], v[168:171]
    ds_read_b64_tr_b16 a[130:131], v216 offset:1536
    v_mfma_f32_16x16x32_bf16 v[12:15], a[184:187], a[204:207], v[12:15]
    ds_read_b64_tr_b16 a[132:133], v216 offset:520
    v_mfma_f32_16x16x32_bf16 v[44:47], a[184:187], a[208:211], v[44:47]
    ds_read_b64_tr_b16 a[134:135], v216 offset:1544
    v_mfma_f32_16x16x32_bf16 v[76:79], a[184:187], a[212:215], v[76:79]
    ds_read_b64_tr_b16 a[136:137], v216 offset:768
    v_mfma_f32_16x16x32_bf16 v[108:111], a[184:187], a[216:219], v[108:111]
    buffer_load_dwordx4 v208, s[12:15], s31 offen offset:0 nt lds
    ds_read_b64_tr_b16 a[138:139], v216 offset:1792
    v_mfma_f32_16x16x32_bf16 v[140:143], a[184:187], a[220:223], v[140:143]
    ds_read_b64_tr_b16 a[140:141], v216 offset:776
    v_mfma_f32_16x16x32_bf16 v[172:175], a[184:187], a[224:227], v[172:175]
    ds_read_b64_tr_b16 a[142:143], v216 offset:1800
    v_mfma_f32_16x16x32_bf16 v[16:19], a[188:191], a[204:207], v[16:19]
    s_add_u32 s39, s39, 32768
    v_mfma_f32_16x16x32_bf16 v[48:51], a[188:191], a[208:211], v[48:51]
    s_cmp_eq_u32 s39, 163840
    s_cselect_b32 s39, 0, s39
    v_mfma_f32_16x16x32_bf16 v[80:83], a[188:191], a[212:215], v[80:83]
    v_add_u32 v216, s39, v219
    v_mfma_f32_16x16x32_bf16 v[112:115], a[188:191], a[216:219], v[112:115]
    v_mfma_f32_16x16x32_bf16 v[144:147], a[188:191], a[220:223], v[144:147]
    buffer_load_dwordx4 v209, s[12:15], s31 offen offset:1024 nt lds
    v_mfma_f32_16x16x32_bf16 v[176:179], a[188:191], a[224:227], v[176:179]
    v_mfma_f32_16x16x32_bf16 v[192:195], a[188:191], a[228:231], v[192:195]
    v_mfma_f32_16x16x32_bf16 v[20:23], a[192:195], a[204:207], v[20:23]
    v_mfma_f32_16x16x32_bf16 v[52:55], a[192:195], a[208:211], v[52:55]
    v_mfma_f32_16x16x32_bf16 v[84:87], a[192:195], a[212:215], v[84:87]
    v_mfma_f32_16x16x32_bf16 v[116:119], a[192:195], a[216:219], v[116:119]
    v_mfma_f32_16x16x32_bf16 v[148:151], a[192:195], a[220:223], v[148:151]
    buffer_load_dwordx4 v210, s[12:15], s31 offen offset:2048 nt lds
    v_mfma_f32_16x16x32_bf16 v[180:183], a[192:195], a[224:227], v[180:183]
    v_mfma_f32_16x16x32_bf16 v[196:199], a[192:195], a[228:231], v[196:199]
    v_mfma_f32_16x16x32_bf16 v[24:27], a[196:199], a[204:207], v[24:27]
    v_mfma_f32_16x16x32_bf16 v[56:59], a[196:199], a[208:211], v[56:59]
    v_mfma_f32_16x16x32_bf16 v[88:91], a[196:199], a[212:215], v[88:91]
    v_mfma_f32_16x16x32_bf16 v[120:123], a[196:199], a[216:219], v[120:123]
    v_mfma_f32_16x16x32_bf16 v[152:155], a[196:199], a[220:223], v[152:155]
    buffer_load_dwordx4 v211, s[12:15], s31 offen offset:3072 nt lds
    s_add_u32 s31, s31, 262144
    v_mfma_f32_16x16x32_bf16 v[184:187], a[196:199], a[224:227], v[184:187]
    s_mov_b32 s51, s29
    s_add_u32 s29, s29, 32768
    v_mfma_f32_16x16x32_bf16 v[200:203], a[196:199], a[228:231], v[200:203]
    s_cmp_eq_u32 s29, 163840
    s_cselect_b32 s29, 0, s29
    v_mfma_f32_16x16x32_bf16 v[28:31], a[200:203], a[204:207], v[28:31]
    v_mfma_f32_16x16x32_bf16 v[60:63], a[200:203], a[208:211], v[60:63]
    v_mfma_f32_16x16x32_bf16 v[92:95], a[200:203], a[212:215], v[92:95]
    v_mfma_f32_16x16x32_bf16 v[124:127], a[200:203], a[216:219], v[124:127]
    v_mfma_f32_16x16x32_bf16 v[156:159], a[200:203], a[220:223], v[156:159]
    v_mfma_f32_16x16x32_bf16 v[188:191], a[200:203], a[224:227], v[188:191]
    v_mfma_f32_16x16x32_bf16 v[204:207], a[200:203], a[228:231], v[204:207]
    s_sub_u32 s28, s28, 1
    s_cmp_lg_u32 s28, 0
    s_cbranch_scc1 L1_q1
    s_waitcnt vmcnt(18) lgkmcnt(0)
    s_barrier
    v_mfma_f32_16x16x32_bf16 v[0:3], a[112:115], a[144:147], v[0:3]
    s_add_u32 m0, s36, s51
    ds_read_b64_tr_b16 a[172:173], v216 offset:0
    v_mfma_f32_16x16x32_bf16 v[32:35], a[112:115], a[148:151], v[32:35]
    buffer_load_dwordx4 v212, s[8:11], s30 offen offset:0  lds
    ds_read_b64_tr_b16 a[174:175], v216 offset:1024
    v_mfma_f32_16x16x32_bf16 v[64:67], a[112:115], a[152:155], v[64:67]
    ds_read_b128 a[204:207], v217 offset:12800
    v_mfma_f32_16x16x32_bf16 v[96:99], a[112:115], a[156:159], v[96:99]
    ds_read_b128 a[208:211], v218 offset:512
    v_mfma_f32_16x16x32_bf16 v[128:131], a[112:115], a[160:163], v[128:131]
    ds_read_b128 a[212:215], v218 offset:2560
    v_mfma_f32_16x16x32_bf16 v[160:163], a[112:115], a[164:167], v[160:163]
    ds_read_b128 a[216:219], v218 offset:4608
    v_mfma_f32_16x16x32_bf16 v[4:7], a[116:119], a[144:147], v[4:7]
    ds_read_b128 a[220:223], v218 offset:6656
    v_mfma_f32_16x16x32_bf16 v[36:39], a[116:119], a[148:151], v[36:39]
    buffer_load_dwordx4 v213, s[8:11], s30 offen offset:1024  lds
    ds_read_b128 a[224:227], v218 offset:8704
    v_mfma_f32_16x16x32_bf16 v[68:71], a[116:119], a[152:155], v[68:71]
    ds_read_b128 a[228:231], v218 offset:10752
    v_mfma_f32_16x16x32_bf16 v[100:103], a[116:119], a[156:159], v[100:103]
    ds_read_b64_tr_b16 a[176:177], v216 offset:8
    v_mfma_f32_16x16x32_bf16 v[132:135], a[116:119], a[160:163], v[132:135]
    ds_read_b64_tr_b16 a[178:179], v216 offset:1032
    v_mfma_f32_16x16x32_bf16 v[164:167], a[116:119], a[164:167], v[164:167]
    ds_read_b64_tr_b16 a[180:181], v216 offset:256
    v_mfma_f32_16x16x32_bf16 v[8:11], a[120:123], a[144:147], v[8:11]
    ds_read_b64_tr_b16 a[182:183], v216 offset:1280
    v_mfma_f32_16x16x32_bf16 v[40:43], a[120:123], a[148:151], v[40:43]
    buffer_load_dwordx4 v214, s[8:11], s30 offen offset:2048  lds
    s_add_u32 s30, s30, 128
    v_mfma_f32_16x16x32_bf16 v[72:75], a[120:123], a[152:155], v[72:75]
    s_add_u32 m0, s35, s29
    ds_read_b64_tr_b16 a[184:185], v216 offset:264
    v_mfma_f32_16x16x32_bf16 v[104:107], a[120:123], a[156:159], v[104:107]
    ds_read_b64_tr_b16 a[186:187], v216 offset:1288
    v_mfma_f32_16x16x32_bf16 v[136:139], a[120:123], a[160:163], v[136:139]
    ds_read_b64_tr_b16 a[188:189], v216 offset:512
    v_mfma_f32_16x16x32_bf16 v[168:171], a[120:123], a[164:167], v[168:171]
    ds_read_b64_tr_b16 a[190:191], v216 offset:1536
    v_mfma_f32_16x16x32_bf16 v[12:15], a[124:127], a[144:147], v[12:15]
    ds_read_b64_tr_b16 a[192:193], v216 offset:520
    v_mfma_f32_16x16x32_bf16 v[44:47], a[124:127], a[148:151], v[44:47]
    buffer_load_dwordx4 v208, s[12:15], s31 offen offset:0 nt lds
    ds_read_b64_tr_b16 a[194:195], v216 offset:1544
    v_mfma_f32_16x16x32_bf16 v[76:79], a[124:127], a[152:155], v[76:79]
    ds_read_b64_tr_b16 a[196:197], v216 offset:768
    v_mfma_f32_16x16x32_bf16 v[108:111], a[124:127], a[156:159], v[108:111]
    ds_read_b64_tr_b16 a[198:199], v216 offset:1792
    v_mfma_f32_16x16x32_bf16 v[140:143], a[124:127], a[160:163], v[140:143]
    ds_read_b64_tr_b16 a[200:201], v216 offset:776
    v_mfma_f32_16x16x32_bf16 v[172:175], a[124:127], a[164:167], v[172:175]
    ds_read_b64_tr_b16 a[202:203], v216 offset:1800
    v_mfma_f32_16x16x32_bf16 v[16:19], a[128:131], a[144:147], v[16:19]
    s_add_u32 s39, s39, 32768
    v_mfma_f32_16x16x32_bf16 v[48:51], a[128:131], a[148:151], v[48:51]
    buffer_load_dwordx4 v209, s[12:15], s31 offen offset:1024 nt lds
    v_mfma_f32_16x16x32_bf16 v[80:83], a[128:131], a[152:155], v[80:83]
    s_cmp_eq_u32 s39, 163840
    s_cselect_b32 s39, 0, s39
    v_mfma_f32_16x16x32_bf16 v[112:115], a[128:131], a[156:159], v[112:115]
    v_add_u32 v216, s39, v219
    v_add_u32 v217, s39, v220
    v_mfma_f32_16x16x32_bf16 v[144:147], a[128:131], a[160:163], v[144:147]
    s_add_u32 s40, s39, 32768
    v_mfma_f32_16x16x32_bf16 v[176:179], a[128:131], a[164:167], v[176:179]
    s_cmp_eq_u32 s40, 163840
    s_cselect_b32 s40, 0, s40
    v_mfma_f32_16x16x32_bf16 v[192:195], a[128:131], a[168:171], v[192:195]
    v_add_u32 v218, s40, v220
    v_mfma_f32_16x16x32_bf16 v[20:23], a[132:135], a[144:147], v[20:23]
    buffer_load_dwordx4 v210, s[12:15], s31 offen offset:2048 nt lds
    v_mfma_f32_16x16x32_bf16 v[52:55], a[132:135], a[148:151], v[52:55]
    v_mfma_f32_16x16x32_bf16 v[84:87], a[132:135], a[152:155], v[84:87]
    v_mfma_f32_16x16x32_bf16 v[116:119], a[132:135], a[156:159], v[116:119]
    v_mfma_f32_16x16x32_bf16 v[148:151], a[132:135], a[160:163], v[148:151]
    v_mfma_f32_16x16x32_bf16 v[180:183], a[132:135], a[164:167], v[180:183]
    v_mfma_f32_16x16x32_bf16 v[196:199], a[132:135], a[168:171], v[196:199]
    buffer_load_dwordx4 v211, s[12:15], s31 offen offset:3072 nt lds
    s_add_u32 s31, s31, 262144
    v_mfma_f32_16x16x32_bf16 v[24:27], a[136:139], a[144:147], v[24:27]
    v_mfma_f32_16x16x32_bf16 v[56:59], a[136:139], a[148:151], v[56:59]
    v_mfma_f32_16x16x32_bf16 v[88:91], a[136:139], a[152:155], v[88:91]
    v_mfma_f32_16x16x32_bf16 v[120:123], a[136:139], a[156:159], v[120:123]
    v_mfma_f32_16x16x32_bf16 v[152:155], a[136:139], a[160:163], v[152:155]
    v_mfma_f32_16x16x32_bf16 v[184:187], a[136:139], a[164:167], v[184:187]
    global_load_dword v255, v[226:227], off
    s_mov_b32 s51, s29
    v_mfma_f32_16x16x32_bf16 v[200:203], a[136:139], a[168:171], v[200:203]
    s_add_u32 s29, s29, 32768
    v_mfma_f32_16x16x32_bf16 v[28:31], a[140:143], a[144:147], v[28:31]
    s_cmp_eq_u32 s29, 163840
    s_cselect_b32 s29, 0, s29
    v_mfma_f32_16x16x32_bf16 v[60:63], a[140:143], a[148:151], v[60:63]
    v_mfma_f32_16x16x32_bf16 v[92:95], a[140:143], a[152:155], v[92:95]
    v_mfma_f32_16x16x32_bf16 v[124:127], a[140:143], a[156:159], v[124:127]
    v_mfma_f32_16x16x32_bf16 v[156:159], a[140:143], a[160:163], v[156:159]
    v_mfma_f32_16x16x32_bf16 v[188:191], a[140:143], a[164:167], v[188:191]
    v_mfma_f32_16x16x32_bf16 v[204:207], a[140:143], a[168:171], v[204:207]
    s_waitcnt vmcnt(12) lgkmcnt(0)
    s_barrier
    v_mfma_f32_16x16x32_bf16 v[0:3], a[172:175], a[204:207], v[0:3]
    s_add_u32 m0, s50, s51
    ds_read_b64_tr_b16 a[112:113], v216 offset:0
    v_mfma_f32_16x16x32_bf16 v[32:35], a[172:175], a[208:211], v[32:35]
    buffer_load_dwordx4 v212, s[8:11], s49 offen offset:0  lds
    ds_read_b64_tr_b16 a[114:115], v216 offset:1024
    v_mfma_f32_16x16x32_bf16 v[64:67], a[172:175], a[212:215], v[64:67]
    ds_read_b128 a[144:147], v217 offset:12288
    v_mfma_f32_16x16x32_bf16 v[96:99], a[172:175], a[216:219], v[96:99]
    ds_read_b128 a[148:151], v218 offset:0
    v_mfma_f32_16x16x32_bf16 v[128:131], a[172:175], a[220:223], v[128:131]
    ds_read_b128 a[152:155], v218 offset:2048
    v_mfma_f32_16x16x32_bf16 v[160:163], a[172:175], a[224:227], v[160:163]
    ds_read_b128 a[156:159], v218 offset:4096
    v_mfma_f32_16x16x32_bf16 v[4:7], a[176:179], a[204:207], v[4:7]
    ds_read_b128 a[160:163], v218 offset:6144
    v_mfma_f32_16x16x32_bf16 v[36:39], a[176:179], a[208:211], v[36:39]
    ds_read_b128 a[164:167], v218 offset:8192
    v_mfma_f32_16x16x32_bf16 v[68:71], a[176:179], a[212:215], v[68:71]
    ds_read_b128 a[168:171], v218 offset:10240
    v_mfma_f32_16x16x32_bf16 v[100:103], a[176:179], a[216:219], v[100:103]
    ds_read_b64_tr_b16 a[116:117], v216 offset:8
    v_mfma_f32_16x16x32_bf16 v[132:135], a[176:179], a[220:223], v[132:135]
    ds_read_b64_tr_b16 a[118:119], v216 offset:1032
    v_mfma_f32_16x16x32_bf16 v[164:167], a[176:179], a[224:227], v[164:167]
    ds_read_b64_tr_b16 a[120:121], v216 offset:256
    v_mfma_f32_16x16x32_bf16 v[8:11], a[180:183], a[204:207], v[8:11]
    ds_read_b64_tr_b16 a[122:123], v216 offset:1280
    v_mfma_f32_16x16x32_bf16 v[40:43], a[180:183], a[208:211], v[40:43]
    ds_read_b64_tr_b16 a[124:125], v216 offset:264
    v_mfma_f32_16x16x32_bf16 v[72:75], a[180:183], a[212:215], v[72:75]
    ds_read_b64_tr_b16 a[126:127], v216 offset:1288
    v_mfma_f32_16x16x32_bf16 v[104:107], a[180:183], a[216:219], v[104:107]
    ds_read_b64_tr_b16 a[128:129], v216 offset:512
    v_mfma_f32_16x16x32_bf16 v[136:139], a[180:183], a[220:223], v[136:139]
    ds_read_b64_tr_b16 a[130:131], v216 offset:1536
    v_mfma_f32_16x16x32_bf16 v[168:171], a[180:183], a[224:227], v[168:171]
    buffer_load_dwordx4 v213, s[8:11], s49 offen offset:1024  lds
    ds_read_b64_tr_b16 a[132:133], v216 offset:520
    v_mfma_f32_16x16x32_bf16 v[12:15], a[184:187], a[204:207], v[12:15]
    ds_read_b64_tr_b16 a[134:135], v216 offset:1544
    v_mfma_f32_16x16x32_bf16 v[44:47], a[184:187], a[208:211], v[44:47]
    ds_read_b64_tr_b16 a[136:137], v216 offset:768
    v_mfma_f32_16x16x32_bf16 v[76:79], a[184:187], a[212:215], v[76:79]
    ds_read_b64_tr_b16 a[138:139], v216 offset:1792
    v_mfma_f32_16x16x32_bf16 v[108:111], a[184:187], a[216:219], v[108:111]
    ds_read_b64_tr_b16 a[140:141], v216 offset:776
    v_mfma_f32_16x16x32_bf16 v[140:143], a[184:187], a[220:223], v[140:143]
    ds_read_b64_tr_b16 a[142:143], v216 offset:1800
    v_mfma_f32_16x16x32_bf16 v[172:175], a[184:187], a[224:227], v[172:175]
    s_add_u32 s39, s39, 32768
    v_mfma_f32_16x16x32_bf16 v[16:19], a[188:191], a[204:207], v[16:19]
    s_cmp_eq_u32 s39, 163840
    s_cselect_b32 s39, 0, s39
    v_mfma_f32_16x16x32_bf16 v[48:51], a[188:191], a[208:211], v[48:51]
    v_add_u32 v216, s39, v219
    v_mfma_f32_16x16x32_bf16 v[80:83], a[188:191], a[212:215], v[80:83]
    v_mfma_f32_16x16x32_bf16 v[112:115], a[188:191], a[216:219], v[112:115]
    v_mfma_f32_16x16x32_bf16 v[144:147], a[188:191], a[220:223], v[144:147]
    v_mfma_f32_16x16x32_bf16 v[176:179], a[188:191], a[224:227], v[176:179]
    v_mfma_f32_16x16x32_bf16 v[192:195], a[188:191], a[228:231], v[192:195]
    v_mfma_f32_16x16x32_bf16 v[20:23], a[192:195], a[204:207], v[20:23]
    v_mfma_f32_16x16x32_bf16 v[52:55], a[192:195], a[208:211], v[52:55]
    v_mfma_f32_16x16x32_bf16 v[84:87], a[192:195], a[212:215], v[84:87]
    buffer_load_dwordx4 v214, s[8:11], s49 offen offset:2048  lds
    s_add_u32 s49, s49, 128
    v_mfma_f32_16x16x32_bf16 v[116:119], a[192:195], a[216:219], v[116:119]
    s_mov_b32 s51, s29
    s_add_u32 s29, s29, 32768
    v_mfma_f32_16x16x32_bf16 v[148:151], a[192:195], a[220:223], v[148:151]
    s_cmp_eq_u32 s29, 163840
    s_cselect_b32 s29, 0, s29
    v_mfma_f32_16x16x32_bf16 v[180:183], a[192:195], a[224:227], v[180:183]
    v_mfma_f32_16x16x32_bf16 v[196:199], a[192:195], a[228:231], v[196:199]
    v_mfma_f32_16x16x32_bf16 v[24:27], a[196:199], a[204:207], v[24:27]
    v_mfma_f32_16x16x32_bf16 v[56:59], a[196:199], a[208:211], v[56:59]
    v_mfma_f32_16x16x32_bf16 v[88:91], a[196:199], a[212:215], v[88:91]
    v_mfma_f32_16x16x32_bf16 v[120:123], a[196:199], a[216:219], v[120:123]
    v_mfma_f32_16x16x32_bf16 v[152:155], a[196:199], a[220:223], v[152:155]
    v_mfma_f32_16x16x32_bf16 v[184:187], a[196:199], a[224:227], v[184:187]
    v_mfma_f32_16x16x32_bf16 v[200:203], a[196:199], a[228:231], v[200:203]
    v_mfma_f32_16x16x32_bf16 v[28:31], a[200:203], a[204:207], v[28:31]
    v_mfma_f32_16x16x32_bf16 v[60:63], a[200:203], a[208:211], v[60:63]
    v_mfma_f32_16x16x32_bf16 v[92:95], a[200:203], a[212:215], v[92:95]
    v_mfma_f32_16x16x32_bf16 v[124:127], a[200:203], a[216:219], v[124:127]
    v_mfma_f32_16x16x32_bf16 v[156:159], a[200:203], a[220:223], v[156:159]
    v_mfma_f32_16x16x32_bf16 v[188:191], a[200:203], a[224:227], v[188:191]
    v_mfma_f32_16x16x32_bf16 v[204:207], a[200:203], a[228:231], v[204:207]
    s_waitcnt vmcnt(15) lgkmcnt(0)
    s_barrier
    v_mfma_f32_16x16x32_bf16 v[0:3], a[112:115], a[144:147], v[0:3]
    s_add_u32 m0, s37, 65536
    ds_read_b64_tr_b16 a[172:173], v216 offset:0
    v_mfma_f32_16x16x32_bf16 v[32:35], a[112:115], a[148:151], v[32:35]
    buffer_load_dwordx4 v248, s[16:19], s32 offen offset:0 nt lds
    ds_read_b64_tr_b16 a[174:175], v216 offset:1024
    v_mfma_f32_16x16x32_bf16 v[64:67], a[112:115], a[152:155], v[64:67]
    ds_read_b128 a[204:207], v217 offset:12800
    v_mfma_f32_16x16x32_bf16 v[96:99], a[112:115], a[156:159], v[96:99]
    ds_read_b128 a[208:211], v218 offset:512
    v_mfma_f32_16x16x32_bf16 v[128:131], a[112:115], a[160:163], v[128:131]
    ds_read_b128 a[212:215], v218 offset:2560
    v_mfma_f32_16x16x32_bf16 v[160:163], a[112:115], a[164:167], v[160:163]
    ds_read_b128 a[216:219], v218 offset:4608
    v_mfma_f32_16x16x32_bf16 v[4:7], a[116:119], a[144:147], v[4:7]
    ds_read_b128 a[220:223], v218 offset:6656
    v_mfma_f32_16x16x32_bf16 v[36:39], a[116:119], a[148:151], v[36:39]
    buffer_load_dwordx4 v249, s[16:19], s32 offen offset:1024 nt lds
    ds_read_b128 a[224:227], v218 offset:8704
    v_mfma_f32_16x16x32_bf16 v[68:71], a[116:119], a[152:155], v[68:71]
    ds_read_b128 a[228:231], v218 offset:10752
    v_mfma_f32_16x16x32_bf16 v[100:103], a[116:119], a[156:159], v[100:103]
    ds_read_b64_tr_b16 a[176:177], v216 offset:8
    v_mfma_f32_16x16x32_bf16 v[132:135], a[116:119], a[160:163], v[132:135]
    ds_read_b64_tr_b16 a[178:179], v216 offset:1032
    v_mfma_f32_16x16x32_bf16 v[164:167], a[116:119], a[164:167], v[164:167]
    ds_read_b64_tr_b16 a[180:181], v216 offset:256
    v_mfma_f32_16x16x32_bf16 v[8:11], a[120:123], a[144:147], v[8:11]
    ds_read_b64_tr_b16 a[182:183], v216 offset:1280
    v_mfma_f32_16x16x32_bf16 v[40:43], a[120:123], a[148:151], v[40:43]
    buffer_load_dwordx4 v248, s[16:19], s32 offen offset:2048 nt lds
    ds_read_b64_tr_b16 a[184:185], v216 offset:264
    v_mfma_f32_16x16x32_bf16 v[72:75], a[120:123], a[152:155], v[72:75]
    ds_read_b64_tr_b16 a[186:187], v216 offset:1288
    v_mfma_f32_16x16x32_bf16 v[104:107], a[120:123], a[156:159], v[104:107]
    ds_read_b64_tr_b16 a[188:189], v216 offset:512
    v_mfma_f32_16x16x32_bf16 v[136:139], a[120:123], a[160:163], v[136:139]
    ds_read_b64_tr_b16 a[190:191], v216 offset:1536
    v_mfma_f32_16x16x32_bf16 v[168:171], a[120:123], a[164:167], v[168:171]
    ds_read_b64_tr_b16 a[192:193], v216 offset:520
    v_mfma_f32_16x16x32_bf16 v[12:15], a[124:127], a[144:147], v[12:15]
    ds_read_b64_tr_b16 a[194:195], v216 offset:1544
    v_mfma_f32_16x16x32_bf16 v[44:47], a[124:127], a[148:151], v[44:47]
    buffer_load_dwordx4 v249, s[16:19], s32 offen offset:3072 nt lds
    s_add_u32 m0, m0, 4096
    v_mfma_f32_16x16x32_bf16 v[76:79], a[124:127], a[152:155], v[76:79]
    ds_read_b64_tr_b16 a[196:197], v216 offset:768
    v_mfma_f32_16x16x32_bf16 v[108:111], a[124:127], a[156:159], v[108:111]
    ds_read_b64_tr_b16 a[198:199], v216 offset:1792
    v_mfma_f32_16x16x32_bf16 v[140:143], a[124:127], a[160:163], v[140:143]
    ds_read_b64_tr_b16 a[200:201], v216 offset:776
    v_mfma_f32_16x16x32_bf16 v[172:175], a[124:127], a[164:167], v[172:175]
    ds_read_b64_tr_b16 a[202:203], v216 offset:1800
    v_mfma_f32_16x16x32_bf16 v[16:19], a[128:131], a[144:147], v[16:19]
    s_add_u32 s39, s39, 32768
    v_mfma_f32_16x16x32_bf16 v[48:51], a[128:131], a[148:151], v[48:51]
    buffer_load_dwordx4 v248, s[16:19], s33 offen offset:0 nt lds
    v_mfma_f32_16x16x32_bf16 v[80:83], a[128:131], a[152:155], v[80:83]
    s_cmp_eq_u32 s39, 163840
    s_cselect_b32 s39, 0, s39
    v_mfma_f32_16x16x32_bf16 v[112:115], a[128:131], a[156:159], v[112:115]
    v_add_u32 v216, s39, v219
    v_add_u32 v217, s39, v220
    v_mfma_f32_16x16x32_bf16 v[144:147], a[128:131], a[160:163], v[144:147]
    s_add_u32 s40, s39, 32768
    v_mfma_f32_16x16x32_bf16 v[176:179], a[128:131], a[164:167], v[176:179]
    s_cmp_eq_u32 s40, 163840
    s_cselect_b32 s40, 0, s40
    v_mfma_f32_16x16x32_bf16 v[192:195], a[128:131], a[168:171], v[192:195]
    v_add_u32 v218, s40, v220
    v_mfma_f32_16x16x32_bf16 v[20:23], a[132:135], a[144:147], v[20:23]
    buffer_load_dwordx4 v249, s[16:19], s33 offen offset:1024 nt lds
    v_mfma_f32_16x16x32_bf16 v[52:55], a[132:135], a[148:151], v[52:55]
    v_mfma_f32_16x16x32_bf16 v[84:87], a[132:135], a[152:155], v[84:87]
    v_mfma_f32_16x16x32_bf16 v[116:119], a[132:135], a[156:159], v[116:119]
    v_mfma_f32_16x16x32_bf16 v[148:151], a[132:135], a[160:163], v[148:151]
    v_mfma_f32_16x16x32_bf16 v[180:183], a[132:135], a[164:167], v[180:183]
    v_mfma_f32_16x16x32_bf16 v[196:199], a[132:135], a[168:171], v[196:199]
    buffer_load_dwordx4 v248, s[16:19], s33 offen offset:2048 nt lds
    v_mfma_f32_16x16x32_bf16 v[24:27], a[136:139], a[144:147], v[24:27]
    v_mfma_f32_16x16x32_bf16 v[56:59], a[136:139], a[148:151], v[56:59]
    v_mfma_f32_16x16x32_bf16 v[88:91], a[136:139], a[152:155], v[88:91]
    v_mfma_f32_16x16x32_bf16 v[120:123], a[136:139], a[156:159], v[120:123]
    v_mfma_f32_16x16x32_bf16 v[152:155], a[136:139], a[160:163], v[152:155]
    v_mfma_f32_16x16x32_bf16 v[184:187], a[136:139], a[164:167], v[184:187]
    buffer_load_dwordx4 v249, s[16:19], s33 offen offset:3072 nt lds
    s_add_u32 s64, s64, 8192
    v_mfma_f32_16x16x32_bf16 v[200:203], a[136:139], a[168:171], v[200:203]
    s_xor_b32 s32, s64, s65
    s_or_b32 s33, s32, 4096
    v_mfma_f32_16x16x32_bf16 v[28:31], a[140:143], a[144:147], v[28:31]
    s_mov_b32 s51, s29
    s_add_u32 s29, s29, 32768
    v_mfma_f32_16x16x32_bf16 v[60:63], a[140:143], a[148:151], v[60:63]
    s_cmp_eq_u32 s29, 163840
    s_cselect_b32 s29, 0, s29
    v_mfma_f32_16x16x32_bf16 v[92:95], a[140:143], a[152:155], v[92:95]
    v_mfma_f32_16x16x32_bf16 v[124:127], a[140:143], a[156:159], v[124:127]
    v_mfma_f32_16x16x32_bf16 v[156:159], a[140:143], a[160:163], v[156:159]
    v_mfma_f32_16x16x32_bf16 v[188:191], a[140:143], a[164:167], v[188:191]
    v_mfma_f32_16x16x32_bf16 v[204:207], a[140:143], a[168:171], v[204:207]
    s_waitcnt vmcnt(8) lgkmcnt(0)
    s_barrier
    v_mfma_f32_16x16x32_bf16 v[0:3], a[172:175], a[204:207], v[0:3]
    ds_read_b64_tr_b16 a[112:113], v216 offset:0
    v_mfma_f32_16x16x32_bf16 v[32:35], a[172:175], a[208:211], v[32:35]
    ds_read_b64_tr_b16 a[114:115], v216 offset:1024
    v_mfma_f32_16x16x32_bf16 v[64:67], a[172:175], a[212:215], v[64:67]
    ds_read_b128 a[144:147], v217 offset:12288
    v_mfma_f32_16x16x32_bf16 v[96:99], a[172:175], a[216:219], v[96:99]
    ds_read_b128 a[148:151], v218 offset:0
    v_mfma_f32_16x16x32_bf16 v[128:131], a[172:175], a[220:223], v[128:131]
    ds_read_b128 a[152:155], v218 offset:2048
    v_mfma_f32_16x16x32_bf16 v[160:163], a[172:175], a[224:227], v[160:163]
    ds_read_b128 a[156:159], v218 offset:4096
    v_mfma_f32_16x16x32_bf16 v[4:7], a[176:179], a[204:207], v[4:7]
    ds_read_b128 a[160:163], v218 offset:6144
    v_mfma_f32_16x16x32_bf16 v[36:39], a[176:179], a[208:211], v[36:39]
    ds_read_b128 a[164:167], v218 offset:8192
    v_mfma_f32_16x16x32_bf16 v[68:71], a[176:179], a[212:215], v[68:71]
    ds_read_b128 a[168:171], v218 offset:10240
    v_mfma_f32_16x16x32_bf16 v[100:103], a[176:179], a[216:219], v[100:103]
    ds_read_b64_tr_b16 a[116:117], v216 offset:8
    v_mfma_f32_16x16x32_bf16 v[132:135], a[176:179], a[220:223], v[132:135]
    ds_read_b64_tr_b16 a[118:119], v216 offset:1032
    v_mfma_f32_16x16x32_bf16 v[164:167], a[176:179], a[224:227], v[164:167]
    ds_read_b64_tr_b16 a[120:121], v216 offset:256
    v_mfma_f32_16x16x32_bf16 v[8:11], a[180:183], a[204:207], v[8:11]
    ds_read_b64_tr_b16 a[122:123], v216 offset:1280
    v_mfma_f32_16x16x32_bf16 v[40:43], a[180:183], a[208:211], v[40:43]
    ds_read_b64_tr_b16 a[124:125], v216 offset:264
    v_mfma_f32_16x16x32_bf16 v[72:75], a[180:183], a[212:215], v[72:75]
    ds_read_b64_tr_b16 a[126:127], v216 offset:1288
    v_mfma_f32_16x16x32_bf16 v[104:107], a[180:183], a[216:219], v[104:107]
    ds_read_b64_tr_b16 a[128:129], v216 offset:512
    v_mfma_f32_16x16x32_bf16 v[136:139], a[180:183], a[220:223], v[136:139]
    ds_read_b64_tr_b16 a[130:131], v216 offset:1536
    v_mfma_f32_16x16x32_bf16 v[168:171], a[180:183], a[224:227], v[168:171]
    ds_read_b64_tr_b16 a[132:133], v216 offset:520
    v_mfma_f32_16x16x32_bf16 v[12:15], a[184:187], a[204:207], v[12:15]
    ds_read_b64_tr_b16 a[134:135], v216 offset:1544
    v_mfma_f32_16x16x32_bf16 v[44:47], a[184:187], a[208:211], v[44:47]
    ds_read_b64_tr_b16 a[136:137], v216 offset:768
    v_mfma_f32_16x16x32_bf16 v[76:79], a[184:187], a[212:215], v[76:79]
    ds_read_b64_tr_b16 a[138:139], v216 offset:1792
    v_mfma_f32_16x16x32_bf16 v[108:111], a[184:187], a[216:219], v[108:111]
    ds_read_b64_tr_b16 a[140:141], v216 offset:776
    v_mfma_f32_16x16x32_bf16 v[140:143], a[184:187], a[220:223], v[140:143]
    ds_read_b64_tr_b16 a[142:143], v216 offset:1800
    v_mfma_f32_16x16x32_bf16 v[172:175], a[184:187], a[224:227], v[172:175]
    s_add_u32 s39, s39, 32768
    v_mfma_f32_16x16x32_bf16 v[16:19], a[188:191], a[204:207], v[16:19]
    s_cmp_eq_u32 s39, 163840
    s_cselect_b32 s39, 0, s39
    v_mfma_f32_16x16x32_bf16 v[48:51], a[188:191], a[208:211], v[48:51]
    v_add_u32 v216, s39, v219
    v_mfma_f32_16x16x32_bf16 v[80:83], a[188:191], a[212:215], v[80:83]
    v_mfma_f32_16x16x32_bf16 v[112:115], a[188:191], a[216:219], v[112:115]
    v_mfma_f32_16x16x32_bf16 v[144:147], a[188:191], a[220:223], v[144:147]
    v_mfma_f32_16x16x32_bf16 v[176:179], a[188:191], a[224:227], v[176:179]
    v_mfma_f32_16x16x32_bf16 v[192:195], a[188:191], a[228:231], v[192:195]
    v_mfma_f32_16x16x32_bf16 v[20:23], a[192:195], a[204:207], v[20:23]
    v_mfma_f32_16x16x32_bf16 v[52:55], a[192:195], a[208:211], v[52:55]
    v_mfma_f32_16x16x32_bf16 v[84:87], a[192:195], a[212:215], v[84:87]
    v_mfma_f32_16x16x32_bf16 v[116:119], a[192:195], a[216:219], v[116:119]
    v_mfma_f32_16x16x32_bf16 v[148:151], a[192:195], a[220:223], v[148:151]
    v_mfma_f32_16x16x32_bf16 v[180:183], a[192:195], a[224:227], v[180:183]
    v_mfma_f32_16x16x32_bf16 v[196:199], a[192:195], a[228:231], v[196:199]
    v_mfma_f32_16x16x32_bf16 v[24:27], a[196:199], a[204:207], v[24:27]
    v_mfma_f32_16x16x32_bf16 v[56:59], a[196:199], a[208:211], v[56:59]
    s_mov_b32 s51, s29
    s_add_u32 s29, s29, 32768
    v_mfma_f32_16x16x32_bf16 v[88:91], a[196:199], a[212:215], v[88:91]
    s_cmp_eq_u32 s29, 163840
    s_cselect_b32 s29, 0, s29
    v_mfma_f32_16x16x32_bf16 v[120:123], a[196:199], a[216:219], v[120:123]
    v_mfma_f32_16x16x32_bf16 v[152:155], a[196:199], a[220:223], v[152:155]
    v_mfma_f32_16x16x32_bf16 v[184:187], a[196:199], a[224:227], v[184:187]
    v_mfma_f32_16x16x32_bf16 v[200:203], a[196:199], a[228:231], v[200:203]
    v_mfma_f32_16x16x32_bf16 v[28:31], a[200:203], a[204:207], v[28:31]
    v_mfma_f32_16x16x32_bf16 v[60:63], a[200:203], a[208:211], v[60:63]
    v_mfma_f32_16x16x32_bf16 v[92:95], a[200:203], a[212:215], v[92:95]
    v_mfma_f32_16x16x32_bf16 v[124:127], a[200:203], a[216:219], v[124:127]
    v_mfma_f32_16x16x32_bf16 v[156:159], a[200:203], a[220:223], v[156:159]
    v_mfma_f32_16x16x32_bf16 v[188:191], a[200:203], a[224:227], v[188:191]
    v_mfma_f32_16x16x32_bf16 v[204:207], a[200:203], a[228:231], v[204:207]
    s_waitcnt vmcnt(8) lgkmcnt(0)
    s_barrier
    v_mfma_f32_16x16x32_bf16 v[0:3], a[112:115], a[144:147], v[0:3]
    s_add_u32 m0, s37, 98304
    ds_read_b64_tr_b16 a[172:173], v216 offset:0
    v_mfma_f32_16x16x32_bf16 v[32:35], a[112:115], a[148:151], v[32:35]
    buffer_load_dwordx4 v248, s[16:19], s32 offen offset:0 nt lds
    ds_read_b64_tr_b16 a[174:175], v216 offset:1024
    v_mfma_f32_16x16x32_bf16 v[64:67], a[112:115], a[152:155], v[64:67]
    ds_read_b128 a[204:207], v217 offset:12800
    v_mfma_f32_16x16x32_bf16 v[96:99], a[112:115], a[156:159], v[96:99]
    ds_read_b128 a[208:211], v218 offset:512
    v_mfma_f32_16x16x32_bf16 v[128:131], a[112:115], a[160:163], v[128:131]
    ds_read_b128 a[212:215], v218 offset:2560
    v_mfma_f32_16x16x32_bf16 v[160:163], a[112:115], a[164:167], v[160:163]
    ds_read_b128 a[216:219], v218 offset:4608
    v_mfma_f32_16x16x32_bf16 v[4:7], a[116:119], a[144:147], v[4:7]
    ds_read_b128 a[220:223], v218 offset:6656
    v_mfma_f32_16x16x32_bf16 v[36:39], a[116:119], a[148:151], v[36:39]
    buffer_load_dwordx4 v249, s[16:19], s32 offen offset:1024 nt lds
    ds_read_b128 a[224:227], v218 offset:8704
    v_mfma_f32_16x16x32_bf16 v[68:71], a[116:119], a[152:155], v[68:71]
    ds_read_b128 a[228:231], v218 offset:10752
    v_mfma_f32_16x16x32_bf16 v[100:103], a[116:119], a[156:159], v[100:103]
    ds_read_b64_tr_b16 a[176:177], v216 offset:8
    v_mfma_f32_16x16x32_bf16 v[132:135], a[116:119], a[160:163], v[132:135]
    ds_read_b64_tr_b16 a[178:179], v216 offset:1032
    v_mfma_f32_16x16x32_bf16 v[164:167], a[116:119], a[164:167], v[164:167]
    ds_read_b64_tr_b16 a[180:181], v216 offset:256
    v_mfma_f32_16x16x32_bf16 v[8:11], a[120:123], a[144:147], v[8:11]
    ds_read_b64_tr_b16 a[182:183], v216 offset:1280
    v_mfma_f32_16x16x32_bf16 v[40:43], a[120:123], a[148:151], v[40:43]
    buffer_load_dwordx4 v248, s[16:19], s32 offen offset:2048 nt lds
    ds_read_b64_tr_b16 a[184:185], v216 offset:264
    v_mfma_f32_16x16x32_bf16 v[72:75], a[120:123], a[152:155], v[72:75]
    ds_read_b64_tr_b16 a[186:187], v216 offset:1288
    v_mfma_f32_16x16x32_bf16 v[104:107], a[120:123], a[156:159], v[104:107]
    ds_read_b64_tr_b16 a[188:189], v216 offset:512
    v_mfma_f32_16x16x32_bf16 v[136:139], a[120:123], a[160:163], v[136:139]
    ds_read_b64_tr_b16 a[190:191], v216 offset:1536
    v_mfma_f32_16x16x32_bf16 v[168:171], a[120:123], a[164:167], v[168:171]
    ds_read_b64_tr_b16 a[192:193], v216 offset:520
    v_mfma_f32_16x16x32_bf16 v[12:15], a[124:127], a[144:147], v[12:15]
    ds_read_b64_tr_b16 a[194:195], v216 offset:1544
    v_mfma_f32_16x16x32_bf16 v[44:47], a[124:127], a[148:151], v[44:47]
    buffer_load_dwordx4 v249, s[16:19], s32 offen offset:3072 nt lds
    s_add_u32 m0, m0, 4096
    v_mfma_f32_16x16x32_bf16 v[76:79], a[124:127], a[152:155], v[76:79]
    ds_read_b64_tr_b16 a[196:197], v216 offset:768
    v_mfma_f32_16x16x32_bf16 v[108:111], a[124:127], a[156:159], v[108:111]
    ds_read_b64_tr_b16 a[198:199], v216 offset:1792
    v_mfma_f32_16x16x32_bf16 v[140:143], a[124:127], a[160:163], v[140:143]
    ds_read_b64_tr_b16 a[200:201], v216 offset:776
    v_mfma_f32_16x16x32_bf16 v[172:175], a[124:127], a[164:167], v[172:175]
    ds_read_b64_tr_b16 a[202:203], v216 offset:1800
    v_mfma_f32_16x16x32_bf16 v[16:19], a[128:131], a[144:147], v[16:19]
    s_add_u32 s39, s39, 32768
    v_mfma_f32_16x16x32_bf16 v[48:51], a[128:131], a[148:151], v[48:51]
    buffer_load_dwordx4 v248, s[16:19], s33 offen offset:0 nt lds
    v_mfma_f32_16x16x32_bf16 v[80:83], a[128:131], a[152:155], v[80:83]
    s_cmp_eq_u32 s39, 163840
    s_cselect_b32 s39, 0, s39
    v_mfma_f32_16x16x32_bf16 v[112:115], a[128:131], a[156:159], v[112:115]
    v_add_u32 v216, s39, v219
    v_add_u32 v217, s39, v220
    v_mfma_f32_16x16x32_bf16 v[144:147], a[128:131], a[160:163], v[144:147]
    s_add_u32 s40, s39, 32768
    v_mfma_f32_16x16x32_bf16 v[176:179], a[128:131], a[164:167], v[176:179]
    s_cmp_eq_u32 s40, 163840
    s_cselect_b32 s40, 0, s40
    v_mfma_f32_16x16x32_bf16 v[192:195], a[128:131], a[168:171], v[192:195]
    v_add_u32 v218, s40, v220
    v_mfma_f32_16x16x32_bf16 v[20:23], a[132:135], a[144:147], v[20:23]
    buffer_load_dwordx4 v249, s[16:19], s33 offen offset:1024 nt lds
    v_mfma_f32_16x16x32_bf16 v[52:55], a[132:135], a[148:151], v[52:55]
    v_mfma_f32_16x16x32_bf16 v[84:87], a[132:135], a[152:155], v[84:87]
    v_mfma_f32_16x16x32_bf16 v[116:119], a[132:135], a[156:159], v[116:119]
    v_mfma_f32_16x16x32_bf16 v[148:151], a[132:135], a[160:163], v[148:151]
    v_mfma_f32_16x16x32_bf16 v[180:183], a[132:135], a[164:167], v[180:183]
    v_mfma_f32_16x16x32_bf16 v[196:199], a[132:135], a[168:171], v[196:199]
    buffer_load_dwordx4 v248, s[16:19], s33 offen offset:2048 nt lds
    v_mfma_f32_16x16x32_bf16 v[24:27], a[136:139], a[144:147], v[24:27]
    v_mfma_f32_16x16x32_bf16 v[56:59], a[136:139], a[148:151], v[56:59]
    v_mfma_f32_16x16x32_bf16 v[88:91], a[136:139], a[152:155], v[88:91]
    v_mfma_f32_16x16x32_bf16 v[120:123], a[136:139], a[156:159], v[120:123]
    v_mfma_f32_16x16x32_bf16 v[152:155], a[136:139], a[160:163], v[152:155]
    v_mfma_f32_16x16x32_bf16 v[184:187], a[136:139], a[164:167], v[184:187]
    buffer_load_dwordx4 v249, s[16:19], s33 offen offset:3072 nt lds
    s_add_u32 s64, s64, 8192
    v_mfma_f32_16x16x32_bf16 v[200:203], a[136:139], a[168:171], v[200:203]
    s_xor_b32 s32, s64, s65
    s_or_b32 s33, s32, 4096
    v_mfma_f32_16x16x32_bf16 v[28:31], a[140:143], a[144:147], v[28:31]
    s_mov_b32 s51, s29
    s_add_u32 s29, s29, 32768
    v_mfma_f32_16x16x32_bf16 v[60:63], a[140:143], a[148:151], v[60:63]
    s_cmp_eq_u32 s29, 163840
    s_cselect_b32 s29, 0, s29
    v_mfma_f32_16x16x32_bf16 v[92:95], a[140:143], a[152:155], v[92:95]
    v_mfma_f32_16x16x32_bf16 v[124:127], a[140:143], a[156:159], v[124:127]
    v_mfma_f32_16x16x32_bf16 v[156:159], a[140:143], a[160:163], v[156:159]
    v_mfma_f32_16x16x32_bf16 v[188:191], a[140:143], a[164:167], v[188:191]
    v_mfma_f32_16x16x32_bf16 v[204:207], a[140:143], a[168:171], v[204:207]
    s_waitcnt vmcnt(63) lgkmcnt(0)
    s_barrier
    v_mfma_f32_16x16x32_bf16 v[0:3], a[172:175], a[204:207], v[0:3]
    v_mfma_f32_16x16x32_bf16 v[32:35], a[172:175], a[208:211], v[32:35]
    v_mfma_f32_16x16x32_bf16 v[64:67], a[172:175], a[212:215], v[64:67]
    v_mfma_f32_16x16x32_bf16 v[96:99], a[172:175], a[216:219], v[96:99]
    v_mfma_f32_16x16x32_bf16 v[128:131], a[172:175], a[220:223], v[128:131]
    v_mfma_f32_16x16x32_bf16 v[160:163], a[172:175], a[224:227], v[160:163]
    v_mfma_f32_16x16x32_bf16 v[4:7], a[176:179], a[204:207], v[4:7]
    v_mfma_f32_16x16x32_bf16 v[36:39], a[176:179], a[208:211], v[36:39]
    v_mfma_f32_16x16x32_bf16 v[68:71], a[176:179], a[212:215], v[68:71]
    v_mfma_f32_16x16x32_bf16 v[100:103], a[176:179], a[216:219], v[100:103]
    v_mfma_f32_16x16x32_bf16 v[132:135], a[176:179], a[220:223], v[132:135]
    v_mfma_f32_16x16x32_bf16 v[164:167], a[176:179], a[224:227], v[164:167]
    v_mfma_f32_16x16x32_bf16 v[8:11], a[180:183], a[204:207], v[8:11]
    v_mfma_f32_16x16x32_bf16 v[40:43], a[180:183], a[208:211], v[40:43]
    v_mfma_f32_16x16x32_bf16 v[72:75], a[180:183], a[212:215], v[72:75]
    v_mfma_f32_16x16x32_bf16 v[104:107], a[180:183], a[216:219], v[104:107]
    v_mfma_f32_16x16x32_bf16 v[136:139], a[180:183], a[220:223], v[136:139]
    v_mfma_f32_16x16x32_bf16 v[168:171], a[180:183], a[224:227], v[168:171]
    v_mfma_f32_16x16x32_bf16 v[12:15], a[184:187], a[204:207], v[12:15]
    v_mfma_f32_16x16x32_bf16 v[44:47], a[184:187], a[208:211], v[44:47]
    v_mfma_f32_16x16x32_bf16 v[76:79], a[184:187], a[212:215], v[76:79]
    v_mfma_f32_16x16x32_bf16 v[108:111], a[184:187], a[216:219], v[108:111]
    v_mfma_f32_16x16x32_bf16 v[140:143], a[184:187], a[220:223], v[140:143]
    v_mfma_f32_16x16x32_bf16 v[172:175], a[184:187], a[224:227], v[172:175]
    v_mfma_f32_16x16x32_bf16 v[16:19], a[188:191], a[204:207], v[16:19]
    v_mfma_f32_16x16x32_bf16 v[48:51], a[188:191], a[208:211], v[48:51]
    v_mfma_f32_16x16x32_bf16 v[80:83], a[188:191], a[212:215], v[80:83]
    v_mfma_f32_16x16x32_bf16 v[112:115], a[188:191], a[216:219], v[112:115]
    v_mfma_f32_16x16x32_bf16 v[144:147], a[188:191], a[220:223], v[144:147]
    v_mfma_f32_16x16x32_bf16 v[176:179], a[188:191], a[224:227], v[176:179]
    v_mfma_f32_16x16x32_bf16 v[192:195], a[188:191], a[228:231], v[192:195]
    v_mfma_f32_16x16x32_bf16 v[20:23], a[192:195], a[204:207], v[20:23]
    v_mfma_f32_16x16x32_bf16 v[52:55], a[192:195], a[208:211], v[52:55]
    v_mfma_f32_16x16x32_bf16 v[84:87], a[192:195], a[212:215], v[84:87]
    v_mfma_f32_16x16x32_bf16 v[116:119], a[192:195], a[216:219], v[116:119]
    v_mfma_f32_16x16x32_bf16 v[148:151], a[192:195], a[220:223], v[148:151]
    v_mfma_f32_16x16x32_bf16 v[180:183], a[192:195], a[224:227], v[180:183]
    v_mfma_f32_16x16x32_bf16 v[196:199], a[192:195], a[228:231], v[196:199]
    v_mfma_f32_16x16x32_bf16 v[24:27], a[196:199], a[204:207], v[24:27]
    v_mfma_f32_16x16x32_bf16 v[56:59], a[196:199], a[208:211], v[56:59]
    s_mov_b32 s51, s29
    s_add_u32 s29, s29, 32768
    v_mfma_f32_16x16x32_bf16 v[88:91], a[196:199], a[212:215], v[88:91]
    s_cmp_eq_u32 s29, 163840
    s_cselect_b32 s29, 0, s29
    v_mfma_f32_16x16x32_bf16 v[120:123], a[196:199], a[216:219], v[120:123]
    v_mfma_f32_16x16x32_bf16 v[152:155], a[196:199], a[220:223], v[152:155]
    v_mfma_f32_16x16x32_bf16 v[184:187], a[196:199], a[224:227], v[184:187]
    v_mfma_f32_16x16x32_bf16 v[200:203], a[196:199], a[228:231], v[200:203]
    v_mfma_f32_16x16x32_bf16 v[28:31], a[200:203], a[204:207], v[28:31]
    v_mfma_f32_16x16x32_bf16 v[60:63], a[200:203], a[208:211], v[60:63]
    v_mfma_f32_16x16x32_bf16 v[92:95], a[200:203], a[212:215], v[92:95]
    v_mfma_f32_16x16x32_bf16 v[124:127], a[200:203], a[216:219], v[124:127]
    v_mfma_f32_16x16x32_bf16 v[156:159], a[200:203], a[220:223], v[156:159]
    v_mfma_f32_16x16x32_bf16 v[188:191], a[200:203], a[224:227], v[188:191]
    v_mfma_f32_16x16x32_bf16 v[204:207], a[200:203], a[228:231], v[204:207]
    s_mov_b32 s40, 0x3e0293ee
    s_mov_b32 s41, 0x3e0293ee
    v_mov_b32 v230, 0
    s_mov_b64 exec, 1
    buffer_load_dword v253, v230, s[72:75], s95 offen sc1 nt
    s_mov_b64 exec, -1
    v_subrev_u32 v252, 40960, v221
    v_pk_mul_f32 v[192:193], v[192:193], s[40:41]
    v_pk_mul_f32 v[194:195], v[194:195], s[40:41]
    v_pk_mul_f32 v[196:197], v[196:197], s[40:41]
    v_pk_mul_f32 v[198:199], v[198:199], s[40:41]
    v_cvt_pk_bf16_f32 v192, v192, v193
    v_cvt_pk_bf16_f32 v193, v194, v195
    v_cvt_pk_bf16_f32 v194, v196, v197
    v_cvt_pk_bf16_f32 v195, v198, v199
    ds_write_b128 v252, v[192:195] offset:0
    v_pk_mul_f32 v[200:201], v[200:201], s[40:41]
    v_pk_mul_f32 v[202:203], v[202:203], s[40:41]
    v_pk_mul_f32 v[204:205], v[204:205], s[40:41]
    v_pk_mul_f32 v[206:207], v[206:207], s[40:41]
    v_cvt_pk_bf16_f32 v200, v200, v201
    v_cvt_pk_bf16_f32 v201, v202, v203
    v_cvt_pk_bf16_f32 v202, v204, v205
    v_cvt_pk_bf16_f32 v203, v206, v207
    ds_write_b128 v252, v[200:203] offset:1024
    s_waitcnt vmcnt(9) lgkmcnt(0)
    s_barrier
    v_pk_mul_f32 v[0:1], v[0:1], s[40:41]
    v_pk_mul_f32 v[2:3], v[2:3], s[40:41]
    v_pk_mul_f32 v[4:5], v[4:5], s[40:41]
    v_pk_mul_f32 v[6:7], v[6:7], s[40:41]
    ds_read_b128 a[112:115], v244 offset:0
    ds_read_b128 a[116:119], v244 offset:256
    ds_read_b128 a[120:123], v244 offset:512
    ds_read_b128 a[124:127], v244 offset:768
    ds_read_b128 a[128:131], v244 offset:4096
    ds_read_b128 a[132:135], v244 offset:4352
    ds_read_b128 a[136:139], v244 offset:4608
    ds_read_b128 a[140:143], v244 offset:4864
    ds_read_b64_tr_b16 a[144:145], v245 offset:0
    ds_read_b64_tr_b16 a[146:147], v245 offset:4096
    v_cvt_pk_bf16_f32 v0, v0, v1
    v_cvt_pk_bf16_f32 v1, v2, v3
    v_cvt_pk_bf16_f32 v2, v4, v5
    v_cvt_pk_bf16_f32 v3, v6, v7
    v_accvgpr_write_b32 a0, v0
    v_accvgpr_write_b32 a1, v1
    v_accvgpr_write_b32 a2, v2
    v_accvgpr_write_b32 a3, v3
    v_pk_mul_f32 v[8:9], v[8:9], s[40:41]
    v_pk_mul_f32 v[10:11], v[10:11], s[40:41]
    v_pk_mul_f32 v[12:13], v[12:13], s[40:41]
    v_pk_mul_f32 v[14:15], v[14:15], s[40:41]
    ds_read_b64_tr_b16 a[148:149], v246 offset:0
    ds_read_b64_tr_b16 a[150:151], v246 offset:4096
    ds_read_b64_tr_b16 a[152:153], v245 offset:256
    v_cvt_pk_bf16_f32 v8, v8, v9
    v_cvt_pk_bf16_f32 v9, v10, v11
    v_cvt_pk_bf16_f32 v10, v12, v13
    v_cvt_pk_bf16_f32 v11, v14, v15
    v_accvgpr_write_b32 a4, v8
    v_accvgpr_write_b32 a5, v9
    v_accvgpr_write_b32 a6, v10
    v_accvgpr_write_b32 a7, v11
    v_pk_mul_f32 v[16:17], v[16:17], s[40:41]
    v_pk_mul_f32 v[18:19], v[18:19], s[40:41]
    v_pk_mul_f32 v[20:21], v[20:21], s[40:41]
    v_pk_mul_f32 v[22:23], v[22:23], s[40:41]
    ds_read_b64_tr_b16 a[154:155], v245 offset:4352
    ds_read_b64_tr_b16 a[156:157], v246 offset:256
    ds_read_b64_tr_b16 a[158:159], v246 offset:4352
    v_cvt_pk_bf16_f32 v16, v16, v17
    v_cvt_pk_bf16_f32 v17, v18, v19
    v_cvt_pk_bf16_f32 v18, v20, v21
    v_cvt_pk_bf16_f32 v19, v22, v23
    v_accvgpr_write_b32 a8, v16
    v_accvgpr_write_b32 a9, v17
    v_accvgpr_write_b32 a10, v18
    v_accvgpr_write_b32 a11, v19
    v_pk_mul_f32 v[24:25], v[24:25], s[40:41]
    v_pk_mul_f32 v[26:27], v[26:27], s[40:41]
    v_pk_mul_f32 v[28:29], v[28:29], s[40:41]
    v_pk_mul_f32 v[30:31], v[30:31], s[40:41]
    ds_read_b64_tr_b16 a[160:161], v245 offset:512
    ds_read_b64_tr_b16 a[162:163], v245 offset:4608
    ds_read_b64_tr_b16 a[164:165], v246 offset:512
    v_cvt_pk_bf16_f32 v24, v24, v25
    v_cvt_pk_bf16_f32 v25, v26, v27
    v_cvt_pk_bf16_f32 v26, v28, v29
    v_cvt_pk_bf16_f32 v27, v30, v31
    v_accvgpr_write_b32 a12, v24
    v_accvgpr_write_b32 a13, v25
    v_accvgpr_write_b32 a14, v26
    v_accvgpr_write_b32 a15, v27
    v_pk_mul_f32 v[32:33], v[32:33], s[40:41]
    v_pk_mul_f32 v[34:35], v[34:35], s[40:41]
    v_pk_mul_f32 v[36:37], v[36:37], s[40:41]
    v_pk_mul_f32 v[38:39], v[38:39], s[40:41]
    s_waitcnt lgkmcnt(15)
    v_mfma_f32_16x16x32_bf16 v[8:11], a[112:115], a[0:3], 0
    ds_read_b64_tr_b16 a[166:167], v246 offset:4608
    ds_read_b64_tr_b16 a[168:169], v245 offset:768
    ds_read_b64_tr_b16 a[170:171], v245 offset:4864
    v_cvt_pk_bf16_f32 v32, v32, v33
    v_cvt_pk_bf16_f32 v33, v34, v35
    v_cvt_pk_bf16_f32 v34, v36, v37
    v_cvt_pk_bf16_f32 v35, v38, v39
    v_accvgpr_write_b32 a16, v32
    v_accvgpr_write_b32 a17, v33
    v_accvgpr_write_b32 a18, v34
    v_accvgpr_write_b32 a19, v35
    v_pk_mul_f32 v[40:41], v[40:41], s[40:41]
    v_pk_mul_f32 v[42:43], v[42:43], s[40:41]
    v_pk_mul_f32 v[44:45], v[44:45], s[40:41]
    v_pk_mul_f32 v[46:47], v[46:47], s[40:41]
    v_mfma_f32_16x16x32_bf16 v[8:11], a[116:119], a[4:7], v[8:11]
    ds_read_b64_tr_b16 a[172:173], v246 offset:768
    ds_read_b64_tr_b16 a[174:175], v246 offset:4864
    s_add_u32 m0, s37, 131072
    v_cvt_pk_bf16_f32 v40, v40, v41
    v_cvt_pk_bf16_f32 v41, v42, v43
    v_cvt_pk_bf16_f32 v42, v44, v45
    v_cvt_pk_bf16_f32 v43, v46, v47
    v_accvgpr_write_b32 a20, v40
    v_accvgpr_write_b32 a21, v41
    v_accvgpr_write_b32 a22, v42
    v_accvgpr_write_b32 a23, v43
    v_pk_mul_f32 v[48:49], v[48:49], s[40:41]
    v_pk_mul_f32 v[50:51], v[50:51], s[40:41]
    v_pk_mul_f32 v[52:53], v[52:53], s[40:41]
    v_pk_mul_f32 v[54:55], v[54:55], s[40:41]
    v_mfma_f32_16x16x32_bf16 v[8:11], a[120:123], a[8:11], v[8:11]
    buffer_load_dwordx4 v248, s[16:19], s32 offen offset:0 nt lds
    buffer_load_dwordx4 v249, s[16:19], s32 offen offset:1024 nt lds
    buffer_load_dwordx4 v248, s[16:19], s32 offen offset:2048 nt lds
    v_cvt_pk_bf16_f32 v48, v48, v49
    v_cvt_pk_bf16_f32 v49, v50, v51
    v_cvt_pk_bf16_f32 v50, v52, v53
    v_cvt_pk_bf16_f32 v51, v54, v55
    v_accvgpr_write_b32 a24, v48
    v_accvgpr_write_b32 a25, v49
    v_accvgpr_write_b32 a26, v50
    v_accvgpr_write_b32 a27, v51
    v_pk_mul_f32 v[56:57], v[56:57], s[40:41]
    v_pk_mul_f32 v[58:59], v[58:59], s[40:41]
    v_pk_mul_f32 v[60:61], v[60:61], s[40:41]
    v_pk_mul_f32 v[62:63], v[62:63], s[40:41]
    v_mfma_f32_16x16x32_bf16 v[8:11], a[124:127], a[12:15], v[8:11]
    buffer_load_dwordx4 v249, s[16:19], s32 offen offset:3072 nt lds
    s_add_u32 m0, m0, 4096
    s_nop 0
    buffer_load_dwordx4 v248, s[16:19], s33 offen offset:0 nt lds
    v_cvt_pk_bf16_f32 v56, v56, v57
    v_cvt_pk_bf16_f32 v57, v58, v59
    v_cvt_pk_bf16_f32 v58, v60, v61
    v_cvt_pk_bf16_f32 v59, v62, v63
    v_accvgpr_write_b32 a28, v56
    v_accvgpr_write_b32 a29, v57
    v_accvgpr_write_b32 a30, v58
    v_accvgpr_write_b32 a31, v59
    v_pk_mul_f32 v[64:65], v[64:65], s[40:41]
    v_pk_mul_f32 v[66:67], v[66:67], s[40:41]
    v_pk_mul_f32 v[68:69], v[68:69], s[40:41]
    v_pk_mul_f32 v[70:71], v[70:71], s[40:41]
    v_mfma_f32_16x16x32_bf16 v[40:43], a[112:115], a[16:19], 0
    buffer_load_dwordx4 v249, s[16:19], s33 offen offset:1024 nt lds
    buffer_load_dwordx4 v248, s[16:19], s33 offen offset:2048 nt lds
    buffer_load_dwordx4 v249, s[16:19], s33 offen offset:3072 nt lds
    v_cvt_pk_bf16_f32 v64, v64, v65
    v_cvt_pk_bf16_f32 v65, v66, v67
    v_cvt_pk_bf16_f32 v66, v68, v69
    v_cvt_pk_bf16_f32 v67, v70, v71
    v_accvgpr_write_b32 a32, v64
    v_accvgpr_write_b32 a33, v65
    v_accvgpr_write_b32 a34, v66
    v_accvgpr_write_b32 a35, v67
    v_pk_mul_f32 v[72:73], v[72:73], s[40:41]
    v_pk_mul_f32 v[74:75], v[74:75], s[40:41]
    v_pk_mul_f32 v[76:77], v[76:77], s[40:41]
    v_pk_mul_f32 v[78:79], v[78:79], s[40:41]
    v_mfma_f32_16x16x32_bf16 v[40:43], a[116:119], a[20:23], v[40:43]
    s_add_u32 s64, s64, 8192
    s_xor_b32 s32, s64, s65
    s_or_b32 s33, s32, 4096
    v_cvt_pk_bf16_f32 v72, v72, v73
    v_cvt_pk_bf16_f32 v73, v74, v75
    v_cvt_pk_bf16_f32 v74, v76, v77
    v_cvt_pk_bf16_f32 v75, v78, v79
    v_accvgpr_write_b32 a36, v72
    v_accvgpr_write_b32 a37, v73
    v_accvgpr_write_b32 a38, v74
    v_accvgpr_write_b32 a39, v75
    v_pk_mul_f32 v[80:81], v[80:81], s[40:41]
    v_pk_mul_f32 v[82:83], v[82:83], s[40:41]
    v_pk_mul_f32 v[84:85], v[84:85], s[40:41]
    v_pk_mul_f32 v[86:87], v[86:87], s[40:41]
    v_mfma_f32_16x16x32_bf16 v[40:43], a[120:123], a[24:27], v[40:43]
    s_lshl_b32 s55, s2, 2
    s_add_u32 s55, s55, s24
    s_lshl_b32 s55, s55, 13
    v_and_b32 v254, 3, v247
    v_cvt_pk_bf16_f32 v80, v80, v81
    v_cvt_pk_bf16_f32 v81, v82, v83
    v_cvt_pk_bf16_f32 v82, v84, v85
    v_cvt_pk_bf16_f32 v83, v86, v87
    v_accvgpr_write_b32 a40, v80
    v_accvgpr_write_b32 a41, v81
    v_accvgpr_write_b32 a42, v82
    v_accvgpr_write_b32 a43, v83
    v_pk_mul_f32 v[88:89], v[88:89], s[40:41]
    v_pk_mul_f32 v[90:91], v[90:91], s[40:41]
    v_pk_mul_f32 v[92:93], v[92:93], s[40:41]
    v_pk_mul_f32 v[94:95], v[94:95], s[40:41]
    v_mfma_f32_16x16x32_bf16 v[40:43], a[124:127], a[28:31], v[40:43]
    v_cmp_eq_u32 vcc, 0, v254
    v_mov_b32 v254, 0x3f803f80
    s_nop 0
    v_cndmask_b32 v254, 0, v254, vcc
    v_accvgpr_write_b32 a204, v254
    v_accvgpr_write_b32 a205, v254
    v_cvt_pk_bf16_f32 v88, v88, v89
    v_cvt_pk_bf16_f32 v89, v90, v91
    v_cvt_pk_bf16_f32 v90, v92, v93
    v_cvt_pk_bf16_f32 v91, v94, v95
    v_accvgpr_write_b32 a44, v88
    v_accvgpr_write_b32 a45, v89
    v_accvgpr_write_b32 a46, v90
    v_accvgpr_write_b32 a47, v91
    v_pk_mul_f32 v[96:97], v[96:97], s[40:41]
    v_pk_mul_f32 v[98:99], v[98:99], s[40:41]
    v_pk_mul_f32 v[100:101], v[100:101], s[40:41]
    v_pk_mul_f32 v[102:103], v[102:103], s[40:41]
    v_mfma_f32_16x16x32_bf16 v[72:75], a[112:115], a[32:35], 0
    v_accvgpr_write_b32 a206, v254
    v_accvgpr_write_b32 a207, v254
    v_cvt_pk_bf16_f32 v96, v96, v97
    v_cvt_pk_bf16_f32 v97, v98, v99
    v_cvt_pk_bf16_f32 v98, v100, v101
    v_cvt_pk_bf16_f32 v99, v102, v103
    v_accvgpr_write_b32 a48, v96
    v_accvgpr_write_b32 a49, v97
    v_accvgpr_write_b32 a50, v98
    v_accvgpr_write_b32 a51, v99
    v_pk_mul_f32 v[104:105], v[104:105], s[40:41]
    v_pk_mul_f32 v[106:107], v[106:107], s[40:41]
    v_pk_mul_f32 v[108:109], v[108:109], s[40:41]
    v_pk_mul_f32 v[110:111], v[110:111], s[40:41]
    v_mfma_f32_16x16x32_bf16 v[72:75], a[116:119], a[36:39], v[72:75]
    v_cvt_pk_bf16_f32 v104, v104, v105
    v_cvt_pk_bf16_f32 v105, v106, v107
    v_cvt_pk_bf16_f32 v106, v108, v109
    v_cvt_pk_bf16_f32 v107, v110, v111
    v_accvgpr_write_b32 a52, v104
    v_accvgpr_write_b32 a53, v105
    v_accvgpr_write_b32 a54, v106
    v_accvgpr_write_b32 a55, v107
    v_pk_mul_f32 v[112:113], v[112:113], s[40:41]
    v_pk_mul_f32 v[114:115], v[114:115], s[40:41]
    v_pk_mul_f32 v[116:117], v[116:117], s[40:41]
    v_pk_mul_f32 v[118:119], v[118:119], s[40:41]
    v_mfma_f32_16x16x32_bf16 v[72:75], a[120:123], a[40:43], v[72:75]
    v_cvt_pk_bf16_f32 v112, v112, v113
    v_cvt_pk_bf16_f32 v113, v114, v115
    v_cvt_pk_bf16_f32 v114, v116, v117
    v_cvt_pk_bf16_f32 v115, v118, v119
    v_accvgpr_write_b32 a56, v112
    v_accvgpr_write_b32 a57, v113
    v_accvgpr_write_b32 a58, v114
    v_accvgpr_write_b32 a59, v115
    v_pk_mul_f32 v[120:121], v[120:121], s[40:41]
    v_pk_mul_f32 v[122:123], v[122:123], s[40:41]
    v_pk_mul_f32 v[124:125], v[124:125], s[40:41]
    v_pk_mul_f32 v[126:127], v[126:127], s[40:41]
    v_mfma_f32_16x16x32_bf16 v[72:75], a[124:127], a[44:47], v[72:75]
    v_cvt_pk_bf16_f32 v120, v120, v121
    v_cvt_pk_bf16_f32 v121, v122, v123
    v_cvt_pk_bf16_f32 v122, v124, v125
    v_cvt_pk_bf16_f32 v123, v126, v127
    v_accvgpr_write_b32 a60, v120
    v_accvgpr_write_b32 a61, v121
    v_accvgpr_write_b32 a62, v122
    v_accvgpr_write_b32 a63, v123
    v_pk_mul_f32 v[128:129], v[128:129], s[40:41]
    v_pk_mul_f32 v[130:131], v[130:131], s[40:41]
    v_pk_mul_f32 v[132:133], v[132:133], s[40:41]
    v_pk_mul_f32 v[134:135], v[134:135], s[40:41]
    v_mfma_f32_16x16x32_bf16 v[104:107], a[112:115], a[48:51], 0
    v_cvt_pk_bf16_f32 v128, v128, v129
    v_cvt_pk_bf16_f32 v129, v130, v131
    v_cvt_pk_bf16_f32 v130, v132, v133
    v_cvt_pk_bf16_f32 v131, v134, v135
    v_accvgpr_write_b32 a64, v128
    v_accvgpr_write_b32 a65, v129
    v_accvgpr_write_b32 a66, v130
    v_accvgpr_write_b32 a67, v131
    v_pk_mul_f32 v[136:137], v[136:137], s[40:41]
    v_pk_mul_f32 v[138:139], v[138:139], s[40:41]
    v_pk_mul_f32 v[140:141], v[140:141], s[40:41]
    v_pk_mul_f32 v[142:143], v[142:143], s[40:41]
    v_mfma_f32_16x16x32_bf16 v[104:107], a[116:119], a[52:55], v[104:107]
    v_cvt_pk_bf16_f32 v136, v136, v137
    v_cvt_pk_bf16_f32 v137, v138, v139
    v_cvt_pk_bf16_f32 v138, v140, v141
    v_cvt_pk_bf16_f32 v139, v142, v143
    v_accvgpr_write_b32 a68, v136
    v_accvgpr_write_b32 a69, v137
    v_accvgpr_write_b32 a70, v138
    v_accvgpr_write_b32 a71, v139
    v_pk_mul_f32 v[144:145], v[144:145], s[40:41]
    v_pk_mul_f32 v[146:147], v[146:147], s[40:41]
    v_pk_mul_f32 v[148:149], v[148:149], s[40:41]
    v_pk_mul_f32 v[150:151], v[150:151], s[40:41]
    v_mfma_f32_16x16x32_bf16 v[104:107], a[120:123], a[56:59], v[104:107]
    v_cvt_pk_bf16_f32 v144, v144, v145
    v_cvt_pk_bf16_f32 v145, v146, v147
    v_cvt_pk_bf16_f32 v146, v148, v149
    v_cvt_pk_bf16_f32 v147, v150, v151
    v_accvgpr_write_b32 a72, v144
    v_accvgpr_write_b32 a73, v145
    v_accvgpr_write_b32 a74, v146
    v_accvgpr_write_b32 a75, v147
    v_pk_mul_f32 v[152:153], v[152:153], s[40:41]
    v_pk_mul_f32 v[154:155], v[154:155], s[40:41]
    v_pk_mul_f32 v[156:157], v[156:157], s[40:41]
    v_pk_mul_f32 v[158:159], v[158:159], s[40:41]
    v_mfma_f32_16x16x32_bf16 v[104:107], a[124:127], a[60:63], v[104:107]
    v_cvt_pk_bf16_f32 v152, v152, v153
    v_cvt_pk_bf16_f32 v153, v154, v155
    v_cvt_pk_bf16_f32 v154, v156, v157
    v_cvt_pk_bf16_f32 v155, v158, v159
    v_accvgpr_write_b32 a76, v152
    v_accvgpr_write_b32 a77, v153
    v_accvgpr_write_b32 a78, v154
    v_accvgpr_write_b32 a79, v155
    v_pk_mul_f32 v[160:161], v[160:161], s[40:41]
    v_pk_mul_f32 v[162:163], v[162:163], s[40:41]
    v_pk_mul_f32 v[164:165], v[164:165], s[40:41]
    v_pk_mul_f32 v[166:167], v[166:167], s[40:41]
    v_mfma_f32_16x16x32_bf16 v[136:139], a[112:115], a[64:67], 0
    v_cvt_pk_bf16_f32 v160, v160, v161
    v_cvt_pk_bf16_f32 v161, v162, v163
    v_cvt_pk_bf16_f32 v162, v164, v165
    v_cvt_pk_bf16_f32 v163, v166, v167
    v_accvgpr_write_b32 a80, v160
    v_accvgpr_write_b32 a81, v161
    v_accvgpr_write_b32 a82, v162
    v_accvgpr_write_b32 a83, v163
    v_pk_mul_f32 v[168:169], v[168:169], s[40:41]
    v_pk_mul_f32 v[170:171], v[170:171], s[40:41]
    v_pk_mul_f32 v[172:173], v[172:173], s[40:41]
    v_pk_mul_f32 v[174:175], v[174:175], s[40:41]
    v_mfma_f32_16x16x32_bf16 v[136:139], a[116:119], a[68:71], v[136:139]
    v_cvt_pk_bf16_f32 v168, v168, v169
    v_cvt_pk_bf16_f32 v169, v170, v171
    v_cvt_pk_bf16_f32 v170, v172, v173
    v_cvt_pk_bf16_f32 v171, v174, v175
    v_accvgpr_write_b32 a84, v168
    v_accvgpr_write_b32 a85, v169
    v_accvgpr_write_b32 a86, v170
    v_accvgpr_write_b32 a87, v171
    v_pk_mul_f32 v[176:177], v[176:177], s[40:41]
    v_pk_mul_f32 v[178:179], v[178:179], s[40:41]
    v_pk_mul_f32 v[180:181], v[180:181], s[40:41]
    v_pk_mul_f32 v[182:183], v[182:183], s[40:41]
    v_mfma_f32_16x16x32_bf16 v[136:139], a[120:123], a[72:75], v[136:139]
    v_cvt_pk_bf16_f32 v176, v176, v177
    v_cvt_pk_bf16_f32 v177, v178, v179
    v_cvt_pk_bf16_f32 v178, v180, v181
    v_cvt_pk_bf16_f32 v179, v182, v183
    v_accvgpr_write_b32 a88, v176
    v_accvgpr_write_b32 a89, v177
    v_accvgpr_write_b32 a90, v178
    v_accvgpr_write_b32 a91, v179
    v_pk_mul_f32 v[184:185], v[184:185], s[40:41]
    v_pk_mul_f32 v[186:187], v[186:187], s[40:41]
    v_pk_mul_f32 v[188:189], v[188:189], s[40:41]
    v_pk_mul_f32 v[190:191], v[190:191], s[40:41]
    v_mfma_f32_16x16x32_bf16 v[136:139], a[124:127], a[76:79], v[136:139]
    v_cvt_pk_bf16_f32 v184, v184, v185
    v_cvt_pk_bf16_f32 v185, v186, v187
    v_cvt_pk_bf16_f32 v186, v188, v189
    v_cvt_pk_bf16_f32 v187, v190, v191
    v_accvgpr_write_b32 a92, v184
    v_accvgpr_write_b32 a93, v185
    v_accvgpr_write_b32 a94, v186
    v_accvgpr_write_b32 a95, v187
    v_mfma_f32_16x16x32_bf16 v[168:171], a[112:115], a[80:83], 0
    v_mfma_f32_16x16x32_bf16 v[168:171], a[116:119], a[84:87], v[168:171]
    v_mfma_f32_16x16x32_bf16 v[168:171], a[120:123], a[88:91], v[168:171]
    v_mfma_f32_16x16x32_bf16 v[168:171], a[124:127], a[92:95], v[168:171]
    v_max3_f32 v8, v8, v9, v10
    v_max_f32 v8, v8, v11
    v_max3_f32 v40, v40, v41, v42
    v_max_f32 v40, v40, v43
    v_max3_f32 v72, v72, v73, v74
    v_max_f32 v72, v72, v75
    v_max3_f32 v104, v104, v105, v106
    v_max_f32 v104, v104, v107
    v_max3_f32 v136, v136, v137, v138
    v_max_f32 v136, v136, v139
    v_max3_f32 v168, v168, v169, v170
    v_max_f32 v168, v168, v171
L1_m1:
    s_waitcnt lgkmcnt(0)
    v_mov_b32 v9, v8
    v_mov_b32 v41, v40
    v_mov_b32 v73, v72
    v_mov_b32 v105, v104
    v_mov_b32 v137, v136
    v_mov_b32 v169, v168
    v_permlane32_swap_b32 v8, v9
    v_permlane32_swap_b32 v40, v41
    v_permlane32_swap_b32 v72, v73
    v_permlane32_swap_b32 v104, v105
    v_permlane32_swap_b32 v136, v137
    v_permlane32_swap_b32 v168, v169
    v_max_f32 v8, v8, v9
    v_mov_b32 v9, v8
    v_max_f32 v40, v40, v41
    v_mov_b32 v41, v40
    v_max_f32 v72, v72, v73
    v_mov_b32 v73, v72
    v_max_f32 v104, v104, v105
    v_mov_b32 v105, v104
    v_max_f32 v136, v136, v137
    v_mov_b32 v137, v136
    v_max_f32 v168, v168, v169
    v_mov_b32 v169, v168
    v_permlane16_swap_b32 v8, v9
    v_permlane16_swap_b32 v40, v41
    v_permlane16_swap_b32 v72, v73
    v_permlane16_swap_b32 v104, v105
    v_permlane16_swap_b32 v136, v137
    v_permlane16_swap_b32 v168, v169
    v_max_f32 v8, v8, v9
    v_max_f32 v40, v40, v41
    v_max_f32 v72, v72, v73
    v_max_f32 v104, v104, v105
    v_max_f32 v136, v136, v137
    v_max_f32 v168, v168, v169
    v_sub_f32 v192, 0, v8
    v_sub_f32 v193, 0, v8
    v_sub_f32 v194, 0, v8
    v_sub_f32 v195, 0, v8
    v_sub_f32 v196, 0, v40
    v_sub_f32 v197, 0, v40
    v_sub_f32 v198, 0, v40
    v_sub_f32 v199, 0, v40
    v_sub_f32 v200, 0, v72
    v_sub_f32 v201, 0, v72
    v_sub_f32 v202, 0, v72
    v_sub_f32 v203, 0, v72
    v_sub_f32 v204, 0, v104
    v_sub_f32 v205, 0, v104
    v_sub_f32 v206, 0, v104
    v_sub_f32 v207, 0, v104
    v_sub_f32 v208, 0, v136
    v_sub_f32 v209, 0, v136
    v_sub_f32 v210, 0, v136
    v_sub_f32 v211, 0, v136
    v_sub_f32 v212, 0, v168
    v_sub_f32 v213, 0, v168
    v_sub_f32 v214, 0, v168
    v_sub_f32 v215, 0, v168
    s_mov_b32 s29, 0
    s_mov_b32 s39, 65536
    v_mfma_f32_16x16x32_bf16 v[220:223], a[112:115], a[0:3], v[192:195]
    v_mfma_f32_16x16x32_bf16 v[220:223], a[116:119], a[4:7], v[220:223]
    v_mfma_f32_16x16x32_bf16 v[220:223], a[120:123], a[8:11], v[220:223]
    v_mfma_f32_16x16x32_bf16 v[220:223], a[124:127], a[12:15], v[220:223]
    v_mfma_f32_16x16x32_bf16 v[224:227], a[128:131], a[0:3], v[192:195]
    v_mfma_f32_16x16x32_bf16 v[224:227], a[132:135], a[4:7], v[224:227]
    v_mfma_f32_16x16x32_bf16 v[224:227], a[136:139], a[8:11], v[224:227]
    v_mfma_f32_16x16x32_bf16 v[224:227], a[140:143], a[12:15], v[224:227]
    v_mfma_f32_16x16x32_bf16 v[228:231], a[112:115], a[16:19], v[196:199]
    s_nop 2
    v_exp_f32 v220, v220
    v_mfma_f32_16x16x32_bf16 v[228:231], a[116:119], a[20:23], v[228:231]
    v_exp_f32 v221, v221
    v_mfma_f32_16x16x32_bf16 v[228:231], a[120:123], a[24:27], v[228:231]
    v_exp_f32 v222, v222
    v_mfma_f32_16x16x32_bf16 v[228:231], a[124:127], a[28:31], v[228:231]
    v_exp_f32 v223, v223
    v_cvt_pk_bf16_f32 v236, v220, v221
    v_cvt_pk_bf16_f32 v237, v222, v223
    v_mfma_f32_16x16x32_bf16 v[232:235], a[128:131], a[16:19], v[196:199]
    v_exp_f32 v224, v224
    v_mfma_f32_16x16x32_bf16 v[232:235], a[132:135], a[20:23], v[232:235]
    v_exp_f32 v225, v225
    v_mfma_f32_16x16x32_bf16 v[232:235], a[136:139], a[24:27], v[232:235]
    v_exp_f32 v226, v226
    v_mfma_f32_16x16x32_bf16 v[232:235], a[140:143], a[28:31], v[232:235]
    v_exp_f32 v227, v227
    v_cvt_pk_bf16_f32 v238, v224, v225
    v_cvt_pk_bf16_f32 v239, v226, v227
    v_mfma_f32_16x16x32_bf16 v[220:223], a[112:115], a[32:35], v[200:203]
    v_exp_f32 v228, v228
    v_mfma_f32_16x16x32_bf16 v[220:223], a[116:119], a[36:39], v[220:223]
    v_exp_f32 v229, v229
    v_mfma_f32_16x16x32_bf16 v[220:223], a[120:123], a[40:43], v[220:223]
    v_exp_f32 v230, v230
    v_mfma_f32_16x16x32_bf16 v[220:223], a[124:127], a[44:47], v[220:223]
    v_exp_f32 v231, v231
    v_mfma_f32_16x16x32_bf16 v[0:3], a[144:147], v[236:239], 0
    v_cvt_pk_bf16_f32 v240, v228, v229
    v_mfma_f32_16x16x32_bf16 v[4:7], a[148:151], v[236:239], 0
    v_cvt_pk_bf16_f32 v241, v230, v231
    v_mfma_f32_16x16x32_bf16 v[8:11], a[152:155], v[236:239], 0
    v_mfma_f32_16x16x32_bf16 v[12:15], a[156:159], v[236:239], 0
    v_mfma_f32_16x16x32_bf16 v[224:227], a[128:131], a[32:35], v[200:203]
    v_exp_f32 v232, v232
    v_mfma_f32_16x16x32_bf16 v[224:227], a[132:135], a[36:39], v[224:227]
    v_exp_f32 v233, v233
    v_mfma_f32_16x16x32_bf16 v[224:227], a[136:139], a[40:43], v[224:227]
    v_exp_f32 v234, v234
    v_mfma_f32_16x16x32_bf16 v[224:227], a[140:143], a[44:47], v[224:227]
    v_exp_f32 v235, v235
    v_mfma_f32_16x16x32_bf16 v[16:19], a[160:163], v[236:239], 0
    v_cvt_pk_bf16_f32 v242, v232, v233
    v_mfma_f32_16x16x32_bf16 v[20:23], a[164:167], v[236:239], 0
    v_cvt_pk_bf16_f32 v243, v234, v235
    v_mfma_f32_16x16x32_bf16 v[24:27], a[168:171], v[236:239], 0
    v_mfma_f32_16x16x32_bf16 v[28:31], a[172:175], v[236:239], 0
    v_mfma_f32_16x16x32_bf16 a[176:179], a[204:207], v[236:239], 0
    s_waitcnt vmcnt(8)
    s_barrier
    v_mfma_f32_16x16x32_bf16 v[228:231], a[112:115], a[48:51], v[204:207]
    v_exp_f32 v220, v220
    v_mfma_f32_16x16x32_bf16 v[228:231], a[116:119], a[52:55], v[228:231]
    v_exp_f32 v221, v221
    v_mfma_f32_16x16x32_bf16 v[228:231], a[120:123], a[56:59], v[228:231]
    v_exp_f32 v222, v222
    v_mfma_f32_16x16x32_bf16 v[228:231], a[124:127], a[60:63], v[228:231]
    v_exp_f32 v223, v223
    v_mfma_f32_16x16x32_bf16 v[32:35], a[144:147], v[240:243], 0
    v_cvt_pk_bf16_f32 v236, v220, v221
    s_add_u32 m0, s37, s29
    v_mfma_f32_16x16x32_bf16 v[36:39], a[148:151], v[240:243], 0
    v_cvt_pk_bf16_f32 v237, v222, v223
    v_mfma_f32_16x16x32_bf16 v[40:43], a[152:155], v[240:243], 0
    buffer_load_dwordx4 v248, s[16:19], s32 offen offset:0 nt lds
    v_mfma_f32_16x16x32_bf16 v[44:47], a[156:159], v[240:243], 0
    buffer_load_dwordx4 v249, s[16:19], s32 offen offset:1024 nt lds
    v_mfma_f32_16x16x32_bf16 v[232:235], a[128:131], a[48:51], v[204:207]
    v_exp_f32 v224, v224
    v_mfma_f32_16x16x32_bf16 v[232:235], a[132:135], a[52:55], v[232:235]
    v_exp_f32 v225, v225
    v_mfma_f32_16x16x32_bf16 v[232:235], a[136:139], a[56:59], v[232:235]
    v_exp_f32 v226, v226
    v_mfma_f32_16x16x32_bf16 v[232:235], a[140:143], a[60:63], v[232:235]
    v_exp_f32 v227, v227
    v_mfma_f32_16x16x32_bf16 v[48:51], a[160:163], v[240:243], 0
    v_cvt_pk_bf16_f32 v238, v224, v225
    v_mfma_f32_16x16x32_bf16 v[52:55], a[164:167], v[240:243], 0
    v_cvt_pk_bf16_f32 v239, v226, v227
    v_mfma_f32_16x16x32_bf16 v[56:59], a[168:171], v[240:243], 0
    buffer_load_dwordx4 v248, s[16:19], s32 offen offset:2048 nt lds
    v_mfma_f32_16x16x32_bf16 v[60:63], a[172:175], v[240:243], 0
    buffer_load_dwordx4 v249, s[16:19], s32 offen offset:3072 nt lds
    s_add_u32 m0, m0, 4096
    v_mfma_f32_16x16x32_bf16 a[180:183], a[204:207], v[240:243], 0
    buffer_load_dwordx4 v248, s[16:19], s33 offen offset:0 nt lds
    v_mfma_f32_16x16x32_bf16 v[220:223], a[112:115], a[64:67], v[208:211]
    v_exp_f32 v228, v228
    v_mfma_f32_16x16x32_bf16 v[220:223], a[116:119], a[68:71], v[220:223]
    v_exp_f32 v229, v229
    v_mfma_f32_16x16x32_bf16 v[220:223], a[120:123], a[72:75], v[220:223]
    v_exp_f32 v230, v230
    v_mfma_f32_16x16x32_bf16 v[220:223], a[124:127], a[76:79], v[220:223]
    v_exp_f32 v231, v231
    v_mfma_f32_16x16x32_bf16 v[64:67], a[144:147], v[236:239], 0
    v_cvt_pk_bf16_f32 v240, v228, v229
    s_add_u32 s44, s39, 32768
    v_mfma_f32_16x16x32_bf16 v[68:71], a[148:151], v[236:239], 0
    v_cvt_pk_bf16_f32 v241, v230, v231
    v_mfma_f32_16x16x32_bf16 v[72:75], a[152:155], v[236:239], 0
    s_cmp_eq_u32 s44, 163840
    s_cselect_b32 s44, 0, s44
    v_mfma_f32_16x16x32_bf16 v[76:79], a[156:159], v[236:239], 0
    buffer_load_dwordx4 v249, s[16:19], s33 offen offset:1024 nt lds
    v_mfma_f32_16x16x32_bf16 v[224:227], a[128:131], a[64:67], v[208:211]
    v_exp_f32 v232, v232
    v_mfma_f32_16x16x32_bf16 v[224:227], a[132:135], a[68:71], v[224:227]
    v_exp_f32 v233, v233
    v_mfma_f32_16x16x32_bf16 v[224:227], a[136:139], a[72:75], v[224:227]
    v_exp_f32 v234, v234
    v_mfma_f32_16x16x32_bf16 v[224:227], a[140:143], a[76:79], v[224:227]
    v_exp_f32 v235, v235
    v_mfma_f32_16x16x32_bf16 v[80:83], a[160:163], v[236:239], 0
    v_cvt_pk_bf16_f32 v242, v232, v233
    s_sub_u32 s34, s44, s39
    v_mfma_f32_16x16x32_bf16 v[84:87], a[164:167], v[236:239], 0
    v_cvt_pk_bf16_f32 v243, v234, v235
    s_mov_b32 s39, s44
    v_mfma_f32_16x16x32_bf16 v[88:91], a[168:171], v[236:239], 0
    buffer_load_dwordx4 v248, s[16:19], s33 offen offset:2048 nt lds
    v_mfma_f32_16x16x32_bf16 v[92:95], a[172:175], v[236:239], 0
    buffer_load_dwordx4 v249, s[16:19], s33 offen offset:3072 nt lds
    v_mfma_f32_16x16x32_bf16 a[184:187], a[204:207], v[236:239], 0
    s_add_u32 s64, s64, 8192
    s_xor_b32 s32, s64, s65
    v_mfma_f32_16x16x32_bf16 v[228:231], a[112:115], a[80:83], v[212:215]
    v_exp_f32 v220, v220
    v_mfma_f32_16x16x32_bf16 v[228:231], a[116:119], a[84:87], v[228:231]
    v_exp_f32 v221, v221
    v_mfma_f32_16x16x32_bf16 v[228:231], a[120:123], a[88:91], v[228:231]
    v_exp_f32 v222, v222
    v_mfma_f32_16x16x32_bf16 v[228:231], a[124:127], a[92:95], v[228:231]
    v_exp_f32 v223, v223
    v_mfma_f32_16x16x32_bf16 v[96:99], a[144:147], v[240:243], 0
    v_cvt_pk_bf16_f32 v236, v220, v221
    v_add_u32 v244, s34, v244
    v_mfma_f32_16x16x32_bf16 v[100:103], a[148:151], v[240:243], 0
    v_cvt_pk_bf16_f32 v237, v222, v223
    s_or_b32 s33, s32, 4096
    v_mfma_f32_16x16x32_bf16 v[104:107], a[152:155], v[240:243], 0
    s_add_u32 s29, s29, 32768
    v_mfma_f32_16x16x32_bf16 v[108:111], a[156:159], v[240:243], 0
    s_cmp_eq_u32 s29, 163840
    s_cselect_b32 s29, 0, s29
    v_mfma_f32_16x16x32_bf16 v[232:235], a[128:131], a[80:83], v[212:215]
    v_exp_f32 v224, v224
    v_mfma_f32_16x16x32_bf16 v[232:235], a[132:135], a[84:87], v[232:235]
    v_exp_f32 v225, v225
    v_mfma_f32_16x16x32_bf16 v[232:235], a[136:139], a[88:91], v[232:235]
    v_exp_f32 v226, v226
    v_mfma_f32_16x16x32_bf16 v[232:235], a[140:143], a[92:95], v[232:235]
    v_exp_f32 v227, v227
    v_mfma_f32_16x16x32_bf16 v[112:115], a[160:163], v[240:243], 0
    v_cvt_pk_bf16_f32 v238, v224, v225
    v_mfma_f32_16x16x32_bf16 v[116:119], a[164:167], v[240:243], 0
    v_cvt_pk_bf16_f32 v239, v226, v227
    v_mfma_f32_16x16x32_bf16 v[120:123], a[168:171], v[240:243], 0
    v_mfma_f32_16x16x32_bf16 v[124:127], a[172:175], v[240:243], 0
    v_mfma_f32_16x16x32_bf16 a[188:191], a[204:207], v[240:243], 0
    ds_read_b128 a[112:115], v244 offset:0
    ds_read_b128 a[116:119], v244 offset:256
    ds_read_b128 a[120:123], v244 offset:512
    ds_read_b128 a[124:127], v244 offset:768
    ds_read_b128 a[128:131], v244 offset:4096
    ds_read_b128 a[132:135], v244 offset:4352
    ds_read_b128 a[136:139], v244 offset:4608
    ds_read_b128 a[140:143], v244 offset:4864
    s_waitcnt lgkmcnt(0)
    v_mfma_f32_16x16x32_bf16 v[220:223], a[112:115], a[0:3], v[192:195]
    v_exp_f32 v228, v228
    v_mfma_f32_16x16x32_bf16 v[220:223], a[116:119], a[4:7], v[220:223]
    v_exp_f32 v229, v229
    v_mfma_f32_16x16x32_bf16 v[220:223], a[120:123], a[8:11], v[220:223]
    v_exp_f32 v230, v230
    v_mfma_f32_16x16x32_bf16 v[220:223], a[124:127], a[12:15], v[220:223]
    v_exp_f32 v231, v231
    v_mfma_f32_16x16x32_bf16 v[128:131], a[144:147], v[236:239], 0
    v_cvt_pk_bf16_f32 v240, v228, v229
    v_mfma_f32_16x16x32_bf16 v[132:135], a[148:151], v[236:239], 0
    v_cvt_pk_bf16_f32 v241, v230, v231
    v_mfma_f32_16x16x32_bf16 v[136:139], a[152:155], v[236:239], 0
    v_mfma_f32_16x16x32_bf16 v[140:143], a[156:159], v[236:239], 0
    v_mfma_f32_16x16x32_bf16 v[224:227], a[128:131], a[0:3], v[192:195]
    v_exp_f32 v232, v232
    v_mfma_f32_16x16x32_bf16 v[224:227], a[132:135], a[4:7], v[224:227]
    v_exp_f32 v233, v233
    v_mfma_f32_16x16x32_bf16 v[224:227], a[136:139], a[8:11], v[224:227]
    v_exp_f32 v234, v234
    v_mfma_f32_16x16x32_bf16 v[224:227], a[140:143], a[12:15], v[224:227]
    v_exp_f32 v235, v235
    v_mfma_f32_16x16x32_bf16 v[144:147], a[160:163], v[236:239], 0
    v_cvt_pk_bf16_f32 v242, v232, v233
    v_add_u32 v245, s34, v245
    v_mfma_f32_16x16x32_bf16 v[148:151], a[164:167], v[236:239], 0
    v_cvt_pk_bf16_f32 v243, v234, v235
    v_add_u32 v246, s34, v246
    v_mfma_f32_16x16x32_bf16 v[152:155], a[168:171], v[236:239], 0
    v_mfma_f32_16x16x32_bf16 v[156:159], a[172:175], v[236:239], 0
    v_mfma_f32_16x16x32_bf16 a[192:195], a[204:207], v[236:239], 0
    v_mfma_f32_16x16x32_bf16 v[228:231], a[112:115], a[16:19], v[196:199]
    v_exp_f32 v220, v220
    v_mfma_f32_16x16x32_bf16 v[228:231], a[116:119], a[20:23], v[228:231]
    v_exp_f32 v221, v221
    v_mfma_f32_16x16x32_bf16 v[228:231], a[120:123], a[24:27], v[228:231]
    v_exp_f32 v222, v222
    v_mfma_f32_16x16x32_bf16 v[228:231], a[124:127], a[28:31], v[228:231]
    v_exp_f32 v223, v223
    v_mfma_f32_16x16x32_bf16 v[160:163], a[144:147], v[240:243], 0
    v_cvt_pk_bf16_f32 v236, v220, v221
    v_mfma_f32_16x16x32_bf16 v[164:167], a[148:151], v[240:243], 0
    v_cvt_pk_bf16_f32 v237, v222, v223
    v_mfma_f32_16x16x32_bf16 v[168:171], a[152:155], v[240:243], 0
    v_mfma_f32_16x16x32_bf16 v[172:175], a[156:159], v[240:243], 0
    v_mfma_f32_16x16x32_bf16 v[232:235], a[128:131], a[16:19], v[196:199]
    v_exp_f32 v224, v224
    v_mfma_f32_16x16x32_bf16 v[232:235], a[132:135], a[20:23], v[232:235]
    v_exp_f32 v225, v225
    v_mfma_f32_16x16x32_bf16 v[232:235], a[136:139], a[24:27], v[232:235]
    v_exp_f32 v226, v226
    v_mfma_f32_16x16x32_bf16 v[232:235], a[140:143], a[28:31], v[232:235]
    v_exp_f32 v227, v227
    v_mfma_f32_16x16x32_bf16 v[176:179], a[160:163], v[240:243], 0
    v_cvt_pk_bf16_f32 v238, v224, v225
    v_mfma_f32_16x16x32_bf16 v[180:183], a[164:167], v[240:243], 0
    v_cvt_pk_bf16_f32 v239, v226, v227
    v_mfma_f32_16x16x32_bf16 v[184:187], a[168:171], v[240:243], 0
    v_mfma_f32_16x16x32_bf16 v[188:191], a[172:175], v[240:243], 0
    v_mfma_f32_16x16x32_bf16 a[196:199], a[204:207], v[240:243], 0
    v_mfma_f32_16x16x32_bf16 v[220:223], a[112:115], a[32:35], v[200:203]
    v_exp_f32 v228, v228
    v_mfma_f32_16x16x32_bf16 v[220:223], a[116:119], a[36:39], v[220:223]
    v_exp_f32 v229, v229
    v_mfma_f32_16x16x32_bf16 v[220:223], a[120:123], a[40:43], v[220:223]
    v_exp_f32 v230, v230
    v_mfma_f32_16x16x32_bf16 v[220:223], a[124:127], a[44:47], v[220:223]
    v_exp_f32 v231, v231
    ds_read_b64_tr_b16 a[144:145], v245 offset:0
    ds_read_b64_tr_b16 a[146:147], v245 offset:4096
    ds_read_b64_tr_b16 a[148:149], v246 offset:0
    ds_read_b64_tr_b16 a[150:151], v246 offset:4096
    ds_read_b64_tr_b16 a[152:153], v245 offset:256
    ds_read_b64_tr_b16 a[154:155], v245 offset:4352
    ds_read_b64_tr_b16 a[156:157], v246 offset:256
    ds_read_b64_tr_b16 a[158:159], v246 offset:4352
    ds_read_b64_tr_b16 a[160:161], v245 offset:512
    ds_read_b64_tr_b16 a[162:163], v245 offset:4608
    ds_read_b64_tr_b16 a[164:165], v246 offset:512
    ds_read_b64_tr_b16 a[166:167], v246 offset:4608
    ds_read_b64_tr_b16 a[168:169], v245 offset:768
    ds_read_b64_tr_b16 a[170:171], v245 offset:4864
    ds_read_b64_tr_b16 a[172:173], v246 offset:768
    ds_read_b64_tr_b16 a[174:175], v246 offset:4864
    s_waitcnt lgkmcnt(0)
    v_mfma_f32_16x16x32_bf16 v[0:3], a[144:147], v[236:239], v[0:3]
    v_cvt_pk_bf16_f32 v240, v228, v229
    v_mfma_f32_16x16x32_bf16 v[4:7], a[148:151], v[236:239], v[4:7]
    v_cvt_pk_bf16_f32 v241, v230, v231
    v_mfma_f32_16x16x32_bf16 v[8:11], a[152:155], v[236:239], v[8:11]
    v_mfma_f32_16x16x32_bf16 v[12:15], a[156:159], v[236:239], v[12:15]
    v_mfma_f32_16x16x32_bf16 v[224:227], a[128:131], a[32:35], v[200:203]
    v_exp_f32 v232, v232
    v_mfma_f32_16x16x32_bf16 v[224:227], a[132:135], a[36:39], v[224:227]
    v_exp_f32 v233, v233
    v_mfma_f32_16x16x32_bf16 v[224:227], a[136:139], a[40:43], v[224:227]
    v_exp_f32 v234, v234
    v_mfma_f32_16x16x32_bf16 v[224:227], a[140:143], a[44:47], v[224:227]
    v_exp_f32 v235, v235
    v_mfma_f32_16x16x32_bf16 v[16:19], a[160:163], v[236:239], v[16:19]
    v_cvt_pk_bf16_f32 v242, v232, v233
    v_mfma_f32_16x16x32_bf16 v[20:23], a[164:167], v[236:239], v[20:23]
    v_cvt_pk_bf16_f32 v243, v234, v235
    v_mfma_f32_16x16x32_bf16 v[24:27], a[168:171], v[236:239], v[24:27]
    v_mfma_f32_16x16x32_bf16 v[28:31], a[172:175], v[236:239], v[28:31]
    v_mfma_f32_16x16x32_bf16 a[176:179], a[204:207], v[236:239], a[176:179]
    s_waitcnt vmcnt(8)
    s_barrier
    v_mfma_f32_16x16x32_bf16 v[228:231], a[112:115], a[48:51], v[204:207]
    v_exp_f32 v220, v220
    v_mfma_f32_16x16x32_bf16 v[228:231], a[116:119], a[52:55], v[228:231]
    v_exp_f32 v221, v221
    v_mfma_f32_16x16x32_bf16 v[228:231], a[120:123], a[56:59], v[228:231]
    v_exp_f32 v222, v222
    v_mfma_f32_16x16x32_bf16 v[228:231], a[124:127], a[60:63], v[228:231]
    v_exp_f32 v223, v223
    v_mfma_f32_16x16x32_bf16 v[32:35], a[144:147], v[240:243], v[32:35]
    v_cvt_pk_bf16_f32 v236, v220, v221
    s_add_u32 m0, s37, s29
    v_mfma_f32_16x16x32_bf16 v[36:39], a[148:151], v[240:243], v[36:39]
    v_cvt_pk_bf16_f32 v237, v222, v223
    v_mfma_f32_16x16x32_bf16 v[40:43], a[152:155], v[240:243], v[40:43]
    buffer_load_dwordx4 v248, s[16:19], s32 offen offset:0 nt lds
    v_mfma_f32_16x16x32_bf16 v[44:47], a[156:159], v[240:243], v[44:47]
    buffer_load_dwordx4 v249, s[16:19], s32 offen offset:1024 nt lds
    v_mfma_f32_16x16x32_bf16 v[232:235], a[128:131], a[48:51], v[204:207]
    v_exp_f32 v224, v224
    v_mfma_f32_16x16x32_bf16 v[232:235], a[132:135], a[52:55], v[232:235]
    v_exp_f32 v225, v225
    v_mfma_f32_16x16x32_bf16 v[232:235], a[136:139], a[56:59], v[232:235]
    v_exp_f32 v226, v226
    v_mfma_f32_16x16x32_bf16 v[232:235], a[140:143], a[60:63], v[232:235]
    v_exp_f32 v227, v227
    v_mfma_f32_16x16x32_bf16 v[48:51], a[160:163], v[240:243], v[48:51]
    v_cvt_pk_bf16_f32 v238, v224, v225
    v_mfma_f32_16x16x32_bf16 v[52:55], a[164:167], v[240:243], v[52:55]
    v_cvt_pk_bf16_f32 v239, v226, v227
    v_mfma_f32_16x16x32_bf16 v[56:59], a[168:171], v[240:243], v[56:59]
    buffer_load_dwordx4 v248, s[16:19], s32 offen offset:2048 nt lds
    v_mfma_f32_16x16x32_bf16 v[60:63], a[172:175], v[240:243], v[60:63]
    buffer_load_dwordx4 v249, s[16:19], s32 offen offset:3072 nt lds
    s_add_u32 m0, m0, 4096
    v_mfma_f32_16x16x32_bf16 a[180:183], a[204:207], v[240:243], a[180:183]
    buffer_load_dwordx4 v248, s[16:19], s33 offen offset:0 nt lds
    v_mfma_f32_16x16x32_bf16 v[220:223], a[112:115], a[64:67], v[208:211]
    v_exp_f32 v228, v228
    v_mfma_f32_16x16x32_bf16 v[220:223], a[116:119], a[68:71], v[220:223]
    v_exp_f32 v229, v229
    v_mfma_f32_16x16x32_bf16 v[220:223], a[120:123], a[72:75], v[220:223]
    v_exp_f32 v230, v230
    v_mfma_f32_16x16x32_bf16 v[220:223], a[124:127], a[76:79], v[220:223]
    v_exp_f32 v231, v231
    v_mfma_f32_16x16x32_bf16 v[64:67], a[144:147], v[236:239], v[64:67]
    v_cvt_pk_bf16_f32 v240, v228, v229
    s_add_u32 s44, s39, 32768
    v_mfma_f32_16x16x32_bf16 v[68:71], a[148:151], v[236:239], v[68:71]
    v_cvt_pk_bf16_f32 v241, v230, v231
    v_mfma_f32_16x16x32_bf16 v[72:75], a[152:155], v[236:239], v[72:75]
    s_cmp_eq_u32 s44, 163840
    s_cselect_b32 s44, 0, s44
    v_mfma_f32_16x16x32_bf16 v[76:79], a[156:159], v[236:239], v[76:79]
    buffer_load_dwordx4 v249, s[16:19], s33 offen offset:1024 nt lds
    v_mfma_f32_16x16x32_bf16 v[224:227], a[128:131], a[64:67], v[208:211]
    v_exp_f32 v232, v232
    v_mfma_f32_16x16x32_bf16 v[224:227], a[132:135], a[68:71], v[224:227]
    v_exp_f32 v233, v233
    v_mfma_f32_16x16x32_bf16 v[224:227], a[136:139], a[72:75], v[224:227]
    v_exp_f32 v234, v234
    v_mfma_f32_16x16x32_bf16 v[224:227], a[140:143], a[76:79], v[224:227]
    v_exp_f32 v235, v235
    v_mfma_f32_16x16x32_bf16 v[80:83], a[160:163], v[236:239], v[80:83]
    v_cvt_pk_bf16_f32 v242, v232, v233
    s_sub_u32 s34, s44, s39
    v_mfma_f32_16x16x32_bf16 v[84:87], a[164:167], v[236:239], v[84:87]
    v_cvt_pk_bf16_f32 v243, v234, v235
    s_mov_b32 s39, s44
    v_mfma_f32_16x16x32_bf16 v[88:91], a[168:171], v[236:239], v[88:91]
    buffer_load_dwordx4 v248, s[16:19], s33 offen offset:2048 nt lds
    v_mfma_f32_16x16x32_bf16 v[92:95], a[172:175], v[236:239], v[92:95]
    buffer_load_dwordx4 v249, s[16:19], s33 offen offset:3072 nt lds
    v_mfma_f32_16x16x32_bf16 a[184:187], a[204:207], v[236:239], a[184:187]
    s_add_u32 s64, s64, 8192
    s_xor_b32 s32, s64, s65
    v_mfma_f32_16x16x32_bf16 v[228:231], a[112:115], a[80:83], v[212:215]
    v_exp_f32 v220, v220
    v_mfma_f32_16x16x32_bf16 v[228:231], a[116:119], a[84:87], v[228:231]
    v_exp_f32 v221, v221
    v_mfma_f32_16x16x32_bf16 v[228:231], a[120:123], a[88:91], v[228:231]
    v_exp_f32 v222, v222
    v_mfma_f32_16x16x32_bf16 v[228:231], a[124:127], a[92:95], v[228:231]
    v_exp_f32 v223, v223
    v_mfma_f32_16x16x32_bf16 v[96:99], a[144:147], v[240:243], v[96:99]
    v_cvt_pk_bf16_f32 v236, v220, v221
    v_add_u32 v244, s34, v244
    v_mfma_f32_16x16x32_bf16 v[100:103], a[148:151], v[240:243], v[100:103]
    v_cvt_pk_bf16_f32 v237, v222, v223
    s_or_b32 s33, s32, 4096
    v_mfma_f32_16x16x32_bf16 v[104:107], a[152:155], v[240:243], v[104:107]
    s_add_u32 s29, s29, 32768
    v_mfma_f32_16x16x32_bf16 v[108:111], a[156:159], v[240:243], v[108:111]
    s_cmp_eq_u32 s29, 163840
    s_cselect_b32 s29, 0, s29
    v_mfma_f32_16x16x32_bf16 v[232:235], a[128:131], a[80:83], v[212:215]
    v_exp_f32 v224, v224
    v_mfma_f32_16x16x32_bf16 v[232:235], a[132:135], a[84:87], v[232:235]
    v_exp_f32 v225, v225
    v_mfma_f32_16x16x32_bf16 v[232:235], a[136:139], a[88:91], v[232:235]
    v_exp_f32 v226, v226
    v_mfma_f32_16x16x32_bf16 v[232:235], a[140:143], a[92:95], v[232:235]
    v_exp_f32 v227, v227
    v_mfma_f32_16x16x32_bf16 v[112:115], a[160:163], v[240:243], v[112:115]
    v_cvt_pk_bf16_f32 v238, v224, v225
    v_mfma_f32_16x16x32_bf16 v[116:119], a[164:167], v[240:243], v[116:119]
    v_cvt_pk_bf16_f32 v239, v226, v227
    v_mfma_f32_16x16x32_bf16 v[120:123], a[168:171], v[240:243], v[120:123]
    v_mfma_f32_16x16x32_bf16 v[124:127], a[172:175], v[240:243], v[124:127]
    v_mfma_f32_16x16x32_bf16 a[188:191], a[204:207], v[240:243], a[188:191]
    s_cmp_lg_u32 s48, 0
    s_cbranch_scc1 L1_nb1
    v_readfirstlane_b32 s96, v253
L1_nb1:
    s_mov_b32 s28, 6
.p2align 6
L1_a1:
    ds_read_b128 a[112:115], v244 offset:0
    ds_read_b128 a[116:119], v244 offset:256
    ds_read_b128 a[120:123], v244 offset:512
    ds_read_b128 a[124:127], v244 offset:768
    ds_read_b128 a[128:131], v244 offset:4096
    ds_read_b128 a[132:135], v244 offset:4352
    ds_read_b128 a[136:139], v244 offset:4608
    ds_read_b128 a[140:143], v244 offset:4864
    s_waitcnt lgkmcnt(0)
    v_mfma_f32_16x16x32_bf16 v[220:223], a[112:115], a[0:3], v[192:195]
    v_exp_f32 v228, v228
    v_mfma_f32_16x16x32_bf16 v[220:223], a[116:119], a[4:7], v[220:223]
    v_exp_f32 v229, v229
    v_mfma_f32_16x16x32_bf16 v[220:223], a[120:123], a[8:11], v[220:223]
    v_exp_f32 v230, v230
    v_mfma_f32_16x16x32_bf16 v[220:223], a[124:127], a[12:15], v[220:223]
    v_exp_f32 v231, v231
    v_mfma_f32_16x16x32_bf16 v[128:131], a[144:147], v[236:239], v[128:131]
    v_cvt_pk_bf16_f32 v240, v228, v229
    v_mfma_f32_16x16x32_bf16 v[132:135], a[148:151], v[236:239], v[132:135]
    v_cvt_pk_bf16_f32 v241, v230, v231
    v_mfma_f32_16x16x32_bf16 v[136:139], a[152:155], v[236:239], v[136:139]
    v_mfma_f32_16x16x32_bf16 v[140:143], a[156:159], v[236:239], v[140:143]
    v_mfma_f32_16x16x32_bf16 v[224:227], a[128:131], a[0:3], v[192:195]
    v_exp_f32 v232, v232
    v_mfma_f32_16x16x32_bf16 v[224:227], a[132:135], a[4:7], v[224:227]
    v_exp_f32 v233, v233
    v_mfma_f32_16x16x32_bf16 v[224:227], a[136:139], a[8:11], v[224:227]
    v_exp_f32 v234, v234
    v_mfma_f32_16x16x32_bf16 v[224:227], a[140:143], a[12:15], v[224:227]
    v_exp_f32 v235, v235
    v_mfma_f32_16x16x32_bf16 v[144:147], a[160:163], v[236:239], v[144:147]
    v_cvt_pk_bf16_f32 v242, v232, v233
    v_add_u32 v245, s34, v245
    v_mfma_f32_16x16x32_bf16 v[148:151], a[164:167], v[236:239], v[148:151]
    v_cvt_pk_bf16_f32 v243, v234, v235
    v_add_u32 v246, s34, v246
    v_mfma_f32_16x16x32_bf16 v[152:155], a[168:171], v[236:239], v[152:155]
    v_mfma_f32_16x16x32_bf16 v[156:159], a[172:175], v[236:239], v[156:159]
    v_mfma_f32_16x16x32_bf16 a[192:195], a[204:207], v[236:239], a[192:195]
    v_mfma_f32_16x16x32_bf16 v[228:231], a[112:115], a[16:19], v[196:199]
    v_exp_f32 v220, v220
    v_mfma_f32_16x16x32_bf16 v[228:231], a[116:119], a[20:23], v[228:231]
    v_exp_f32 v221, v221
    v_mfma_f32_16x16x32_bf16 v[228:231], a[120:123], a[24:27], v[228:231]
    v_exp_f32 v222, v222
    v_mfma_f32_16x16x32_bf16 v[228:231], a[124:127], a[28:31], v[228:231]
    v_exp_f32 v223, v223
    v_mfma_f32_16x16x32_bf16 v[160:163], a[144:147], v[240:243], v[160:163]
    v_cvt_pk_bf16_f32 v236, v220, v221
    v_mfma_f32_16x16x32_bf16 v[164:167], a[148:151], v[240:243], v[164:167]
    v_cvt_pk_bf16_f32 v237, v222, v223
    v_mfma_f32_16x16x32_bf16 v[168:171], a[152:155], v[240:243], v[168:171]
    v_mfma_f32_16x16x32_bf16 v[172:175], a[156:159], v[240:243], v[172:175]
    v_mfma_f32_16x16x32_bf16 v[232:235], a[128:131], a[16:19], v[196:199]
    v_exp_f32 v224, v224
    v_mfma_f32_16x16x32_bf16 v[232:235], a[132:135], a[20:23], v[232:235]
    v_exp_f32 v225, v225
    v_mfma_f32_16x16x32_bf16 v[232:235], a[136:139], a[24:27], v[232:235]
    v_exp_f32 v226, v226
    v_mfma_f32_16x16x32_bf16 v[232:235], a[140:143], a[28:31], v[232:235]
    v_exp_f32 v227, v227
    v_mfma_f32_16x16x32_bf16 v[176:179], a[160:163], v[240:243], v[176:179]
    v_cvt_pk_bf16_f32 v238, v224, v225
    v_mfma_f32_16x16x32_bf16 v[180:183], a[164:167], v[240:243], v[180:183]
    v_cvt_pk_bf16_f32 v239, v226, v227
    v_mfma_f32_16x16x32_bf16 v[184:187], a[168:171], v[240:243], v[184:187]
    v_mfma_f32_16x16x32_bf16 v[188:191], a[172:175], v[240:243], v[188:191]
    v_mfma_f32_16x16x32_bf16 a[196:199], a[204:207], v[240:243], a[196:199]
    v_mfma_f32_16x16x32_bf16 v[220:223], a[112:115], a[32:35], v[200:203]
    v_exp_f32 v228, v228
    v_mfma_f32_16x16x32_bf16 v[220:223], a[116:119], a[36:39], v[220:223]
    v_exp_f32 v229, v229
    v_mfma_f32_16x16x32_bf16 v[220:223], a[120:123], a[40:43], v[220:223]
    v_exp_f32 v230, v230
    v_mfma_f32_16x16x32_bf16 v[220:223], a[124:127], a[44:47], v[220:223]
    v_exp_f32 v231, v231
    ds_read_b64_tr_b16 a[144:145], v245 offset:0
    ds_read_b64_tr_b16 a[146:147], v245 offset:4096
    ds_read_b64_tr_b16 a[148:149], v246 offset:0
    ds_read_b64_tr_b16 a[150:151], v246 offset:4096
    ds_read_b64_tr_b16 a[152:153], v245 offset:256
    ds_read_b64_tr_b16 a[154:155], v245 offset:4352
    ds_read_b64_tr_b16 a[156:157], v246 offset:256
    ds_read_b64_tr_b16 a[158:159], v246 offset:4352
    ds_read_b64_tr_b16 a[160:161], v245 offset:512
    ds_read_b64_tr_b16 a[162:163], v245 offset:4608
    ds_read_b64_tr_b16 a[164:165], v246 offset:512
    ds_read_b64_tr_b16 a[166:167], v246 offset:4608
    ds_read_b64_tr_b16 a[168:169], v245 offset:768
    ds_read_b64_tr_b16 a[170:171], v245 offset:4864
    ds_read_b64_tr_b16 a[172:173], v246 offset:768
    ds_read_b64_tr_b16 a[174:175], v246 offset:4864
    s_waitcnt lgkmcnt(0)
    v_mfma_f32_16x16x32_bf16 v[0:3], a[144:147], v[236:239], v[0:3]
    v_cvt_pk_bf16_f32 v240, v228, v229
    v_mfma_f32_16x16x32_bf16 v[4:7], a[148:151], v[236:239], v[4:7]
    v_cvt_pk_bf16_f32 v241, v230, v231
    v_mfma_f32_16x16x32_bf16 v[8:11], a[152:155], v[236:239], v[8:11]
    v_mfma_f32_16x16x32_bf16 v[12:15], a[156:159], v[236:239], v[12:15]
    v_mfma_f32_16x16x32_bf16 v[224:227], a[128:131], a[32:35], v[200:203]
    v_exp_f32 v232, v232
    v_mfma_f32_16x16x32_bf16 v[224:227], a[132:135], a[36:39], v[224:227]
    v_exp_f32 v233, v233
    v_mfma_f32_16x16x32_bf16 v[224:227], a[136:139], a[40:43], v[224:227]
    v_exp_f32 v234, v234
    v_mfma_f32_16x16x32_bf16 v[224:227], a[140:143], a[44:47], v[224:227]
    v_exp_f32 v235, v235
    v_mfma_f32_16x16x32_bf16 v[16:19], a[160:163], v[236:239], v[16:19]
    v_cvt_pk_bf16_f32 v242, v232, v233
    v_mfma_f32_16x16x32_bf16 v[20:23], a[164:167], v[236:239], v[20:23]
    v_cvt_pk_bf16_f32 v243, v234, v235
    v_mfma_f32_16x16x32_bf16 v[24:27], a[168:171], v[236:239], v[24:27]
    v_mfma_f32_16x16x32_bf16 v[28:31], a[172:175], v[236:239], v[28:31]
    v_mfma_f32_16x16x32_bf16 a[176:179], a[204:207], v[236:239], a[176:179]
    s_waitcnt vmcnt(8)
    s_barrier
    v_mfma_f32_16x16x32_bf16 v[228:231], a[112:115], a[48:51], v[204:207]
    v_exp_f32 v220, v220
    v_mfma_f32_16x16x32_bf16 v[228:231], a[116:119], a[52:55], v[228:231]
    v_exp_f32 v221, v221
    v_mfma_f32_16x16x32_bf16 v[228:231], a[120:123], a[56:59], v[228:231]
    v_exp_f32 v222, v222
    v_mfma_f32_16x16x32_bf16 v[228:231], a[124:127], a[60:63], v[228:231]
    v_exp_f32 v223, v223
    v_mfma_f32_16x16x32_bf16 v[32:35], a[144:147], v[240:243], v[32:35]
    v_cvt_pk_bf16_f32 v236, v220, v221
    s_add_u32 m0, s37, s29
    v_mfma_f32_16x16x32_bf16 v[36:39], a[148:151], v[240:243], v[36:39]
    v_cvt_pk_bf16_f32 v237, v222, v223
    v_mfma_f32_16x16x32_bf16 v[40:43], a[152:155], v[240:243], v[40:43]
    buffer_load_dwordx4 v248, s[16:19], s32 offen offset:0 nt lds
    v_mfma_f32_16x16x32_bf16 v[44:47], a[156:159], v[240:243], v[44:47]
    buffer_load_dwordx4 v249, s[16:19], s32 offen offset:1024 nt lds
    v_mfma_f32_16x16x32_bf16 v[232:235], a[128:131], a[48:51], v[204:207]
    v_exp_f32 v224, v224
    v_mfma_f32_16x16x32_bf16 v[232:235], a[132:135], a[52:55], v[232:235]
    v_exp_f32 v225, v225
    v_mfma_f32_16x16x32_bf16 v[232:235], a[136:139], a[56:59], v[232:235]
    v_exp_f32 v226, v226
    v_mfma_f32_16x16x32_bf16 v[232:235], a[140:143], a[60:63], v[232:235]
    v_exp_f32 v227, v227
    v_mfma_f32_16x16x32_bf16 v[48:51], a[160:163], v[240:243], v[48:51]
    v_cvt_pk_bf16_f32 v238, v224, v225
    v_mfma_f32_16x16x32_bf16 v[52:55], a[164:167], v[240:243], v[52:55]
    v_cvt_pk_bf16_f32 v239, v226, v227
    v_mfma_f32_16x16x32_bf16 v[56:59], a[168:171], v[240:243], v[56:59]
    buffer_load_dwordx4 v248, s[16:19], s32 offen offset:2048 nt lds
    v_mfma_f32_16x16x32_bf16 v[60:63], a[172:175], v[240:243], v[60:63]
    buffer_load_dwordx4 v249, s[16:19], s32 offen offset:3072 nt lds
    s_add_u32 m0, m0, 4096
    v_mfma_f32_16x16x32_bf16 a[180:183], a[204:207], v[240:243], a[180:183]
    buffer_load_dwordx4 v248, s[16:19], s33 offen offset:0 nt lds
    v_mfma_f32_16x16x32_bf16 v[220:223], a[112:115], a[64:67], v[208:211]
    v_exp_f32 v228, v228
    v_mfma_f32_16x16x32_bf16 v[220:223], a[116:119], a[68:71], v[220:223]
    v_exp_f32 v229, v229
    v_mfma_f32_16x16x32_bf16 v[220:223], a[120:123], a[72:75], v[220:223]
    v_exp_f32 v230, v230
    v_mfma_f32_16x16x32_bf16 v[220:223], a[124:127], a[76:79], v[220:223]
    v_exp_f32 v231, v231
    v_mfma_f32_16x16x32_bf16 v[64:67], a[144:147], v[236:239], v[64:67]
    v_cvt_pk_bf16_f32 v240, v228, v229
    s_add_u32 s44, s39, 32768
    v_mfma_f32_16x16x32_bf16 v[68:71], a[148:151], v[236:239], v[68:71]
    v_cvt_pk_bf16_f32 v241, v230, v231
    v_mfma_f32_16x16x32_bf16 v[72:75], a[152:155], v[236:239], v[72:75]
    s_cmp_eq_u32 s44, 163840
    s_cselect_b32 s44, 0, s44
    v_mfma_f32_16x16x32_bf16 v[76:79], a[156:159], v[236:239], v[76:79]
    buffer_load_dwordx4 v249, s[16:19], s33 offen offset:1024 nt lds
    v_mfma_f32_16x16x32_bf16 v[224:227], a[128:131], a[64:67], v[208:211]
    v_exp_f32 v232, v232
    v_mfma_f32_16x16x32_bf16 v[224:227], a[132:135], a[68:71], v[224:227]
    v_exp_f32 v233, v233
    v_mfma_f32_16x16x32_bf16 v[224:227], a[136:139], a[72:75], v[224:227]
    v_exp_f32 v234, v234
    v_mfma_f32_16x16x32_bf16 v[224:227], a[140:143], a[76:79], v[224:227]
    v_exp_f32 v235, v235
    v_mfma_f32_16x16x32_bf16 v[80:83], a[160:163], v[236:239], v[80:83]
    v_cvt_pk_bf16_f32 v242, v232, v233
    s_sub_u32 s34, s44, s39
    v_mfma_f32_16x16x32_bf16 v[84:87], a[164:167], v[236:239], v[84:87]
    v_cvt_pk_bf16_f32 v243, v234, v235
    s_mov_b32 s39, s44
    v_mfma_f32_16x16x32_bf16 v[88:91], a[168:171], v[236:239], v[88:91]
    buffer_load_dwordx4 v248, s[16:19], s33 offen offset:2048 nt lds
    v_mfma_f32_16x16x32_bf16 v[92:95], a[172:175], v[236:239], v[92:95]
    buffer_load_dwordx4 v249, s[16:19], s33 offen offset:3072 nt lds
    v_mfma_f32_16x16x32_bf16 a[184:187], a[204:207], v[236:239], a[184:187]
    s_add_u32 s64, s64, 8192
    s_xor_b32 s32, s64, s65
    v_mfma_f32_16x16x32_bf16 v[228:231], a[112:115], a[80:83], v[212:215]
    v_exp_f32 v220, v220
    v_mfma_f32_16x16x32_bf16 v[228:231], a[116:119], a[84:87], v[228:231]
    v_exp_f32 v221, v221
    v_mfma_f32_16x16x32_bf16 v[228:231], a[120:123], a[88:91], v[228:231]
    v_exp_f32 v222, v222
    v_mfma_f32_16x16x32_bf16 v[228:231], a[124:127], a[92:95], v[228:231]
    v_exp_f32 v223, v223
    v_mfma_f32_16x16x32_bf16 v[96:99], a[144:147], v[240:243], v[96:99]
    v_cvt_pk_bf16_f32 v236, v220, v221
    v_add_u32 v244, s34, v244
    v_mfma_f32_16x16x32_bf16 v[100:103], a[148:151], v[240:243], v[100:103]
    v_cvt_pk_bf16_f32 v237, v222, v223
    s_or_b32 s33, s32, 4096
    v_mfma_f32_16x16x32_bf16 v[104:107], a[152:155], v[240:243], v[104:107]
    s_add_u32 s29, s29, 32768
    v_mfma_f32_16x16x32_bf16 v[108:111], a[156:159], v[240:243], v[108:111]
    s_cmp_eq_u32 s29, 163840
    s_cselect_b32 s29, 0, s29
    v_mfma_f32_16x16x32_bf16 v[232:235], a[128:131], a[80:83], v[212:215]
    v_exp_f32 v224, v224
    v_mfma_f32_16x16x32_bf16 v[232:235], a[132:135], a[84:87], v[232:235]
    v_exp_f32 v225, v225
    v_mfma_f32_16x16x32_bf16 v[232:235], a[136:139], a[88:91], v[232:235]
    v_exp_f32 v226, v226
    v_mfma_f32_16x16x32_bf16 v[232:235], a[140:143], a[92:95], v[232:235]
    v_exp_f32 v227, v227
    v_mfma_f32_16x16x32_bf16 v[112:115], a[160:163], v[240:243], v[112:115]
    v_cvt_pk_bf16_f32 v238, v224, v225
    v_mfma_f32_16x16x32_bf16 v[116:119], a[164:167], v[240:243], v[116:119]
    v_cvt_pk_bf16_f32 v239, v226, v227
    v_mfma_f32_16x16x32_bf16 v[120:123], a[168:171], v[240:243], v[120:123]
    v_mfma_f32_16x16x32_bf16 v[124:127], a[172:175], v[240:243], v[124:127]
    v_mfma_f32_16x16x32_bf16 a[188:191], a[204:207], v[240:243], a[188:191]
    ds_read_b128 a[112:115], v244 offset:0
    ds_read_b128 a[116:119], v244 offset:256
    ds_read_b128 a[120:123], v244 offset:512
    ds_read_b128 a[124:127], v244 offset:768
    ds_read_b128 a[128:131], v244 offset:4096
    ds_read_b128 a[132:135], v244 offset:4352
    ds_read_b128 a[136:139], v244 offset:4608
    ds_read_b128 a[140:143], v244 offset:4864
    s_waitcnt lgkmcnt(0)
    v_mfma_f32_16x16x32_bf16 v[220:223], a[112:115], a[0:3], v[192:195]
    v_exp_f32 v228, v228
    v_mfma_f32_16x16x32_bf16 v[220:223], a[116:119], a[4:7], v[220:223]
    v_exp_f32 v229, v229
    v_mfma_f32_16x16x32_bf16 v[220:223], a[120:123], a[8:11], v[220:223]
    v_exp_f32 v230, v230
    v_mfma_f32_16x16x32_bf16 v[220:223], a[124:127], a[12:15], v[220:223]
    v_exp_f32 v231, v231
    v_mfma_f32_16x16x32_bf16 v[128:131], a[144:147], v[236:239], v[128:131]
    v_cvt_pk_bf16_f32 v240, v228, v229
    v_mfma_f32_16x16x32_bf16 v[132:135], a[148:151], v[236:239], v[132:135]
    v_cvt_pk_bf16_f32 v241, v230, v231
    v_mfma_f32_16x16x32_bf16 v[136:139], a[152:155], v[236:239], v[136:139]
    v_mfma_f32_16x16x32_bf16 v[140:143], a[156:159], v[236:239], v[140:143]
    v_mfma_f32_16x16x32_bf16 v[224:227], a[128:131], a[0:3], v[192:195]
    v_exp_f32 v232, v232
    v_mfma_f32_16x16x32_bf16 v[224:227], a[132:135], a[4:7], v[224:227]
    v_exp_f32 v233, v233
    v_mfma_f32_16x16x32_bf16 v[224:227], a[136:139], a[8:11], v[224:227]
    v_exp_f32 v234, v234
    v_mfma_f32_16x16x32_bf16 v[224:227], a[140:143], a[12:15], v[224:227]
    v_exp_f32 v235, v235
    v_mfma_f32_16x16x32_bf16 v[144:147], a[160:163], v[236:239], v[144:147]
    v_cvt_pk_bf16_f32 v242, v232, v233
    v_add_u32 v245, s34, v245
    v_mfma_f32_16x16x32_bf16 v[148:151], a[164:167], v[236:239], v[148:151]
    v_cvt_pk_bf16_f32 v243, v234, v235
    v_add_u32 v246, s34, v246
    v_mfma_f32_16x16x32_bf16 v[152:155], a[168:171], v[236:239], v[152:155]
    v_mfma_f32_16x16x32_bf16 v[156:159], a[172:175], v[236:239], v[156:159]
    v_mfma_f32_16x16x32_bf16 a[192:195], a[204:207], v[236:239], a[192:195]
    v_mfma_f32_16x16x32_bf16 v[228:231], a[112:115], a[16:19], v[196:199]
    v_exp_f32 v220, v220
    v_mfma_f32_16x16x32_bf16 v[228:231], a[116:119], a[20:23], v[228:231]
    v_exp_f32 v221, v221
    v_mfma_f32_16x16x32_bf16 v[228:231], a[120:123], a[24:27], v[228:231]
    v_exp_f32 v222, v222
    v_mfma_f32_16x16x32_bf16 v[228:231], a[124:127], a[28:31], v[228:231]
    v_exp_f32 v223, v223
    v_mfma_f32_16x16x32_bf16 v[160:163], a[144:147], v[240:243], v[160:163]
    v_cvt_pk_bf16_f32 v236, v220, v221
    v_mfma_f32_16x16x32_bf16 v[164:167], a[148:151], v[240:243], v[164:167]
    v_cvt_pk_bf16_f32 v237, v222, v223
    v_mfma_f32_16x16x32_bf16 v[168:171], a[152:155], v[240:243], v[168:171]
    v_mfma_f32_16x16x32_bf16 v[172:175], a[156:159], v[240:243], v[172:175]
    v_mfma_f32_16x16x32_bf16 v[232:235], a[128:131], a[16:19], v[196:199]
    v_exp_f32 v224, v224
    v_mfma_f32_16x16x32_bf16 v[232:235], a[132:135], a[20:23], v[232:235]
    v_exp_f32 v225, v225
    v_mfma_f32_16x16x32_bf16 v[232:235], a[136:139], a[24:27], v[232:235]
    v_exp_f32 v226, v226
    v_mfma_f32_16x16x32_bf16 v[232:235], a[140:143], a[28:31], v[232:235]
    v_exp_f32 v227, v227
    v_mfma_f32_16x16x32_bf16 v[176:179], a[160:163], v[240:243], v[176:179]
    v_cvt_pk_bf16_f32 v238, v224, v225
    v_mfma_f32_16x16x32_bf16 v[180:183], a[164:167], v[240:243], v[180:183]
    v_cvt_pk_bf16_f32 v239, v226, v227
    v_mfma_f32_16x16x32_bf16 v[184:187], a[168:171], v[240:243], v[184:187]
    v_mfma_f32_16x16x32_bf16 v[188:191], a[172:175], v[240:243], v[188:191]
    v_mfma_f32_16x16x32_bf16 a[196:199], a[204:207], v[240:243], a[196:199]
    v_mfma_f32_16x16x32_bf16 v[220:223], a[112:115], a[32:35], v[200:203]
    v_exp_f32 v228, v228
    v_mfma_f32_16x16x32_bf16 v[220:223], a[116:119], a[36:39], v[220:223]
    v_exp_f32 v229, v229
    v_mfma_f32_16x16x32_bf16 v[220:223], a[120:123], a[40:43], v[220:223]
    v_exp_f32 v230, v230
    v_mfma_f32_16x16x32_bf16 v[220:223], a[124:127], a[44:47], v[220:223]
    v_exp_f32 v231, v231
    ds_read_b64_tr_b16 a[144:145], v245 offset:0
    ds_read_b64_tr_b16 a[146:147], v245 offset:4096
    ds_read_b64_tr_b16 a[148:149], v246 offset:0
    ds_read_b64_tr_b16 a[150:151], v246 offset:4096
    ds_read_b64_tr_b16 a[152:153], v245 offset:256
    ds_read_b64_tr_b16 a[154:155], v245 offset:4352
    ds_read_b64_tr_b16 a[156:157], v246 offset:256
    ds_read_b64_tr_b16 a[158:159], v246 offset:4352
    ds_read_b64_tr_b16 a[160:161], v245 offset:512
    ds_read_b64_tr_b16 a[162:163], v245 offset:4608
    ds_read_b64_tr_b16 a[164:165], v246 offset:512
    ds_read_b64_tr_b16 a[166:167], v246 offset:4608
    ds_read_b64_tr_b16 a[168:169], v245 offset:768
    ds_read_b64_tr_b16 a[170:171], v245 offset:4864
    ds_read_b64_tr_b16 a[172:173], v246 offset:768
    ds_read_b64_tr_b16 a[174:175], v246 offset:4864
    s_waitcnt lgkmcnt(0)
    v_mfma_f32_16x16x32_bf16 v[0:3], a[144:147], v[236:239], v[0:3]
    v_cvt_pk_bf16_f32 v240, v228, v229
    v_mfma_f32_16x16x32_bf16 v[4:7], a[148:151], v[236:239], v[4:7]
    v_cvt_pk_bf16_f32 v241, v230, v231
    v_mfma_f32_16x16x32_bf16 v[8:11], a[152:155], v[236:239], v[8:11]
    v_mfma_f32_16x16x32_bf16 v[12:15], a[156:159], v[236:239], v[12:15]
    v_mfma_f32_16x16x32_bf16 v[224:227], a[128:131], a[32:35], v[200:203]
    v_exp_f32 v232, v232
    v_mfma_f32_16x16x32_bf16 v[224:227], a[132:135], a[36:39], v[224:227]
    v_exp_f32 v233, v233
    v_mfma_f32_16x16x32_bf16 v[224:227], a[136:139], a[40:43], v[224:227]
    v_exp_f32 v234, v234
    v_mfma_f32_16x16x32_bf16 v[224:227], a[140:143], a[44:47], v[224:227]
    v_exp_f32 v235, v235
    v_mfma_f32_16x16x32_bf16 v[16:19], a[160:163], v[236:239], v[16:19]
    v_cvt_pk_bf16_f32 v242, v232, v233
    v_mfma_f32_16x16x32_bf16 v[20:23], a[164:167], v[236:239], v[20:23]
    v_cvt_pk_bf16_f32 v243, v234, v235
    v_mfma_f32_16x16x32_bf16 v[24:27], a[168:171], v[236:239], v[24:27]
    v_mfma_f32_16x16x32_bf16 v[28:31], a[172:175], v[236:239], v[28:31]
    v_mfma_f32_16x16x32_bf16 a[176:179], a[204:207], v[236:239], a[176:179]
    s_waitcnt vmcnt(8)
    s_barrier
    v_mfma_f32_16x16x32_bf16 v[228:231], a[112:115], a[48:51], v[204:207]
    v_exp_f32 v220, v220
    v_mfma_f32_16x16x32_bf16 v[228:231], a[116:119], a[52:55], v[228:231]
    v_exp_f32 v221, v221
    v_mfma_f32_16x16x32_bf16 v[228:231], a[120:123], a[56:59], v[228:231]
    v_exp_f32 v222, v222
    v_mfma_f32_16x16x32_bf16 v[228:231], a[124:127], a[60:63], v[228:231]
    v_exp_f32 v223, v223
    v_mfma_f32_16x16x32_bf16 v[32:35], a[144:147], v[240:243], v[32:35]
    v_cvt_pk_bf16_f32 v236, v220, v221
    s_add_u32 m0, s37, s29
    v_mfma_f32_16x16x32_bf16 v[36:39], a[148:151], v[240:243], v[36:39]
    v_cvt_pk_bf16_f32 v237, v222, v223
    v_mfma_f32_16x16x32_bf16 v[40:43], a[152:155], v[240:243], v[40:43]
    buffer_load_dwordx4 v248, s[16:19], s32 offen offset:0 nt lds
    v_mfma_f32_16x16x32_bf16 v[44:47], a[156:159], v[240:243], v[44:47]
    buffer_load_dwordx4 v249, s[16:19], s32 offen offset:1024 nt lds
    v_mfma_f32_16x16x32_bf16 v[232:235], a[128:131], a[48:51], v[204:207]
    v_exp_f32 v224, v224
    v_mfma_f32_16x16x32_bf16 v[232:235], a[132:135], a[52:55], v[232:235]
    v_exp_f32 v225, v225
    v_mfma_f32_16x16x32_bf16 v[232:235], a[136:139], a[56:59], v[232:235]
    v_exp_f32 v226, v226
    v_mfma_f32_16x16x32_bf16 v[232:235], a[140:143], a[60:63], v[232:235]
    v_exp_f32 v227, v227
    v_mfma_f32_16x16x32_bf16 v[48:51], a[160:163], v[240:243], v[48:51]
    v_cvt_pk_bf16_f32 v238, v224, v225
    v_mfma_f32_16x16x32_bf16 v[52:55], a[164:167], v[240:243], v[52:55]
    v_cvt_pk_bf16_f32 v239, v226, v227
    v_mfma_f32_16x16x32_bf16 v[56:59], a[168:171], v[240:243], v[56:59]
    buffer_load_dwordx4 v248, s[16:19], s32 offen offset:2048 nt lds
    v_mfma_f32_16x16x32_bf16 v[60:63], a[172:175], v[240:243], v[60:63]
    buffer_load_dwordx4 v249, s[16:19], s32 offen offset:3072 nt lds
    s_add_u32 m0, m0, 4096
    v_mfma_f32_16x16x32_bf16 a[180:183], a[204:207], v[240:243], a[180:183]
    buffer_load_dwordx4 v248, s[16:19], s33 offen offset:0 nt lds
    v_mfma_f32_16x16x32_bf16 v[220:223], a[112:115], a[64:67], v[208:211]
    v_exp_f32 v228, v228
    v_mfma_f32_16x16x32_bf16 v[220:223], a[116:119], a[68:71], v[220:223]
    v_exp_f32 v229, v229
    v_mfma_f32_16x16x32_bf16 v[220:223], a[120:123], a[72:75], v[220:223]
    v_exp_f32 v230, v230
    v_mfma_f32_16x16x32_bf16 v[220:223], a[124:127], a[76:79], v[220:223]
    v_exp_f32 v231, v231
    v_mfma_f32_16x16x32_bf16 v[64:67], a[144:147], v[236:239], v[64:67]
    v_cvt_pk_bf16_f32 v240, v228, v229
    s_add_u32 s44, s39, 32768
    v_mfma_f32_16x16x32_bf16 v[68:71], a[148:151], v[236:239], v[68:71]
    v_cvt_pk_bf16_f32 v241, v230, v231
    v_mfma_f32_16x16x32_bf16 v[72:75], a[152:155], v[236:239], v[72:75]
    s_cmp_eq_u32 s44, 163840
    s_cselect_b32 s44, 0, s44
    v_mfma_f32_16x16x32_bf16 v[76:79], a[156:159], v[236:239], v[76:79]
    buffer_load_dwordx4 v249, s[16:19], s33 offen offset:1024 nt lds
    v_mfma_f32_16x16x32_bf16 v[224:227], a[128:131], a[64:67], v[208:211]
    v_exp_f32 v232, v232
    v_mfma_f32_16x16x32_bf16 v[224:227], a[132:135], a[68:71], v[224:227]
    v_exp_f32 v233, v233
    v_mfma_f32_16x16x32_bf16 v[224:227], a[136:139], a[72:75], v[224:227]
    v_exp_f32 v234, v234
    v_mfma_f32_16x16x32_bf16 v[224:227], a[140:143], a[76:79], v[224:227]
    v_exp_f32 v235, v235
    v_mfma_f32_16x16x32_bf16 v[80:83], a[160:163], v[236:239], v[80:83]
    v_cvt_pk_bf16_f32 v242, v232, v233
    s_sub_u32 s34, s44, s39
    v_mfma_f32_16x16x32_bf16 v[84:87], a[164:167], v[236:239], v[84:87]
    v_cvt_pk_bf16_f32 v243, v234, v235
    s_mov_b32 s39, s44
    v_mfma_f32_16x16x32_bf16 v[88:91], a[168:171], v[236:239], v[88:91]
    buffer_load_dwordx4 v248, s[16:19], s33 offen offset:2048 nt lds
    v_mfma_f32_16x16x32_bf16 v[92:95], a[172:175], v[236:239], v[92:95]
    buffer_load_dwordx4 v249, s[16:19], s33 offen offset:3072 nt lds
    v_mfma_f32_16x16x32_bf16 a[184:187], a[204:207], v[236:239], a[184:187]
    s_add_u32 s64, s64, 8192
    s_xor_b32 s32, s64, s65
    v_mfma_f32_16x16x32_bf16 v[228:231], a[112:115], a[80:83], v[212:215]
    v_exp_f32 v220, v220
    v_mfma_f32_16x16x32_bf16 v[228:231], a[116:119], a[84:87], v[228:231]
    v_exp_f32 v221, v221
    v_mfma_f32_16x16x32_bf16 v[228:231], a[120:123], a[88:91], v[228:231]
    v_exp_f32 v222, v222
    v_mfma_f32_16x16x32_bf16 v[228:231], a[124:127], a[92:95], v[228:231]
    v_exp_f32 v223, v223
    v_mfma_f32_16x16x32_bf16 v[96:99], a[144:147], v[240:243], v[96:99]
    v_cvt_pk_bf16_f32 v236, v220, v221
    v_add_u32 v244, s34, v244
    v_mfma_f32_16x16x32_bf16 v[100:103], a[148:151], v[240:243], v[100:103]
    v_cvt_pk_bf16_f32 v237, v222, v223
    s_or_b32 s33, s32, 4096
    v_mfma_f32_16x16x32_bf16 v[104:107], a[152:155], v[240:243], v[104:107]
    s_add_u32 s29, s29, 32768
    v_mfma_f32_16x16x32_bf16 v[108:111], a[156:159], v[240:243], v[108:111]
    s_cmp_eq_u32 s29, 163840
    s_cselect_b32 s29, 0, s29
    v_mfma_f32_16x16x32_bf16 v[232:235], a[128:131], a[80:83], v[212:215]
    v_exp_f32 v224, v224
    v_mfma_f32_16x16x32_bf16 v[232:235], a[132:135], a[84:87], v[232:235]
    v_exp_f32 v225, v225
    v_mfma_f32_16x16x32_bf16 v[232:235], a[136:139], a[88:91], v[232:235]
    v_exp_f32 v226, v226
    v_mfma_f32_16x16x32_bf16 v[232:235], a[140:143], a[92:95], v[232:235]
    v_exp_f32 v227, v227
    v_mfma_f32_16x16x32_bf16 v[112:115], a[160:163], v[240:243], v[112:115]
    v_cvt_pk_bf16_f32 v238, v224, v225
    v_mfma_f32_16x16x32_bf16 v[116:119], a[164:167], v[240:243], v[116:119]
    v_cvt_pk_bf16_f32 v239, v226, v227
    v_mfma_f32_16x16x32_bf16 v[120:123], a[168:171], v[240:243], v[120:123]
    v_mfma_f32_16x16x32_bf16 v[124:127], a[172:175], v[240:243], v[124:127]
    v_mfma_f32_16x16x32_bf16 a[188:191], a[204:207], v[240:243], a[188:191]
    s_sub_u32 s28, s28, 1
    s_cmp_lg_u32 s28, 0
    s_cbranch_scc1 L1_a1
    s_mov_b32 s28, 8
.p2align 6
L1_a1_1:
    ds_read_b128 a[112:115], v244 offset:0
    ds_read_b128 a[116:119], v244 offset:256
    ds_read_b128 a[120:123], v244 offset:512
    ds_read_b128 a[124:127], v244 offset:768
    ds_read_b128 a[128:131], v244 offset:4096
    ds_read_b128 a[132:135], v244 offset:4352
    ds_read_b128 a[136:139], v244 offset:4608
    ds_read_b128 a[140:143], v244 offset:4864
    s_waitcnt lgkmcnt(4)
    v_mfma_f32_16x16x32_bf16 v[220:223], a[112:115], a[0:3], v[192:195]
    v_exp_f32 v228, v228
    v_mfma_f32_16x16x32_bf16 v[220:223], a[116:119], a[4:7], v[220:223]
    v_exp_f32 v229, v229
    v_mfma_f32_16x16x32_bf16 v[220:223], a[120:123], a[8:11], v[220:223]
    v_exp_f32 v230, v230
    v_mfma_f32_16x16x32_bf16 v[220:223], a[124:127], a[12:15], v[220:223]
    v_exp_f32 v231, v231
    v_mfma_f32_16x16x32_bf16 v[128:131], a[144:147], v[236:239], v[128:131]
    v_cvt_pk_bf16_f32 v240, v228, v229
    v_mfma_f32_16x16x32_bf16 v[132:135], a[148:151], v[236:239], v[132:135]
    v_cvt_pk_bf16_f32 v241, v230, v231
    v_mfma_f32_16x16x32_bf16 v[136:139], a[152:155], v[236:239], v[136:139]
    v_mfma_f32_16x16x32_bf16 v[140:143], a[156:159], v[236:239], v[140:143]
    s_waitcnt lgkmcnt(0)
    v_mfma_f32_16x16x32_bf16 v[224:227], a[128:131], a[0:3], v[192:195]
    v_exp_f32 v232, v232
    v_mfma_f32_16x16x32_bf16 v[224:227], a[132:135], a[4:7], v[224:227]
    v_exp_f32 v233, v233
    v_mfma_f32_16x16x32_bf16 v[224:227], a[136:139], a[8:11], v[224:227]
    v_exp_f32 v234, v234
    v_mfma_f32_16x16x32_bf16 v[224:227], a[140:143], a[12:15], v[224:227]
    v_exp_f32 v235, v235
    v_mfma_f32_16x16x32_bf16 v[144:147], a[160:163], v[236:239], v[144:147]
    v_cvt_pk_bf16_f32 v242, v232, v233
    v_add_u32 v245, s34, v245
    v_mfma_f32_16x16x32_bf16 v[148:151], a[164:167], v[236:239], v[148:151]
    v_cvt_pk_bf16_f32 v243, v234, v235
    v_add_u32 v246, s34, v246
    v_mfma_f32_16x16x32_bf16 v[152:155], a[168:171], v[236:239], v[152:155]
    v_mfma_f32_16x16x32_bf16 v[156:159], a[172:175], v[236:239], v[156:159]
    v_mfma_f32_16x16x32_bf16 a[192:195], a[204:207], v[236:239], a[192:195]
    v_mfma_f32_16x16x32_bf16 v[228:231], a[112:115], a[16:19], v[196:199]
    v_exp_f32 v220, v220
    v_mfma_f32_16x16x32_bf16 v[228:231], a[116:119], a[20:23], v[228:231]
    v_exp_f32 v221, v221
    v_mfma_f32_16x16x32_bf16 v[228:231], a[120:123], a[24:27], v[228:231]
    v_exp_f32 v222, v222
    v_mfma_f32_16x16x32_bf16 v[228:231], a[124:127], a[28:31], v[228:231]
    v_exp_f32 v223, v223
    v_mfma_f32_16x16x32_bf16 v[160:163], a[144:147], v[240:243], v[160:163]
    v_cvt_pk_bf16_f32 v236, v220, v221
    ds_read_b64_tr_b16 a[144:145], v245 offset:0
    v_mfma_f32_16x16x32_bf16 v[164:167], a[148:151], v[240:243], v[164:167]
    v_cvt_pk_bf16_f32 v237, v222, v223
    ds_read_b64_tr_b16 a[146:147], v245 offset:4096
    v_mfma_f32_16x16x32_bf16 v[168:171], a[152:155], v[240:243], v[168:171]
    ds_read_b64_tr_b16 a[148:149], v246 offset:0
    ds_read_b64_tr_b16 a[150:151], v246 offset:4096
    v_mfma_f32_16x16x32_bf16 v[172:175], a[156:159], v[240:243], v[172:175]
    ds_read_b64_tr_b16 a[152:153], v245 offset:256
    ds_read_b64_tr_b16 a[154:155], v245 offset:4352
    v_mfma_f32_16x16x32_bf16 v[232:235], a[128:131], a[16:19], v[196:199]
    v_exp_f32 v224, v224
    v_mfma_f32_16x16x32_bf16 v[232:235], a[132:135], a[20:23], v[232:235]
    v_exp_f32 v225, v225
    v_mfma_f32_16x16x32_bf16 v[232:235], a[136:139], a[24:27], v[232:235]
    v_exp_f32 v226, v226
    v_mfma_f32_16x16x32_bf16 v[232:235], a[140:143], a[28:31], v[232:235]
    v_exp_f32 v227, v227
    v_mfma_f32_16x16x32_bf16 v[176:179], a[160:163], v[240:243], v[176:179]
    v_cvt_pk_bf16_f32 v238, v224, v225
    ds_read_b64_tr_b16 a[156:157], v246 offset:256
    v_mfma_f32_16x16x32_bf16 v[180:183], a[164:167], v[240:243], v[180:183]
    v_cvt_pk_bf16_f32 v239, v226, v227
    ds_read_b64_tr_b16 a[158:159], v246 offset:4352
    v_mfma_f32_16x16x32_bf16 v[184:187], a[168:171], v[240:243], v[184:187]
    ds_read_b64_tr_b16 a[160:161], v245 offset:512
    ds_read_b64_tr_b16 a[162:163], v245 offset:4608
    v_mfma_f32_16x16x32_bf16 v[188:191], a[172:175], v[240:243], v[188:191]
    ds_read_b64_tr_b16 a[164:165], v246 offset:512
    ds_read_b64_tr_b16 a[166:167], v246 offset:4608
    v_mfma_f32_16x16x32_bf16 a[196:199], a[204:207], v[240:243], a[196:199]
    ds_read_b64_tr_b16 a[168:169], v245 offset:768
    ds_read_b64_tr_b16 a[170:171], v245 offset:4864
    v_mfma_f32_16x16x32_bf16 v[220:223], a[112:115], a[32:35], v[200:203]
    v_exp_f32 v228, v228
    v_mfma_f32_16x16x32_bf16 v[220:223], a[116:119], a[36:39], v[220:223]
    v_exp_f32 v229, v229
    v_mfma_f32_16x16x32_bf16 v[220:223], a[120:123], a[40:43], v[220:223]
    v_exp_f32 v230, v230
    v_mfma_f32_16x16x32_bf16 v[220:223], a[124:127], a[44:47], v[220:223]
    v_exp_f32 v231, v231
    s_waitcnt lgkmcnt(6)
    v_mfma_f32_16x16x32_bf16 v[0:3], a[144:147], v[236:239], v[0:3]
    v_cvt_pk_bf16_f32 v240, v228, v229
    ds_read_b64_tr_b16 a[172:173], v246 offset:768
    v_mfma_f32_16x16x32_bf16 v[4:7], a[148:151], v[236:239], v[4:7]
    v_cvt_pk_bf16_f32 v241, v230, v231
    ds_read_b64_tr_b16 a[174:175], v246 offset:4864
    v_mfma_f32_16x16x32_bf16 v[8:11], a[152:155], v[236:239], v[8:11]
    v_mfma_f32_16x16x32_bf16 v[12:15], a[156:159], v[236:239], v[12:15]
    s_waitcnt lgkmcnt(2)
    v_mfma_f32_16x16x32_bf16 v[224:227], a[128:131], a[32:35], v[200:203]
    v_exp_f32 v232, v232
    v_mfma_f32_16x16x32_bf16 v[224:227], a[132:135], a[36:39], v[224:227]
    v_exp_f32 v233, v233
    v_mfma_f32_16x16x32_bf16 v[224:227], a[136:139], a[40:43], v[224:227]
    v_exp_f32 v234, v234
    v_mfma_f32_16x16x32_bf16 v[224:227], a[140:143], a[44:47], v[224:227]
    v_exp_f32 v235, v235
    v_mfma_f32_16x16x32_bf16 v[16:19], a[160:163], v[236:239], v[16:19]
    v_cvt_pk_bf16_f32 v242, v232, v233
    v_mfma_f32_16x16x32_bf16 v[20:23], a[164:167], v[236:239], v[20:23]
    v_cvt_pk_bf16_f32 v243, v234, v235
    v_mfma_f32_16x16x32_bf16 v[24:27], a[168:171], v[236:239], v[24:27]
    s_waitcnt lgkmcnt(0)
    v_mfma_f32_16x16x32_bf16 v[28:31], a[172:175], v[236:239], v[28:31]
    v_mfma_f32_16x16x32_bf16 a[176:179], a[204:207], v[236:239], a[176:179]
    s_waitcnt vmcnt(8)
    s_barrier
    v_mfma_f32_16x16x32_bf16 v[228:231], a[112:115], a[48:51], v[204:207]
    v_exp_f32 v220, v220
    v_mfma_f32_16x16x32_bf16 v[228:231], a[116:119], a[52:55], v[228:231]
    v_exp_f32 v221, v221
    v_mfma_f32_16x16x32_bf16 v[228:231], a[120:123], a[56:59], v[228:231]
    v_exp_f32 v222, v222
    v_mfma_f32_16x16x32_bf16 v[228:231], a[124:127], a[60:63], v[228:231]
    v_exp_f32 v223, v223
    v_mfma_f32_16x16x32_bf16 v[32:35], a[144:147], v[240:243], v[32:35]
    v_cvt_pk_bf16_f32 v236, v220, v221
    s_add_u32 m0, s37, s29
    v_mfma_f32_16x16x32_bf16 v[36:39], a[148:151], v[240:243], v[36:39]
    v_cvt_pk_bf16_f32 v237, v222, v223
    v_mfma_f32_16x16x32_bf16 v[40:43], a[152:155], v[240:243], v[40:43]
    buffer_load_dwordx4 v248, s[16:19], s32 offen offset:0 nt lds
    v_mfma_f32_16x16x32_bf16 v[44:47], a[156:159], v[240:243], v[44:47]
    buffer_load_dwordx4 v249, s[16:19], s32 offen offset:1024 nt lds
    v_mfma_f32_16x16x32_bf16 v[232:235], a[128:131], a[48:51], v[204:207]
    v_exp_f32 v224, v224
    v_mfma_f32_16x16x32_bf16 v[232:235], a[132:135], a[52:55], v[232:235]
    v_exp_f32 v225, v225
    v_mfma_f32_16x16x32_bf16 v[232:235], a[136:139], a[56:59], v[232:235]
    v_exp_f32 v226, v226
    v_mfma_f32_16x16x32_bf16 v[232:235], a[140:143], a[60:63], v[232:235]
    v_exp_f32 v227, v227
    v_mfma_f32_16x16x32_bf16 v[48:51], a[160:163], v[240:243], v[48:51]
    v_cvt_pk_bf16_f32 v238, v224, v225
    v_mfma_f32_16x16x32_bf16 v[52:55], a[164:167], v[240:243], v[52:55]
    v_cvt_pk_bf16_f32 v239, v226, v227
    v_mfma_f32_16x16x32_bf16 v[56:59], a[168:171], v[240:243], v[56:59]
    buffer_load_dwordx4 v248, s[16:19], s32 offen offset:2048 nt lds
    v_mfma_f32_16x16x32_bf16 v[60:63], a[172:175], v[240:243], v[60:63]
    buffer_load_dwordx4 v249, s[16:19], s32 offen offset:3072 nt lds
    s_add_u32 m0, m0, 4096
    v_mfma_f32_16x16x32_bf16 a[180:183], a[204:207], v[240:243], a[180:183]
    buffer_load_dwordx4 v248, s[16:19], s33 offen offset:0 nt lds
    v_mfma_f32_16x16x32_bf16 v[220:223], a[112:115], a[64:67], v[208:211]
    v_exp_f32 v228, v228
    v_mfma_f32_16x16x32_bf16 v[220:223], a[116:119], a[68:71], v[220:223]
    v_exp_f32 v229, v229
    v_mfma_f32_16x16x32_bf16 v[220:223], a[120:123], a[72:75], v[220:223]
    v_exp_f32 v230, v230
    v_mfma_f32_16x16x32_bf16 v[220:223], a[124:127], a[76:79], v[220:223]
    v_exp_f32 v231, v231
    v_mfma_f32_16x16x32_bf16 v[64:67], a[144:147], v[236:239], v[64:67]
    v_cvt_pk_bf16_f32 v240, v228, v229
    s_add_u32 s44, s39, 32768
    v_mfma_f32_16x16x32_bf16 v[68:71], a[148:151], v[236:239], v[68:71]
    v_cvt_pk_bf16_f32 v241, v230, v231
    v_mfma_f32_16x16x32_bf16 v[72:75], a[152:155], v[236:239], v[72:75]
    s_cmp_eq_u32 s44, 163840
    s_cselect_b32 s44, 0, s44
    v_mfma_f32_16x16x32_bf16 v[76:79], a[156:159], v[236:239], v[76:79]
    buffer_load_dwordx4 v249, s[16:19], s33 offen offset:1024 nt lds
    v_mfma_f32_16x16x32_bf16 v[224:227], a[128:131], a[64:67], v[208:211]
    v_exp_f32 v232, v232
    v_mfma_f32_16x16x32_bf16 v[224:227], a[132:135], a[68:71], v[224:227]
    v_exp_f32 v233, v233
    v_mfma_f32_16x16x32_bf16 v[224:227], a[136:139], a[72:75], v[224:227]
    v_exp_f32 v234, v234
    v_mfma_f32_16x16x32_bf16 v[224:227], a[140:143], a[76:79], v[224:227]
    v_exp_f32 v235, v235
    v_mfma_f32_16x16x32_bf16 v[80:83], a[160:163], v[236:239], v[80:83]
    v_cvt_pk_bf16_f32 v242, v232, v233
    s_sub_u32 s34, s44, s39
    v_mfma_f32_16x16x32_bf16 v[84:87], a[164:167], v[236:239], v[84:87]
    v_cvt_pk_bf16_f32 v243, v234, v235
    s_mov_b32 s39, s44
    v_mfma_f32_16x16x32_bf16 v[88:91], a[168:171], v[236:239], v[88:91]
    buffer_load_dwordx4 v248, s[16:19], s33 offen offset:2048 nt lds
    v_mfma_f32_16x16x32_bf16 v[92:95], a[172:175], v[236:239], v[92:95]
    buffer_load_dwordx4 v249, s[16:19], s33 offen offset:3072 nt lds
    v_mfma_f32_16x16x32_bf16 a[184:187], a[204:207], v[236:239], a[184:187]
    s_add_u32 s64, s64, 8192
    s_xor_b32 s32, s64, s65
    v_mfma_f32_16x16x32_bf16 v[228:231], a[112:115], a[80:83], v[212:215]
    v_exp_f32 v220, v220
    v_mfma_f32_16x16x32_bf16 v[228:231], a[116:119], a[84:87], v[228:231]
    v_exp_f32 v221, v221
    v_mfma_f32_16x16x32_bf16 v[228:231], a[120:123], a[88:91], v[228:231]
    v_exp_f32 v222, v222
    v_mfma_f32_16x16x32_bf16 v[228:231], a[124:127], a[92:95], v[228:231]
    v_exp_f32 v223, v223
    v_mfma_f32_16x16x32_bf16 v[96:99], a[144:147], v[240:243], v[96:99]
    v_cvt_pk_bf16_f32 v236, v220, v221
    v_add_u32 v244, s34, v244
    v_mfma_f32_16x16x32_bf16 v[100:103], a[148:151], v[240:243], v[100:103]
    v_cvt_pk_bf16_f32 v237, v222, v223
    s_or_b32 s33, s32, 4096
    v_mfma_f32_16x16x32_bf16 v[104:107], a[152:155], v[240:243], v[104:107]
    s_add_u32 s29, s29, 32768
    v_mfma_f32_16x16x32_bf16 v[108:111], a[156:159], v[240:243], v[108:111]
    s_cmp_eq_u32 s29, 163840
    s_cselect_b32 s29, 0, s29
    v_mfma_f32_16x16x32_bf16 v[232:235], a[128:131], a[80:83], v[212:215]
    v_exp_f32 v224, v224
    v_mfma_f32_16x16x32_bf16 v[232:235], a[132:135], a[84:87], v[232:235]
    v_exp_f32 v225, v225
    v_mfma_f32_16x16x32_bf16 v[232:235], a[136:139], a[88:91], v[232:235]
    v_exp_f32 v226, v226
    v_mfma_f32_16x16x32_bf16 v[232:235], a[140:143], a[92:95], v[232:235]
    v_exp_f32 v227, v227
    v_mfma_f32_16x16x32_bf16 v[112:115], a[160:163], v[240:243], v[112:115]
    v_cvt_pk_bf16_f32 v238, v224, v225
    v_mfma_f32_16x16x32_bf16 v[116:119], a[164:167], v[240:243], v[116:119]
    v_cvt_pk_bf16_f32 v239, v226, v227
    v_mfma_f32_16x16x32_bf16 v[120:123], a[168:171], v[240:243], v[120:123]
    v_mfma_f32_16x16x32_bf16 v[124:127], a[172:175], v[240:243], v[124:127]
    v_mfma_f32_16x16x32_bf16 a[188:191], a[204:207], v[240:243], a[188:191]
    ds_read_b128 a[112:115], v244 offset:0
    ds_read_b128 a[116:119], v244 offset:256
    ds_read_b128 a[120:123], v244 offset:512
    ds_read_b128 a[124:127], v244 offset:768
    ds_read_b128 a[128:131], v244 offset:4096
    ds_read_b128 a[132:135], v244 offset:4352
    ds_read_b128 a[136:139], v244 offset:4608
    ds_read_b128 a[140:143], v244 offset:4864
    s_waitcnt lgkmcnt(4)
    v_mfma_f32_16x16x32_bf16 v[220:223], a[112:115], a[0:3], v[192:195]
    v_exp_f32 v228, v228
    v_mfma_f32_16x16x32_bf16 v[220:223], a[116:119], a[4:7], v[220:223]
    v_exp_f32 v229, v229
    v_mfma_f32_16x16x32_bf16 v[220:223], a[120:123], a[8:11], v[220:223]
    v_exp_f32 v230, v230
    v_mfma_f32_16x16x32_bf16 v[220:223], a[124:127], a[12:15], v[220:223]
    v_exp_f32 v231, v231
    v_mfma_f32_16x16x32_bf16 v[128:131], a[144:147], v[236:239], v[128:131]
    v_cvt_pk_bf16_f32 v240, v228, v229
    v_mfma_f32_16x16x32_bf16 v[132:135], a[148:151], v[236:239], v[132:135]
    v_cvt_pk_bf16_f32 v241, v230, v231
    v_mfma_f32_16x16x32_bf16 v[136:139], a[152:155], v[236:239], v[136:139]
    v_mfma_f32_16x16x32_bf16 v[140:143], a[156:159], v[236:239], v[140:143]
    s_waitcnt lgkmcnt(0)
    v_mfma_f32_16x16x32_bf16 v[224:227], a[128:131], a[0:3], v[192:195]
    v_exp_f32 v232, v232
    v_mfma_f32_16x16x32_bf16 v[224:227], a[132:135], a[4:7], v[224:227]
    v_exp_f32 v233, v233
    v_mfma_f32_16x16x32_bf16 v[224:227], a[136:139], a[8:11], v[224:227]
    v_exp_f32 v234, v234
    v_mfma_f32_16x16x32_bf16 v[224:227], a[140:143], a[12:15], v[224:227]
    v_exp_f32 v235, v235
    v_mfma_f32_16x16x32_bf16 v[144:147], a[160:163], v[236:239], v[144:147]
    v_cvt_pk_bf16_f32 v242, v232, v233
    v_add_u32 v245, s34, v245
    v_mfma_f32_16x16x32_bf16 v[148:151], a[164:167], v[236:239], v[148:151]
    v_cvt_pk_bf16_f32 v243, v234, v235
    v_add_u32 v246, s34, v246
    v_mfma_f32_16x16x32_bf16 v[152:155], a[168:171], v[236:239], v[152:155]
    v_mfma_f32_16x16x32_bf16 v[156:159], a[172:175], v[236:239], v[156:159]
    v_mfma_f32_16x16x32_bf16 a[192:195], a[204:207], v[236:239], a[192:195]
    v_mfma_f32_16x16x32_bf16 v[228:231], a[112:115], a[16:19], v[196:199]
    v_exp_f32 v220, v220
    v_mfma_f32_16x16x32_bf16 v[228:231], a[116:119], a[20:23], v[228:231]
    v_exp_f32 v221, v221
    v_mfma_f32_16x16x32_bf16 v[228:231], a[120:123], a[24:27], v[228:231]
    v_exp_f32 v222, v222
    v_mfma_f32_16x16x32_bf16 v[228:231], a[124:127], a[28:31], v[228:231]
    v_exp_f32 v223, v223
    v_mfma_f32_16x16x32_bf16 v[160:163], a[144:147], v[240:243], v[160:163]
    v_cvt_pk_bf16_f32 v236, v220, v221
    ds_read_b64_tr_b16 a[144:145], v245 offset:0
    v_mfma_f32_16x16x32_bf16 v[164:167], a[148:151], v[240:243], v[164:167]
    v_cvt_pk_bf16_f32 v237, v222, v223
    ds_read_b64_tr_b16 a[146:147], v245 offset:4096
    v_mfma_f32_16x16x32_bf16 v[168:171], a[152:155], v[240:243], v[168:171]
    ds_read_b64_tr_b16 a[148:149], v246 offset:0
    ds_read_b64_tr_b16 a[150:151], v246 offset:4096
    v_mfma_f32_16x16x32_bf16 v[172:175], a[156:159], v[240:243], v[172:175]
    ds_read_b64_tr_b16 a[152:153], v245 offset:256
    ds_read_b64_tr_b16 a[154:155], v245 offset:4352
    v_mfma_f32_16x16x32_bf16 v[232:235], a[128:131], a[16:19], v[196:199]
    v_exp_f32 v224, v224
    v_mfma_f32_16x16x32_bf16 v[232:235], a[132:135], a[20:23], v[232:235]
    v_exp_f32 v225, v225
    v_mfma_f32_16x16x32_bf16 v[232:235], a[136:139], a[24:27], v[232:235]
    v_exp_f32 v226, v226
    v_mfma_f32_16x16x32_bf16 v[232:235], a[140:143], a[28:31], v[232:235]
    v_exp_f32 v227, v227
    v_mfma_f32_16x16x32_bf16 v[176:179], a[160:163], v[240:243], v[176:179]
    v_cvt_pk_bf16_f32 v238, v224, v225
    ds_read_b64_tr_b16 a[156:157], v246 offset:256
    v_mfma_f32_16x16x32_bf16 v[180:183], a[164:167], v[240:243], v[180:183]
    v_cvt_pk_bf16_f32 v239, v226, v227
    ds_read_b64_tr_b16 a[158:159], v246 offset:4352
    v_mfma_f32_16x16x32_bf16 v[184:187], a[168:171], v[240:243], v[184:187]
    ds_read_b64_tr_b16 a[160:161], v245 offset:512
    ds_read_b64_tr_b16 a[162:163], v245 offset:4608
    v_mfma_f32_16x16x32_bf16 v[188:191], a[172:175], v[240:243], v[188:191]
    ds_read_b64_tr_b16 a[164:165], v246 offset:512
    ds_read_b64_tr_b16 a[166:167], v246 offset:4608
    v_mfma_f32_16x16x32_bf16 a[196:199], a[204:207], v[240:243], a[196:199]
    ds_read_b64_tr_b16 a[168:169], v245 offset:768
    ds_read_b64_tr_b16 a[170:171], v245 offset:4864
    v_mfma_f32_16x16x32_bf16 v[220:223], a[112:115], a[32:35], v[200:203]
    v_exp_f32 v228, v228
    v_mfma_f32_16x16x32_bf16 v[220:223], a[116:119], a[36:39], v[220:223]
    v_exp_f32 v229, v229
    v_mfma_f32_16x16x32_bf16 v[220:223], a[120:123], a[40:43], v[220:223]
    v_exp_f32 v230, v230
    v_mfma_f32_16x16x32_bf16 v[220:223], a[124:127], a[44:47], v[220:223]
    v_exp_f32 v231, v231
    s_waitcnt lgkmcnt(6)
    v_mfma_f32_16x16x32_bf16 v[0:3], a[144:147], v[236:239], v[0:3]
    v_cvt_pk_bf16_f32 v240, v228, v229
    ds_read_b64_tr_b16 a[172:173], v246 offset:768
    v_mfma_f32_16x16x32_bf16 v[4:7], a[148:151], v[236:239], v[4:7]
    v_cvt_pk_bf16_f32 v241, v230, v231
    ds_read_b64_tr_b16 a[174:175], v246 offset:4864
    v_mfma_f32_16x16x32_bf16 v[8:11], a[152:155], v[236:239], v[8:11]
    v_mfma_f32_16x16x32_bf16 v[12:15], a[156:159], v[236:239], v[12:15]
    s_waitcnt lgkmcnt(2)
    v_mfma_f32_16x16x32_bf16 v[224:227], a[128:131], a[32:35], v[200:203]
    v_exp_f32 v232, v232
    v_mfma_f32_16x16x32_bf16 v[224:227], a[132:135], a[36:39], v[224:227]
    v_exp_f32 v233, v233
    v_mfma_f32_16x16x32_bf16 v[224:227], a[136:139], a[40:43], v[224:227]
    v_exp_f32 v234, v234
    v_mfma_f32_16x16x32_bf16 v[224:227], a[140:143], a[44:47], v[224:227]
    v_exp_f32 v235, v235
    v_mfma_f32_16x16x32_bf16 v[16:19], a[160:163], v[236:239], v[16:19]
    v_cvt_pk_bf16_f32 v242, v232, v233
    v_mfma_f32_16x16x32_bf16 v[20:23], a[164:167], v[236:239], v[20:23]
    v_cvt_pk_bf16_f32 v243, v234, v235
    v_mfma_f32_16x16x32_bf16 v[24:27], a[168:171], v[236:239], v[24:27]
    s_waitcnt lgkmcnt(0)
    v_mfma_f32_16x16x32_bf16 v[28:31], a[172:175], v[236:239], v[28:31]
    v_mfma_f32_16x16x32_bf16 a[176:179], a[204:207], v[236:239], a[176:179]
    s_waitcnt vmcnt(8)
    s_barrier
    v_mfma_f32_16x16x32_bf16 v[228:231], a[112:115], a[48:51], v[204:207]
    v_exp_f32 v220, v220
    v_mfma_f32_16x16x32_bf16 v[228:231], a[116:119], a[52:55], v[228:231]
    v_exp_f32 v221, v221
    v_mfma_f32_16x16x32_bf16 v[228:231], a[120:123], a[56:59], v[228:231]
    v_exp_f32 v222, v222
    v_mfma_f32_16x16x32_bf16 v[228:231], a[124:127], a[60:63], v[228:231]
    v_exp_f32 v223, v223
    v_mfma_f32_16x16x32_bf16 v[32:35], a[144:147], v[240:243], v[32:35]
    v_cvt_pk_bf16_f32 v236, v220, v221
    s_add_u32 m0, s37, s29
    v_mfma_f32_16x16x32_bf16 v[36:39], a[148:151], v[240:243], v[36:39]
    v_cvt_pk_bf16_f32 v237, v222, v223
    v_mfma_f32_16x16x32_bf16 v[40:43], a[152:155], v[240:243], v[40:43]
    buffer_load_dwordx4 v248, s[16:19], s32 offen offset:0 nt lds
    v_mfma_f32_16x16x32_bf16 v[44:47], a[156:159], v[240:243], v[44:47]
    buffer_load_dwordx4 v249, s[16:19], s32 offen offset:1024 nt lds
    v_mfma_f32_16x16x32_bf16 v[232:235], a[128:131], a[48:51], v[204:207]
    v_exp_f32 v224, v224
    v_mfma_f32_16x16x32_bf16 v[232:235], a[132:135], a[52:55], v[232:235]
    v_exp_f32 v225, v225
    v_mfma_f32_16x16x32_bf16 v[232:235], a[136:139], a[56:59], v[232:235]
    v_exp_f32 v226, v226
    v_mfma_f32_16x16x32_bf16 v[232:235], a[140:143], a[60:63], v[232:235]
    v_exp_f32 v227, v227
    v_mfma_f32_16x16x32_bf16 v[48:51], a[160:163], v[240:243], v[48:51]
    v_cvt_pk_bf16_f32 v238, v224, v225
    v_mfma_f32_16x16x32_bf16 v[52:55], a[164:167], v[240:243], v[52:55]
    v_cvt_pk_bf16_f32 v239, v226, v227
    v_mfma_f32_16x16x32_bf16 v[56:59], a[168:171], v[240:243], v[56:59]
    buffer_load_dwordx4 v248, s[16:19], s32 offen offset:2048 nt lds
    v_mfma_f32_16x16x32_bf16 v[60:63], a[172:175], v[240:243], v[60:63]
    buffer_load_dwordx4 v249, s[16:19], s32 offen offset:3072 nt lds
    s_add_u32 m0, m0, 4096
    v_mfma_f32_16x16x32_bf16 a[180:183], a[204:207], v[240:243], a[180:183]
    buffer_load_dwordx4 v248, s[16:19], s33 offen offset:0 nt lds
    v_mfma_f32_16x16x32_bf16 v[220:223], a[112:115], a[64:67], v[208:211]
    v_exp_f32 v228, v228
    v_mfma_f32_16x16x32_bf16 v[220:223], a[116:119], a[68:71], v[220:223]
    v_exp_f32 v229, v229
    v_mfma_f32_16x16x32_bf16 v[220:223], a[120:123], a[72:75], v[220:223]
    v_exp_f32 v230, v230
    v_mfma_f32_16x16x32_bf16 v[220:223], a[124:127], a[76:79], v[220:223]
    v_exp_f32 v231, v231
    v_mfma_f32_16x16x32_bf16 v[64:67], a[144:147], v[236:239], v[64:67]
    v_cvt_pk_bf16_f32 v240, v228, v229
    s_add_u32 s44, s39, 32768
    v_mfma_f32_16x16x32_bf16 v[68:71], a[148:151], v[236:239], v[68:71]
    v_cvt_pk_bf16_f32 v241, v230, v231
    v_mfma_f32_16x16x32_bf16 v[72:75], a[152:155], v[236:239], v[72:75]
    s_cmp_eq_u32 s44, 163840
    s_cselect_b32 s44, 0, s44
    v_mfma_f32_16x16x32_bf16 v[76:79], a[156:159], v[236:239], v[76:79]
    buffer_load_dwordx4 v249, s[16:19], s33 offen offset:1024 nt lds
    v_mfma_f32_16x16x32_bf16 v[224:227], a[128:131], a[64:67], v[208:211]
    v_exp_f32 v232, v232
    v_mfma_f32_16x16x32_bf16 v[224:227], a[132:135], a[68:71], v[224:227]
    v_exp_f32 v233, v233
    v_mfma_f32_16x16x32_bf16 v[224:227], a[136:139], a[72:75], v[224:227]
    v_exp_f32 v234, v234
    v_mfma_f32_16x16x32_bf16 v[224:227], a[140:143], a[76:79], v[224:227]
    v_exp_f32 v235, v235
    v_mfma_f32_16x16x32_bf16 v[80:83], a[160:163], v[236:239], v[80:83]
    v_cvt_pk_bf16_f32 v242, v232, v233
    s_sub_u32 s34, s44, s39
    v_mfma_f32_16x16x32_bf16 v[84:87], a[164:167], v[236:239], v[84:87]
    v_cvt_pk_bf16_f32 v243, v234, v235
    s_mov_b32 s39, s44
    v_mfma_f32_16x16x32_bf16 v[88:91], a[168:171], v[236:239], v[88:91]
    buffer_load_dwordx4 v248, s[16:19], s33 offen offset:2048 nt lds
    v_mfma_f32_16x16x32_bf16 v[92:95], a[172:175], v[236:239], v[92:95]
    buffer_load_dwordx4 v249, s[16:19], s33 offen offset:3072 nt lds
    v_mfma_f32_16x16x32_bf16 a[184:187], a[204:207], v[236:239], a[184:187]
    s_add_u32 s64, s64, 8192
    s_xor_b32 s32, s64, s65
    v_mfma_f32_16x16x32_bf16 v[228:231], a[112:115], a[80:83], v[212:215]
    v_exp_f32 v220, v220
    v_mfma_f32_16x16x32_bf16 v[228:231], a[116:119], a[84:87], v[228:231]
    v_exp_f32 v221, v221
    v_mfma_f32_16x16x32_bf16 v[228:231], a[120:123], a[88:91], v[228:231]
    v_exp_f32 v222, v222
    v_mfma_f32_16x16x32_bf16 v[228:231], a[124:127], a[92:95], v[228:231]
    v_exp_f32 v223, v223
    v_mfma_f32_16x16x32_bf16 v[96:99], a[144:147], v[240:243], v[96:99]
    v_cvt_pk_bf16_f32 v236, v220, v221
    v_add_u32 v244, s34, v244
    v_mfma_f32_16x16x32_bf16 v[100:103], a[148:151], v[240:243], v[100:103]
    v_cvt_pk_bf16_f32 v237, v222, v223
    s_or_b32 s33, s32, 4096
    v_mfma_f32_16x16x32_bf16 v[104:107], a[152:155], v[240:243], v[104:107]
    s_add_u32 s29, s29, 32768
    v_mfma_f32_16x16x32_bf16 v[108:111], a[156:159], v[240:243], v[108:111]
    s_cmp_eq_u32 s29, 163840
    s_cselect_b32 s29, 0, s29
    v_mfma_f32_16x16x32_bf16 v[232:235], a[128:131], a[80:83], v[212:215]
    v_exp_f32 v224, v224
    v_mfma_f32_16x16x32_bf16 v[232:235], a[132:135], a[84:87], v[232:235]
    v_exp_f32 v225, v225
    v_mfma_f32_16x16x32_bf16 v[232:235], a[136:139], a[88:91], v[232:235]
    v_exp_f32 v226, v226
    v_mfma_f32_16x16x32_bf16 v[232:235], a[140:143], a[92:95], v[232:235]
    v_exp_f32 v227, v227
    v_mfma_f32_16x16x32_bf16 v[112:115], a[160:163], v[240:243], v[112:115]
    v_cvt_pk_bf16_f32 v238, v224, v225
    v_mfma_f32_16x16x32_bf16 v[116:119], a[164:167], v[240:243], v[116:119]
    v_cvt_pk_bf16_f32 v239, v226, v227
    v_mfma_f32_16x16x32_bf16 v[120:123], a[168:171], v[240:243], v[120:123]
    v_mfma_f32_16x16x32_bf16 v[124:127], a[172:175], v[240:243], v[124:127]
    v_mfma_f32_16x16x32_bf16 a[188:191], a[204:207], v[240:243], a[188:191]
    s_sub_u32 s28, s28, 1
    s_cmp_lg_u32 s28, 0
    s_cbranch_scc1 L1_a1_1
    ds_read_b128 a[112:115], v244 offset:0
    ds_read_b128 a[116:119], v244 offset:256
    ds_read_b128 a[120:123], v244 offset:512
    ds_read_b128 a[124:127], v244 offset:768
    ds_read_b128 a[128:131], v244 offset:4096
    ds_read_b128 a[132:135], v244 offset:4352
    ds_read_b128 a[136:139], v244 offset:4608
    ds_read_b128 a[140:143], v244 offset:4864
    s_waitcnt lgkmcnt(4)
    v_mfma_f32_16x16x32_bf16 v[220:223], a[112:115], a[0:3], v[192:195]
    v_exp_f32 v228, v228
    v_mfma_f32_16x16x32_bf16 v[220:223], a[116:119], a[4:7], v[220:223]
    v_exp_f32 v229, v229
    v_mfma_f32_16x16x32_bf16 v[220:223], a[120:123], a[8:11], v[220:223]
    v_exp_f32 v230, v230
    v_mfma_f32_16x16x32_bf16 v[220:223], a[124:127], a[12:15], v[220:223]
    v_exp_f32 v231, v231
    v_mfma_f32_16x16x32_bf16 v[128:131], a[144:147], v[236:239], v[128:131]
    v_cvt_pk_bf16_f32 v240, v228, v229
    buffer_load_dword v255, v250, s[56:59], s55 offen
    v_mfma_f32_16x16x32_bf16 v[132:135], a[148:151], v[236:239], v[132:135]
    v_cvt_pk_bf16_f32 v241, v230, v231
    s_xor_b32 s54, s55, 32768
    v_mfma_f32_16x16x32_bf16 v[136:139], a[152:155], v[236:239], v[136:139]
    buffer_load_dword v255, v250, s[56:59], s54 offen
    v_lshlrev_b32 v253, 4, v247
    s_lshl_b32 s43, s27, 1
    v_mfma_f32_16x16x32_bf16 v[140:143], a[156:159], v[236:239], v[140:143]
    s_waitcnt lgkmcnt(0)
    s_add_u32 s43, s43, s25
    s_mul_i32 s43, s43, 53248
    v_mfma_f32_16x16x32_bf16 v[224:227], a[128:131], a[0:3], v[192:195]
    v_exp_f32 v232, v232
    v_mfma_f32_16x16x32_bf16 v[224:227], a[132:135], a[4:7], v[224:227]
    v_exp_f32 v233, v233
    v_mfma_f32_16x16x32_bf16 v[224:227], a[136:139], a[8:11], v[224:227]
    v_exp_f32 v234, v234
    v_mfma_f32_16x16x32_bf16 v[224:227], a[140:143], a[12:15], v[224:227]
    v_exp_f32 v235, v235
    v_mfma_f32_16x16x32_bf16 v[144:147], a[160:163], v[236:239], v[144:147]
    v_cvt_pk_bf16_f32 v242, v232, v233
    v_add_u32 v245, s34, v245
    v_mfma_f32_16x16x32_bf16 v[148:151], a[164:167], v[236:239], v[148:151]
    v_cvt_pk_bf16_f32 v243, v234, v235
    v_add_u32 v246, s34, v246
    v_mfma_f32_16x16x32_bf16 v[152:155], a[168:171], v[236:239], v[152:155]
    v_mfma_f32_16x16x32_bf16 v[156:159], a[172:175], v[236:239], v[156:159]
    v_mfma_f32_16x16x32_bf16 a[192:195], a[204:207], v[236:239], a[192:195]
    v_mfma_f32_16x16x32_bf16 v[228:231], a[112:115], a[16:19], v[196:199]
    v_exp_f32 v220, v220
    v_mfma_f32_16x16x32_bf16 v[228:231], a[116:119], a[20:23], v[228:231]
    v_exp_f32 v221, v221
    v_mfma_f32_16x16x32_bf16 v[228:231], a[120:123], a[24:27], v[228:231]
    v_exp_f32 v222, v222
    v_mfma_f32_16x16x32_bf16 v[228:231], a[124:127], a[28:31], v[228:231]
    v_exp_f32 v223, v223
    v_mfma_f32_16x16x32_bf16 v[160:163], a[144:147], v[240:243], v[160:163]
    v_cvt_pk_bf16_f32 v236, v220, v221
    ds_read_b64_tr_b16 a[144:145], v245 offset:0
    v_mfma_f32_16x16x32_bf16 v[164:167], a[148:151], v[240:243], v[164:167]
    v_cvt_pk_bf16_f32 v237, v222, v223
    ds_read_b64_tr_b16 a[146:147], v245 offset:4096
    v_mfma_f32_16x16x32_bf16 v[168:171], a[152:155], v[240:243], v[168:171]
    ds_read_b64_tr_b16 a[148:149], v246 offset:0
    ds_read_b64_tr_b16 a[150:151], v246 offset:4096
    v_mfma_f32_16x16x32_bf16 v[172:175], a[156:159], v[240:243], v[172:175]
    ds_read_b64_tr_b16 a[152:153], v245 offset:256
    ds_read_b64_tr_b16 a[154:155], v245 offset:4352
    v_mfma_f32_16x16x32_bf16 v[232:235], a[128:131], a[16:19], v[196:199]
    v_exp_f32 v224, v224
    v_mfma_f32_16x16x32_bf16 v[232:235], a[132:135], a[20:23], v[232:235]
    v_exp_f32 v225, v225
    v_mfma_f32_16x16x32_bf16 v[232:235], a[136:139], a[24:27], v[232:235]
    v_exp_f32 v226, v226
    v_mfma_f32_16x16x32_bf16 v[232:235], a[140:143], a[28:31], v[232:235]
    v_exp_f32 v227, v227
    v_mfma_f32_16x16x32_bf16 v[176:179], a[160:163], v[240:243], v[176:179]
    v_cvt_pk_bf16_f32 v238, v224, v225
    ds_read_b64_tr_b16 a[156:157], v246 offset:256
    v_mfma_f32_16x16x32_bf16 v[180:183], a[164:167], v[240:243], v[180:183]
    v_cvt_pk_bf16_f32 v239, v226, v227
    ds_read_b64_tr_b16 a[158:159], v246 offset:4352
    v_mfma_f32_16x16x32_bf16 v[184:187], a[168:171], v[240:243], v[184:187]
    ds_read_b64_tr_b16 a[160:161], v245 offset:512
    ds_read_b64_tr_b16 a[162:163], v245 offset:4608
    v_mfma_f32_16x16x32_bf16 v[188:191], a[172:175], v[240:243], v[188:191]
    ds_read_b64_tr_b16 a[164:165], v246 offset:512
    ds_read_b64_tr_b16 a[166:167], v246 offset:4608
    v_mfma_f32_16x16x32_bf16 a[196:199], a[204:207], v[240:243], a[196:199]
    ds_read_b64_tr_b16 a[168:169], v245 offset:768
    ds_read_b64_tr_b16 a[170:171], v245 offset:4864
    s_waitcnt vmcnt(2)
    s_barrier
    v_mfma_f32_16x16x32_bf16 v[220:223], a[112:115], a[32:35], v[200:203]
    v_exp_f32 v228, v228
    v_mfma_f32_16x16x32_bf16 v[220:223], a[116:119], a[36:39], v[220:223]
    v_exp_f32 v229, v229
    v_mfma_f32_16x16x32_bf16 v[220:223], a[120:123], a[40:43], v[220:223]
    v_exp_f32 v230, v230
    v_mfma_f32_16x16x32_bf16 v[220:223], a[124:127], a[44:47], v[220:223]
    v_exp_f32 v231, v231
    s_waitcnt lgkmcnt(6)
    v_mfma_f32_16x16x32_bf16 v[0:3], a[144:147], v[236:239], v[0:3]
    v_cvt_pk_bf16_f32 v240, v228, v229
    ds_read_b64_tr_b16 a[172:173], v246 offset:768
    v_add_u32 v244, 32768, v244
    v_mfma_f32_16x16x32_bf16 v[4:7], a[148:151], v[236:239], v[4:7]
    v_cvt_pk_bf16_f32 v241, v230, v231
    ds_read_b64_tr_b16 a[174:175], v246 offset:4864
    v_mfma_f32_16x16x32_bf16 v[8:11], a[152:155], v[236:239], v[8:11]
    ds_read_b128 a[112:115], v244 offset:0
    ds_read_b128 a[116:119], v244 offset:256
    v_mfma_f32_16x16x32_bf16 v[12:15], a[156:159], v[236:239], v[12:15]
    s_waitcnt lgkmcnt(2)
    ds_read_b128 a[120:123], v244 offset:512
    ds_read_b128 a[124:127], v244 offset:768
    v_mfma_f32_16x16x32_bf16 v[224:227], a[128:131], a[32:35], v[200:203]
    v_exp_f32 v232, v232
    v_mfma_f32_16x16x32_bf16 v[224:227], a[132:135], a[36:39], v[224:227]
    v_exp_f32 v233, v233
    v_mfma_f32_16x16x32_bf16 v[224:227], a[136:139], a[40:43], v[224:227]
    v_exp_f32 v234, v234
    v_mfma_f32_16x16x32_bf16 v[224:227], a[140:143], a[44:47], v[224:227]
    v_exp_f32 v235, v235
    v_mfma_f32_16x16x32_bf16 v[16:19], a[160:163], v[236:239], v[16:19]
    v_cvt_pk_bf16_f32 v242, v232, v233
    v_mfma_f32_16x16x32_bf16 v[20:23], a[164:167], v[236:239], v[20:23]
    v_cvt_pk_bf16_f32 v243, v234, v235
    v_mfma_f32_16x16x32_bf16 v[24:27], a[168:171], v[236:239], v[24:27]
    s_waitcnt lgkmcnt(0)
    ds_read_b128 a[128:131], v244 offset:4096
    ds_read_b128 a[132:135], v244 offset:4352
    v_mfma_f32_16x16x32_bf16 v[28:31], a[172:175], v[236:239], v[28:31]
    ds_read_b128 a[136:139], v244 offset:4608
    ds_read_b128 a[140:143], v244 offset:4864
    v_mfma_f32_16x16x32_bf16 a[176:179], a[204:207], v[236:239], a[176:179]
    v_mfma_f32_16x16x32_bf16 v[228:231], a[112:115], a[0:3], v[192:195]
    v_exp_f32 v220, v220
    v_mfma_f32_16x16x32_bf16 v[228:231], a[116:119], a[4:7], v[228:231]
    v_exp_f32 v221, v221
    v_mfma_f32_16x16x32_bf16 v[228:231], a[120:123], a[8:11], v[228:231]
    v_exp_f32 v222, v222
    v_mfma_f32_16x16x32_bf16 v[228:231], a[124:127], a[12:15], v[228:231]
    v_exp_f32 v223, v223
    v_mfma_f32_16x16x32_bf16 v[32:35], a[144:147], v[240:243], v[32:35]
    v_cvt_pk_bf16_f32 v236, v220, v221
    v_mfma_f32_16x16x32_bf16 v[36:39], a[148:151], v[240:243], v[36:39]
    v_cvt_pk_bf16_f32 v237, v222, v223
    v_mfma_f32_16x16x32_bf16 v[40:43], a[152:155], v[240:243], v[40:43]
    v_mfma_f32_16x16x32_bf16 v[44:47], a[156:159], v[240:243], v[44:47]
    s_waitcnt lgkmcnt(3)
    v_mfma_f32_16x16x32_bf16 v[232:235], a[128:131], a[0:3], v[192:195]
    v_exp_f32 v224, v224
    s_waitcnt lgkmcnt(2)
    v_mfma_f32_16x16x32_bf16 v[232:235], a[132:135], a[4:7], v[232:235]
    v_exp_f32 v225, v225
    s_waitcnt lgkmcnt(1)
    v_mfma_f32_16x16x32_bf16 v[232:235], a[136:139], a[8:11], v[232:235]
    v_exp_f32 v226, v226
    s_waitcnt lgkmcnt(0)
    v_mfma_f32_16x16x32_bf16 v[232:235], a[140:143], a[12:15], v[232:235]
    v_exp_f32 v227, v227
    v_mfma_f32_16x16x32_bf16 v[48:51], a[160:163], v[240:243], v[48:51]
    v_cvt_pk_bf16_f32 v238, v224, v225
    v_add_u32 v245, 32768, v245
    v_mfma_f32_16x16x32_bf16 v[52:55], a[164:167], v[240:243], v[52:55]
    v_cvt_pk_bf16_f32 v239, v226, v227
    v_add_u32 v246, 32768, v246
    v_mfma_f32_16x16x32_bf16 v[56:59], a[168:171], v[240:243], v[56:59]
    v_mfma_f32_16x16x32_bf16 v[60:63], a[172:175], v[240:243], v[60:63]
    v_mfma_f32_16x16x32_bf16 a[180:183], a[204:207], v[240:243], a[180:183]
    v_mfma_f32_16x16x32_bf16 v[220:223], a[112:115], a[16:19], v[196:199]
    v_exp_f32 v228, v228
    v_mfma_f32_16x16x32_bf16 v[220:223], a[116:119], a[20:23], v[220:223]
    v_exp_f32 v229, v229
    v_mfma_f32_16x16x32_bf16 v[220:223], a[120:123], a[24:27], v[220:223]
    v_exp_f32 v230, v230
    v_mfma_f32_16x16x32_bf16 v[220:223], a[124:127], a[28:31], v[220:223]
    v_exp_f32 v231, v231
    v_mfma_f32_16x16x32_bf16 v[64:67], a[144:147], v[236:239], v[64:67]
    v_cvt_pk_bf16_f32 v240, v228, v229
    ds_read_b64_tr_b16 a[144:145], v245 offset:0
    v_mfma_f32_16x16x32_bf16 v[68:71], a[148:151], v[236:239], v[68:71]
    v_cvt_pk_bf16_f32 v241, v230, v231
    ds_read_b64_tr_b16 a[146:147], v245 offset:4096
    v_mfma_f32_16x16x32_bf16 v[72:75], a[152:155], v[236:239], v[72:75]
    ds_read_b64_tr_b16 a[148:149], v246 offset:0
    ds_read_b64_tr_b16 a[150:151], v246 offset:4096
    v_mfma_f32_16x16x32_bf16 v[76:79], a[156:159], v[236:239], v[76:79]
    ds_read_b64_tr_b16 a[152:153], v245 offset:256
    ds_read_b64_tr_b16 a[154:155], v245 offset:4352
    v_mfma_f32_16x16x32_bf16 v[224:227], a[128:131], a[16:19], v[196:199]
    v_exp_f32 v232, v232
    v_mfma_f32_16x16x32_bf16 v[224:227], a[132:135], a[20:23], v[224:227]
    v_exp_f32 v233, v233
    v_mfma_f32_16x16x32_bf16 v[224:227], a[136:139], a[24:27], v[224:227]
    v_exp_f32 v234, v234
    v_mfma_f32_16x16x32_bf16 v[224:227], a[140:143], a[28:31], v[224:227]
    v_exp_f32 v235, v235
    v_mfma_f32_16x16x32_bf16 v[80:83], a[160:163], v[236:239], v[80:83]
    v_cvt_pk_bf16_f32 v242, v232, v233
    ds_read_b64_tr_b16 a[156:157], v246 offset:256
    v_mfma_f32_16x16x32_bf16 v[84:87], a[164:167], v[236:239], v[84:87]
    v_cvt_pk_bf16_f32 v243, v234, v235
    ds_read_b64_tr_b16 a[158:159], v246 offset:4352
    v_mfma_f32_16x16x32_bf16 v[88:91], a[168:171], v[236:239], v[88:91]
    ds_read_b64_tr_b16 a[160:161], v245 offset:512
    ds_read_b64_tr_b16 a[162:163], v245 offset:4608
    v_mfma_f32_16x16x32_bf16 v[92:95], a[172:175], v[236:239], v[92:95]
    ds_read_b64_tr_b16 a[164:165], v246 offset:512
    ds_read_b64_tr_b16 a[166:167], v246 offset:4608
    v_mfma_f32_16x16x32_bf16 a[184:187], a[204:207], v[236:239], a[184:187]
    ds_read_b64_tr_b16 a[168:169], v245 offset:768
    ds_read_b64_tr_b16 a[170:171], v245 offset:4864
    v_mfma_f32_16x16x32_bf16 v[228:231], a[112:115], a[32:35], v[200:203]
    v_exp_f32 v220, v220
    v_mfma_f32_16x16x32_bf16 v[228:231], a[116:119], a[36:39], v[228:231]
    v_exp_f32 v221, v221
    v_mfma_f32_16x16x32_bf16 v[228:231], a[120:123], a[40:43], v[228:231]
    v_exp_f32 v222, v222
    v_mfma_f32_16x16x32_bf16 v[228:231], a[124:127], a[44:47], v[228:231]
    v_exp_f32 v223, v223
    s_waitcnt lgkmcnt(12)
    v_mfma_f32_16x16x32_bf16 v[0:3], a[144:147], v[240:243], v[0:3]
    v_cvt_pk_bf16_f32 v236, v220, v221
    ds_read_b64_tr_b16 a[172:173], v246 offset:768
    v_subrev_u32 v244, 32768, v244
    s_waitcnt lgkmcnt(11)
    v_mfma_f32_16x16x32_bf16 v[4:7], a[148:151], v[240:243], v[4:7]
    v_cvt_pk_bf16_f32 v237, v222, v223
    ds_read_b64_tr_b16 a[174:175], v246 offset:4864
    s_waitcnt lgkmcnt(10)
    v_mfma_f32_16x16x32_bf16 v[8:11], a[152:155], v[240:243], v[8:11]
    ds_read_b128 a[112:115], v244 offset:0
    ds_read_b128 a[116:119], v244 offset:256
    s_waitcnt lgkmcnt(10)
    v_mfma_f32_16x16x32_bf16 v[12:15], a[156:159], v[240:243], v[12:15]
    ds_read_b128 a[120:123], v244 offset:512
    ds_read_b128 a[124:127], v244 offset:768
    v_mfma_f32_16x16x32_bf16 v[232:235], a[128:131], a[32:35], v[200:203]
    v_exp_f32 v224, v224
    v_mfma_f32_16x16x32_bf16 v[232:235], a[132:135], a[36:39], v[232:235]
    v_exp_f32 v225, v225
    v_mfma_f32_16x16x32_bf16 v[232:235], a[136:139], a[40:43], v[232:235]
    v_exp_f32 v226, v226
    v_mfma_f32_16x16x32_bf16 v[232:235], a[140:143], a[44:47], v[232:235]
    v_exp_f32 v227, v227
    s_waitcnt lgkmcnt(10)
    v_mfma_f32_16x16x32_bf16 v[16:19], a[160:163], v[240:243], v[16:19]
    v_cvt_pk_bf16_f32 v238, v224, v225
    s_waitcnt lgkmcnt(8)
    v_mfma_f32_16x16x32_bf16 v[20:23], a[164:167], v[240:243], v[20:23]
    v_cvt_pk_bf16_f32 v239, v226, v227
    s_waitcnt lgkmcnt(6)
    v_mfma_f32_16x16x32_bf16 v[24:27], a[168:171], v[240:243], v[24:27]
    ds_read_b128 a[128:131], v244 offset:4096
    ds_read_b128 a[132:135], v244 offset:4352
    s_waitcnt lgkmcnt(6)
    v_mfma_f32_16x16x32_bf16 v[28:31], a[172:175], v[240:243], v[28:31]
    ds_read_b128 a[136:139], v244 offset:4608
    ds_read_b128 a[140:143], v244 offset:4864
    v_mfma_f32_16x16x32_bf16 a[176:179], a[204:207], v[240:243], a[176:179]
    s_waitcnt lgkmcnt(7)
    v_mfma_f32_16x16x32_bf16 v[220:223], a[112:115], a[48:51], v[204:207]
    v_exp_f32 v228, v228
    s_nop 4
    v_accvgpr_read_b32 v194, a176
    s_waitcnt lgkmcnt(6)
    v_mfma_f32_16x16x32_bf16 v[220:223], a[116:119], a[52:55], v[220:223]
    v_exp_f32 v229, v229
    v_rcp_f32 v192, v194
    s_waitcnt lgkmcnt(5)
    v_mfma_f32_16x16x32_bf16 v[220:223], a[120:123], a[56:59], v[220:223]
    v_exp_f32 v230, v230
    v_mov_b32 v254, v194
    s_waitcnt lgkmcnt(4)
    v_mfma_f32_16x16x32_bf16 v[220:223], a[124:127], a[60:63], v[220:223]
    v_exp_f32 v231, v231
    v_mul_f32 v0, v0, v192
    v_mfma_f32_16x16x32_bf16 v[32:35], a[144:147], v[236:239], v[32:35]
    v_cvt_pk_bf16_f32 v240, v228, v229
    v_mul_f32 v1, v1, v192
    v_mul_f32 v2, v2, v192
    v_mfma_f32_16x16x32_bf16 v[36:39], a[148:151], v[236:239], v[36:39]
    v_cvt_pk_bf16_f32 v241, v230, v231
    v_mul_f32 v3, v3, v192
    v_mul_f32 v4, v4, v192
    v_mfma_f32_16x16x32_bf16 v[40:43], a[152:155], v[236:239], v[40:43]
    v_mul_f32 v5, v5, v192
    v_mul_f32 v6, v6, v192
    v_mul_f32 v7, v7, v192
    v_mfma_f32_16x16x32_bf16 v[44:47], a[156:159], v[236:239], v[44:47]
    v_cvt_pk_bf16_f32 v0, v0, v1
    v_cvt_pk_bf16_f32 v1, v2, v3
    v_cvt_pk_bf16_f32 v2, v4, v5
    s_waitcnt lgkmcnt(3)
    v_mfma_f32_16x16x32_bf16 v[224:227], a[128:131], a[48:51], v[204:207]
    v_exp_f32 v232, v232
    v_cvt_pk_bf16_f32 v3, v6, v7
    s_waitcnt lgkmcnt(2)
    v_mfma_f32_16x16x32_bf16 v[224:227], a[132:135], a[52:55], v[224:227]
    v_exp_f32 v233, v233
    s_add_u32 s45, s43, 6144
    s_waitcnt lgkmcnt(1)
    v_mfma_f32_16x16x32_bf16 v[224:227], a[136:139], a[56:59], v[224:227]
    v_exp_f32 v234, v234
    buffer_store_dwordx4 v[0:3], v253, s[20:23], s45 offen sc1
    s_waitcnt lgkmcnt(0)
    v_mfma_f32_16x16x32_bf16 v[224:227], a[140:143], a[60:63], v[224:227]
    v_exp_f32 v235, v235
    v_mul_f32 v8, v8, v192
    v_mfma_f32_16x16x32_bf16 v[48:51], a[160:163], v[236:239], v[48:51]
    v_cvt_pk_bf16_f32 v242, v232, v233
    v_subrev_u32 v245, 32768, v245
    v_mul_f32 v9, v9, v192
    v_mfma_f32_16x16x32_bf16 v[52:55], a[164:167], v[236:239], v[52:55]
    v_cvt_pk_bf16_f32 v243, v234, v235
    v_subrev_u32 v246, 32768, v246
    v_mul_f32 v10, v10, v192
    v_mfma_f32_16x16x32_bf16 v[56:59], a[168:171], v[236:239], v[56:59]
    v_mul_f32 v11, v11, v192
    v_mul_f32 v12, v12, v192
    v_mul_f32 v13, v13, v192
    v_mfma_f32_16x16x32_bf16 v[60:63], a[172:175], v[236:239], v[60:63]
    v_mul_f32 v14, v14, v192
    v_mul_f32 v15, v15, v192
    v_cvt_pk_bf16_f32 v8, v8, v9
    v_mfma_f32_16x16x32_bf16 a[180:183], a[204:207], v[236:239], a[180:183]
    v_cvt_pk_bf16_f32 v9, v10, v11
    v_cvt_pk_bf16_f32 v10, v12, v13
    v_cvt_pk_bf16_f32 v11, v14, v15
    v_mfma_f32_16x16x32_bf16 v[228:231], a[112:115], a[64:67], v[208:211]
    v_exp_f32 v220, v220
    s_add_u32 s45, s43, 19456
    v_mfma_f32_16x16x32_bf16 v[228:231], a[116:119], a[68:71], v[228:231]
    v_exp_f32 v221, v221
    buffer_store_dwordx4 v[8:11], v253, s[20:23], s45 offen sc1
    v_mfma_f32_16x16x32_bf16 v[228:231], a[120:123], a[72:75], v[228:231]
    v_exp_f32 v222, v222
    v_mul_f32 v16, v16, v192
    v_mfma_f32_16x16x32_bf16 v[228:231], a[124:127], a[76:79], v[228:231]
    v_exp_f32 v223, v223
    v_mul_f32 v17, v17, v192
    v_mfma_f32_16x16x32_bf16 v[64:67], a[144:147], v[240:243], v[64:67]
    v_cvt_pk_bf16_f32 v236, v220, v221
    ds_read_b64_tr_b16 a[144:145], v245 offset:0
    v_mul_f32 v18, v18, v192
    v_mfma_f32_16x16x32_bf16 v[68:71], a[148:151], v[240:243], v[68:71]
    v_cvt_pk_bf16_f32 v237, v222, v223
    ds_read_b64_tr_b16 a[146:147], v245 offset:4096
    v_mul_f32 v19, v19, v192
    v_mfma_f32_16x16x32_bf16 v[72:75], a[152:155], v[240:243], v[72:75]
    ds_read_b64_tr_b16 a[148:149], v246 offset:0
    ds_read_b64_tr_b16 a[150:151], v246 offset:4096
    v_mul_f32 v20, v20, v192
    v_mfma_f32_16x16x32_bf16 v[76:79], a[156:159], v[240:243], v[76:79]
    ds_read_b64_tr_b16 a[152:153], v245 offset:256
    ds_read_b64_tr_b16 a[154:155], v245 offset:4352
    v_mul_f32 v21, v21, v192
    v_mfma_f32_16x16x32_bf16 v[232:235], a[128:131], a[64:67], v[208:211]
    v_exp_f32 v224, v224
    v_mul_f32 v22, v22, v192
    v_mfma_f32_16x16x32_bf16 v[232:235], a[132:135], a[68:71], v[232:235]
    v_exp_f32 v225, v225
    v_mul_f32 v23, v23, v192
    v_mfma_f32_16x16x32_bf16 v[232:235], a[136:139], a[72:75], v[232:235]
    v_exp_f32 v226, v226
    v_cvt_pk_bf16_f32 v16, v16, v17
    v_mfma_f32_16x16x32_bf16 v[232:235], a[140:143], a[76:79], v[232:235]
    v_exp_f32 v227, v227
    v_cvt_pk_bf16_f32 v17, v18, v19
    v_mfma_f32_16x16x32_bf16 v[80:83], a[160:163], v[240:243], v[80:83]
    v_cvt_pk_bf16_f32 v238, v224, v225
    ds_read_b64_tr_b16 a[156:157], v246 offset:256
    v_cvt_pk_bf16_f32 v18, v20, v21
    v_mfma_f32_16x16x32_bf16 v[84:87], a[164:167], v[240:243], v[84:87]
    v_cvt_pk_bf16_f32 v239, v226, v227
    ds_read_b64_tr_b16 a[158:159], v246 offset:4352
    v_cvt_pk_bf16_f32 v19, v22, v23
    v_mfma_f32_16x16x32_bf16 v[88:91], a[168:171], v[240:243], v[88:91]
    ds_read_b64_tr_b16 a[160:161], v245 offset:512
    ds_read_b64_tr_b16 a[162:163], v245 offset:4608
    s_add_u32 s45, s43, 32768
    v_mfma_f32_16x16x32_bf16 v[92:95], a[172:175], v[240:243], v[92:95]
    ds_read_b64_tr_b16 a[164:165], v246 offset:512
    ds_read_b64_tr_b16 a[166:167], v246 offset:4608
    buffer_store_dwordx4 v[16:19], v253, s[20:23], s45 offen sc1
    v_mfma_f32_16x16x32_bf16 a[184:187], a[204:207], v[240:243], a[184:187]
    ds_read_b64_tr_b16 a[168:169], v245 offset:768
    ds_read_b64_tr_b16 a[170:171], v245 offset:4864
    v_mul_f32 v24, v24, v192
    v_mfma_f32_16x16x32_bf16 v[220:223], a[112:115], a[80:83], v[212:215]
    v_exp_f32 v228, v228
    v_mul_f32 v25, v25, v192
    v_mfma_f32_16x16x32_bf16 v[220:223], a[116:119], a[84:87], v[220:223]
    v_exp_f32 v229, v229
    v_mul_f32 v26, v26, v192
    v_mfma_f32_16x16x32_bf16 v[220:223], a[120:123], a[88:91], v[220:223]
    v_exp_f32 v230, v230
    v_mul_f32 v27, v27, v192
    v_mfma_f32_16x16x32_bf16 v[220:223], a[124:127], a[92:95], v[220:223]
    v_exp_f32 v231, v231
    v_mul_f32 v28, v28, v192
    s_waitcnt lgkmcnt(12)
    v_mfma_f32_16x16x32_bf16 v[96:99], a[144:147], v[236:239], v[96:99]
    v_cvt_pk_bf16_f32 v240, v228, v229
    ds_read_b64_tr_b16 a[172:173], v246 offset:768
    v_add_u32 v244, 32768, v244
    v_mul_f32 v29, v29, v192
    s_waitcnt lgkmcnt(11)
    v_mfma_f32_16x16x32_bf16 v[100:103], a[148:151], v[236:239], v[100:103]
    v_cvt_pk_bf16_f32 v241, v230, v231
    ds_read_b64_tr_b16 a[174:175], v246 offset:4864
    v_mul_f32 v30, v30, v192
    s_waitcnt lgkmcnt(10)
    v_mfma_f32_16x16x32_bf16 v[104:107], a[152:155], v[236:239], v[104:107]
    ds_read_b128 a[112:115], v244 offset:0
    ds_read_b128 a[116:119], v244 offset:256
    v_mul_f32 v31, v31, v192
    s_waitcnt lgkmcnt(10)
    v_mfma_f32_16x16x32_bf16 v[108:111], a[156:159], v[236:239], v[108:111]
    ds_read_b128 a[120:123], v244 offset:512
    ds_read_b128 a[124:127], v244 offset:768
    v_cvt_pk_bf16_f32 v24, v24, v25
    v_mfma_f32_16x16x32_bf16 v[224:227], a[128:131], a[80:83], v[212:215]
    v_exp_f32 v232, v232
    v_cvt_pk_bf16_f32 v25, v26, v27
    v_mfma_f32_16x16x32_bf16 v[224:227], a[132:135], a[84:87], v[224:227]
    v_exp_f32 v233, v233
    v_cvt_pk_bf16_f32 v26, v28, v29
    v_mfma_f32_16x16x32_bf16 v[224:227], a[136:139], a[88:91], v[224:227]
    v_exp_f32 v234, v234
    v_cvt_pk_bf16_f32 v27, v30, v31
    v_mfma_f32_16x16x32_bf16 v[224:227], a[140:143], a[92:95], v[224:227]
    v_exp_f32 v235, v235
    s_add_u32 s45, s43, 46080
    s_waitcnt lgkmcnt(10)
    v_mfma_f32_16x16x32_bf16 v[112:115], a[160:163], v[236:239], v[112:115]
    v_cvt_pk_bf16_f32 v242, v232, v233
    buffer_store_dwordx4 v[24:27], v253, s[20:23], s45 offen sc1
    s_waitcnt lgkmcnt(8)
    v_mfma_f32_16x16x32_bf16 v[116:119], a[164:167], v[236:239], v[116:119]
    v_cvt_pk_bf16_f32 v243, v234, v235
    v_accvgpr_read_b32 v198, a180
    v_rcp_f32 v196, v198
    s_waitcnt lgkmcnt(6)
    v_mfma_f32_16x16x32_bf16 v[120:123], a[168:171], v[236:239], v[120:123]
    ds_read_b128 a[128:131], v244 offset:4096
    ds_read_b128 a[132:135], v244 offset:4352
    v_add_f32 v254, v254, v198
    s_waitcnt lgkmcnt(6)
    v_mfma_f32_16x16x32_bf16 v[124:127], a[172:175], v[236:239], v[124:127]
    ds_read_b128 a[136:139], v244 offset:4608
    ds_read_b128 a[140:143], v244 offset:4864
    v_mul_f32 v32, v32, v196
    v_mfma_f32_16x16x32_bf16 a[188:191], a[204:207], v[236:239], a[188:191]
    v_mul_f32 v33, v33, v196
    v_mul_f32 v34, v34, v196
    v_mul_f32 v35, v35, v196
    s_waitcnt lgkmcnt(7)
    v_mfma_f32_16x16x32_bf16 v[228:231], a[112:115], a[48:51], v[204:207]
    v_exp_f32 v220, v220
    v_mul_f32 v36, v36, v196
    s_waitcnt lgkmcnt(6)
    v_mfma_f32_16x16x32_bf16 v[228:231], a[116:119], a[52:55], v[228:231]
    v_exp_f32 v221, v221
    v_mul_f32 v37, v37, v196
    s_waitcnt lgkmcnt(5)
    v_mfma_f32_16x16x32_bf16 v[228:231], a[120:123], a[56:59], v[228:231]
    v_exp_f32 v222, v222
    v_mul_f32 v38, v38, v196
    s_waitcnt lgkmcnt(4)
    v_mfma_f32_16x16x32_bf16 v[228:231], a[124:127], a[60:63], v[228:231]
    v_exp_f32 v223, v223
    v_mul_f32 v39, v39, v196
    v_mfma_f32_16x16x32_bf16 v[128:131], a[144:147], v[240:243], v[128:131]
    v_cvt_pk_bf16_f32 v236, v220, v221
    v_cvt_pk_bf16_f32 v32, v32, v33
    v_cvt_pk_bf16_f32 v33, v34, v35
    v_mfma_f32_16x16x32_bf16 v[132:135], a[148:151], v[240:243], v[132:135]
    v_cvt_pk_bf16_f32 v237, v222, v223
    v_cvt_pk_bf16_f32 v34, v36, v37
    v_cvt_pk_bf16_f32 v35, v38, v39
    v_mfma_f32_16x16x32_bf16 v[136:139], a[152:155], v[240:243], v[136:139]
    s_add_u32 s45, s43, 7168
    buffer_store_dwordx4 v[32:35], v253, s[20:23], s45 offen sc1
    v_mul_f32 v40, v40, v196
    v_mfma_f32_16x16x32_bf16 v[140:143], a[156:159], v[240:243], v[140:143]
    v_mul_f32 v41, v41, v196
    v_mul_f32 v42, v42, v196
    v_mul_f32 v43, v43, v196
    s_waitcnt lgkmcnt(3)
    v_mfma_f32_16x16x32_bf16 v[232:235], a[128:131], a[48:51], v[204:207]
    v_exp_f32 v224, v224
    v_mul_f32 v44, v44, v196
    s_waitcnt lgkmcnt(2)
    v_mfma_f32_16x16x32_bf16 v[232:235], a[132:135], a[52:55], v[232:235]
    v_exp_f32 v225, v225
    v_mul_f32 v45, v45, v196
    s_waitcnt lgkmcnt(1)
    v_mfma_f32_16x16x32_bf16 v[232:235], a[136:139], a[56:59], v[232:235]
    v_exp_f32 v226, v226
    v_mul_f32 v46, v46, v196
    s_waitcnt lgkmcnt(0)
    v_mfma_f32_16x16x32_bf16 v[232:235], a[140:143], a[60:63], v[232:235]
    v_exp_f32 v227, v227
    v_mul_f32 v47, v47, v196
    v_mfma_f32_16x16x32_bf16 v[144:147], a[160:163], v[240:243], v[144:147]
    v_cvt_pk_bf16_f32 v238, v224, v225
    v_add_u32 v245, 32768, v245
    v_cvt_pk_bf16_f32 v40, v40, v41
    v_mfma_f32_16x16x32_bf16 v[148:151], a[164:167], v[240:243], v[148:151]
    v_cvt_pk_bf16_f32 v239, v226, v227
    v_add_u32 v246, 32768, v246
    v_cvt_pk_bf16_f32 v41, v42, v43
    v_mfma_f32_16x16x32_bf16 v[152:155], a[168:171], v[240:243], v[152:155]
    v_cvt_pk_bf16_f32 v42, v44, v45
    v_cvt_pk_bf16_f32 v43, v46, v47
    s_add_u32 s45, s43, 20480
    v_mfma_f32_16x16x32_bf16 v[156:159], a[172:175], v[240:243], v[156:159]
    buffer_store_dwordx4 v[40:43], v253, s[20:23], s45 offen sc1
    v_mul_f32 v48, v48, v196
    v_mul_f32 v49, v49, v196
    v_mfma_f32_16x16x32_bf16 a[192:195], a[204:207], v[240:243], a[192:195]
    v_mul_f32 v50, v50, v196
    v_mul_f32 v51, v51, v196
    v_mul_f32 v52, v52, v196
    v_mfma_f32_16x16x32_bf16 v[220:223], a[112:115], a[64:67], v[208:211]
    v_exp_f32 v228, v228
    v_mul_f32 v53, v53, v196
    v_mfma_f32_16x16x32_bf16 v[220:223], a[116:119], a[68:71], v[220:223]
    v_exp_f32 v229, v229
    v_mul_f32 v54, v54, v196
    v_mfma_f32_16x16x32_bf16 v[220:223], a[120:123], a[72:75], v[220:223]
    v_exp_f32 v230, v230
    v_mul_f32 v55, v55, v196
    v_mfma_f32_16x16x32_bf16 v[220:223], a[124:127], a[76:79], v[220:223]
    v_exp_f32 v231, v231
    v_cvt_pk_bf16_f32 v48, v48, v49
    v_mfma_f32_16x16x32_bf16 v[160:163], a[144:147], v[236:239], v[160:163]
    v_cvt_pk_bf16_f32 v240, v228, v229
    ds_read_b64_tr_b16 a[144:145], v245 offset:0
    v_cvt_pk_bf16_f32 v49, v50, v51
    v_mfma_f32_16x16x32_bf16 v[164:167], a[148:151], v[236:239], v[164:167]
    v_cvt_pk_bf16_f32 v241, v230, v231
    ds_read_b64_tr_b16 a[146:147], v245 offset:4096
    v_cvt_pk_bf16_f32 v50, v52, v53
    v_mfma_f32_16x16x32_bf16 v[168:171], a[152:155], v[236:239], v[168:171]
    ds_read_b64_tr_b16 a[148:149], v246 offset:0
    ds_read_b64_tr_b16 a[150:151], v246 offset:4096
    v_cvt_pk_bf16_f32 v51, v54, v55
    v_mfma_f32_16x16x32_bf16 v[172:175], a[156:159], v[236:239], v[172:175]
    ds_read_b64_tr_b16 a[152:153], v245 offset:256
    ds_read_b64_tr_b16 a[154:155], v245 offset:4352
    s_add_u32 s45, s43, 33792
    v_mfma_f32_16x16x32_bf16 v[224:227], a[128:131], a[64:67], v[208:211]
    v_exp_f32 v232, v232
    buffer_store_dwordx4 v[48:51], v253, s[20:23], s45 offen sc1
    v_mfma_f32_16x16x32_bf16 v[224:227], a[132:135], a[68:71], v[224:227]
    v_exp_f32 v233, v233
    v_mul_f32 v56, v56, v196
    v_mfma_f32_16x16x32_bf16 v[224:227], a[136:139], a[72:75], v[224:227]
    v_exp_f32 v234, v234
    v_mul_f32 v57, v57, v196
    v_mfma_f32_16x16x32_bf16 v[224:227], a[140:143], a[76:79], v[224:227]
    v_exp_f32 v235, v235
    v_mul_f32 v58, v58, v196
    v_mfma_f32_16x16x32_bf16 v[176:179], a[160:163], v[236:239], v[176:179]
    v_cvt_pk_bf16_f32 v242, v232, v233
    ds_read_b64_tr_b16 a[156:157], v246 offset:256
    v_mul_f32 v59, v59, v196
    v_mfma_f32_16x16x32_bf16 v[180:183], a[164:167], v[236:239], v[180:183]
    v_cvt_pk_bf16_f32 v243, v234, v235
    ds_read_b64_tr_b16 a[158:159], v246 offset:4352
    v_mul_f32 v60, v60, v196
    v_mfma_f32_16x16x32_bf16 v[184:187], a[168:171], v[236:239], v[184:187]
    ds_read_b64_tr_b16 a[160:161], v245 offset:512
    ds_read_b64_tr_b16 a[162:163], v245 offset:4608
    v_mul_f32 v61, v61, v196
    v_mfma_f32_16x16x32_bf16 v[188:191], a[172:175], v[236:239], v[188:191]
    ds_read_b64_tr_b16 a[164:165], v246 offset:512
    ds_read_b64_tr_b16 a[166:167], v246 offset:4608
    v_mul_f32 v62, v62, v196
    v_mfma_f32_16x16x32_bf16 a[196:199], a[204:207], v[236:239], a[196:199]
    ds_read_b64_tr_b16 a[168:169], v245 offset:768
    ds_read_b64_tr_b16 a[170:171], v245 offset:4864
    v_mul_f32 v63, v63, v196
    v_mfma_f32_16x16x32_bf16 v[228:231], a[112:115], a[80:83], v[212:215]
    v_exp_f32 v220, v220
    v_cvt_pk_bf16_f32 v56, v56, v57
    v_mfma_f32_16x16x32_bf16 v[228:231], a[116:119], a[84:87], v[228:231]
    v_exp_f32 v221, v221
    v_cvt_pk_bf16_f32 v57, v58, v59
    v_mfma_f32_16x16x32_bf16 v[228:231], a[120:123], a[88:91], v[228:231]
    v_exp_f32 v222, v222
    v_cvt_pk_bf16_f32 v58, v60, v61
    v_mfma_f32_16x16x32_bf16 v[228:231], a[124:127], a[92:95], v[228:231]
    v_exp_f32 v223, v223
    v_cvt_pk_bf16_f32 v59, v62, v63
    s_waitcnt lgkmcnt(12)
    v_mfma_f32_16x16x32_bf16 v[96:99], a[144:147], v[240:243], v[96:99]
    v_cvt_pk_bf16_f32 v236, v220, v221
    ds_read_b64_tr_b16 a[172:173], v246 offset:768
    s_add_u32 s45, s43, 47104
    s_waitcnt lgkmcnt(11)
    v_mfma_f32_16x16x32_bf16 v[100:103], a[148:151], v[240:243], v[100:103]
    v_cvt_pk_bf16_f32 v237, v222, v223
    ds_read_b64_tr_b16 a[174:175], v246 offset:4864
    buffer_store_dwordx4 v[56:59], v253, s[20:23], s45 offen sc1
    s_waitcnt lgkmcnt(10)
    v_mfma_f32_16x16x32_bf16 v[104:107], a[152:155], v[240:243], v[104:107]
    v_accvgpr_read_b32 v202, a184
    v_rcp_f32 v200, v202
    v_add_f32 v254, v254, v202
    s_waitcnt lgkmcnt(8)
    v_mfma_f32_16x16x32_bf16 v[108:111], a[156:159], v[240:243], v[108:111]
    v_mul_f32 v64, v64, v200
    v_mul_f32 v65, v65, v200
    v_mul_f32 v66, v66, v200
    v_mfma_f32_16x16x32_bf16 v[232:235], a[128:131], a[80:83], v[212:215]
    v_exp_f32 v224, v224
    v_mul_f32 v67, v67, v200
    v_mfma_f32_16x16x32_bf16 v[232:235], a[132:135], a[84:87], v[232:235]
    v_exp_f32 v225, v225
    v_mul_f32 v68, v68, v200
    v_mfma_f32_16x16x32_bf16 v[232:235], a[136:139], a[88:91], v[232:235]
    v_exp_f32 v226, v226
    v_mul_f32 v69, v69, v200
    v_mfma_f32_16x16x32_bf16 v[232:235], a[140:143], a[92:95], v[232:235]
    v_exp_f32 v227, v227
    v_mul_f32 v70, v70, v200
    s_waitcnt lgkmcnt(6)
    v_mfma_f32_16x16x32_bf16 v[112:115], a[160:163], v[240:243], v[112:115]
    v_cvt_pk_bf16_f32 v238, v224, v225
    v_mul_f32 v71, v71, v200
    v_cvt_pk_bf16_f32 v64, v64, v65
    s_waitcnt lgkmcnt(4)
    v_mfma_f32_16x16x32_bf16 v[116:119], a[164:167], v[240:243], v[116:119]
    v_cvt_pk_bf16_f32 v239, v226, v227
    v_cvt_pk_bf16_f32 v65, v66, v67
    v_cvt_pk_bf16_f32 v66, v68, v69
    s_waitcnt lgkmcnt(2)
    v_mfma_f32_16x16x32_bf16 v[120:123], a[168:171], v[240:243], v[120:123]
    v_cvt_pk_bf16_f32 v67, v70, v71
    s_add_u32 s45, s43, 8192
    buffer_store_dwordx4 v[64:67], v253, s[20:23], s45 offen sc1
    s_waitcnt lgkmcnt(0)
    v_mfma_f32_16x16x32_bf16 v[124:127], a[172:175], v[240:243], v[124:127]
    v_mul_f32 v72, v72, v200
    v_mul_f32 v73, v73, v200
    v_mul_f32 v74, v74, v200
    v_mfma_f32_16x16x32_bf16 a[188:191], a[204:207], v[240:243], a[188:191]
    v_mul_f32 v75, v75, v200
    v_mul_f32 v76, v76, v200
    v_mul_f32 v77, v77, v200
    v_exp_f32 v228, v228
    v_exp_f32 v229, v229
    v_exp_f32 v230, v230
    v_exp_f32 v231, v231
    v_mfma_f32_16x16x32_bf16 v[128:131], a[144:147], v[236:239], v[128:131]
    v_cvt_pk_bf16_f32 v240, v228, v229
    v_mul_f32 v78, v78, v200
    v_mul_f32 v79, v79, v200
    v_mfma_f32_16x16x32_bf16 v[132:135], a[148:151], v[236:239], v[132:135]
    v_cvt_pk_bf16_f32 v241, v230, v231
    v_cvt_pk_bf16_f32 v72, v72, v73
    v_cvt_pk_bf16_f32 v73, v74, v75
    v_mfma_f32_16x16x32_bf16 v[136:139], a[152:155], v[236:239], v[136:139]
    v_cvt_pk_bf16_f32 v74, v76, v77
    v_cvt_pk_bf16_f32 v75, v78, v79
    s_add_u32 s45, s43, 21504
    v_mfma_f32_16x16x32_bf16 v[140:143], a[156:159], v[236:239], v[140:143]
    buffer_store_dwordx4 v[72:75], v253, s[20:23], s45 offen sc1
    v_mul_f32 v80, v80, v200
    v_mul_f32 v81, v81, v200
    v_exp_f32 v232, v232
    v_exp_f32 v233, v233
    v_exp_f32 v234, v234
    v_exp_f32 v235, v235
    v_mfma_f32_16x16x32_bf16 v[144:147], a[160:163], v[236:239], v[144:147]
    v_cvt_pk_bf16_f32 v242, v232, v233
    v_mul_f32 v82, v82, v200
    v_mul_f32 v83, v83, v200
    v_mfma_f32_16x16x32_bf16 v[148:151], a[164:167], v[236:239], v[148:151]
    v_cvt_pk_bf16_f32 v243, v234, v235
    v_mul_f32 v84, v84, v200
    v_mul_f32 v85, v85, v200
    v_mfma_f32_16x16x32_bf16 v[152:155], a[168:171], v[236:239], v[152:155]
    v_mul_f32 v86, v86, v200
    v_mul_f32 v87, v87, v200
    v_cvt_pk_bf16_f32 v80, v80, v81
    v_mfma_f32_16x16x32_bf16 v[156:159], a[172:175], v[236:239], v[156:159]
    v_cvt_pk_bf16_f32 v81, v82, v83
    v_cvt_pk_bf16_f32 v82, v84, v85
    v_cvt_pk_bf16_f32 v83, v86, v87
    v_mfma_f32_16x16x32_bf16 a[192:195], a[204:207], v[236:239], a[192:195]
    s_add_u32 s45, s43, 34816
    buffer_store_dwordx4 v[80:83], v253, s[20:23], s45 offen sc1
    v_mul_f32 v88, v88, v200
    v_mfma_f32_16x16x32_bf16 v[160:163], a[144:147], v[240:243], v[160:163]
    v_mul_f32 v89, v89, v200
    v_mul_f32 v90, v90, v200
    v_mfma_f32_16x16x32_bf16 v[164:167], a[148:151], v[240:243], v[164:167]
    v_mul_f32 v91, v91, v200
    v_mul_f32 v92, v92, v200
    v_mfma_f32_16x16x32_bf16 v[168:171], a[152:155], v[240:243], v[168:171]
    v_mul_f32 v93, v93, v200
    v_mul_f32 v94, v94, v200
    v_mul_f32 v95, v95, v200
    v_mfma_f32_16x16x32_bf16 v[172:175], a[156:159], v[240:243], v[172:175]
    v_cvt_pk_bf16_f32 v88, v88, v89
    v_cvt_pk_bf16_f32 v89, v90, v91
    v_cvt_pk_bf16_f32 v90, v92, v93
    v_mfma_f32_16x16x32_bf16 v[176:179], a[160:163], v[240:243], v[176:179]
    v_cvt_pk_bf16_f32 v91, v94, v95
    s_add_u32 s45, s43, 48128
    v_mfma_f32_16x16x32_bf16 v[180:183], a[164:167], v[240:243], v[180:183]
    buffer_store_dwordx4 v[88:91], v253, s[20:23], s45 offen sc1
    v_mfma_f32_16x16x32_bf16 v[184:187], a[168:171], v[240:243], v[184:187]
    v_accvgpr_read_b32 v206, a188
    v_rcp_f32 v204, v206
    v_add_f32 v254, v254, v206
    v_mfma_f32_16x16x32_bf16 v[188:191], a[172:175], v[240:243], v[188:191]
    v_mul_f32 v96, v96, v204
    v_mul_f32 v97, v97, v204
    v_mul_f32 v98, v98, v204
    v_mfma_f32_16x16x32_bf16 a[196:199], a[204:207], v[240:243], a[196:199]
    v_mul_f32 v99, v99, v204
    v_mul_f32 v100, v100, v204
    v_mul_f32 v101, v101, v204
    v_mul_f32 v102, v102, v204
    v_mul_f32 v103, v103, v204
    v_cvt_pk_bf16_f32 v96, v96, v97
    v_cvt_pk_bf16_f32 v97, v98, v99
    v_cvt_pk_bf16_f32 v98, v100, v101
    v_cvt_pk_bf16_f32 v99, v102, v103
    s_add_u32 s45, s43, 9216
    buffer_store_dwordx4 v[96:99], v253, s[20:23], s45 offen sc1
    v_mul_f32 v104, v104, v204
    v_mul_f32 v105, v105, v204
    v_mul_f32 v106, v106, v204
    v_mul_f32 v107, v107, v204
    v_mul_f32 v108, v108, v204
    v_mul_f32 v109, v109, v204
    v_mul_f32 v110, v110, v204
    v_mul_f32 v111, v111, v204
    v_cvt_pk_bf16_f32 v104, v104, v105
    v_cvt_pk_bf16_f32 v105, v106, v107
    v_cvt_pk_bf16_f32 v106, v108, v109
    v_cvt_pk_bf16_f32 v107, v110, v111
    s_add_u32 s45, s43, 22528
    buffer_store_dwordx4 v[104:107], v253, s[20:23], s45 offen sc1
    v_mul_f32 v112, v112, v204
    v_mul_f32 v113, v113, v204
    v_mul_f32 v114, v114, v204
    v_mul_f32 v115, v115, v204
    v_mul_f32 v116, v116, v204
    v_mul_f32 v117, v117, v204
    v_mul_f32 v118, v118, v204
    v_mul_f32 v119, v119, v204
    v_cvt_pk_bf16_f32 v112, v112, v113
    v_cvt_pk_bf16_f32 v113, v114, v115
    v_cvt_pk_bf16_f32 v114, v116, v117
    v_cvt_pk_bf16_f32 v115, v118, v119
    s_add_u32 s45, s43, 35840
    buffer_store_dwordx4 v[112:115], v253, s[20:23], s45 offen sc1
    v_mul_f32 v120, v120, v204
    v_mul_f32 v121, v121, v204
    v_mul_f32 v122, v122, v204
    v_mul_f32 v123, v123, v204
    v_mul_f32 v124, v124, v204
    v_mul_f32 v125, v125, v204
    v_mul_f32 v126, v126, v204
    v_mul_f32 v127, v127, v204
    v_cvt_pk_bf16_f32 v120, v120, v121
    v_cvt_pk_bf16_f32 v121, v122, v123
    v_cvt_pk_bf16_f32 v122, v124, v125
    v_cvt_pk_bf16_f32 v123, v126, v127
    s_add_u32 s45, s43, 49152
    buffer_store_dwordx4 v[120:123], v253, s[20:23], s45 offen sc1
    v_accvgpr_read_b32 v210, a192
    v_rcp_f32 v208, v210
    v_add_f32 v254, v254, v210
    v_mul_f32 v128, v128, v208
    v_mul_f32 v129, v129, v208
    v_mul_f32 v130, v130, v208
    v_mul_f32 v131, v131, v208
    v_mul_f32 v132, v132, v208
    v_mul_f32 v133, v133, v208
    v_mul_f32 v134, v134, v208
    v_mul_f32 v135, v135, v208
    v_cvt_pk_bf16_f32 v128, v128, v129
    v_cvt_pk_bf16_f32 v129, v130, v131
    v_cvt_pk_bf16_f32 v130, v132, v133
    v_cvt_pk_bf16_f32 v131, v134, v135
    s_add_u32 s45, s43, 10240
    buffer_store_dwordx4 v[128:131], v253, s[20:23], s45 offen sc1
    v_mul_f32 v136, v136, v208
    v_mul_f32 v137, v137, v208
    v_mul_f32 v138, v138, v208
    v_mul_f32 v139, v139, v208
    v_mul_f32 v140, v140, v208
    v_mul_f32 v141, v141, v208
    v_mul_f32 v142, v142, v208
    v_mul_f32 v143, v143, v208
    v_cvt_pk_bf16_f32 v136, v136, v137
    v_cvt_pk_bf16_f32 v137, v138, v139
    v_cvt_pk_bf16_f32 v138, v140, v141
    v_cvt_pk_bf16_f32 v139, v142, v143
    s_add_u32 s45, s43, 23552
    buffer_store_dwordx4 v[136:139], v253, s[20:23], s45 offen sc1
    v_mul_f32 v144, v144, v208
    v_mul_f32 v145, v145, v208
    v_mul_f32 v146, v146, v208
    v_mul_f32 v147, v147, v208
    v_mul_f32 v148, v148, v208
    v_mul_f32 v149, v149, v208
    v_mul_f32 v150, v150, v208
    v_mul_f32 v151, v151, v208
    v_cvt_pk_bf16_f32 v144, v144, v145
    v_cvt_pk_bf16_f32 v145, v146, v147
    v_cvt_pk_bf16_f32 v146, v148, v149
    v_cvt_pk_bf16_f32 v147, v150, v151
    s_add_u32 s45, s43, 36864
    buffer_store_dwordx4 v[144:147], v253, s[20:23], s45 offen sc1
    v_mul_f32 v152, v152, v208
    v_mul_f32 v153, v153, v208
    v_mul_f32 v154, v154, v208
    v_mul_f32 v155, v155, v208
    v_mul_f32 v156, v156, v208
    v_mul_f32 v157, v157, v208
    v_mul_f32 v158, v158, v208
    v_mul_f32 v159, v159, v208
    v_cvt_pk_bf16_f32 v152, v152, v153
    v_cvt_pk_bf16_f32 v153, v154, v155
    v_cvt_pk_bf16_f32 v154, v156, v157
    v_cvt_pk_bf16_f32 v155, v158, v159
    s_add_u32 s45, s43, 50176
    buffer_store_dwordx4 v[152:155], v253, s[20:23], s45 offen sc1
L1_e1:
    v_accvgpr_read_b32 v214, a196
    v_rcp_f32 v212, v214
    v_add_f32 v254, v254, v214
    v_pk_mul_f32 v[160:161], v[160:161], v[212:213] op_sel_hi:[1,0]
    v_pk_mul_f32 v[162:163], v[162:163], v[212:213] op_sel_hi:[1,0]
    v_pk_mul_f32 v[164:165], v[164:165], v[212:213] op_sel_hi:[1,0]
    v_pk_mul_f32 v[166:167], v[166:167], v[212:213] op_sel_hi:[1,0]
    v_cvt_pk_bf16_f32 v160, v160, v161
    v_cvt_pk_bf16_f32 v161, v162, v163
    v_cvt_pk_bf16_f32 v162, v164, v165
    v_cvt_pk_bf16_f32 v163, v166, v167
    s_add_u32 s45, s43, 11264
    buffer_store_dwordx4 v[160:163], v253, s[20:23], s45 offen sc1
    v_pk_mul_f32 v[168:169], v[168:169], v[212:213] op_sel_hi:[1,0]
    v_pk_mul_f32 v[170:171], v[170:171], v[212:213] op_sel_hi:[1,0]
    v_pk_mul_f32 v[172:173], v[172:173], v[212:213] op_sel_hi:[1,0]
    v_pk_mul_f32 v[174:175], v[174:175], v[212:213] op_sel_hi:[1,0]
    v_cvt_pk_bf16_f32 v168, v168, v169
    v_cvt_pk_bf16_f32 v169, v170, v171
    v_cvt_pk_bf16_f32 v170, v172, v173
    v_cvt_pk_bf16_f32 v171, v174, v175
    s_add_u32 s45, s43, 24576
    buffer_store_dwordx4 v[168:171], v253, s[20:23], s45 offen sc1
    v_pk_mul_f32 v[176:177], v[176:177], v[212:213] op_sel_hi:[1,0]
    v_pk_mul_f32 v[178:179], v[178:179], v[212:213] op_sel_hi:[1,0]
    v_pk_mul_f32 v[180:181], v[180:181], v[212:213] op_sel_hi:[1,0]
    v_pk_mul_f32 v[182:183], v[182:183], v[212:213] op_sel_hi:[1,0]
    v_cvt_pk_bf16_f32 v176, v176, v177
    v_cvt_pk_bf16_f32 v177, v178, v179
    v_cvt_pk_bf16_f32 v178, v180, v181
    v_cvt_pk_bf16_f32 v179, v182, v183
    s_add_u32 s45, s43, 37888
    buffer_store_dwordx4 v[176:179], v253, s[20:23], s45 offen sc1
    v_pk_mul_f32 v[184:185], v[184:185], v[212:213] op_sel_hi:[1,0]
    v_pk_mul_f32 v[186:187], v[186:187], v[212:213] op_sel_hi:[1,0]
    v_pk_mul_f32 v[188:189], v[188:189], v[212:213] op_sel_hi:[1,0]
    v_pk_mul_f32 v[190:191], v[190:191], v[212:213] op_sel_hi:[1,0]
    v_cvt_pk_bf16_f32 v184, v184, v185
    v_cvt_pk_bf16_f32 v185, v186, v187
    v_cvt_pk_bf16_f32 v186, v188, v189
    v_cvt_pk_bf16_f32 v187, v190, v191
    s_add_u32 s45, s43, 51200
    buffer_store_dwordx4 v[184:187], v253, s[20:23], s45 offen sc1
    v_lshlrev_b32 v252, 2, v247
    v_add_u32 v252, 139264, v252
    s_lshl_b32 s42, s24, 8
    v_add_u32 v240, s42, v252
    ds_write_b32 v240, v254
    s_mul_i32 s67, s83, 6144
    v_lshlrev_b32 v232, 4, v247
    v_add_u32 v220, s67, v232
    v_add_u32 v221, 4096, v220
    v_add_u32 v222, 12288, v232
    v_lshrrev_b32 v232, 2, v247
    v_and_b32 v232, 3, v232
    v_lshlrev_b32 v232, 11, v232
    v_lshrrev_b32 v233, 4, v247
    v_lshl_add_u32 v232, v233, 6, v232
    v_and_b32 v234, 3, v247
    v_lshl_add_u32 v224, v234, 4, v232
    v_add_u32 v225, 15360, v224
    v_add_u32 v226, 30720, v224
    v_add_u32 v227, 46080, v224
    v_and_b32 v232, 1, v233
    v_mul_u32_u24 v232, 4104, v232
    v_lshrrev_b32 v233, 1, v233
    v_lshl_add_u32 v232, v233, 10, v232
    v_and_b32 v234, 15, v247
    v_lshl_add_u32 v232, v234, 4, v232
    s_lshl_b32 s67, s83, 9
    s_add_u32 s68, s97, s67
    v_add_u32 v228, s68, v232
    s_sub_u32 s67, 512, s67
    s_add_u32 s68, s97, s67
    v_add_u32 v229, s68, v232
    v_mov_b32 v231, 0
    s_bitcmp1_b32 s24, 0
    s_cselect_b32 s53, 12, 4
    s_and_b32 s52, s27, 12
    s_add_u32 s52, s52, s24
    s_add_u32 s52, s52, s53
    s_and_b32 s52, s52, 15
    s_mul_i32 s92, s52, 106496
    s_lshl_b32 s93, s52, 19
    s_add_u32 s94, s93, 8192
    s_lshl_b32 s46, 1, s27
    v_mov_b32 v241, s46
    s_mov_b64 exec, 1
    buffer_load_dword v230, v231, s[72:75], s95 offen sc1
    s_mov_b64 exec, -1
    s_waitcnt vmcnt(0) lgkmcnt(0)
    s_barrier
    ds_read_b32 v216, v252 offset:0
    ds_read_b32 v217, v252 offset:256
    ds_read_b32 v218, v252 offset:512
    ds_read_b32 v219, v252 offset:768
    s_mov_b32 s45, 0x4f800000
    s_waitcnt lgkmcnt(2)
    v_add_f32 v216, v216, v217
    s_waitcnt lgkmcnt(0)
    v_add_f32 v218, v218, v219
    v_add_f32 v216, v216, v218
    v_cmp_ngt_f32 vcc, s45, v216
    s_cmp_lg_u32 s48, 0
    s_cbranch_scc1 L1_ok1
    s_cbranch_vccnz L1_fb1
L1_ok1:
    s_branch L2_main
L1_fb1:
    s_waitcnt vmcnt(0) lgkmcnt(0)
    s_barrier
    v_subrev_u32 v244, 32768, v244
    v_subrev_u32 v245, 32768, v245
    v_subrev_u32 v246, 32768, v246
    v_mov_b32 v24, 0xff800000
    v_mov_b32 v25, 0xff800000
    v_mov_b32 v26, 0xff800000
    v_mov_b32 v27, 0xff800000
    v_mov_b32 v28, 0xff800000
    v_mov_b32 v29, 0xff800000
    s_mov_b32 s64, 0
    s_mov_b32 s32, s65
    s_or_b32 s33, s65, 4096
    s_mov_b32 s28, 32
    s_mov_b32 s48, 1
L1_fl1:
    s_add_u32 m0, s37, 65536
    s_nop 0
    buffer_load_dwordx4 v248, s[16:19], s32 offen offset:0 nt lds
    buffer_load_dwordx4 v249, s[16:19], s32 offen offset:1024 nt lds
    buffer_load_dwordx4 v248, s[16:19], s32 offen offset:2048 nt lds
    buffer_load_dwordx4 v249, s[16:19], s32 offen offset:3072 nt lds
    s_add_u32 m0, m0, 4096
    s_nop 0
    buffer_load_dwordx4 v248, s[16:19], s33 offen offset:0 nt lds
    buffer_load_dwordx4 v249, s[16:19], s33 offen offset:1024 nt lds
    buffer_load_dwordx4 v248, s[16:19], s33 offen offset:2048 nt lds
    buffer_load_dwordx4 v249, s[16:19], s33 offen offset:3072 nt lds
    s_add_u32 s64, s64, 8192
    s_xor_b32 s32, s64, s65
    s_or_b32 s33, s32, 4096
    s_waitcnt vmcnt(0)
    s_barrier
    ds_read_b128 a[112:115], v244 offset:0
    ds_read_b128 a[116:119], v244 offset:256
    ds_read_b128 a[120:123], v244 offset:512
    ds_read_b128 a[124:127], v244 offset:768
    ds_read_b128 a[128:131], v244 offset:4096
    ds_read_b128 a[132:135], v244 offset:4352
    ds_read_b128 a[136:139], v244 offset:4608
    ds_read_b128 a[140:143], v244 offset:4864
    s_waitcnt lgkmcnt(7)
    v_mfma_f32_16x16x32_bf16 v[8:11], a[112:115], a[0:3], 0
    s_waitcnt lgkmcnt(6)
    v_mfma_f32_16x16x32_bf16 v[8:11], a[116:119], a[4:7], v[8:11]
    s_waitcnt lgkmcnt(5)
    v_mfma_f32_16x16x32_bf16 v[8:11], a[120:123], a[8:11], v[8:11]
    s_waitcnt lgkmcnt(4)
    v_mfma_f32_16x16x32_bf16 v[8:11], a[124:127], a[12:15], v[8:11]
    s_waitcnt lgkmcnt(3)
    v_mfma_f32_16x16x32_bf16 v[12:15], a[128:131], a[0:3], 0
    s_waitcnt lgkmcnt(2)
    v_mfma_f32_16x16x32_bf16 v[12:15], a[132:135], a[4:7], v[12:15]
    s_waitcnt lgkmcnt(1)
    v_mfma_f32_16x16x32_bf16 v[12:15], a[136:139], a[8:11], v[12:15]
    s_waitcnt lgkmcnt(0)
    v_mfma_f32_16x16x32_bf16 v[12:15], a[140:143], a[12:15], v[12:15]
    v_mfma_f32_16x16x32_bf16 v[40:43], a[112:115], a[16:19], 0
    v_mfma_f32_16x16x32_bf16 v[40:43], a[116:119], a[20:23], v[40:43]
    v_mfma_f32_16x16x32_bf16 v[40:43], a[120:123], a[24:27], v[40:43]
    v_mfma_f32_16x16x32_bf16 v[40:43], a[124:127], a[28:31], v[40:43]
    v_mfma_f32_16x16x32_bf16 v[44:47], a[128:131], a[16:19], 0
    v_mfma_f32_16x16x32_bf16 v[44:47], a[132:135], a[20:23], v[44:47]
    v_mfma_f32_16x16x32_bf16 v[44:47], a[136:139], a[24:27], v[44:47]
    v_mfma_f32_16x16x32_bf16 v[44:47], a[140:143], a[28:31], v[44:47]
    v_mfma_f32_16x16x32_bf16 v[72:75], a[112:115], a[32:35], 0
    v_mfma_f32_16x16x32_bf16 v[72:75], a[116:119], a[36:39], v[72:75]
    v_mfma_f32_16x16x32_bf16 v[72:75], a[120:123], a[40:43], v[72:75]
    v_mfma_f32_16x16x32_bf16 v[72:75], a[124:127], a[44:47], v[72:75]
    v_mfma_f32_16x16x32_bf16 v[76:79], a[128:131], a[32:35], 0
    v_mfma_f32_16x16x32_bf16 v[76:79], a[132:135], a[36:39], v[76:79]
    v_mfma_f32_16x16x32_bf16 v[76:79], a[136:139], a[40:43], v[76:79]
    v_mfma_f32_16x16x32_bf16 v[76:79], a[140:143], a[44:47], v[76:79]
    v_mfma_f32_16x16x32_bf16 v[104:107], a[112:115], a[48:51], 0
    v_mfma_f32_16x16x32_bf16 v[104:107], a[116:119], a[52:55], v[104:107]
    v_mfma_f32_16x16x32_bf16 v[104:107], a[120:123], a[56:59], v[104:107]
    v_mfma_f32_16x16x32_bf16 v[104:107], a[124:127], a[60:63], v[104:107]
    v_mfma_f32_16x16x32_bf16 v[108:111], a[128:131], a[48:51], 0
    v_mfma_f32_16x16x32_bf16 v[108:111], a[132:135], a[52:55], v[108:111]
    v_mfma_f32_16x16x32_bf16 v[108:111], a[136:139], a[56:59], v[108:111]
    v_mfma_f32_16x16x32_bf16 v[108:111], a[140:143], a[60:63], v[108:111]
    v_mfma_f32_16x16x32_bf16 v[136:139], a[112:115], a[64:67], 0
    v_mfma_f32_16x16x32_bf16 v[136:139], a[116:119], a[68:71], v[136:139]
    v_mfma_f32_16x16x32_bf16 v[136:139], a[120:123], a[72:75], v[136:139]
    v_mfma_f32_16x16x32_bf16 v[136:139], a[124:127], a[76:79], v[136:139]
    v_mfma_f32_16x16x32_bf16 v[140:143], a[128:131], a[64:67], 0
    v_mfma_f32_16x16x32_bf16 v[140:143], a[132:135], a[68:71], v[140:143]
    v_mfma_f32_16x16x32_bf16 v[140:143], a[136:139], a[72:75], v[140:143]
    v_mfma_f32_16x16x32_bf16 v[140:143], a[140:143], a[76:79], v[140:143]
    v_mfma_f32_16x16x32_bf16 v[168:171], a[112:115], a[80:83], 0
    v_mfma_f32_16x16x32_bf16 v[168:171], a[116:119], a[84:87], v[168:171]
    v_mfma_f32_16x16x32_bf16 v[168:171], a[120:123], a[88:91], v[168:171]
    v_mfma_f32_16x16x32_bf16 v[168:171], a[124:127], a[92:95], v[168:171]
    v_mfma_f32_16x16x32_bf16 v[172:175], a[128:131], a[80:83], 0
    v_mfma_f32_16x16x32_bf16 v[172:175], a[132:135], a[84:87], v[172:175]
    v_mfma_f32_16x16x32_bf16 v[172:175], a[136:139], a[88:91], v[172:175]
    v_mfma_f32_16x16x32_bf16 v[172:175], a[140:143], a[92:95], v[172:175]
    v_max3_f32 v8, v8, v9, v10
    v_max3_f32 v11, v11, v12, v13
    v_max3_f32 v8, v8, v14, v15
    v_max3_f32 v24, v24, v8, v11
    v_max3_f32 v40, v40, v41, v42
    v_max3_f32 v43, v43, v44, v45
    v_max3_f32 v40, v40, v46, v47
    v_max3_f32 v25, v25, v40, v43
    v_max3_f32 v72, v72, v73, v74
    v_max3_f32 v75, v75, v76, v77
    v_max3_f32 v72, v72, v78, v79
    v_max3_f32 v26, v26, v72, v75
    v_max3_f32 v104, v104, v105, v106
    v_max3_f32 v107, v107, v108, v109
    v_max3_f32 v104, v104, v110, v111
    v_max3_f32 v27, v27, v104, v107
    v_max3_f32 v136, v136, v137, v138
    v_max3_f32 v139, v139, v140, v141
    v_max3_f32 v136, v136, v142, v143
    v_max3_f32 v28, v28, v136, v139
    v_max3_f32 v168, v168, v169, v170
    v_max3_f32 v171, v171, v172, v173
    v_max3_f32 v168, v168, v174, v175
    v_max3_f32 v29, v29, v168, v171
    s_barrier
    s_sub_u32 s28, s28, 1
    s_cmp_lg_u32 s28, 0
    s_cbranch_scc1 L1_fl1
    s_mov_b32 s64, 0
    s_mov_b32 s32, s65
    s_or_b32 s33, s65, 4096
    s_add_u32 m0, s37, 65536
    s_nop 0
    buffer_load_dwordx4 v248, s[16:19], s32 offen offset:0 nt lds
    buffer_load_dwordx4 v249, s[16:19], s32 offen offset:1024 nt lds
    buffer_load_dwordx4 v248, s[16:19], s32 offen offset:2048 nt lds
    buffer_load_dwordx4 v249, s[16:19], s32 offen offset:3072 nt lds
    s_add_u32 m0, m0, 4096
    s_nop 0
    buffer_load_dwordx4 v248, s[16:19], s33 offen offset:0 nt lds
    buffer_load_dwordx4 v249, s[16:19], s33 offen offset:1024 nt lds
    buffer_load_dwordx4 v248, s[16:19], s33 offen offset:2048 nt lds
    buffer_load_dwordx4 v249, s[16:19], s33 offen offset:3072 nt lds
    s_add_u32 s64, s64, 8192
    s_xor_b32 s32, s64, s65
    s_or_b32 s33, s32, 4096
    s_add_u32 m0, s37, 98304
    s_nop 0
    buffer_load_dwordx4 v248, s[16:19], s32 offen offset:0 nt lds
    buffer_load_dwordx4 v249, s[16:19], s32 offen offset:1024 nt lds
    buffer_load_dwordx4 v248, s[16:19], s32 offen offset:2048 nt lds
    buffer_load_dwordx4 v249, s[16:19], s32 offen offset:3072 nt lds
    s_add_u32 m0, m0, 4096
    s_nop 0
    buffer_load_dwordx4 v248, s[16:19], s33 offen offset:0 nt lds
    buffer_load_dwordx4 v249, s[16:19], s33 offen offset:1024 nt lds
    buffer_load_dwordx4 v248, s[16:19], s33 offen offset:2048 nt lds
    buffer_load_dwordx4 v249, s[16:19], s33 offen offset:3072 nt lds
    s_add_u32 s64, s64, 8192
    s_xor_b32 s32, s64, s65
    s_or_b32 s33, s32, 4096
    s_add_u32 m0, s37, 131072
    s_nop 0
    buffer_load_dwordx4 v248, s[16:19], s32 offen offset:0 nt lds
    buffer_load_dwordx4 v249, s[16:19], s32 offen offset:1024 nt lds
    buffer_load_dwordx4 v248, s[16:19], s32 offen offset:2048 nt lds
    buffer_load_dwordx4 v249, s[16:19], s32 offen offset:3072 nt lds
    s_add_u32 m0, m0, 4096
    s_nop 0
    buffer_load_dwordx4 v248, s[16:19], s33 offen offset:0 nt lds
    buffer_load_dwordx4 v249, s[16:19], s33 offen offset:1024 nt lds
    buffer_load_dwordx4 v248, s[16:19], s33 offen offset:2048 nt lds
    buffer_load_dwordx4 v249, s[16:19], s33 offen offset:3072 nt lds
    s_add_u32 s64, s64, 8192
    s_xor_b32 s32, s64, s65
    s_or_b32 s33, s32, 4096
    v_mov_b32 v8, v24
    v_mov_b32 v40, v25
    v_mov_b32 v72, v26
    v_mov_b32 v104, v27
    v_mov_b32 v136, v28
    v_mov_b32 v168, v29
    s_waitcnt vmcnt(0)
    s_barrier
    ds_read_b128 a[112:115], v244 offset:0
    ds_read_b128 a[116:119], v244 offset:256
    ds_read_b128 a[120:123], v244 offset:512
    ds_read_b128 a[124:127], v244 offset:768
    ds_read_b128 a[128:131], v244 offset:4096
    ds_read_b128 a[132:135], v244 offset:4352
    ds_read_b128 a[136:139], v244 offset:4608
    ds_read_b128 a[140:143], v244 offset:4864
    ds_read_b64_tr_b16 a[144:145], v245 offset:0
    ds_read_b64_tr_b16 a[146:147], v245 offset:4096
    ds_read_b64_tr_b16 a[148:149], v246 offset:0
    ds_read_b64_tr_b16 a[150:151], v246 offset:4096
    ds_read_b64_tr_b16 a[152:153], v245 offset:256
    ds_read_b64_tr_b16 a[154:155], v245 offset:4352
    ds_read_b64_tr_b16 a[156:157], v246 offset:256
    ds_read_b64_tr_b16 a[158:159], v246 offset:4352
    ds_read_b64_tr_b16 a[160:161], v245 offset:512
    ds_read_b64_tr_b16 a[162:163], v245 offset:4608
    ds_read_b64_tr_b16 a[164:165], v246 offset:512
    ds_read_b64_tr_b16 a[166:167], v246 offset:4608
    ds_read_b64_tr_b16 a[168:169], v245 offset:768
    ds_read_b64_tr_b16 a[170:171], v245 offset:4864
    ds_read_b64_tr_b16 a[172:173], v246 offset:768
    ds_read_b64_tr_b16 a[174:175], v246 offset:4864
    s_branch L1_m1
L1_end:
    s_endpgm
L2_main:
    s_add_u32 m0, s97, 0
    s_nop 0
    buffer_load_dwordx4 v224, s[84:87], s93 offen offset:0 lds
    buffer_load_dwordx4 v225, s[84:87], s93 offen offset:1024 lds
    buffer_load_dwordx4 v226, s[84:87], s93 offen offset:2048 lds
    buffer_load_dwordx4 v227, s[84:87], s93 offen offset:3072 lds
    s_add_u32 m0, s97, 4104
    s_nop 0
    buffer_load_dwordx4 v224, s[84:87], s94 offen offset:0 lds
    buffer_load_dwordx4 v225, s[84:87], s94 offen offset:1024 lds
    buffer_load_dwordx4 v226, s[84:87], s94 offen offset:2048 lds
    buffer_load_dwordx4 v227, s[84:87], s94 offen offset:3072 lds
    s_add_u32 s93, s93, 65536
    s_add_u32 s94, s94, 65536
    s_add_u32 m0, s97, 8448
    s_nop 0
    buffer_load_dwordx4 v224, s[84:87], s93 offen offset:0 lds
    buffer_load_dwordx4 v225, s[84:87], s93 offen offset:1024 lds
    buffer_load_dwordx4 v226, s[84:87], s93 offen offset:2048 lds
    buffer_load_dwordx4 v227, s[84:87], s93 offen offset:3072 lds
    s_add_u32 m0, s97, 12552
    s_nop 0
    buffer_load_dwordx4 v224, s[84:87], s94 offen offset:0 lds
    buffer_load_dwordx4 v225, s[84:87], s94 offen offset:1024 lds
    buffer_load_dwordx4 v226, s[84:87], s94 offen offset:2048 lds
    buffer_load_dwordx4 v227, s[84:87], s94 offen offset:3072 lds
    s_add_u32 s93, s93, 65536
    s_add_u32 s94, s94, 65536
    s_add_u32 m0, s97, 16896
    s_nop 0
    buffer_load_dwordx4 v224, s[84:87], s93 offen offset:0 lds
    buffer_load_dwordx4 v225, s[84:87], s93 offen offset:1024 lds
    buffer_load_dwordx4 v226, s[84:87], s93 offen offset:2048 lds
    buffer_load_dwordx4 v227, s[84:87], s93 offen offset:3072 lds
    s_add_u32 m0, s97, 21000
    s_nop 0
    buffer_load_dwordx4 v224, s[84:87], s94 offen offset:0 lds
    buffer_load_dwordx4 v225, s[84:87], s94 offen offset:1024 lds
    buffer_load_dwordx4 v226, s[84:87], s94 offen offset:2048 lds
    buffer_load_dwordx4 v227, s[84:87], s94 offen offset:3072 lds
    s_add_u32 s93, s93, 65536
    s_add_u32 s94, s94, 65536
    s_add_u32 m0, s97, 25344
    s_nop 0
    buffer_load_dwordx4 v224, s[84:87], s93 offen offset:0 lds
    buffer_load_dwordx4 v225, s[84:87], s93 offen offset:1024 lds
    buffer_load_dwordx4 v226, s[84:87], s93 offen offset:2048 lds
    buffer_load_dwordx4 v227, s[84:87], s93 offen offset:3072 lds
    s_add_u32 m0, s97, 29448
    s_nop 0
    buffer_load_dwordx4 v224, s[84:87], s94 offen offset:0 lds
    buffer_load_dwordx4 v225, s[84:87], s94 offen offset:1024 lds
    buffer_load_dwordx4 v226, s[84:87], s94 offen offset:2048 lds
    buffer_load_dwordx4 v227, s[84:87], s94 offen offset:3072 lds
    s_add_u32 s93, s93, 65536
    s_add_u32 s94, s94, 65536
    v_readfirstlane_b32 s67, v230
    s_nop 0
    s_sub_u32 s67, s67, s96
    s_bitcmp1_b32 s67, s52
    s_cbranch_scc1 L2_f_k
    s_mov_b32 s69, 0x3ffff
    s_mov_b64 exec, 1
L2_f_p:
    s_and_b32 s68, s69, 15
    s_cbranch_scc0 L2_f_d
    buffer_load_dword v230, v231, s[72:75], s95 offen sc1
    s_waitcnt vmcnt(0)
    v_readfirstlane_b32 s67, v230
    s_nop 0
    s_sub_u32 s67, s67, s96
    s_branch L2_f_c
L2_f_d:
    buffer_load_dword v230, v231, s[76:79], s66 offen sc1
    s_waitcnt vmcnt(0)
    v_readfirstlane_b32 s67, v230
L2_f_c:
    s_nop 0
    s_bitcmp1_b32 s67, s52
    s_cbranch_scc1 L2_f_o
    s_sub_u32 s69, s69, 1
    s_cbranch_scc1 L2_f_o
    s_sleep 2
    s_branch L2_f_p
L2_f_o:
    s_mov_b64 exec, -1
L2_f_k:
    buffer_load_dwordx4 a[112:115], v220, s[60:63], s92 offen offset:0 sc1
    buffer_load_dwordx4 a[116:119], v220, s[60:63], s92 offen offset:1024 sc1
    buffer_load_dwordx4 a[120:123], v220, s[60:63], s92 offen offset:2048 sc1
    buffer_load_dwordx4 a[124:127], v220, s[60:63], s92 offen offset:3072 sc1
    buffer_load_dwordx4 a[128:131], v221, s[60:63], s92 offen offset:0 sc1
    buffer_load_dwordx4 a[132:135], v221, s[60:63], s92 offen offset:1024 sc1
    buffer_load_dwordx4 a[136:139], v222, s[60:63], s92 offen offset:0 sc1
    s_add_u32 s92, s92, 13312
    buffer_load_dwordx4 a[140:143], v220, s[60:63], s92 offen offset:0 sc1
    buffer_load_dwordx4 a[144:147], v220, s[60:63], s92 offen offset:1024 sc1
    buffer_load_dwordx4 a[148:151], v220, s[60:63], s92 offen offset:2048 sc1
    buffer_load_dwordx4 a[152:155], v220, s[60:63], s92 offen offset:3072 sc1
    buffer_load_dwordx4 a[156:159], v221, s[60:63], s92 offen offset:0 sc1
    buffer_load_dwordx4 a[160:163], v221, s[60:63], s92 offen offset:1024 sc1
    buffer_load_dwordx4 a[164:167], v222, s[60:63], s92 offen offset:0 sc1
    s_add_u32 s92, s92, 13312
    buffer_load_dwordx4 a[168:171], v220, s[60:63], s92 offen offset:0 sc1
    buffer_load_dwordx4 a[172:175], v220, s[60:63], s92 offen offset:1024 sc1
    buffer_load_dwordx4 a[176:179], v220, s[60:63], s92 offen offset:2048 sc1
    buffer_load_dwordx4 a[180:183], v220, s[60:63], s92 offen offset:3072 sc1
    buffer_load_dwordx4 a[184:187], v221, s[60:63], s92 offen offset:0 sc1
    buffer_load_dwordx4 a[188:191], v221, s[60:63], s92 offen offset:1024 sc1
    buffer_load_dwordx4 a[192:195], v222, s[60:63], s92 offen offset:0 sc1
    s_add_u32 s92, s92, 13312
    s_waitcnt vmcnt(45)
    ds_read_b64_tr_b16 a[0:1], v228 offset:0
    ds_read_b64_tr_b16 a[2:3], v228 offset:2048
    ds_read_b64_tr_b16 a[4:5], v228 offset:8
    ds_read_b64_tr_b16 a[6:7], v228 offset:2056
    ds_read_b64_tr_b16 a[8:9], v228 offset:256
    ds_read_b64_tr_b16 a[10:11], v228 offset:2304
    ds_read_b64_tr_b16 a[12:13], v228 offset:264
    ds_read_b64_tr_b16 a[14:15], v228 offset:2312
    ds_read_b64_tr_b16 a[16:17], v229 offset:0
    ds_read_b64_tr_b16 a[18:19], v229 offset:2048
    ds_read_b64_tr_b16 a[20:21], v229 offset:8
    ds_read_b64_tr_b16 a[22:23], v229 offset:2056
    ds_read_b64_tr_b16 a[24:25], v229 offset:256
    ds_read_b64_tr_b16 a[26:27], v229 offset:2304
    ds_read_b64_tr_b16 a[28:29], v229 offset:264
    ds_read_b64_tr_b16 a[30:31], v229 offset:2312
    s_waitcnt vmcnt(14) lgkmcnt(0)
    v_mfma_f32_16x16x32_bf16 v[0:3], a[0:3], a[112:115], 0
    v_mfma_f32_16x16x32_bf16 v[32:35], a[0:3], a[116:119], 0
    buffer_load_dwordx4 a[196:199], v220, s[60:63], s92 offen offset:0 sc1
    v_mfma_f32_16x16x32_bf16 v[64:67], a[0:3], a[120:123], 0
    ds_read_b64_tr_b16 a[32:33], v228 offset:8448
    v_mfma_f32_16x16x32_bf16 v[96:99], a[0:3], a[124:127], 0
    ds_read_b64_tr_b16 a[34:35], v228 offset:10496
    v_mfma_f32_16x16x32_bf16 v[128:131], a[0:3], a[128:131], 0
    buffer_load_dwordx4 a[200:203], v220, s[60:63], s92 offen offset:1024 sc1
    v_mfma_f32_16x16x32_bf16 v[160:163], a[0:3], a[132:135], 0
    ds_read_b64_tr_b16 a[36:37], v228 offset:8456
    v_mfma_f32_16x16x32_bf16 v[192:195], a[0:3], a[136:139], 0
    ds_read_b64_tr_b16 a[38:39], v228 offset:10504
    v_mfma_f32_16x16x32_bf16 v[4:7], a[4:7], a[112:115], 0
    buffer_load_dwordx4 a[204:207], v220, s[60:63], s92 offen offset:2048 sc1
    v_mfma_f32_16x16x32_bf16 v[36:39], a[4:7], a[116:119], 0
    ds_read_b64_tr_b16 a[40:41], v228 offset:8704
    v_mfma_f32_16x16x32_bf16 v[68:71], a[4:7], a[120:123], 0
    ds_read_b64_tr_b16 a[42:43], v228 offset:10752
    v_mfma_f32_16x16x32_bf16 v[100:103], a[4:7], a[124:127], 0
    buffer_load_dwordx4 a[208:211], v220, s[60:63], s92 offen offset:3072 sc1
    v_mfma_f32_16x16x32_bf16 v[132:135], a[4:7], a[128:131], 0
    ds_read_b64_tr_b16 a[44:45], v228 offset:8712
    v_mfma_f32_16x16x32_bf16 v[164:167], a[4:7], a[132:135], 0
    ds_read_b64_tr_b16 a[46:47], v228 offset:10760
    v_mfma_f32_16x16x32_bf16 v[196:199], a[4:7], a[136:139], 0
    buffer_load_dwordx4 a[212:215], v221, s[60:63], s92 offen offset:0 sc1
    v_mfma_f32_16x16x32_bf16 v[8:11], a[8:11], a[112:115], 0
    ds_read_b64_tr_b16 a[48:49], v229 offset:8448
    v_mfma_f32_16x16x32_bf16 v[40:43], a[8:11], a[116:119], 0
    ds_read_b64_tr_b16 a[50:51], v229 offset:10496
    v_mfma_f32_16x16x32_bf16 v[72:75], a[8:11], a[120:123], 0
    buffer_load_dwordx4 a[216:219], v221, s[60:63], s92 offen offset:1024 sc1
    v_mfma_f32_16x16x32_bf16 v[104:107], a[8:11], a[124:127], 0
    ds_read_b64_tr_b16 a[52:53], v229 offset:8456
    v_mfma_f32_16x16x32_bf16 v[136:139], a[8:11], a[128:131], 0
    ds_read_b64_tr_b16 a[54:55], v229 offset:10504
    v_mfma_f32_16x16x32_bf16 v[168:171], a[8:11], a[132:135], 0
    buffer_load_dwordx4 a[220:223], v222, s[60:63], s92 offen offset:0 sc1
    v_mfma_f32_16x16x32_bf16 v[200:203], a[8:11], a[136:139], 0
    ds_read_b64_tr_b16 a[56:57], v229 offset:8704
    v_mfma_f32_16x16x32_bf16 v[12:15], a[12:15], a[112:115], 0
    ds_read_b64_tr_b16 a[58:59], v229 offset:10752
    v_mfma_f32_16x16x32_bf16 v[44:47], a[12:15], a[116:119], 0
    s_add_u32 s92, s92, 13312
    s_add_u32 m0, s97, 0
    s_nop 0
    buffer_load_dwordx4 v224, s[84:87], s93 offen offset:0 lds
    v_mfma_f32_16x16x32_bf16 v[76:79], a[12:15], a[120:123], 0
    ds_read_b64_tr_b16 a[60:61], v229 offset:8712
    v_mfma_f32_16x16x32_bf16 v[108:111], a[12:15], a[124:127], 0
    ds_read_b64_tr_b16 a[62:63], v229 offset:10760
    v_mfma_f32_16x16x32_bf16 v[140:143], a[12:15], a[128:131], 0
    buffer_load_dwordx4 v225, s[84:87], s93 offen offset:1024 lds
    v_mfma_f32_16x16x32_bf16 v[172:175], a[12:15], a[132:135], 0
    v_mfma_f32_16x16x32_bf16 v[204:207], a[12:15], a[136:139], 0
    v_mfma_f32_16x16x32_bf16 v[16:19], a[16:19], a[112:115], 0
    buffer_load_dwordx4 v226, s[84:87], s93 offen offset:2048 lds
    v_mfma_f32_16x16x32_bf16 v[48:51], a[16:19], a[116:119], 0
    v_mfma_f32_16x16x32_bf16 v[80:83], a[16:19], a[120:123], 0
    v_mfma_f32_16x16x32_bf16 v[112:115], a[16:19], a[124:127], 0
    buffer_load_dwordx4 v227, s[84:87], s93 offen offset:3072 lds
    v_mfma_f32_16x16x32_bf16 v[144:147], a[16:19], a[128:131], 0
    v_mfma_f32_16x16x32_bf16 v[176:179], a[16:19], a[132:135], 0
    v_mfma_f32_16x16x32_bf16 v[20:23], a[20:23], a[112:115], 0
    s_add_u32 m0, s97, 4104
    s_nop 0
    buffer_load_dwordx4 v224, s[84:87], s94 offen offset:0 lds
    v_mfma_f32_16x16x32_bf16 v[52:55], a[20:23], a[116:119], 0
    v_mfma_f32_16x16x32_bf16 v[84:87], a[20:23], a[120:123], 0
    v_mfma_f32_16x16x32_bf16 v[116:119], a[20:23], a[124:127], 0
    buffer_load_dwordx4 v225, s[84:87], s94 offen offset:1024 lds
    v_mfma_f32_16x16x32_bf16 v[148:151], a[20:23], a[128:131], 0
    v_mfma_f32_16x16x32_bf16 v[180:183], a[20:23], a[132:135], 0
    v_mfma_f32_16x16x32_bf16 v[24:27], a[24:27], a[112:115], 0
    buffer_load_dwordx4 v226, s[84:87], s94 offen offset:2048 lds
    v_mfma_f32_16x16x32_bf16 v[56:59], a[24:27], a[116:119], 0
    v_mfma_f32_16x16x32_bf16 v[88:91], a[24:27], a[120:123], 0
    v_mfma_f32_16x16x32_bf16 v[120:123], a[24:27], a[124:127], 0
    buffer_load_dwordx4 v227, s[84:87], s94 offen offset:3072 lds
    v_mfma_f32_16x16x32_bf16 v[152:155], a[24:27], a[128:131], 0
    v_mfma_f32_16x16x32_bf16 v[184:187], a[24:27], a[132:135], 0
    v_mfma_f32_16x16x32_bf16 v[28:31], a[28:31], a[112:115], 0
    s_add_u32 s93, s93, 65536
    s_add_u32 s94, s94, 65536
    v_mfma_f32_16x16x32_bf16 v[60:63], a[28:31], a[116:119], 0
    v_mfma_f32_16x16x32_bf16 v[92:95], a[28:31], a[120:123], 0
    v_mfma_f32_16x16x32_bf16 v[124:127], a[28:31], a[124:127], 0
    v_mfma_f32_16x16x32_bf16 v[156:159], a[28:31], a[128:131], 0
    v_mfma_f32_16x16x32_bf16 v[188:191], a[28:31], a[132:135], 0
    s_waitcnt vmcnt(22) lgkmcnt(0)
    v_mfma_f32_16x16x32_bf16 v[0:3], a[32:35], a[140:143], v[0:3]
    v_mfma_f32_16x16x32_bf16 v[32:35], a[32:35], a[144:147], v[32:35]
    buffer_load_dwordx4 a[112:115], v220, s[60:63], s92 offen offset:0 sc1
    v_mfma_f32_16x16x32_bf16 v[64:67], a[32:35], a[148:151], v[64:67]
    ds_read_b64_tr_b16 a[0:1], v228 offset:16896
    v_mfma_f32_16x16x32_bf16 v[96:99], a[32:35], a[152:155], v[96:99]
    ds_read_b64_tr_b16 a[2:3], v228 offset:18944
    v_mfma_f32_16x16x32_bf16 v[128:131], a[32:35], a[156:159], v[128:131]
    buffer_load_dwordx4 a[116:119], v220, s[60:63], s92 offen offset:1024 sc1
    v_mfma_f32_16x16x32_bf16 v[160:163], a[32:35], a[160:163], v[160:163]
    ds_read_b64_tr_b16 a[4:5], v228 offset:16904
    v_mfma_f32_16x16x32_bf16 v[192:195], a[32:35], a[164:167], v[192:195]
    ds_read_b64_tr_b16 a[6:7], v228 offset:18952
    v_mfma_f32_16x16x32_bf16 v[4:7], a[36:39], a[140:143], v[4:7]
    buffer_load_dwordx4 a[120:123], v220, s[60:63], s92 offen offset:2048 sc1
    v_mfma_f32_16x16x32_bf16 v[36:39], a[36:39], a[144:147], v[36:39]
    ds_read_b64_tr_b16 a[8:9], v228 offset:17152
    v_mfma_f32_16x16x32_bf16 v[68:71], a[36:39], a[148:151], v[68:71]
    ds_read_b64_tr_b16 a[10:11], v228 offset:19200
    v_mfma_f32_16x16x32_bf16 v[100:103], a[36:39], a[152:155], v[100:103]
    buffer_load_dwordx4 a[124:127], v220, s[60:63], s92 offen offset:3072 sc1
    v_mfma_f32_16x16x32_bf16 v[132:135], a[36:39], a[156:159], v[132:135]
    ds_read_b64_tr_b16 a[12:13], v228 offset:17160
    v_mfma_f32_16x16x32_bf16 v[164:167], a[36:39], a[160:163], v[164:167]
    ds_read_b64_tr_b16 a[14:15], v228 offset:19208
    v_mfma_f32_16x16x32_bf16 v[196:199], a[36:39], a[164:167], v[196:199]
    buffer_load_dwordx4 a[128:131], v221, s[60:63], s92 offen offset:0 sc1
    v_mfma_f32_16x16x32_bf16 v[8:11], a[40:43], a[140:143], v[8:11]
    ds_read_b64_tr_b16 a[16:17], v229 offset:16896
    v_mfma_f32_16x16x32_bf16 v[40:43], a[40:43], a[144:147], v[40:43]
    ds_read_b64_tr_b16 a[18:19], v229 offset:18944
    v_mfma_f32_16x16x32_bf16 v[72:75], a[40:43], a[148:151], v[72:75]
    buffer_load_dwordx4 a[132:135], v221, s[60:63], s92 offen offset:1024 sc1
    v_mfma_f32_16x16x32_bf16 v[104:107], a[40:43], a[152:155], v[104:107]
    ds_read_b64_tr_b16 a[20:21], v229 offset:16904
    v_mfma_f32_16x16x32_bf16 v[136:139], a[40:43], a[156:159], v[136:139]
    ds_read_b64_tr_b16 a[22:23], v229 offset:18952
    v_mfma_f32_16x16x32_bf16 v[168:171], a[40:43], a[160:163], v[168:171]
    buffer_load_dwordx4 a[136:139], v222, s[60:63], s92 offen offset:0 sc1
    v_mfma_f32_16x16x32_bf16 v[200:203], a[40:43], a[164:167], v[200:203]
    ds_read_b64_tr_b16 a[24:25], v229 offset:17152
    v_mfma_f32_16x16x32_bf16 v[12:15], a[44:47], a[140:143], v[12:15]
    ds_read_b64_tr_b16 a[26:27], v229 offset:19200
    v_mfma_f32_16x16x32_bf16 v[44:47], a[44:47], a[144:147], v[44:47]
    s_add_u32 s92, s92, 13312
    s_add_u32 m0, s97, 8448
    s_nop 0
    buffer_load_dwordx4 v224, s[84:87], s93 offen offset:0 lds
    v_mfma_f32_16x16x32_bf16 v[76:79], a[44:47], a[148:151], v[76:79]
    ds_read_b64_tr_b16 a[28:29], v229 offset:17160
    v_mfma_f32_16x16x32_bf16 v[108:111], a[44:47], a[152:155], v[108:111]
    ds_read_b64_tr_b16 a[30:31], v229 offset:19208
    v_mfma_f32_16x16x32_bf16 v[140:143], a[44:47], a[156:159], v[140:143]
    buffer_load_dwordx4 v225, s[84:87], s93 offen offset:1024 lds
    v_mfma_f32_16x16x32_bf16 v[172:175], a[44:47], a[160:163], v[172:175]
    v_mfma_f32_16x16x32_bf16 v[204:207], a[44:47], a[164:167], v[204:207]
    v_mfma_f32_16x16x32_bf16 v[16:19], a[48:51], a[140:143], v[16:19]
    buffer_load_dwordx4 v226, s[84:87], s93 offen offset:2048 lds
    v_mfma_f32_16x16x32_bf16 v[48:51], a[48:51], a[144:147], v[48:51]
    v_mfma_f32_16x16x32_bf16 v[80:83], a[48:51], a[148:151], v[80:83]
    v_mfma_f32_16x16x32_bf16 v[112:115], a[48:51], a[152:155], v[112:115]
    buffer_load_dwordx4 v227, s[84:87], s93 offen offset:3072 lds
    v_mfma_f32_16x16x32_bf16 v[144:147], a[48:51], a[156:159], v[144:147]
    v_mfma_f32_16x16x32_bf16 v[176:179], a[48:51], a[160:163], v[176:179]
    v_mfma_f32_16x16x32_bf16 v[20:23], a[52:55], a[140:143], v[20:23]
    s_add_u32 m0, s97, 12552
    s_nop 0
    buffer_load_dwordx4 v224, s[84:87], s94 offen offset:0 lds
    v_mfma_f32_16x16x32_bf16 v[52:55], a[52:55], a[144:147], v[52:55]
    v_mfma_f32_16x16x32_bf16 v[84:87], a[52:55], a[148:151], v[84:87]
    v_mfma_f32_16x16x32_bf16 v[116:119], a[52:55], a[152:155], v[116:119]
    buffer_load_dwordx4 v225, s[84:87], s94 offen offset:1024 lds
    v_mfma_f32_16x16x32_bf16 v[148:151], a[52:55], a[156:159], v[148:151]
    v_mfma_f32_16x16x32_bf16 v[180:183], a[52:55], a[160:163], v[180:183]
    v_mfma_f32_16x16x32_bf16 v[24:27], a[56:59], a[140:143], v[24:27]
    buffer_load_dwordx4 v226, s[84:87], s94 offen offset:2048 lds
    v_mfma_f32_16x16x32_bf16 v[56:59], a[56:59], a[144:147], v[56:59]
    v_mfma_f32_16x16x32_bf16 v[88:91], a[56:59], a[148:151], v[88:91]
    v_mfma_f32_16x16x32_bf16 v[120:123], a[56:59], a[152:155], v[120:123]
    buffer_load_dwordx4 v227, s[84:87], s94 offen offset:3072 lds
    v_mfma_f32_16x16x32_bf16 v[152:155], a[56:59], a[156:159], v[152:155]
    v_mfma_f32_16x16x32_bf16 v[184:187], a[56:59], a[160:163], v[184:187]
    v_mfma_f32_16x16x32_bf16 v[28:31], a[60:63], a[140:143], v[28:31]
    s_add_u32 s93, s93, 65536
    s_add_u32 s94, s94, 65536
    v_mfma_f32_16x16x32_bf16 v[60:63], a[60:63], a[144:147], v[60:63]
    v_mfma_f32_16x16x32_bf16 v[92:95], a[60:63], a[148:151], v[92:95]
    v_mfma_f32_16x16x32_bf16 v[124:127], a[60:63], a[152:155], v[124:127]
    v_mfma_f32_16x16x32_bf16 v[156:159], a[60:63], a[156:159], v[156:159]
    v_mfma_f32_16x16x32_bf16 v[188:191], a[60:63], a[160:163], v[188:191]
    s_waitcnt vmcnt(30) lgkmcnt(0)
    v_mfma_f32_16x16x32_bf16 v[0:3], a[0:3], a[168:171], v[0:3]
    s_mov_b64 exec, 1
    buffer_load_dword v230, v231, s[72:75], s95 offen sc1
    s_mov_b64 exec, -1
    v_mfma_f32_16x16x32_bf16 v[32:35], a[0:3], a[172:175], v[32:35]
    buffer_load_dwordx4 a[140:143], v220, s[60:63], s92 offen offset:0 sc1
    v_mfma_f32_16x16x32_bf16 v[64:67], a[0:3], a[176:179], v[64:67]
    ds_read_b64_tr_b16 a[32:33], v228 offset:25344
    v_mfma_f32_16x16x32_bf16 v[96:99], a[0:3], a[180:183], v[96:99]
    ds_read_b64_tr_b16 a[34:35], v228 offset:27392
    v_mfma_f32_16x16x32_bf16 v[128:131], a[0:3], a[184:187], v[128:131]
    buffer_load_dwordx4 a[144:147], v220, s[60:63], s92 offen offset:1024 sc1
    v_mfma_f32_16x16x32_bf16 v[160:163], a[0:3], a[188:191], v[160:163]
    ds_read_b64_tr_b16 a[36:37], v228 offset:25352
    v_mfma_f32_16x16x32_bf16 v[192:195], a[0:3], a[192:195], v[192:195]
    ds_read_b64_tr_b16 a[38:39], v228 offset:27400
    v_mfma_f32_16x16x32_bf16 v[4:7], a[4:7], a[168:171], v[4:7]
    buffer_load_dwordx4 a[148:151], v220, s[60:63], s92 offen offset:2048 sc1
    v_mfma_f32_16x16x32_bf16 v[36:39], a[4:7], a[172:175], v[36:39]
    ds_read_b64_tr_b16 a[40:41], v228 offset:25600
    v_mfma_f32_16x16x32_bf16 v[68:71], a[4:7], a[176:179], v[68:71]
    ds_read_b64_tr_b16 a[42:43], v228 offset:27648
    v_mfma_f32_16x16x32_bf16 v[100:103], a[4:7], a[180:183], v[100:103]
    buffer_load_dwordx4 a[152:155], v220, s[60:63], s92 offen offset:3072 sc1
    v_mfma_f32_16x16x32_bf16 v[132:135], a[4:7], a[184:187], v[132:135]
    ds_read_b64_tr_b16 a[44:45], v228 offset:25608
    v_mfma_f32_16x16x32_bf16 v[164:167], a[4:7], a[188:191], v[164:167]
    ds_read_b64_tr_b16 a[46:47], v228 offset:27656
    v_mfma_f32_16x16x32_bf16 v[196:199], a[4:7], a[192:195], v[196:199]
    buffer_load_dwordx4 a[156:159], v221, s[60:63], s92 offen offset:0 sc1
    v_mfma_f32_16x16x32_bf16 v[8:11], a[8:11], a[168:171], v[8:11]
    ds_read_b64_tr_b16 a[48:49], v229 offset:25344
    v_mfma_f32_16x16x32_bf16 v[40:43], a[8:11], a[172:175], v[40:43]
    ds_read_b64_tr_b16 a[50:51], v229 offset:27392
    v_mfma_f32_16x16x32_bf16 v[72:75], a[8:11], a[176:179], v[72:75]
    buffer_load_dwordx4 a[160:163], v221, s[60:63], s92 offen offset:1024 sc1
    v_mfma_f32_16x16x32_bf16 v[104:107], a[8:11], a[180:183], v[104:107]
    ds_read_b64_tr_b16 a[52:53], v229 offset:25352
    v_mfma_f32_16x16x32_bf16 v[136:139], a[8:11], a[184:187], v[136:139]
    ds_read_b64_tr_b16 a[54:55], v229 offset:27400
    v_mfma_f32_16x16x32_bf16 v[168:171], a[8:11], a[188:191], v[168:171]
    buffer_load_dwordx4 a[164:167], v222, s[60:63], s92 offen offset:0 sc1
    v_mfma_f32_16x16x32_bf16 v[200:203], a[8:11], a[192:195], v[200:203]
    ds_read_b64_tr_b16 a[56:57], v229 offset:25600
    v_mfma_f32_16x16x32_bf16 v[12:15], a[12:15], a[168:171], v[12:15]
    ds_read_b64_tr_b16 a[58:59], v229 offset:27648
    v_mfma_f32_16x16x32_bf16 v[44:47], a[12:15], a[172:175], v[44:47]
    s_add_u32 s92, s92, 13312
    s_add_u32 m0, s97, 16896
    s_nop 0
    buffer_load_dwordx4 v224, s[84:87], s93 offen offset:0 lds
    v_mfma_f32_16x16x32_bf16 v[76:79], a[12:15], a[176:179], v[76:79]
    ds_read_b64_tr_b16 a[60:61], v229 offset:25608
    v_mfma_f32_16x16x32_bf16 v[108:111], a[12:15], a[180:183], v[108:111]
    ds_read_b64_tr_b16 a[62:63], v229 offset:27656
    v_mfma_f32_16x16x32_bf16 v[140:143], a[12:15], a[184:187], v[140:143]
    buffer_load_dwordx4 v225, s[84:87], s93 offen offset:1024 lds
    v_mfma_f32_16x16x32_bf16 v[172:175], a[12:15], a[188:191], v[172:175]
    v_mfma_f32_16x16x32_bf16 v[204:207], a[12:15], a[192:195], v[204:207]
    v_mfma_f32_16x16x32_bf16 v[16:19], a[16:19], a[168:171], v[16:19]
    buffer_load_dwordx4 v226, s[84:87], s93 offen offset:2048 lds
    v_mfma_f32_16x16x32_bf16 v[48:51], a[16:19], a[172:175], v[48:51]
    v_mfma_f32_16x16x32_bf16 v[80:83], a[16:19], a[176:179], v[80:83]
    v_mfma_f32_16x16x32_bf16 v[112:115], a[16:19], a[180:183], v[112:115]
    buffer_load_dwordx4 v227, s[84:87], s93 offen offset:3072 lds
    v_mfma_f32_16x16x32_bf16 v[144:147], a[16:19], a[184:187], v[144:147]
    v_mfma_f32_16x16x32_bf16 v[176:179], a[16:19], a[188:191], v[176:179]
    v_mfma_f32_16x16x32_bf16 v[20:23], a[20:23], a[168:171], v[20:23]
    s_add_u32 m0, s97, 21000
    s_nop 0
    buffer_load_dwordx4 v224, s[84:87], s94 offen offset:0 lds
    v_mfma_f32_16x16x32_bf16 v[52:55], a[20:23], a[172:175], v[52:55]
    v_mfma_f32_16x16x32_bf16 v[84:87], a[20:23], a[176:179], v[84:87]
    v_mfma_f32_16x16x32_bf16 v[116:119], a[20:23], a[180:183], v[116:119]
    buffer_load_dwordx4 v225, s[84:87], s94 offen offset:1024 lds
    v_mfma_f32_16x16x32_bf16 v[148:151], a[20:23], a[184:187], v[148:151]
    v_mfma_f32_16x16x32_bf16 v[180:183], a[20:23], a[188:191], v[180:183]
    v_mfma_f32_16x16x32_bf16 v[24:27], a[24:27], a[168:171], v[24:27]
    buffer_load_dwordx4 v226, s[84:87], s94 offen offset:2048 lds
    v_mfma_f32_16x16x32_bf16 v[56:59], a[24:27], a[172:175], v[56:59]
    v_mfma_f32_16x16x32_bf16 v[88:91], a[24:27], a[176:179], v[88:91]
    v_mfma_f32_16x16x32_bf16 v[120:123], a[24:27], a[180:183], v[120:123]
    buffer_load_dwordx4 v227, s[84:87], s94 offen offset:3072 lds
    v_mfma_f32_16x16x32_bf16 v[152:155], a[24:27], a[184:187], v[152:155]
    v_mfma_f32_16x16x32_bf16 v[184:187], a[24:27], a[188:191], v[184:187]
    v_mfma_f32_16x16x32_bf16 v[28:31], a[28:31], a[168:171], v[28:31]
    s_add_u32 s93, s93, 65536
    s_add_u32 s94, s94, 65536
    v_mfma_f32_16x16x32_bf16 v[60:63], a[28:31], a[172:175], v[60:63]
    v_mfma_f32_16x16x32_bf16 v[92:95], a[28:31], a[176:179], v[92:95]
    v_mfma_f32_16x16x32_bf16 v[124:127], a[28:31], a[180:183], v[124:127]
    v_mfma_f32_16x16x32_bf16 v[156:159], a[28:31], a[184:187], v[156:159]
    v_mfma_f32_16x16x32_bf16 v[188:191], a[28:31], a[188:191], v[188:191]
    s_waitcnt vmcnt(30) lgkmcnt(0)
    v_mfma_f32_16x16x32_bf16 v[0:3], a[32:35], a[196:199], v[0:3]
    v_mfma_f32_16x16x32_bf16 v[32:35], a[32:35], a[200:203], v[32:35]
    buffer_load_dwordx4 a[168:171], v220, s[60:63], s92 offen offset:0 sc1
    v_mfma_f32_16x16x32_bf16 v[64:67], a[32:35], a[204:207], v[64:67]
    ds_read_b64_tr_b16 a[0:1], v228 offset:0
    v_mfma_f32_16x16x32_bf16 v[96:99], a[32:35], a[208:211], v[96:99]
    ds_read_b64_tr_b16 a[2:3], v228 offset:2048
    v_mfma_f32_16x16x32_bf16 v[128:131], a[32:35], a[212:215], v[128:131]
    buffer_load_dwordx4 a[172:175], v220, s[60:63], s92 offen offset:1024 sc1
    v_mfma_f32_16x16x32_bf16 v[160:163], a[32:35], a[216:219], v[160:163]
    ds_read_b64_tr_b16 a[4:5], v228 offset:8
    v_mfma_f32_16x16x32_bf16 v[192:195], a[32:35], a[220:223], v[192:195]
    ds_read_b64_tr_b16 a[6:7], v228 offset:2056
    v_mfma_f32_16x16x32_bf16 v[4:7], a[36:39], a[196:199], v[4:7]
    buffer_load_dwordx4 a[176:179], v220, s[60:63], s92 offen offset:2048 sc1
    v_mfma_f32_16x16x32_bf16 v[36:39], a[36:39], a[200:203], v[36:39]
    ds_read_b64_tr_b16 a[8:9], v228 offset:256
    v_mfma_f32_16x16x32_bf16 v[68:71], a[36:39], a[204:207], v[68:71]
    ds_read_b64_tr_b16 a[10:11], v228 offset:2304
    v_mfma_f32_16x16x32_bf16 v[100:103], a[36:39], a[208:211], v[100:103]
    buffer_load_dwordx4 a[180:183], v220, s[60:63], s92 offen offset:3072 sc1
    v_mfma_f32_16x16x32_bf16 v[132:135], a[36:39], a[212:215], v[132:135]
    ds_read_b64_tr_b16 a[12:13], v228 offset:264
    v_mfma_f32_16x16x32_bf16 v[164:167], a[36:39], a[216:219], v[164:167]
    ds_read_b64_tr_b16 a[14:15], v228 offset:2312
    v_mfma_f32_16x16x32_bf16 v[196:199], a[36:39], a[220:223], v[196:199]
    buffer_load_dwordx4 a[184:187], v221, s[60:63], s92 offen offset:0 sc1
    v_mfma_f32_16x16x32_bf16 v[8:11], a[40:43], a[196:199], v[8:11]
    ds_read_b64_tr_b16 a[16:17], v229 offset:0
    v_mfma_f32_16x16x32_bf16 v[40:43], a[40:43], a[200:203], v[40:43]
    ds_read_b64_tr_b16 a[18:19], v229 offset:2048
    v_mfma_f32_16x16x32_bf16 v[72:75], a[40:43], a[204:207], v[72:75]
    buffer_load_dwordx4 a[188:191], v221, s[60:63], s92 offen offset:1024 sc1
    v_mfma_f32_16x16x32_bf16 v[104:107], a[40:43], a[208:211], v[104:107]
    ds_read_b64_tr_b16 a[20:21], v229 offset:8
    v_mfma_f32_16x16x32_bf16 v[136:139], a[40:43], a[212:215], v[136:139]
    ds_read_b64_tr_b16 a[22:23], v229 offset:2056
    v_mfma_f32_16x16x32_bf16 v[168:171], a[40:43], a[216:219], v[168:171]
    buffer_load_dwordx4 a[192:195], v222, s[60:63], s92 offen offset:0 sc1
    v_mfma_f32_16x16x32_bf16 v[200:203], a[40:43], a[220:223], v[200:203]
    ds_read_b64_tr_b16 a[24:25], v229 offset:256
    v_mfma_f32_16x16x32_bf16 v[12:15], a[44:47], a[196:199], v[12:15]
    ds_read_b64_tr_b16 a[26:27], v229 offset:2304
    v_mfma_f32_16x16x32_bf16 v[44:47], a[44:47], a[200:203], v[44:47]
    s_add_u32 s92, s92, 13312
    s_add_u32 m0, s97, 25344
    s_nop 0
    buffer_load_dwordx4 v224, s[84:87], s93 offen offset:0 lds
    v_mfma_f32_16x16x32_bf16 v[76:79], a[44:47], a[204:207], v[76:79]
    ds_read_b64_tr_b16 a[28:29], v229 offset:264
    v_mfma_f32_16x16x32_bf16 v[108:111], a[44:47], a[208:211], v[108:111]
    ds_read_b64_tr_b16 a[30:31], v229 offset:2312
    v_mfma_f32_16x16x32_bf16 v[140:143], a[44:47], a[212:215], v[140:143]
    buffer_load_dwordx4 v225, s[84:87], s93 offen offset:1024 lds
    v_mfma_f32_16x16x32_bf16 v[172:175], a[44:47], a[216:219], v[172:175]
    v_mfma_f32_16x16x32_bf16 v[204:207], a[44:47], a[220:223], v[204:207]
    v_mfma_f32_16x16x32_bf16 v[16:19], a[48:51], a[196:199], v[16:19]
    buffer_load_dwordx4 v226, s[84:87], s93 offen offset:2048 lds
    v_mfma_f32_16x16x32_bf16 v[48:51], a[48:51], a[200:203], v[48:51]
    v_mfma_f32_16x16x32_bf16 v[80:83], a[48:51], a[204:207], v[80:83]
    v_mfma_f32_16x16x32_bf16 v[112:115], a[48:51], a[208:211], v[112:115]
    buffer_load_dwordx4 v227, s[84:87], s93 offen offset:3072 lds
    v_mfma_f32_16x16x32_bf16 v[144:147], a[48:51], a[212:215], v[144:147]
    v_mfma_f32_16x16x32_bf16 v[176:179], a[48:51], a[216:219], v[176:179]
    v_mfma_f32_16x16x32_bf16 v[20:23], a[52:55], a[196:199], v[20:23]
    s_add_u32 m0, s97, 29448
    s_nop 0
    buffer_load_dwordx4 v224, s[84:87], s94 offen offset:0 lds
    v_mfma_f32_16x16x32_bf16 v[52:55], a[52:55], a[200:203], v[52:55]
    v_mfma_f32_16x16x32_bf16 v[84:87], a[52:55], a[204:207], v[84:87]
    v_mfma_f32_16x16x32_bf16 v[116:119], a[52:55], a[208:211], v[116:119]
    buffer_load_dwordx4 v225, s[84:87], s94 offen offset:1024 lds
    v_mfma_f32_16x16x32_bf16 v[148:151], a[52:55], a[212:215], v[148:151]
    v_mfma_f32_16x16x32_bf16 v[180:183], a[52:55], a[216:219], v[180:183]
    v_mfma_f32_16x16x32_bf16 v[24:27], a[56:59], a[196:199], v[24:27]
    buffer_load_dwordx4 v226, s[84:87], s94 offen offset:2048 lds
    v_mfma_f32_16x16x32_bf16 v[56:59], a[56:59], a[200:203], v[56:59]
    v_mfma_f32_16x16x32_bf16 v[88:91], a[56:59], a[204:207], v[88:91]
    v_mfma_f32_16x16x32_bf16 v[120:123], a[56:59], a[208:211], v[120:123]
    buffer_load_dwordx4 v227, s[84:87], s94 offen offset:3072 lds
    v_mfma_f32_16x16x32_bf16 v[152:155], a[56:59], a[212:215], v[152:155]
    v_mfma_f32_16x16x32_bf16 v[184:187], a[56:59], a[216:219], v[184:187]
    v_mfma_f32_16x16x32_bf16 v[28:31], a[60:63], a[196:199], v[28:31]
    s_add_u32 s93, s93, 65536
    s_add_u32 s94, s94, 65536
    v_mfma_f32_16x16x32_bf16 v[60:63], a[60:63], a[200:203], v[60:63]
    v_mfma_f32_16x16x32_bf16 v[92:95], a[60:63], a[204:207], v[92:95]
    v_mfma_f32_16x16x32_bf16 v[124:127], a[60:63], a[208:211], v[124:127]
    v_mfma_f32_16x16x32_bf16 v[156:159], a[60:63], a[212:215], v[156:159]
    v_mfma_f32_16x16x32_bf16 v[188:191], a[60:63], a[216:219], v[188:191]
    s_mov_b32 s70, 6
.p2align 6
L2_loop:
    s_waitcnt vmcnt(30) lgkmcnt(0)
    v_mfma_f32_16x16x32_bf16 v[0:3], a[0:3], a[112:115], v[0:3]
    v_mfma_f32_16x16x32_bf16 v[32:35], a[0:3], a[116:119], v[32:35]
    buffer_load_dwordx4 a[196:199], v220, s[60:63], s92 offen offset:0 sc1
    v_mfma_f32_16x16x32_bf16 v[64:67], a[0:3], a[120:123], v[64:67]
    ds_read_b64_tr_b16 a[32:33], v228 offset:8448
    v_mfma_f32_16x16x32_bf16 v[96:99], a[0:3], a[124:127], v[96:99]
    ds_read_b64_tr_b16 a[34:35], v228 offset:10496
    v_mfma_f32_16x16x32_bf16 v[128:131], a[0:3], a[128:131], v[128:131]
    buffer_load_dwordx4 a[200:203], v220, s[60:63], s92 offen offset:1024 sc1
    v_mfma_f32_16x16x32_bf16 v[160:163], a[0:3], a[132:135], v[160:163]
    ds_read_b64_tr_b16 a[36:37], v228 offset:8456
    v_mfma_f32_16x16x32_bf16 v[192:195], a[0:3], a[136:139], v[192:195]
    ds_read_b64_tr_b16 a[38:39], v228 offset:10504
    v_mfma_f32_16x16x32_bf16 v[4:7], a[4:7], a[112:115], v[4:7]
    buffer_load_dwordx4 a[204:207], v220, s[60:63], s92 offen offset:2048 sc1
    v_mfma_f32_16x16x32_bf16 v[36:39], a[4:7], a[116:119], v[36:39]
    ds_read_b64_tr_b16 a[40:41], v228 offset:8704
    v_mfma_f32_16x16x32_bf16 v[68:71], a[4:7], a[120:123], v[68:71]
    ds_read_b64_tr_b16 a[42:43], v228 offset:10752
    v_mfma_f32_16x16x32_bf16 v[100:103], a[4:7], a[124:127], v[100:103]
    buffer_load_dwordx4 a[208:211], v220, s[60:63], s92 offen offset:3072 sc1
    v_mfma_f32_16x16x32_bf16 v[132:135], a[4:7], a[128:131], v[132:135]
    ds_read_b64_tr_b16 a[44:45], v228 offset:8712
    v_mfma_f32_16x16x32_bf16 v[164:167], a[4:7], a[132:135], v[164:167]
    ds_read_b64_tr_b16 a[46:47], v228 offset:10760
    v_mfma_f32_16x16x32_bf16 v[196:199], a[4:7], a[136:139], v[196:199]
    buffer_load_dwordx4 a[212:215], v221, s[60:63], s92 offen offset:0 sc1
    v_mfma_f32_16x16x32_bf16 v[8:11], a[8:11], a[112:115], v[8:11]
    ds_read_b64_tr_b16 a[48:49], v229 offset:8448
    v_mfma_f32_16x16x32_bf16 v[40:43], a[8:11], a[116:119], v[40:43]
    ds_read_b64_tr_b16 a[50:51], v229 offset:10496
    v_mfma_f32_16x16x32_bf16 v[72:75], a[8:11], a[120:123], v[72:75]
    buffer_load_dwordx4 a[216:219], v221, s[60:63], s92 offen offset:1024 sc1
    v_mfma_f32_16x16x32_bf16 v[104:107], a[8:11], a[124:127], v[104:107]
    ds_read_b64_tr_b16 a[52:53], v229 offset:8456
    v_mfma_f32_16x16x32_bf16 v[136:139], a[8:11], a[128:131], v[136:139]
    ds_read_b64_tr_b16 a[54:55], v229 offset:10504
    v_mfma_f32_16x16x32_bf16 v[168:171], a[8:11], a[132:135], v[168:171]
    buffer_load_dwordx4 a[220:223], v222, s[60:63], s92 offen offset:0 sc1
    v_mfma_f32_16x16x32_bf16 v[200:203], a[8:11], a[136:139], v[200:203]
    ds_read_b64_tr_b16 a[56:57], v229 offset:8704
    v_mfma_f32_16x16x32_bf16 v[12:15], a[12:15], a[112:115], v[12:15]
    ds_read_b64_tr_b16 a[58:59], v229 offset:10752
    v_mfma_f32_16x16x32_bf16 v[44:47], a[12:15], a[116:119], v[44:47]
    s_add_u32 s92, s92, 13312
    s_add_u32 s67, s52, s53
    s_and_b32 s67, s67, 15
    s_lshl_b32 s68, s67, 19
    s_bitcmp0_b32 s70, 0
    s_cselect_b32 s52, s67, s52
    s_cselect_b32 s93, s68, s93
    s_add_u32 s94, s93, 8192
    s_add_u32 m0, s97, 0
    s_nop 0
    buffer_load_dwordx4 v224, s[84:87], s93 offen offset:0 lds
    v_mfma_f32_16x16x32_bf16 v[76:79], a[12:15], a[120:123], v[76:79]
    ds_read_b64_tr_b16 a[60:61], v229 offset:8712
    v_mfma_f32_16x16x32_bf16 v[108:111], a[12:15], a[124:127], v[108:111]
    ds_read_b64_tr_b16 a[62:63], v229 offset:10760
    v_mfma_f32_16x16x32_bf16 v[140:143], a[12:15], a[128:131], v[140:143]
    buffer_load_dwordx4 v225, s[84:87], s93 offen offset:1024 lds
    v_mfma_f32_16x16x32_bf16 v[172:175], a[12:15], a[132:135], v[172:175]
    v_mfma_f32_16x16x32_bf16 v[204:207], a[12:15], a[136:139], v[204:207]
    v_mfma_f32_16x16x32_bf16 v[16:19], a[16:19], a[112:115], v[16:19]
    buffer_load_dwordx4 v226, s[84:87], s93 offen offset:2048 lds
    v_mfma_f32_16x16x32_bf16 v[48:51], a[16:19], a[116:119], v[48:51]
    v_mfma_f32_16x16x32_bf16 v[80:83], a[16:19], a[120:123], v[80:83]
    v_mfma_f32_16x16x32_bf16 v[112:115], a[16:19], a[124:127], v[112:115]
    buffer_load_dwordx4 v227, s[84:87], s93 offen offset:3072 lds
    v_mfma_f32_16x16x32_bf16 v[144:147], a[16:19], a[128:131], v[144:147]
    v_mfma_f32_16x16x32_bf16 v[176:179], a[16:19], a[132:135], v[176:179]
    v_mfma_f32_16x16x32_bf16 v[20:23], a[20:23], a[112:115], v[20:23]
    s_add_u32 m0, s97, 4104
    s_nop 0
    buffer_load_dwordx4 v224, s[84:87], s94 offen offset:0 lds
    v_mfma_f32_16x16x32_bf16 v[52:55], a[20:23], a[116:119], v[52:55]
    v_mfma_f32_16x16x32_bf16 v[84:87], a[20:23], a[120:123], v[84:87]
    v_mfma_f32_16x16x32_bf16 v[116:119], a[20:23], a[124:127], v[116:119]
    buffer_load_dwordx4 v225, s[84:87], s94 offen offset:1024 lds
    v_mfma_f32_16x16x32_bf16 v[148:151], a[20:23], a[128:131], v[148:151]
    v_mfma_f32_16x16x32_bf16 v[180:183], a[20:23], a[132:135], v[180:183]
    v_mfma_f32_16x16x32_bf16 v[24:27], a[24:27], a[112:115], v[24:27]
    buffer_load_dwordx4 v226, s[84:87], s94 offen offset:2048 lds
    v_mfma_f32_16x16x32_bf16 v[56:59], a[24:27], a[116:119], v[56:59]
    v_mfma_f32_16x16x32_bf16 v[88:91], a[24:27], a[120:123], v[88:91]
    v_mfma_f32_16x16x32_bf16 v[120:123], a[24:27], a[124:127], v[120:123]
    buffer_load_dwordx4 v227, s[84:87], s94 offen offset:3072 lds
    v_mfma_f32_16x16x32_bf16 v[152:155], a[24:27], a[128:131], v[152:155]
    v_mfma_f32_16x16x32_bf16 v[184:187], a[24:27], a[132:135], v[184:187]
    v_mfma_f32_16x16x32_bf16 v[28:31], a[28:31], a[112:115], v[28:31]
    s_add_u32 s93, s93, 65536
    s_add_u32 s94, s94, 65536
    v_mfma_f32_16x16x32_bf16 v[60:63], a[28:31], a[116:119], v[60:63]
    v_mfma_f32_16x16x32_bf16 v[92:95], a[28:31], a[120:123], v[92:95]
    v_mfma_f32_16x16x32_bf16 v[124:127], a[28:31], a[124:127], v[124:127]
    v_mfma_f32_16x16x32_bf16 v[156:159], a[28:31], a[128:131], v[156:159]
    v_mfma_f32_16x16x32_bf16 v[188:191], a[28:31], a[132:135], v[188:191]
    s_waitcnt vmcnt(30) lgkmcnt(0)
    v_readfirstlane_b32 s67, v230
    s_nop 0
    s_sub_u32 s67, s67, s96
    s_bitcmp1_b32 s67, s52
    s_cbranch_scc1 L2_c_k
    s_mov_b32 s69, 0x3ffff
    s_mov_b64 exec, 1
L2_c_p:
    s_and_b32 s68, s69, 15
    s_cbranch_scc0 L2_c_d
    buffer_load_dword v230, v231, s[72:75], s95 offen sc1
    s_waitcnt vmcnt(0)
    v_readfirstlane_b32 s67, v230
    s_nop 0
    s_sub_u32 s67, s67, s96
    s_branch L2_c_c
L2_c_d:
    buffer_load_dword v230, v231, s[76:79], s66 offen sc1
    s_waitcnt vmcnt(0)
    v_readfirstlane_b32 s67, v230
L2_c_c:
    s_nop 0
    s_bitcmp1_b32 s67, s52
    s_cbranch_scc1 L2_c_o
    s_sub_u32 s69, s69, 1
    s_cbranch_scc1 L2_c_o
    s_sleep 2
    s_branch L2_c_p
L2_c_o:
    s_mov_b64 exec, -1
L2_c_k:
    s_mul_i32 s67, s52, 106496
    s_bitcmp0_b32 s70, 0
    s_cselect_b32 s92, s67, s92
    v_mfma_f32_16x16x32_bf16 v[0:3], a[32:35], a[140:143], v[0:3]
    v_mfma_f32_16x16x32_bf16 v[32:35], a[32:35], a[144:147], v[32:35]
    buffer_load_dwordx4 a[112:115], v220, s[60:63], s92 offen offset:0 sc1
    v_mfma_f32_16x16x32_bf16 v[64:67], a[32:35], a[148:151], v[64:67]
    ds_read_b64_tr_b16 a[0:1], v228 offset:16896
    v_mfma_f32_16x16x32_bf16 v[96:99], a[32:35], a[152:155], v[96:99]
    ds_read_b64_tr_b16 a[2:3], v228 offset:18944
    v_mfma_f32_16x16x32_bf16 v[128:131], a[32:35], a[156:159], v[128:131]
    buffer_load_dwordx4 a[116:119], v220, s[60:63], s92 offen offset:1024 sc1
    v_mfma_f32_16x16x32_bf16 v[160:163], a[32:35], a[160:163], v[160:163]
    ds_read_b64_tr_b16 a[4:5], v228 offset:16904
    v_mfma_f32_16x16x32_bf16 v[192:195], a[32:35], a[164:167], v[192:195]
    ds_read_b64_tr_b16 a[6:7], v228 offset:18952
    v_mfma_f32_16x16x32_bf16 v[4:7], a[36:39], a[140:143], v[4:7]
    buffer_load_dwordx4 a[120:123], v220, s[60:63], s92 offen offset:2048 sc1
    v_mfma_f32_16x16x32_bf16 v[36:39], a[36:39], a[144:147], v[36:39]
    ds_read_b64_tr_b16 a[8:9], v228 offset:17152
    v_mfma_f32_16x16x32_bf16 v[68:71], a[36:39], a[148:151], v[68:71]
    ds_read_b64_tr_b16 a[10:11], v228 offset:19200
    v_mfma_f32_16x16x32_bf16 v[100:103], a[36:39], a[152:155], v[100:103]
    buffer_load_dwordx4 a[124:127], v220, s[60:63], s92 offen offset:3072 sc1
    v_mfma_f32_16x16x32_bf16 v[132:135], a[36:39], a[156:159], v[132:135]
    ds_read_b64_tr_b16 a[12:13], v228 offset:17160
    v_mfma_f32_16x16x32_bf16 v[164:167], a[36:39], a[160:163], v[164:167]
    ds_read_b64_tr_b16 a[14:15], v228 offset:19208
    v_mfma_f32_16x16x32_bf16 v[196:199], a[36:39], a[164:167], v[196:199]
    buffer_load_dwordx4 a[128:131], v221, s[60:63], s92 offen offset:0 sc1
    v_mfma_f32_16x16x32_bf16 v[8:11], a[40:43], a[140:143], v[8:11]
    ds_read_b64_tr_b16 a[16:17], v229 offset:16896
    v_mfma_f32_16x16x32_bf16 v[40:43], a[40:43], a[144:147], v[40:43]
    ds_read_b64_tr_b16 a[18:19], v229 offset:18944
    v_mfma_f32_16x16x32_bf16 v[72:75], a[40:43], a[148:151], v[72:75]
    buffer_load_dwordx4 a[132:135], v221, s[60:63], s92 offen offset:1024 sc1
    v_mfma_f32_16x16x32_bf16 v[104:107], a[40:43], a[152:155], v[104:107]
    ds_read_b64_tr_b16 a[20:21], v229 offset:16904
    v_mfma_f32_16x16x32_bf16 v[136:139], a[40:43], a[156:159], v[136:139]
    ds_read_b64_tr_b16 a[22:23], v229 offset:18952
    v_mfma_f32_16x16x32_bf16 v[168:171], a[40:43], a[160:163], v[168:171]
    buffer_load_dwordx4 a[136:139], v222, s[60:63], s92 offen offset:0 sc1
    v_mfma_f32_16x16x32_bf16 v[200:203], a[40:43], a[164:167], v[200:203]
    ds_read_b64_tr_b16 a[24:25], v229 offset:17152
    v_mfma_f32_16x16x32_bf16 v[12:15], a[44:47], a[140:143], v[12:15]
    ds_read_b64_tr_b16 a[26:27], v229 offset:19200
    v_mfma_f32_16x16x32_bf16 v[44:47], a[44:47], a[144:147], v[44:47]
    s_add_u32 s92, s92, 13312
    s_add_u32 m0, s97, 8448
    s_nop 0
    buffer_load_dwordx4 v224, s[84:87], s93 offen offset:0 lds
    v_mfma_f32_16x16x32_bf16 v[76:79], a[44:47], a[148:151], v[76:79]
    ds_read_b64_tr_b16 a[28:29], v229 offset:17160
    v_mfma_f32_16x16x32_bf16 v[108:111], a[44:47], a[152:155], v[108:111]
    ds_read_b64_tr_b16 a[30:31], v229 offset:19208
    v_mfma_f32_16x16x32_bf16 v[140:143], a[44:47], a[156:159], v[140:143]
    buffer_load_dwordx4 v225, s[84:87], s93 offen offset:1024 lds
    v_mfma_f32_16x16x32_bf16 v[172:175], a[44:47], a[160:163], v[172:175]
    v_mfma_f32_16x16x32_bf16 v[204:207], a[44:47], a[164:167], v[204:207]
    v_mfma_f32_16x16x32_bf16 v[16:19], a[48:51], a[140:143], v[16:19]
    buffer_load_dwordx4 v226, s[84:87], s93 offen offset:2048 lds
    v_mfma_f32_16x16x32_bf16 v[48:51], a[48:51], a[144:147], v[48:51]
    v_mfma_f32_16x16x32_bf16 v[80:83], a[48:51], a[148:151], v[80:83]
    v_mfma_f32_16x16x32_bf16 v[112:115], a[48:51], a[152:155], v[112:115]
    buffer_load_dwordx4 v227, s[84:87], s93 offen offset:3072 lds
    v_mfma_f32_16x16x32_bf16 v[144:147], a[48:51], a[156:159], v[144:147]
    v_mfma_f32_16x16x32_bf16 v[176:179], a[48:51], a[160:163], v[176:179]
    v_mfma_f32_16x16x32_bf16 v[20:23], a[52:55], a[140:143], v[20:23]
    s_add_u32 m0, s97, 12552
    s_nop 0
    buffer_load_dwordx4 v224, s[84:87], s94 offen offset:0 lds
    v_mfma_f32_16x16x32_bf16 v[52:55], a[52:55], a[144:147], v[52:55]
    v_mfma_f32_16x16x32_bf16 v[84:87], a[52:55], a[148:151], v[84:87]
    v_mfma_f32_16x16x32_bf16 v[116:119], a[52:55], a[152:155], v[116:119]
    buffer_load_dwordx4 v225, s[84:87], s94 offen offset:1024 lds
    v_mfma_f32_16x16x32_bf16 v[148:151], a[52:55], a[156:159], v[148:151]
    v_mfma_f32_16x16x32_bf16 v[180:183], a[52:55], a[160:163], v[180:183]
    v_mfma_f32_16x16x32_bf16 v[24:27], a[56:59], a[140:143], v[24:27]
    buffer_load_dwordx4 v226, s[84:87], s94 offen offset:2048 lds
    v_mfma_f32_16x16x32_bf16 v[56:59], a[56:59], a[144:147], v[56:59]
    v_mfma_f32_16x16x32_bf16 v[88:91], a[56:59], a[148:151], v[88:91]
    v_mfma_f32_16x16x32_bf16 v[120:123], a[56:59], a[152:155], v[120:123]
    buffer_load_dwordx4 v227, s[84:87], s94 offen offset:3072 lds
    v_mfma_f32_16x16x32_bf16 v[152:155], a[56:59], a[156:159], v[152:155]
    v_mfma_f32_16x16x32_bf16 v[184:187], a[56:59], a[160:163], v[184:187]
    v_mfma_f32_16x16x32_bf16 v[28:31], a[60:63], a[140:143], v[28:31]
    s_add_u32 s93, s93, 65536
    s_add_u32 s94, s94, 65536
    v_mfma_f32_16x16x32_bf16 v[60:63], a[60:63], a[144:147], v[60:63]
    v_mfma_f32_16x16x32_bf16 v[92:95], a[60:63], a[148:151], v[92:95]
    v_mfma_f32_16x16x32_bf16 v[124:127], a[60:63], a[152:155], v[124:127]
    v_mfma_f32_16x16x32_bf16 v[156:159], a[60:63], a[156:159], v[156:159]
    v_mfma_f32_16x16x32_bf16 v[188:191], a[60:63], a[160:163], v[188:191]
    s_waitcnt vmcnt(30) lgkmcnt(0)
    v_mfma_f32_16x16x32_bf16 v[0:3], a[0:3], a[168:171], v[0:3]
    s_mov_b64 exec, 1
    buffer_load_dword v230, v231, s[72:75], s95 offen sc1
    s_mov_b64 exec, -1
    v_mfma_f32_16x16x32_bf16 v[32:35], a[0:3], a[172:175], v[32:35]
    buffer_load_dwordx4 a[140:143], v220, s[60:63], s92 offen offset:0 sc1
    v_mfma_f32_16x16x32_bf16 v[64:67], a[0:3], a[176:179], v[64:67]
    ds_read_b64_tr_b16 a[32:33], v228 offset:25344
    v_mfma_f32_16x16x32_bf16 v[96:99], a[0:3], a[180:183], v[96:99]
    ds_read_b64_tr_b16 a[34:35], v228 offset:27392
    v_mfma_f32_16x16x32_bf16 v[128:131], a[0:3], a[184:187], v[128:131]
    buffer_load_dwordx4 a[144:147], v220, s[60:63], s92 offen offset:1024 sc1
    v_mfma_f32_16x16x32_bf16 v[160:163], a[0:3], a[188:191], v[160:163]
    ds_read_b64_tr_b16 a[36:37], v228 offset:25352
    v_mfma_f32_16x16x32_bf16 v[192:195], a[0:3], a[192:195], v[192:195]
    ds_read_b64_tr_b16 a[38:39], v228 offset:27400
    v_mfma_f32_16x16x32_bf16 v[4:7], a[4:7], a[168:171], v[4:7]
    buffer_load_dwordx4 a[148:151], v220, s[60:63], s92 offen offset:2048 sc1
    v_mfma_f32_16x16x32_bf16 v[36:39], a[4:7], a[172:175], v[36:39]
    ds_read_b64_tr_b16 a[40:41], v228 offset:25600
    v_mfma_f32_16x16x32_bf16 v[68:71], a[4:7], a[176:179], v[68:71]
    ds_read_b64_tr_b16 a[42:43], v228 offset:27648
    v_mfma_f32_16x16x32_bf16 v[100:103], a[4:7], a[180:183], v[100:103]
    buffer_load_dwordx4 a[152:155], v220, s[60:63], s92 offen offset:3072 sc1
    v_mfma_f32_16x16x32_bf16 v[132:135], a[4:7], a[184:187], v[132:135]
    ds_read_b64_tr_b16 a[44:45], v228 offset:25608
    v_mfma_f32_16x16x32_bf16 v[164:167], a[4:7], a[188:191], v[164:167]
    ds_read_b64_tr_b16 a[46:47], v228 offset:27656
    v_mfma_f32_16x16x32_bf16 v[196:199], a[4:7], a[192:195], v[196:199]
    buffer_load_dwordx4 a[156:159], v221, s[60:63], s92 offen offset:0 sc1
    v_mfma_f32_16x16x32_bf16 v[8:11], a[8:11], a[168:171], v[8:11]
    ds_read_b64_tr_b16 a[48:49], v229 offset:25344
    v_mfma_f32_16x16x32_bf16 v[40:43], a[8:11], a[172:175], v[40:43]
    ds_read_b64_tr_b16 a[50:51], v229 offset:27392
    v_mfma_f32_16x16x32_bf16 v[72:75], a[8:11], a[176:179], v[72:75]
    buffer_load_dwordx4 a[160:163], v221, s[60:63], s92 offen offset:1024 sc1
    v_mfma_f32_16x16x32_bf16 v[104:107], a[8:11], a[180:183], v[104:107]
    ds_read_b64_tr_b16 a[52:53], v229 offset:25352
    v_mfma_f32_16x16x32_bf16 v[136:139], a[8:11], a[184:187], v[136:139]
    ds_read_b64_tr_b16 a[54:55], v229 offset:27400
    v_mfma_f32_16x16x32_bf16 v[168:171], a[8:11], a[188:191], v[168:171]
    buffer_load_dwordx4 a[164:167], v222, s[60:63], s92 offen offset:0 sc1
    v_mfma_f32_16x16x32_bf16 v[200:203], a[8:11], a[192:195], v[200:203]
    ds_read_b64_tr_b16 a[56:57], v229 offset:25600
    v_mfma_f32_16x16x32_bf16 v[12:15], a[12:15], a[168:171], v[12:15]
    ds_read_b64_tr_b16 a[58:59], v229 offset:27648
    v_mfma_f32_16x16x32_bf16 v[44:47], a[12:15], a[172:175], v[44:47]
    s_add_u32 s92, s92, 13312
    s_add_u32 m0, s97, 16896
    s_nop 0
    buffer_load_dwordx4 v224, s[84:87], s93 offen offset:0 lds
    v_mfma_f32_16x16x32_bf16 v[76:79], a[12:15], a[176:179], v[76:79]
    ds_read_b64_tr_b16 a[60:61], v229 offset:25608
    v_mfma_f32_16x16x32_bf16 v[108:111], a[12:15], a[180:183], v[108:111]
    ds_read_b64_tr_b16 a[62:63], v229 offset:27656
    v_mfma_f32_16x16x32_bf16 v[140:143], a[12:15], a[184:187], v[140:143]
    buffer_load_dwordx4 v225, s[84:87], s93 offen offset:1024 lds
    v_mfma_f32_16x16x32_bf16 v[172:175], a[12:15], a[188:191], v[172:175]
    v_mfma_f32_16x16x32_bf16 v[204:207], a[12:15], a[192:195], v[204:207]
    v_mfma_f32_16x16x32_bf16 v[16:19], a[16:19], a[168:171], v[16:19]
    buffer_load_dwordx4 v226, s[84:87], s93 offen offset:2048 lds
    v_mfma_f32_16x16x32_bf16 v[48:51], a[16:19], a[172:175], v[48:51]
    v_mfma_f32_16x16x32_bf16 v[80:83], a[16:19], a[176:179], v[80:83]
    v_mfma_f32_16x16x32_bf16 v[112:115], a[16:19], a[180:183], v[112:115]
    buffer_load_dwordx4 v227, s[84:87], s93 offen offset:3072 lds
    v_mfma_f32_16x16x32_bf16 v[144:147], a[16:19], a[184:187], v[144:147]
    v_mfma_f32_16x16x32_bf16 v[176:179], a[16:19], a[188:191], v[176:179]
    v_mfma_f32_16x16x32_bf16 v[20:23], a[20:23], a[168:171], v[20:23]
    s_add_u32 m0, s97, 21000
    s_nop 0
    buffer_load_dwordx4 v224, s[84:87], s94 offen offset:0 lds
    v_mfma_f32_16x16x32_bf16 v[52:55], a[20:23], a[172:175], v[52:55]
    v_mfma_f32_16x16x32_bf16 v[84:87], a[20:23], a[176:179], v[84:87]
    v_mfma_f32_16x16x32_bf16 v[116:119], a[20:23], a[180:183], v[116:119]
    buffer_load_dwordx4 v225, s[84:87], s94 offen offset:1024 lds
    v_mfma_f32_16x16x32_bf16 v[148:151], a[20:23], a[184:187], v[148:151]
    v_mfma_f32_16x16x32_bf16 v[180:183], a[20:23], a[188:191], v[180:183]
    v_mfma_f32_16x16x32_bf16 v[24:27], a[24:27], a[168:171], v[24:27]
    buffer_load_dwordx4 v226, s[84:87], s94 offen offset:2048 lds
    v_mfma_f32_16x16x32_bf16 v[56:59], a[24:27], a[172:175], v[56:59]
    v_mfma_f32_16x16x32_bf16 v[88:91], a[24:27], a[176:179], v[88:91]
    v_mfma_f32_16x16x32_bf16 v[120:123], a[24:27], a[180:183], v[120:123]
    buffer_load_dwordx4 v227, s[84:87], s94 offen offset:3072 lds
    v_mfma_f32_16x16x32_bf16 v[152:155], a[24:27], a[184:187], v[152:155]
    v_mfma_f32_16x16x32_bf16 v[184:187], a[24:27], a[188:191], v[184:187]
    v_mfma_f32_16x16x32_bf16 v[28:31], a[28:31], a[168:171], v[28:31]
    s_add_u32 s93, s93, 65536
    s_add_u32 s94, s94, 65536
    v_mfma_f32_16x16x32_bf16 v[60:63], a[28:31], a[172:175], v[60:63]
    v_mfma_f32_16x16x32_bf16 v[92:95], a[28:31], a[176:179], v[92:95]
    v_mfma_f32_16x16x32_bf16 v[124:127], a[28:31], a[180:183], v[124:127]
    v_mfma_f32_16x16x32_bf16 v[156:159], a[28:31], a[184:187], v[156:159]
    v_mfma_f32_16x16x32_bf16 v[188:191], a[28:31], a[188:191], v[188:191]
    s_waitcnt vmcnt(30) lgkmcnt(0)
    v_mfma_f32_16x16x32_bf16 v[0:3], a[32:35], a[196:199], v[0:3]
    v_mfma_f32_16x16x32_bf16 v[32:35], a[32:35], a[200:203], v[32:35]
    buffer_load_dwordx4 a[168:171], v220, s[60:63], s92 offen offset:0 sc1
    v_mfma_f32_16x16x32_bf16 v[64:67], a[32:35], a[204:207], v[64:67]
    ds_read_b64_tr_b16 a[0:1], v228 offset:0
    v_mfma_f32_16x16x32_bf16 v[96:99], a[32:35], a[208:211], v[96:99]
    ds_read_b64_tr_b16 a[2:3], v228 offset:2048
    v_mfma_f32_16x16x32_bf16 v[128:131], a[32:35], a[212:215], v[128:131]
    buffer_load_dwordx4 a[172:175], v220, s[60:63], s92 offen offset:1024 sc1
    v_mfma_f32_16x16x32_bf16 v[160:163], a[32:35], a[216:219], v[160:163]
    ds_read_b64_tr_b16 a[4:5], v228 offset:8
    v_mfma_f32_16x16x32_bf16 v[192:195], a[32:35], a[220:223], v[192:195]
    ds_read_b64_tr_b16 a[6:7], v228 offset:2056
    v_mfma_f32_16x16x32_bf16 v[4:7], a[36:39], a[196:199], v[4:7]
    buffer_load_dwordx4 a[176:179], v220, s[60:63], s92 offen offset:2048 sc1
    v_mfma_f32_16x16x32_bf16 v[36:39], a[36:39], a[200:203], v[36:39]
    ds_read_b64_tr_b16 a[8:9], v228 offset:256
    v_mfma_f32_16x16x32_bf16 v[68:71], a[36:39], a[204:207], v[68:71]
    ds_read_b64_tr_b16 a[10:11], v228 offset:2304
    v_mfma_f32_16x16x32_bf16 v[100:103], a[36:39], a[208:211], v[100:103]
    buffer_load_dwordx4 a[180:183], v220, s[60:63], s92 offen offset:3072 sc1
    v_mfma_f32_16x16x32_bf16 v[132:135], a[36:39], a[212:215], v[132:135]
    ds_read_b64_tr_b16 a[12:13], v228 offset:264
    v_mfma_f32_16x16x32_bf16 v[164:167], a[36:39], a[216:219], v[164:167]
    ds_read_b64_tr_b16 a[14:15], v228 offset:2312
    v_mfma_f32_16x16x32_bf16 v[196:199], a[36:39], a[220:223], v[196:199]
    buffer_load_dwordx4 a[184:187], v221, s[60:63], s92 offen offset:0 sc1
    v_mfma_f32_16x16x32_bf16 v[8:11], a[40:43], a[196:199], v[8:11]
    ds_read_b64_tr_b16 a[16:17], v229 offset:0
    v_mfma_f32_16x16x32_bf16 v[40:43], a[40:43], a[200:203], v[40:43]
    ds_read_b64_tr_b16 a[18:19], v229 offset:2048
    v_mfma_f32_16x16x32_bf16 v[72:75], a[40:43], a[204:207], v[72:75]
    buffer_load_dwordx4 a[188:191], v221, s[60:63], s92 offen offset:1024 sc1
    v_mfma_f32_16x16x32_bf16 v[104:107], a[40:43], a[208:211], v[104:107]
    ds_read_b64_tr_b16 a[20:21], v229 offset:8
    v_mfma_f32_16x16x32_bf16 v[136:139], a[40:43], a[212:215], v[136:139]
    ds_read_b64_tr_b16 a[22:23], v229 offset:2056
    v_mfma_f32_16x16x32_bf16 v[168:171], a[40:43], a[216:219], v[168:171]
    buffer_load_dwordx4 a[192:195], v222, s[60:63], s92 offen offset:0 sc1
    v_mfma_f32_16x16x32_bf16 v[200:203], a[40:43], a[220:223], v[200:203]
    ds_read_b64_tr_b16 a[24:25], v229 offset:256
    v_mfma_f32_16x16x32_bf16 v[12:15], a[44:47], a[196:199], v[12:15]
    ds_read_b64_tr_b16 a[26:27], v229 offset:2304
    v_mfma_f32_16x16x32_bf16 v[44:47], a[44:47], a[200:203], v[44:47]
    s_add_u32 s92, s92, 13312
    s_add_u32 m0, s97, 25344
    s_nop 0
    buffer_load_dwordx4 v224, s[84:87], s93 offen offset:0 lds
    v_mfma_f32_16x16x32_bf16 v[76:79], a[44:47], a[204:207], v[76:79]
    ds_read_b64_tr_b16 a[28:29], v229 offset:264
    v_mfma_f32_16x16x32_bf16 v[108:111], a[44:47], a[208:211], v[108:111]
    ds_read_b64_tr_b16 a[30:31], v229 offset:2312
    v_mfma_f32_16x16x32_bf16 v[140:143], a[44:47], a[212:215], v[140:143]
    buffer_load_dwordx4 v225, s[84:87], s93 offen offset:1024 lds
    v_mfma_f32_16x16x32_bf16 v[172:175], a[44:47], a[216:219], v[172:175]
    v_mfma_f32_16x16x32_bf16 v[204:207], a[44:47], a[220:223], v[204:207]
    v_mfma_f32_16x16x32_bf16 v[16:19], a[48:51], a[196:199], v[16:19]
    buffer_load_dwordx4 v226, s[84:87], s93 offen offset:2048 lds
    v_mfma_f32_16x16x32_bf16 v[48:51], a[48:51], a[200:203], v[48:51]
    v_mfma_f32_16x16x32_bf16 v[80:83], a[48:51], a[204:207], v[80:83]
    v_mfma_f32_16x16x32_bf16 v[112:115], a[48:51], a[208:211], v[112:115]
    buffer_load_dwordx4 v227, s[84:87], s93 offen offset:3072 lds
    v_mfma_f32_16x16x32_bf16 v[144:147], a[48:51], a[212:215], v[144:147]
    v_mfma_f32_16x16x32_bf16 v[176:179], a[48:51], a[216:219], v[176:179]
    v_mfma_f32_16x16x32_bf16 v[20:23], a[52:55], a[196:199], v[20:23]
    s_add_u32 m0, s97, 29448
    s_nop 0
    buffer_load_dwordx4 v224, s[84:87], s94 offen offset:0 lds
    v_mfma_f32_16x16x32_bf16 v[52:55], a[52:55], a[200:203], v[52:55]
    v_mfma_f32_16x16x32_bf16 v[84:87], a[52:55], a[204:207], v[84:87]
    v_mfma_f32_16x16x32_bf16 v[116:119], a[52:55], a[208:211], v[116:119]
    buffer_load_dwordx4 v225, s[84:87], s94 offen offset:1024 lds
    v_mfma_f32_16x16x32_bf16 v[148:151], a[52:55], a[212:215], v[148:151]
    v_mfma_f32_16x16x32_bf16 v[180:183], a[52:55], a[216:219], v[180:183]
    v_mfma_f32_16x16x32_bf16 v[24:27], a[56:59], a[196:199], v[24:27]
    buffer_load_dwordx4 v226, s[84:87], s94 offen offset:2048 lds
    v_mfma_f32_16x16x32_bf16 v[56:59], a[56:59], a[200:203], v[56:59]
    v_mfma_f32_16x16x32_bf16 v[88:91], a[56:59], a[204:207], v[88:91]
    v_mfma_f32_16x16x32_bf16 v[120:123], a[56:59], a[208:211], v[120:123]
    buffer_load_dwordx4 v227, s[84:87], s94 offen offset:3072 lds
    v_mfma_f32_16x16x32_bf16 v[152:155], a[56:59], a[212:215], v[152:155]
    v_mfma_f32_16x16x32_bf16 v[184:187], a[56:59], a[216:219], v[184:187]
    v_mfma_f32_16x16x32_bf16 v[28:31], a[60:63], a[196:199], v[28:31]
    s_add_u32 s93, s93, 65536
    s_add_u32 s94, s94, 65536
    v_mfma_f32_16x16x32_bf16 v[60:63], a[60:63], a[200:203], v[60:63]
    v_mfma_f32_16x16x32_bf16 v[92:95], a[60:63], a[204:207], v[92:95]
    v_mfma_f32_16x16x32_bf16 v[124:127], a[60:63], a[208:211], v[124:127]
    v_mfma_f32_16x16x32_bf16 v[156:159], a[60:63], a[212:215], v[156:159]
    v_mfma_f32_16x16x32_bf16 v[188:191], a[60:63], a[216:219], v[188:191]
    s_sub_u32 s70, s70, 1
    s_cmp_lg_u32 s70, 0
    s_cbranch_scc1 L2_loop
    s_waitcnt vmcnt(30) lgkmcnt(0)
    v_mfma_f32_16x16x32_bf16 v[0:3], a[0:3], a[112:115], v[0:3]
    v_mfma_f32_16x16x32_bf16 v[32:35], a[0:3], a[116:119], v[32:35]
    buffer_load_dwordx4 a[196:199], v220, s[60:63], s92 offen offset:0 sc1
    v_mfma_f32_16x16x32_bf16 v[64:67], a[0:3], a[120:123], v[64:67]
    ds_read_b64_tr_b16 a[32:33], v228 offset:8448
    v_mfma_f32_16x16x32_bf16 v[96:99], a[0:3], a[124:127], v[96:99]
    ds_read_b64_tr_b16 a[34:35], v228 offset:10496
    v_mfma_f32_16x16x32_bf16 v[128:131], a[0:3], a[128:131], v[128:131]
    buffer_load_dwordx4 a[200:203], v220, s[60:63], s92 offen offset:1024 sc1
    v_mfma_f32_16x16x32_bf16 v[160:163], a[0:3], a[132:135], v[160:163]
    ds_read_b64_tr_b16 a[36:37], v228 offset:8456
    v_mfma_f32_16x16x32_bf16 v[192:195], a[0:3], a[136:139], v[192:195]
    ds_read_b64_tr_b16 a[38:39], v228 offset:10504
    v_mfma_f32_16x16x32_bf16 v[4:7], a[4:7], a[112:115], v[4:7]
    buffer_load_dwordx4 a[204:207], v220, s[60:63], s92 offen offset:2048 sc1
    v_mfma_f32_16x16x32_bf16 v[36:39], a[4:7], a[116:119], v[36:39]
    ds_read_b64_tr_b16 a[40:41], v228 offset:8704
    v_mfma_f32_16x16x32_bf16 v[68:71], a[4:7], a[120:123], v[68:71]
    ds_read_b64_tr_b16 a[42:43], v228 offset:10752
    v_mfma_f32_16x16x32_bf16 v[100:103], a[4:7], a[124:127], v[100:103]
    buffer_load_dwordx4 a[208:211], v220, s[60:63], s92 offen offset:3072 sc1
    v_mfma_f32_16x16x32_bf16 v[132:135], a[4:7], a[128:131], v[132:135]
    ds_read_b64_tr_b16 a[44:45], v228 offset:8712
    v_mfma_f32_16x16x32_bf16 v[164:167], a[4:7], a[132:135], v[164:167]
    ds_read_b64_tr_b16 a[46:47], v228 offset:10760
    v_mfma_f32_16x16x32_bf16 v[196:199], a[4:7], a[136:139], v[196:199]
    buffer_load_dwordx4 a[212:215], v221, s[60:63], s92 offen offset:0 sc1
    v_mfma_f32_16x16x32_bf16 v[8:11], a[8:11], a[112:115], v[8:11]
    ds_read_b64_tr_b16 a[48:49], v229 offset:8448
    v_mfma_f32_16x16x32_bf16 v[40:43], a[8:11], a[116:119], v[40:43]
    ds_read_b64_tr_b16 a[50:51], v229 offset:10496
    v_mfma_f32_16x16x32_bf16 v[72:75], a[8:11], a[120:123], v[72:75]
    buffer_load_dwordx4 a[216:219], v221, s[60:63], s92 offen offset:1024 sc1
    v_mfma_f32_16x16x32_bf16 v[104:107], a[8:11], a[124:127], v[104:107]
    ds_read_b64_tr_b16 a[52:53], v229 offset:8456
    v_mfma_f32_16x16x32_bf16 v[136:139], a[8:11], a[128:131], v[136:139]
    ds_read_b64_tr_b16 a[54:55], v229 offset:10504
    v_mfma_f32_16x16x32_bf16 v[168:171], a[8:11], a[132:135], v[168:171]
    buffer_load_dwordx4 a[220:223], v222, s[60:63], s92 offen offset:0 sc1
    v_mfma_f32_16x16x32_bf16 v[200:203], a[8:11], a[136:139], v[200:203]
    ds_read_b64_tr_b16 a[56:57], v229 offset:8704
    v_mfma_f32_16x16x32_bf16 v[12:15], a[12:15], a[112:115], v[12:15]
    ds_read_b64_tr_b16 a[58:59], v229 offset:10752
    v_mfma_f32_16x16x32_bf16 v[44:47], a[12:15], a[116:119], v[44:47]
    s_add_u32 s92, s92, 13312
    v_mfma_f32_16x16x32_bf16 v[76:79], a[12:15], a[120:123], v[76:79]
    ds_read_b64_tr_b16 a[60:61], v229 offset:8712
    v_mfma_f32_16x16x32_bf16 v[108:111], a[12:15], a[124:127], v[108:111]
    ds_read_b64_tr_b16 a[62:63], v229 offset:10760
    v_mfma_f32_16x16x32_bf16 v[140:143], a[12:15], a[128:131], v[140:143]
    v_mfma_f32_16x16x32_bf16 v[172:175], a[12:15], a[132:135], v[172:175]
    v_mfma_f32_16x16x32_bf16 v[204:207], a[12:15], a[136:139], v[204:207]
    v_mfma_f32_16x16x32_bf16 v[16:19], a[16:19], a[112:115], v[16:19]
    v_mfma_f32_16x16x32_bf16 v[48:51], a[16:19], a[116:119], v[48:51]
    v_mfma_f32_16x16x32_bf16 v[80:83], a[16:19], a[120:123], v[80:83]
    v_mfma_f32_16x16x32_bf16 v[112:115], a[16:19], a[124:127], v[112:115]
    v_mfma_f32_16x16x32_bf16 v[144:147], a[16:19], a[128:131], v[144:147]
    v_mfma_f32_16x16x32_bf16 v[176:179], a[16:19], a[132:135], v[176:179]
    v_mfma_f32_16x16x32_bf16 v[20:23], a[20:23], a[112:115], v[20:23]
    v_mfma_f32_16x16x32_bf16 v[52:55], a[20:23], a[116:119], v[52:55]
    v_mfma_f32_16x16x32_bf16 v[84:87], a[20:23], a[120:123], v[84:87]
    v_mfma_f32_16x16x32_bf16 v[116:119], a[20:23], a[124:127], v[116:119]
    v_mfma_f32_16x16x32_bf16 v[148:151], a[20:23], a[128:131], v[148:151]
    v_mfma_f32_16x16x32_bf16 v[180:183], a[20:23], a[132:135], v[180:183]
    v_mfma_f32_16x16x32_bf16 v[24:27], a[24:27], a[112:115], v[24:27]
    v_mfma_f32_16x16x32_bf16 v[56:59], a[24:27], a[116:119], v[56:59]
    v_mfma_f32_16x16x32_bf16 v[88:91], a[24:27], a[120:123], v[88:91]
    v_mfma_f32_16x16x32_bf16 v[120:123], a[24:27], a[124:127], v[120:123]
    v_mfma_f32_16x16x32_bf16 v[152:155], a[24:27], a[128:131], v[152:155]
    v_mfma_f32_16x16x32_bf16 v[184:187], a[24:27], a[132:135], v[184:187]
    v_mfma_f32_16x16x32_bf16 v[28:31], a[28:31], a[112:115], v[28:31]
    v_mfma_f32_16x16x32_bf16 v[60:63], a[28:31], a[116:119], v[60:63]
    v_mfma_f32_16x16x32_bf16 v[92:95], a[28:31], a[120:123], v[92:95]
    v_mfma_f32_16x16x32_bf16 v[124:127], a[28:31], a[124:127], v[124:127]
    v_mfma_f32_16x16x32_bf16 v[156:159], a[28:31], a[128:131], v[156:159]
    v_mfma_f32_16x16x32_bf16 v[188:191], a[28:31], a[132:135], v[188:191]
    s_waitcnt vmcnt(22) lgkmcnt(0)
    v_mfma_f32_16x16x32_bf16 v[0:3], a[32:35], a[140:143], v[0:3]
    v_mfma_f32_16x16x32_bf16 v[32:35], a[32:35], a[144:147], v[32:35]
    v_mfma_f32_16x16x32_bf16 v[64:67], a[32:35], a[148:151], v[64:67]
    ds_read_b64_tr_b16 a[0:1], v228 offset:16896
    v_mfma_f32_16x16x32_bf16 v[96:99], a[32:35], a[152:155], v[96:99]
    ds_read_b64_tr_b16 a[2:3], v228 offset:18944
    v_mfma_f32_16x16x32_bf16 v[128:131], a[32:35], a[156:159], v[128:131]
    v_mfma_f32_16x16x32_bf16 v[160:163], a[32:35], a[160:163], v[160:163]
    ds_read_b64_tr_b16 a[4:5], v228 offset:16904
    v_mfma_f32_16x16x32_bf16 v[192:195], a[32:35], a[164:167], v[192:195]
    ds_read_b64_tr_b16 a[6:7], v228 offset:18952
    v_mfma_f32_16x16x32_bf16 v[4:7], a[36:39], a[140:143], v[4:7]
    v_mfma_f32_16x16x32_bf16 v[36:39], a[36:39], a[144:147], v[36:39]
    ds_read_b64_tr_b16 a[8:9], v228 offset:17152
    v_mfma_f32_16x16x32_bf16 v[68:71], a[36:39], a[148:151], v[68:71]
    ds_read_b64_tr_b16 a[10:11], v228 offset:19200
    v_mfma_f32_16x16x32_bf16 v[100:103], a[36:39], a[152:155], v[100:103]
    v_mfma_f32_16x16x32_bf16 v[132:135], a[36:39], a[156:159], v[132:135]
    ds_read_b64_tr_b16 a[12:13], v228 offset:17160
    v_mfma_f32_16x16x32_bf16 v[164:167], a[36:39], a[160:163], v[164:167]
    ds_read_b64_tr_b16 a[14:15], v228 offset:19208
    v_mfma_f32_16x16x32_bf16 v[196:199], a[36:39], a[164:167], v[196:199]
    v_mfma_f32_16x16x32_bf16 v[8:11], a[40:43], a[140:143], v[8:11]
    ds_read_b64_tr_b16 a[16:17], v229 offset:16896
    v_mfma_f32_16x16x32_bf16 v[40:43], a[40:43], a[144:147], v[40:43]
    ds_read_b64_tr_b16 a[18:19], v229 offset:18944
    v_mfma_f32_16x16x32_bf16 v[72:75], a[40:43], a[148:151], v[72:75]
    v_mfma_f32_16x16x32_bf16 v[104:107], a[40:43], a[152:155], v[104:107]
    ds_read_b64_tr_b16 a[20:21], v229 offset:16904
    v_mfma_f32_16x16x32_bf16 v[136:139], a[40:43], a[156:159], v[136:139]
    ds_read_b64_tr_b16 a[22:23], v229 offset:18952
    v_mfma_f32_16x16x32_bf16 v[168:171], a[40:43], a[160:163], v[168:171]
    v_mfma_f32_16x16x32_bf16 v[200:203], a[40:43], a[164:167], v[200:203]
    ds_read_b64_tr_b16 a[24:25], v229 offset:17152
    v_mfma_f32_16x16x32_bf16 v[12:15], a[44:47], a[140:143], v[12:15]
    ds_read_b64_tr_b16 a[26:27], v229 offset:19200
    v_mfma_f32_16x16x32_bf16 v[44:47], a[44:47], a[144:147], v[44:47]
    v_mfma_f32_16x16x32_bf16 v[76:79], a[44:47], a[148:151], v[76:79]
    ds_read_b64_tr_b16 a[28:29], v229 offset:17160
    v_mfma_f32_16x16x32_bf16 v[108:111], a[44:47], a[152:155], v[108:111]
    ds_read_b64_tr_b16 a[30:31], v229 offset:19208
    v_mfma_f32_16x16x32_bf16 v[140:143], a[44:47], a[156:159], v[140:143]
    v_mfma_f32_16x16x32_bf16 v[172:175], a[44:47], a[160:163], v[172:175]
    v_mfma_f32_16x16x32_bf16 v[204:207], a[44:47], a[164:167], v[204:207]
    v_mfma_f32_16x16x32_bf16 v[16:19], a[48:51], a[140:143], v[16:19]
    v_mfma_f32_16x16x32_bf16 v[48:51], a[48:51], a[144:147], v[48:51]
    s_waitcnt vmcnt(7)
    v_mfma_f32_16x16x32_bf16 v[80:83], a[48:51], a[148:151], v[80:83]
    ds_read_b64_tr_b16 a[64:65], v228 offset:25344
    v_mfma_f32_16x16x32_bf16 v[112:115], a[48:51], a[152:155], v[112:115]
    ds_read_b64_tr_b16 a[66:67], v228 offset:27392
    v_mfma_f32_16x16x32_bf16 v[144:147], a[48:51], a[156:159], v[144:147]
    ds_read_b64_tr_b16 a[68:69], v228 offset:25352
    v_mfma_f32_16x16x32_bf16 v[176:179], a[48:51], a[160:163], v[176:179]
    ds_read_b64_tr_b16 a[70:71], v228 offset:27400
    v_mfma_f32_16x16x32_bf16 v[20:23], a[52:55], a[140:143], v[20:23]
    ds_read_b64_tr_b16 a[72:73], v228 offset:25600
    v_mfma_f32_16x16x32_bf16 v[52:55], a[52:55], a[144:147], v[52:55]
    ds_read_b64_tr_b16 a[74:75], v228 offset:27648
    v_mfma_f32_16x16x32_bf16 v[84:87], a[52:55], a[148:151], v[84:87]
    ds_read_b64_tr_b16 a[76:77], v228 offset:25608
    v_mfma_f32_16x16x32_bf16 v[116:119], a[52:55], a[152:155], v[116:119]
    ds_read_b64_tr_b16 a[78:79], v228 offset:27656
    v_mfma_f32_16x16x32_bf16 v[148:151], a[52:55], a[156:159], v[148:151]
    ds_read_b64_tr_b16 a[80:81], v229 offset:25344
    v_mfma_f32_16x16x32_bf16 v[180:183], a[52:55], a[160:163], v[180:183]
    ds_read_b64_tr_b16 a[82:83], v229 offset:27392
    v_mfma_f32_16x16x32_bf16 v[24:27], a[56:59], a[140:143], v[24:27]
    ds_read_b64_tr_b16 a[84:85], v229 offset:25352
    v_mfma_f32_16x16x32_bf16 v[56:59], a[56:59], a[144:147], v[56:59]
    ds_read_b64_tr_b16 a[86:87], v229 offset:27400
    v_mfma_f32_16x16x32_bf16 v[88:91], a[56:59], a[148:151], v[88:91]
    ds_read_b64_tr_b16 a[88:89], v229 offset:25600
    v_mfma_f32_16x16x32_bf16 v[120:123], a[56:59], a[152:155], v[120:123]
    ds_read_b64_tr_b16 a[90:91], v229 offset:27648
    v_mfma_f32_16x16x32_bf16 v[152:155], a[56:59], a[156:159], v[152:155]
    ds_read_b64_tr_b16 a[92:93], v229 offset:25608
    v_mfma_f32_16x16x32_bf16 v[184:187], a[56:59], a[160:163], v[184:187]
    ds_read_b64_tr_b16 a[94:95], v229 offset:27656
    v_mfma_f32_16x16x32_bf16 v[28:31], a[60:63], a[140:143], v[28:31]
    v_mfma_f32_16x16x32_bf16 v[60:63], a[60:63], a[144:147], v[60:63]
    v_mfma_f32_16x16x32_bf16 v[92:95], a[60:63], a[148:151], v[92:95]
    v_mfma_f32_16x16x32_bf16 v[124:127], a[60:63], a[152:155], v[124:127]
    v_mfma_f32_16x16x32_bf16 v[156:159], a[60:63], a[156:159], v[156:159]
    v_mfma_f32_16x16x32_bf16 v[188:191], a[60:63], a[160:163], v[188:191]
    v_lshlrev_b32 v232, 4, v247
    v_add_u32 v233, 65536, v232
    v_add_u32 v234, 131072, v232
    v_and_b32 v235, 15, v247
    v_lshlrev_b32 v235, 11, v235
    v_lshrrev_b32 v236, 4, v247
    v_lshlrev_b32 v236, 4, v236
    s_lshl_b32 s67, s82, 8
    v_add3_u32 v235, v235, v236, s67
    s_lshl_b32 s68, s83, 7
    s_sub_u32 s69, 128, s68
    s_mul_i32 s70, s83, 196608
    s_waitcnt vmcnt(0) lgkmcnt(0)
    s_barrier
    s_cmp_eq_u32 s24, 1
    s_cbranch_scc1 L2_e1
    s_cmp_eq_u32 s24, 2
    s_cbranch_scc1 L2_e2
    s_cmp_eq_u32 s24, 3
    s_cbranch_scc1 L2_e3
L2_e0:
    v_mfma_f32_16x16x32_bf16 v[8:11], a[8:11], a[168:171], v[8:11]
    v_mfma_f32_16x16x32_bf16 v[8:11], a[72:75], a[196:199], v[8:11]
    v_mfma_f32_16x16x32_bf16 v[12:15], a[12:15], a[168:171], v[12:15]
    v_mfma_f32_16x16x32_bf16 v[12:15], a[76:79], a[196:199], v[12:15]
    v_mfma_f32_16x16x32_bf16 v[16:19], a[16:19], a[168:171], v[16:19]
    v_mfma_f32_16x16x32_bf16 v[16:19], a[80:83], a[196:199], v[16:19]
    v_mfma_f32_16x16x32_bf16 v[20:23], a[20:23], a[168:171], v[20:23]
    v_mfma_f32_16x16x32_bf16 v[20:23], a[84:87], a[196:199], v[20:23]
    s_nop 1
    ds_write_b128 v232, v[8:11] offset:10240
    v_mfma_f32_16x16x32_bf16 v[24:27], a[24:27], a[168:171], v[24:27]
    v_mfma_f32_16x16x32_bf16 v[24:27], a[88:91], a[196:199], v[24:27]
    ds_write_b128 v232, v[12:15] offset:11264
    v_mfma_f32_16x16x32_bf16 v[28:31], a[28:31], a[168:171], v[28:31]
    v_mfma_f32_16x16x32_bf16 v[28:31], a[92:95], a[196:199], v[28:31]
    ds_write_b128 v232, v[16:19] offset:14336
    v_mfma_f32_16x16x32_bf16 v[40:43], a[8:11], a[172:175], v[40:43]
    v_mfma_f32_16x16x32_bf16 v[40:43], a[72:75], a[200:203], v[40:43]
    ds_write_b128 v232, v[20:23] offset:15360
    v_mfma_f32_16x16x32_bf16 v[44:47], a[12:15], a[172:175], v[44:47]
    v_mfma_f32_16x16x32_bf16 v[44:47], a[76:79], a[200:203], v[44:47]
    ds_write_b128 v232, v[24:27] offset:18432
    v_mfma_f32_16x16x32_bf16 v[48:51], a[16:19], a[172:175], v[48:51]
    v_mfma_f32_16x16x32_bf16 v[48:51], a[80:83], a[200:203], v[48:51]
    ds_write_b128 v232, v[28:31] offset:19456
    v_mfma_f32_16x16x32_bf16 v[52:55], a[20:23], a[172:175], v[52:55]
    v_mfma_f32_16x16x32_bf16 v[52:55], a[84:87], a[200:203], v[52:55]
    ds_write_b128 v232, v[40:43] offset:34816
    v_mfma_f32_16x16x32_bf16 v[56:59], a[24:27], a[172:175], v[56:59]
    v_mfma_f32_16x16x32_bf16 v[56:59], a[88:91], a[200:203], v[56:59]
    ds_write_b128 v232, v[44:47] offset:35840
    v_mfma_f32_16x16x32_bf16 v[60:63], a[28:31], a[172:175], v[60:63]
    v_mfma_f32_16x16x32_bf16 v[60:63], a[92:95], a[200:203], v[60:63]
    ds_write_b128 v232, v[48:51] offset:38912
    v_mfma_f32_16x16x32_bf16 v[72:75], a[8:11], a[176:179], v[72:75]
    v_mfma_f32_16x16x32_bf16 v[72:75], a[72:75], a[204:207], v[72:75]
    ds_write_b128 v232, v[52:55] offset:39936
    v_mfma_f32_16x16x32_bf16 v[76:79], a[12:15], a[176:179], v[76:79]
    v_mfma_f32_16x16x32_bf16 v[76:79], a[76:79], a[204:207], v[76:79]
    ds_write_b128 v232, v[56:59] offset:43008
    v_mfma_f32_16x16x32_bf16 v[80:83], a[16:19], a[176:179], v[80:83]
    v_mfma_f32_16x16x32_bf16 v[80:83], a[80:83], a[204:207], v[80:83]
    ds_write_b128 v232, v[60:63] offset:44032
    v_mfma_f32_16x16x32_bf16 v[84:87], a[20:23], a[176:179], v[84:87]
    v_mfma_f32_16x16x32_bf16 v[84:87], a[84:87], a[204:207], v[84:87]
    ds_write_b128 v232, v[72:75] offset:59392
    v_mfma_f32_16x16x32_bf16 v[88:91], a[24:27], a[176:179], v[88:91]
    v_mfma_f32_16x16x32_bf16 v[88:91], a[88:91], a[204:207], v[88:91]
    ds_write_b128 v232, v[76:79] offset:60416
    v_mfma_f32_16x16x32_bf16 v[92:95], a[28:31], a[176:179], v[92:95]
    v_mfma_f32_16x16x32_bf16 v[92:95], a[92:95], a[204:207], v[92:95]
    ds_write_b128 v232, v[80:83] offset:63488
    v_mfma_f32_16x16x32_bf16 v[104:107], a[8:11], a[180:183], v[104:107]
    v_mfma_f32_16x16x32_bf16 v[104:107], a[72:75], a[208:211], v[104:107]
    ds_write_b128 v232, v[84:87] offset:64512
    v_mfma_f32_16x16x32_bf16 v[108:111], a[12:15], a[180:183], v[108:111]
    v_mfma_f32_16x16x32_bf16 v[108:111], a[76:79], a[208:211], v[108:111]
    ds_write_b128 v233, v[88:91] offset:2048
    v_mfma_f32_16x16x32_bf16 v[112:115], a[16:19], a[180:183], v[112:115]
    v_mfma_f32_16x16x32_bf16 v[112:115], a[80:83], a[208:211], v[112:115]
    ds_write_b128 v233, v[92:95] offset:3072
    v_mfma_f32_16x16x32_bf16 v[116:119], a[20:23], a[180:183], v[116:119]
    v_mfma_f32_16x16x32_bf16 v[116:119], a[84:87], a[208:211], v[116:119]
    ds_write_b128 v233, v[104:107] offset:18432
    v_mfma_f32_16x16x32_bf16 v[120:123], a[24:27], a[180:183], v[120:123]
    v_mfma_f32_16x16x32_bf16 v[120:123], a[88:91], a[208:211], v[120:123]
    ds_write_b128 v233, v[108:111] offset:19456
    v_mfma_f32_16x16x32_bf16 v[124:127], a[28:31], a[180:183], v[124:127]
    v_mfma_f32_16x16x32_bf16 v[124:127], a[92:95], a[208:211], v[124:127]
    ds_write_b128 v233, v[112:115] offset:22528
    v_mfma_f32_16x16x32_bf16 v[136:139], a[8:11], a[184:187], v[136:139]
    v_mfma_f32_16x16x32_bf16 v[136:139], a[72:75], a[212:215], v[136:139]
    ds_write_b128 v233, v[116:119] offset:23552
    v_mfma_f32_16x16x32_bf16 v[140:143], a[12:15], a[184:187], v[140:143]
    v_mfma_f32_16x16x32_bf16 v[140:143], a[76:79], a[212:215], v[140:143]
    ds_write_b128 v233, v[120:123] offset:26624
    v_mfma_f32_16x16x32_bf16 v[144:147], a[16:19], a[184:187], v[144:147]
    v_mfma_f32_16x16x32_bf16 v[144:147], a[80:83], a[212:215], v[144:147]
    ds_write_b128 v233, v[124:127] offset:27648
    v_mfma_f32_16x16x32_bf16 v[148:151], a[20:23], a[184:187], v[148:151]
    v_mfma_f32_16x16x32_bf16 v[148:151], a[84:87], a[212:215], v[148:151]
    ds_write_b128 v233, v[136:139] offset:43008
    v_mfma_f32_16x16x32_bf16 v[152:155], a[24:27], a[184:187], v[152:155]
    v_mfma_f32_16x16x32_bf16 v[152:155], a[88:91], a[212:215], v[152:155]
    ds_write_b128 v233, v[140:143] offset:44032
    v_mfma_f32_16x16x32_bf16 v[156:159], a[28:31], a[184:187], v[156:159]
    v_mfma_f32_16x16x32_bf16 v[156:159], a[92:95], a[212:215], v[156:159]
    ds_write_b128 v233, v[144:147] offset:47104
    v_mfma_f32_16x16x32_bf16 v[168:171], a[8:11], a[188:191], v[168:171]
    v_mfma_f32_16x16x32_bf16 v[168:171], a[72:75], a[216:219], v[168:171]
    ds_write_b128 v233, v[148:151] offset:48128
    v_mfma_f32_16x16x32_bf16 v[172:175], a[12:15], a[188:191], v[172:175]
    v_mfma_f32_16x16x32_bf16 v[172:175], a[76:79], a[216:219], v[172:175]
    ds_write_b128 v233, v[152:155] offset:51200
    v_mfma_f32_16x16x32_bf16 v[176:179], a[16:19], a[188:191], v[176:179]
    v_mfma_f32_16x16x32_bf16 v[176:179], a[80:83], a[216:219], v[176:179]
    ds_write_b128 v233, v[156:159] offset:52224
    v_mfma_f32_16x16x32_bf16 v[180:183], a[20:23], a[188:191], v[180:183]
    v_mfma_f32_16x16x32_bf16 v[180:183], a[84:87], a[216:219], v[180:183]
    ds_write_b128 v234, v[168:171] offset:2048
    v_mfma_f32_16x16x32_bf16 v[184:187], a[24:27], a[188:191], v[184:187]
    v_mfma_f32_16x16x32_bf16 v[184:187], a[88:91], a[216:219], v[184:187]
    ds_write_b128 v234, v[172:175] offset:3072
    v_mfma_f32_16x16x32_bf16 v[188:191], a[28:31], a[188:191], v[188:191]
    v_mfma_f32_16x16x32_bf16 v[188:191], a[92:95], a[216:219], v[188:191]
    ds_write_b128 v234, v[176:179] offset:6144
    v_mfma_f32_16x16x32_bf16 v[200:203], a[8:11], a[192:195], v[200:203]
    v_mfma_f32_16x16x32_bf16 v[200:203], a[72:75], a[220:223], v[200:203]
    ds_write_b128 v234, v[180:183] offset:7168
    v_mfma_f32_16x16x32_bf16 v[204:207], a[12:15], a[192:195], v[204:207]
    v_mfma_f32_16x16x32_bf16 v[204:207], a[76:79], a[220:223], v[204:207]
    ds_write_b128 v234, v[184:187] offset:10240
    v_mfma_f32_16x16x32_bf16 v[0:3], a[0:3], a[168:171], v[0:3]
    v_mfma_f32_16x16x32_bf16 v[0:3], a[64:67], a[196:199], v[0:3]
    ds_write_b128 v234, v[188:191] offset:11264
    v_mfma_f32_16x16x32_bf16 v[4:7], a[4:7], a[168:171], v[4:7]
    v_mfma_f32_16x16x32_bf16 v[4:7], a[68:71], a[196:199], v[4:7]
    ds_write_b128 v234, v[200:203] offset:26624
    v_mfma_f32_16x16x32_bf16 v[32:35], a[0:3], a[172:175], v[32:35]
    v_mfma_f32_16x16x32_bf16 v[32:35], a[64:67], a[200:203], v[32:35]
    ds_write_b128 v234, v[204:207] offset:27648
    v_mfma_f32_16x16x32_bf16 v[36:39], a[4:7], a[172:175], v[36:39]
    v_mfma_f32_16x16x32_bf16 v[36:39], a[68:71], a[200:203], v[36:39]
    v_mfma_f32_16x16x32_bf16 v[64:67], a[0:3], a[176:179], v[64:67]
    v_mfma_f32_16x16x32_bf16 v[64:67], a[64:67], a[204:207], v[64:67]
    v_mfma_f32_16x16x32_bf16 v[68:71], a[4:7], a[176:179], v[68:71]
    v_mfma_f32_16x16x32_bf16 v[68:71], a[68:71], a[204:207], v[68:71]
    v_mfma_f32_16x16x32_bf16 v[96:99], a[0:3], a[180:183], v[96:99]
    v_mfma_f32_16x16x32_bf16 v[96:99], a[64:67], a[208:211], v[96:99]
    v_mfma_f32_16x16x32_bf16 v[100:103], a[4:7], a[180:183], v[100:103]
    v_mfma_f32_16x16x32_bf16 v[100:103], a[68:71], a[208:211], v[100:103]
    v_mfma_f32_16x16x32_bf16 v[128:131], a[0:3], a[184:187], v[128:131]
    v_mfma_f32_16x16x32_bf16 v[128:131], a[64:67], a[212:215], v[128:131]
    v_mfma_f32_16x16x32_bf16 v[132:135], a[4:7], a[184:187], v[132:135]
    v_mfma_f32_16x16x32_bf16 v[132:135], a[68:71], a[212:215], v[132:135]
    v_mfma_f32_16x16x32_bf16 v[160:163], a[0:3], a[188:191], v[160:163]
    v_mfma_f32_16x16x32_bf16 v[160:163], a[64:67], a[216:219], v[160:163]
    v_mfma_f32_16x16x32_bf16 v[164:167], a[4:7], a[188:191], v[164:167]
    v_mfma_f32_16x16x32_bf16 v[164:167], a[68:71], a[216:219], v[164:167]
    v_mfma_f32_16x16x32_bf16 v[192:195], a[0:3], a[192:195], v[192:195]
    v_mfma_f32_16x16x32_bf16 v[192:195], a[64:67], a[220:223], v[192:195]
    v_mfma_f32_16x16x32_bf16 v[196:199], a[4:7], a[192:195], v[196:199]
    v_mfma_f32_16x16x32_bf16 v[196:199], a[68:71], a[220:223], v[196:199]
    s_waitcnt lgkmcnt(0)
    s_barrier
    ds_read_b128 v[8:11], v232 offset:0
    ds_read_b128 v[12:15], v232 offset:1024
    ds_read_b128 v[16:19], v232 offset:2048
    ds_read_b128 v[20:23], v232 offset:3072
    ds_read_b128 v[24:27], v232 offset:4096
    ds_read_b128 v[28:31], v232 offset:5120
    ds_read_b128 v[40:43], v232 offset:24576
    ds_read_b128 v[44:47], v232 offset:25600
    ds_read_b128 v[48:51], v232 offset:26624
    ds_read_b128 v[52:55], v232 offset:27648
    ds_read_b128 v[56:59], v232 offset:28672
    ds_read_b128 v[60:63], v232 offset:29696
    ds_read_b128 v[72:75], v232 offset:49152
    ds_read_b128 v[76:79], v232 offset:50176
    ds_read_b128 v[80:83], v232 offset:51200
    ds_read_b128 v[84:87], v232 offset:52224
    ds_read_b128 v[88:91], v232 offset:53248
    ds_read_b128 v[92:95], v232 offset:54272
    ds_read_b128 v[104:107], v233 offset:8192
    ds_read_b128 v[108:111], v233 offset:9216
    ds_read_b128 v[112:115], v233 offset:10240
    ds_read_b128 v[116:119], v233 offset:11264
    ds_read_b128 v[120:123], v233 offset:12288
    ds_read_b128 v[124:127], v233 offset:13312
    ds_read_b128 v[136:139], v233 offset:32768
    ds_read_b128 v[140:143], v233 offset:33792
    ds_read_b128 v[144:147], v233 offset:34816
    ds_read_b128 v[148:151], v233 offset:35840
    ds_read_b128 v[152:155], v233 offset:36864
    ds_read_b128 v[156:159], v233 offset:37888
    ds_read_b128 v[168:171], v233 offset:57344
    ds_read_b128 v[172:175], v233 offset:58368
    ds_read_b128 v[176:179], v233 offset:59392
    ds_read_b128 v[180:183], v233 offset:60416
    ds_read_b128 v[184:187], v233 offset:61440
    ds_read_b128 v[188:191], v233 offset:62464
    ds_read_b128 v[200:203], v234 offset:16384
    ds_read_b128 v[204:207], v234 offset:17408
    ds_read_b128 v[208:211], v234 offset:18432
    ds_read_b128 v[212:215], v234 offset:19456
    ds_read_b128 v[216:219], v234 offset:20480
    ds_read_b128 v[220:223], v234 offset:21504
    s_waitcnt lgkmcnt(15)
    v_pk_add_f32 v[0:1], v[0:1], v[8:9]
    v_pk_add_f32 v[16:17], v[16:17], v[24:25]
    v_pk_add_f32 v[2:3], v[2:3], v[10:11]
    v_pk_add_f32 v[18:19], v[18:19], v[26:27]
    v_pk_add_f32 v[0:1], v[0:1], v[16:17]
    v_pk_add_f32 v[2:3], v[2:3], v[18:19]
    v_pk_add_f32 v[4:5], v[4:5], v[12:13]
    v_pk_add_f32 v[20:21], v[20:21], v[28:29]
    v_pk_add_f32 v[6:7], v[6:7], v[14:15]
    v_pk_add_f32 v[22:23], v[22:23], v[30:31]
    v_pk_add_f32 v[4:5], v[4:5], v[20:21]
    v_pk_add_f32 v[6:7], v[6:7], v[22:23]
    v_cvt_pk_bf16_f32 v0, v0, v1
    v_cvt_pk_bf16_f32 v1, v2, v3
    v_cvt_pk_bf16_f32 v2, v4, v5
    v_cvt_pk_bf16_f32 v3, v6, v7
    s_add_u32 s71, s70, 0
    s_add_u32 s71, s71, s68
    buffer_store_dwordx4 v[0:3], v235, s[88:91], s71 offen offset:0 sc0 sc1 nt
    v_pk_add_f32 v[32:33], v[32:33], v[40:41]
    v_pk_add_f32 v[48:49], v[48:49], v[56:57]
    v_pk_add_f32 v[34:35], v[34:35], v[42:43]
    v_pk_add_f32 v[50:51], v[50:51], v[58:59]
    v_pk_add_f32 v[32:33], v[32:33], v[48:49]
    v_pk_add_f32 v[34:35], v[34:35], v[50:51]
    v_pk_add_f32 v[36:37], v[36:37], v[44:45]
    v_pk_add_f32 v[52:53], v[52:53], v[60:61]
    v_pk_add_f32 v[38:39], v[38:39], v[46:47]
    v_pk_add_f32 v[54:55], v[54:55], v[62:63]
    v_pk_add_f32 v[36:37], v[36:37], v[52:53]
    v_pk_add_f32 v[38:39], v[38:39], v[54:55]
    v_cvt_pk_bf16_f32 v32, v32, v33
    v_cvt_pk_bf16_f32 v33, v34, v35
    v_cvt_pk_bf16_f32 v34, v36, v37
    v_cvt_pk_bf16_f32 v35, v38, v39
    s_add_u32 s71, s70, 32768
    s_add_u32 s71, s71, s68
    buffer_store_dwordx4 v[32:35], v235, s[88:91], s71 offen offset:0 sc0 sc1 nt
    v_pk_add_f32 v[64:65], v[64:65], v[72:73]
    v_pk_add_f32 v[80:81], v[80:81], v[88:89]
    v_pk_add_f32 v[66:67], v[66:67], v[74:75]
    v_pk_add_f32 v[82:83], v[82:83], v[90:91]
    v_pk_add_f32 v[64:65], v[64:65], v[80:81]
    v_pk_add_f32 v[66:67], v[66:67], v[82:83]
    v_pk_add_f32 v[68:69], v[68:69], v[76:77]
    v_pk_add_f32 v[84:85], v[84:85], v[92:93]
    v_pk_add_f32 v[70:71], v[70:71], v[78:79]
    v_pk_add_f32 v[86:87], v[86:87], v[94:95]
    v_pk_add_f32 v[68:69], v[68:69], v[84:85]
    v_pk_add_f32 v[70:71], v[70:71], v[86:87]
    v_cvt_pk_bf16_f32 v64, v64, v65
    v_cvt_pk_bf16_f32 v65, v66, v67
    v_cvt_pk_bf16_f32 v66, v68, v69
    v_cvt_pk_bf16_f32 v67, v70, v71
    s_add_u32 s71, s70, 65536
    s_add_u32 s71, s71, s68
    buffer_store_dwordx4 v[64:67], v235, s[88:91], s71 offen offset:0 sc0 sc1 nt
    v_pk_add_f32 v[96:97], v[96:97], v[104:105]
    v_pk_add_f32 v[112:113], v[112:113], v[120:121]
    v_pk_add_f32 v[98:99], v[98:99], v[106:107]
    v_pk_add_f32 v[114:115], v[114:115], v[122:123]
    v_pk_add_f32 v[96:97], v[96:97], v[112:113]
    v_pk_add_f32 v[98:99], v[98:99], v[114:115]
    v_pk_add_f32 v[100:101], v[100:101], v[108:109]
    v_pk_add_f32 v[116:117], v[116:117], v[124:125]
    v_pk_add_f32 v[102:103], v[102:103], v[110:111]
    v_pk_add_f32 v[118:119], v[118:119], v[126:127]
    v_pk_add_f32 v[100:101], v[100:101], v[116:117]
    v_pk_add_f32 v[102:103], v[102:103], v[118:119]
    v_cvt_pk_bf16_f32 v96, v96, v97
    v_cvt_pk_bf16_f32 v97, v98, v99
    v_cvt_pk_bf16_f32 v98, v100, v101
    v_cvt_pk_bf16_f32 v99, v102, v103
    s_add_u32 s71, s70, 98304
    s_add_u32 s71, s71, s68
    buffer_store_dwordx4 v[96:99], v235, s[88:91], s71 offen offset:0 sc0 sc1 nt
    v_pk_add_f32 v[128:129], v[128:129], v[136:137]
    s_waitcnt lgkmcnt(13)
    v_pk_add_f32 v[144:145], v[144:145], v[152:153]
    v_pk_add_f32 v[130:131], v[130:131], v[138:139]
    v_pk_add_f32 v[146:147], v[146:147], v[154:155]
    v_pk_add_f32 v[128:129], v[128:129], v[144:145]
    v_pk_add_f32 v[130:131], v[130:131], v[146:147]
    v_pk_add_f32 v[132:133], v[132:133], v[140:141]
    s_waitcnt lgkmcnt(12)
    v_pk_add_f32 v[148:149], v[148:149], v[156:157]
    v_pk_add_f32 v[134:135], v[134:135], v[142:143]
    v_pk_add_f32 v[150:151], v[150:151], v[158:159]
    v_pk_add_f32 v[132:133], v[132:133], v[148:149]
    v_pk_add_f32 v[134:135], v[134:135], v[150:151]
    v_cvt_pk_bf16_f32 v128, v128, v129
    v_cvt_pk_bf16_f32 v129, v130, v131
    v_cvt_pk_bf16_f32 v130, v132, v133
    v_cvt_pk_bf16_f32 v131, v134, v135
    s_add_u32 s71, s70, 131072
    s_add_u32 s71, s71, s68
    buffer_store_dwordx4 v[128:131], v235, s[88:91], s71 offen offset:0 sc0 sc1 nt
    s_waitcnt lgkmcnt(11)
    v_pk_add_f32 v[160:161], v[160:161], v[168:169]
    s_waitcnt lgkmcnt(7)
    v_pk_add_f32 v[176:177], v[176:177], v[184:185]
    v_pk_add_f32 v[162:163], v[162:163], v[170:171]
    v_pk_add_f32 v[178:179], v[178:179], v[186:187]
    v_pk_add_f32 v[160:161], v[160:161], v[176:177]
    v_pk_add_f32 v[162:163], v[162:163], v[178:179]
    v_pk_add_f32 v[164:165], v[164:165], v[172:173]
    s_waitcnt lgkmcnt(6)
    v_pk_add_f32 v[180:181], v[180:181], v[188:189]
    v_pk_add_f32 v[166:167], v[166:167], v[174:175]
    v_pk_add_f32 v[182:183], v[182:183], v[190:191]
    v_pk_add_f32 v[164:165], v[164:165], v[180:181]
    v_pk_add_f32 v[166:167], v[166:167], v[182:183]
    v_cvt_pk_bf16_f32 v160, v160, v161
    v_cvt_pk_bf16_f32 v161, v162, v163
    v_cvt_pk_bf16_f32 v162, v164, v165
    v_cvt_pk_bf16_f32 v163, v166, v167
    s_add_u32 s71, s70, 163840
    s_add_u32 s71, s71, s68
    buffer_store_dwordx4 v[160:163], v235, s[88:91], s71 offen offset:0 sc0 sc1 nt
    s_waitcnt lgkmcnt(5)
    v_pk_add_f32 v[192:193], v[192:193], v[200:201]
    s_waitcnt lgkmcnt(1)
    v_pk_add_f32 v[208:209], v[208:209], v[216:217]
    v_pk_add_f32 v[194:195], v[194:195], v[202:203]
    v_pk_add_f32 v[210:211], v[210:211], v[218:219]
    v_pk_add_f32 v[192:193], v[192:193], v[208:209]
    v_pk_add_f32 v[194:195], v[194:195], v[210:211]
    v_pk_add_f32 v[196:197], v[196:197], v[204:205]
    s_waitcnt lgkmcnt(0)
    v_pk_add_f32 v[212:213], v[212:213], v[220:221]
    v_pk_add_f32 v[198:199], v[198:199], v[206:207]
    v_pk_add_f32 v[214:215], v[214:215], v[222:223]
    v_pk_add_f32 v[196:197], v[196:197], v[212:213]
    v_pk_add_f32 v[198:199], v[198:199], v[214:215]
    v_cvt_pk_bf16_f32 v192, v192, v193
    v_cvt_pk_bf16_f32 v193, v194, v195
    v_cvt_pk_bf16_f32 v194, v196, v197
    v_cvt_pk_bf16_f32 v195, v198, v199
    s_add_u32 s71, s68, 393216
    buffer_store_dwordx4 v[192:195], v235, s[88:91], s71 offen offset:0 sc0 sc1 nt
    s_endpgm
L2_e1:
    v_mfma_f32_16x16x32_bf16 v[0:3], a[0:3], a[168:171], v[0:3]
    v_mfma_f32_16x16x32_bf16 v[0:3], a[64:67], a[196:199], v[0:3]
    v_mfma_f32_16x16x32_bf16 v[4:7], a[4:7], a[168:171], v[4:7]
    v_mfma_f32_16x16x32_bf16 v[4:7], a[68:71], a[196:199], v[4:7]
    v_mfma_f32_16x16x32_bf16 v[16:19], a[16:19], a[168:171], v[16:19]
    v_mfma_f32_16x16x32_bf16 v[16:19], a[80:83], a[196:199], v[16:19]
    v_mfma_f32_16x16x32_bf16 v[20:23], a[20:23], a[168:171], v[20:23]
    v_mfma_f32_16x16x32_bf16 v[20:23], a[84:87], a[196:199], v[20:23]
    s_nop 1
    ds_write_b128 v232, v[0:3] offset:0
    v_mfma_f32_16x16x32_bf16 v[24:27], a[24:27], a[168:171], v[24:27]
    v_mfma_f32_16x16x32_bf16 v[24:27], a[88:91], a[196:199], v[24:27]
    ds_write_b128 v232, v[4:7] offset:1024
    v_mfma_f32_16x16x32_bf16 v[28:31], a[28:31], a[168:171], v[28:31]
    v_mfma_f32_16x16x32_bf16 v[28:31], a[92:95], a[196:199], v[28:31]
    ds_write_b128 v232, v[16:19] offset:16384
    v_mfma_f32_16x16x32_bf16 v[32:35], a[0:3], a[172:175], v[32:35]
    v_mfma_f32_16x16x32_bf16 v[32:35], a[64:67], a[200:203], v[32:35]
    ds_write_b128 v232, v[20:23] offset:17408
    v_mfma_f32_16x16x32_bf16 v[36:39], a[4:7], a[172:175], v[36:39]
    v_mfma_f32_16x16x32_bf16 v[36:39], a[68:71], a[200:203], v[36:39]
    ds_write_b128 v232, v[24:27] offset:20480
    v_mfma_f32_16x16x32_bf16 v[48:51], a[16:19], a[172:175], v[48:51]
    v_mfma_f32_16x16x32_bf16 v[48:51], a[80:83], a[200:203], v[48:51]
    ds_write_b128 v232, v[28:31] offset:21504
    v_mfma_f32_16x16x32_bf16 v[52:55], a[20:23], a[172:175], v[52:55]
    v_mfma_f32_16x16x32_bf16 v[52:55], a[84:87], a[200:203], v[52:55]
    ds_write_b128 v232, v[32:35] offset:24576
    v_mfma_f32_16x16x32_bf16 v[56:59], a[24:27], a[172:175], v[56:59]
    v_mfma_f32_16x16x32_bf16 v[56:59], a[88:91], a[200:203], v[56:59]
    ds_write_b128 v232, v[36:39] offset:25600
    v_mfma_f32_16x16x32_bf16 v[60:63], a[28:31], a[172:175], v[60:63]
    v_mfma_f32_16x16x32_bf16 v[60:63], a[92:95], a[200:203], v[60:63]
    ds_write_b128 v232, v[48:51] offset:40960
    v_mfma_f32_16x16x32_bf16 v[64:67], a[0:3], a[176:179], v[64:67]
    v_mfma_f32_16x16x32_bf16 v[64:67], a[64:67], a[204:207], v[64:67]
    ds_write_b128 v232, v[52:55] offset:41984
    v_mfma_f32_16x16x32_bf16 v[68:71], a[4:7], a[176:179], v[68:71]
    v_mfma_f32_16x16x32_bf16 v[68:71], a[68:71], a[204:207], v[68:71]
    ds_write_b128 v232, v[56:59] offset:45056
    v_mfma_f32_16x16x32_bf16 v[80:83], a[16:19], a[176:179], v[80:83]
    v_mfma_f32_16x16x32_bf16 v[80:83], a[80:83], a[204:207], v[80:83]
    ds_write_b128 v232, v[60:63] offset:46080
    v_mfma_f32_16x16x32_bf16 v[84:87], a[20:23], a[176:179], v[84:87]
    v_mfma_f32_16x16x32_bf16 v[84:87], a[84:87], a[204:207], v[84:87]
    ds_write_b128 v232, v[64:67] offset:49152
    v_mfma_f32_16x16x32_bf16 v[88:91], a[24:27], a[176:179], v[88:91]
    v_mfma_f32_16x16x32_bf16 v[88:91], a[88:91], a[204:207], v[88:91]
    ds_write_b128 v232, v[68:71] offset:50176
    v_mfma_f32_16x16x32_bf16 v[92:95], a[28:31], a[176:179], v[92:95]
    v_mfma_f32_16x16x32_bf16 v[92:95], a[92:95], a[204:207], v[92:95]
    ds_write_b128 v233, v[80:83] offset:0
    v_mfma_f32_16x16x32_bf16 v[96:99], a[0:3], a[180:183], v[96:99]
    v_mfma_f32_16x16x32_bf16 v[96:99], a[64:67], a[208:211], v[96:99]
    ds_write_b128 v233, v[84:87] offset:1024
    v_mfma_f32_16x16x32_bf16 v[100:103], a[4:7], a[180:183], v[100:103]
    v_mfma_f32_16x16x32_bf16 v[100:103], a[68:71], a[208:211], v[100:103]
    ds_write_b128 v233, v[88:91] offset:4096
    v_mfma_f32_16x16x32_bf16 v[112:115], a[16:19], a[180:183], v[112:115]
    v_mfma_f32_16x16x32_bf16 v[112:115], a[80:83], a[208:211], v[112:115]
    ds_write_b128 v233, v[92:95] offset:5120
    v_mfma_f32_16x16x32_bf16 v[116:119], a[20:23], a[180:183], v[116:119]
    v_mfma_f32_16x16x32_bf16 v[116:119], a[84:87], a[208:211], v[116:119]
    ds_write_b128 v233, v[96:99] offset:8192
    v_mfma_f32_16x16x32_bf16 v[120:123], a[24:27], a[180:183], v[120:123]
    v_mfma_f32_16x16x32_bf16 v[120:123], a[88:91], a[208:211], v[120:123]
    ds_write_b128 v233, v[100:103] offset:9216
    v_mfma_f32_16x16x32_bf16 v[124:127], a[28:31], a[180:183], v[124:127]
    v_mfma_f32_16x16x32_bf16 v[124:127], a[92:95], a[208:211], v[124:127]
    ds_write_b128 v233, v[112:115] offset:24576
    v_mfma_f32_16x16x32_bf16 v[128:131], a[0:3], a[184:187], v[128:131]
    v_mfma_f32_16x16x32_bf16 v[128:131], a[64:67], a[212:215], v[128:131]
    ds_write_b128 v233, v[116:119] offset:25600
    v_mfma_f32_16x16x32_bf16 v[132:135], a[4:7], a[184:187], v[132:135]
    v_mfma_f32_16x16x32_bf16 v[132:135], a[68:71], a[212:215], v[132:135]
    ds_write_b128 v233, v[120:123] offset:28672
    v_mfma_f32_16x16x32_bf16 v[144:147], a[16:19], a[184:187], v[144:147]
    v_mfma_f32_16x16x32_bf16 v[144:147], a[80:83], a[212:215], v[144:147]
    ds_write_b128 v233, v[124:127] offset:29696
    v_mfma_f32_16x16x32_bf16 v[148:151], a[20:23], a[184:187], v[148:151]
    v_mfma_f32_16x16x32_bf16 v[148:151], a[84:87], a[212:215], v[148:151]
    ds_write_b128 v233, v[128:131] offset:32768
    v_mfma_f32_16x16x32_bf16 v[152:155], a[24:27], a[184:187], v[152:155]
    v_mfma_f32_16x16x32_bf16 v[152:155], a[88:91], a[212:215], v[152:155]
    ds_write_b128 v233, v[132:135] offset:33792
    v_mfma_f32_16x16x32_bf16 v[156:159], a[28:31], a[184:187], v[156:159]
    v_mfma_f32_16x16x32_bf16 v[156:159], a[92:95], a[212:215], v[156:159]
    ds_write_b128 v233, v[144:147] offset:49152
    v_mfma_f32_16x16x32_bf16 v[160:163], a[0:3], a[188:191], v[160:163]
    v_mfma_f32_16x16x32_bf16 v[160:163], a[64:67], a[216:219], v[160:163]
    ds_write_b128 v233, v[148:151] offset:50176
    v_mfma_f32_16x16x32_bf16 v[164:167], a[4:7], a[188:191], v[164:167]
    v_mfma_f32_16x16x32_bf16 v[164:167], a[68:71], a[216:219], v[164:167]
    ds_write_b128 v233, v[152:155] offset:53248
    v_mfma_f32_16x16x32_bf16 v[176:179], a[16:19], a[188:191], v[176:179]
    v_mfma_f32_16x16x32_bf16 v[176:179], a[80:83], a[216:219], v[176:179]
    ds_write_b128 v233, v[156:159] offset:54272
    v_mfma_f32_16x16x32_bf16 v[180:183], a[20:23], a[188:191], v[180:183]
    v_mfma_f32_16x16x32_bf16 v[180:183], a[84:87], a[216:219], v[180:183]
    ds_write_b128 v233, v[160:163] offset:57344
    v_mfma_f32_16x16x32_bf16 v[184:187], a[24:27], a[188:191], v[184:187]
    v_mfma_f32_16x16x32_bf16 v[184:187], a[88:91], a[216:219], v[184:187]
    ds_write_b128 v233, v[164:167] offset:58368
    v_mfma_f32_16x16x32_bf16 v[188:191], a[28:31], a[188:191], v[188:191]
    v_mfma_f32_16x16x32_bf16 v[188:191], a[92:95], a[216:219], v[188:191]
    ds_write_b128 v234, v[176:179] offset:8192
    v_mfma_f32_16x16x32_bf16 v[192:195], a[0:3], a[192:195], v[192:195]
    v_mfma_f32_16x16x32_bf16 v[192:195], a[64:67], a[220:223], v[192:195]
    ds_write_b128 v234, v[180:183] offset:9216
    v_mfma_f32_16x16x32_bf16 v[196:199], a[4:7], a[192:195], v[196:199]
    v_mfma_f32_16x16x32_bf16 v[196:199], a[68:71], a[220:223], v[196:199]
    ds_write_b128 v234, v[184:187] offset:12288
    v_mfma_f32_16x16x32_bf16 v[8:11], a[8:11], a[168:171], v[8:11]
    v_mfma_f32_16x16x32_bf16 v[8:11], a[72:75], a[196:199], v[8:11]
    ds_write_b128 v234, v[188:191] offset:13312
    v_mfma_f32_16x16x32_bf16 v[12:15], a[12:15], a[168:171], v[12:15]
    v_mfma_f32_16x16x32_bf16 v[12:15], a[76:79], a[196:199], v[12:15]
    ds_write_b128 v234, v[192:195] offset:16384
    v_mfma_f32_16x16x32_bf16 v[40:43], a[8:11], a[172:175], v[40:43]
    v_mfma_f32_16x16x32_bf16 v[40:43], a[72:75], a[200:203], v[40:43]
    ds_write_b128 v234, v[196:199] offset:17408
    v_mfma_f32_16x16x32_bf16 v[44:47], a[12:15], a[172:175], v[44:47]
    v_mfma_f32_16x16x32_bf16 v[44:47], a[76:79], a[200:203], v[44:47]
    v_mfma_f32_16x16x32_bf16 v[72:75], a[8:11], a[176:179], v[72:75]
    v_mfma_f32_16x16x32_bf16 v[72:75], a[72:75], a[204:207], v[72:75]
    v_mfma_f32_16x16x32_bf16 v[76:79], a[12:15], a[176:179], v[76:79]
    v_mfma_f32_16x16x32_bf16 v[76:79], a[76:79], a[204:207], v[76:79]
    v_mfma_f32_16x16x32_bf16 v[104:107], a[8:11], a[180:183], v[104:107]
    v_mfma_f32_16x16x32_bf16 v[104:107], a[72:75], a[208:211], v[104:107]
    v_mfma_f32_16x16x32_bf16 v[108:111], a[12:15], a[180:183], v[108:111]
    v_mfma_f32_16x16x32_bf16 v[108:111], a[76:79], a[208:211], v[108:111]
    v_mfma_f32_16x16x32_bf16 v[136:139], a[8:11], a[184:187], v[136:139]
    v_mfma_f32_16x16x32_bf16 v[136:139], a[72:75], a[212:215], v[136:139]
    v_mfma_f32_16x16x32_bf16 v[140:143], a[12:15], a[184:187], v[140:143]
    v_mfma_f32_16x16x32_bf16 v[140:143], a[76:79], a[212:215], v[140:143]
    v_mfma_f32_16x16x32_bf16 v[168:171], a[8:11], a[188:191], v[168:171]
    v_mfma_f32_16x16x32_bf16 v[168:171], a[72:75], a[216:219], v[168:171]
    v_mfma_f32_16x16x32_bf16 v[172:175], a[12:15], a[188:191], v[172:175]
    v_mfma_f32_16x16x32_bf16 v[172:175], a[76:79], a[216:219], v[172:175]
    v_mfma_f32_16x16x32_bf16 v[200:203], a[8:11], a[192:195], v[200:203]
    v_mfma_f32_16x16x32_bf16 v[200:203], a[72:75], a[220:223], v[200:203]
    v_mfma_f32_16x16x32_bf16 v[204:207], a[12:15], a[192:195], v[204:207]
    v_mfma_f32_16x16x32_bf16 v[204:207], a[76:79], a[220:223], v[204:207]
    s_waitcnt lgkmcnt(0)
    s_barrier
    ds_read_b128 v[0:3], v232 offset:6144
    ds_read_b128 v[4:7], v232 offset:7168
    ds_read_b128 v[16:19], v232 offset:8192
    ds_read_b128 v[20:23], v232 offset:9216
    ds_read_b128 v[24:27], v232 offset:10240
    ds_read_b128 v[28:31], v232 offset:11264
    ds_read_b128 v[32:35], v232 offset:30720
    ds_read_b128 v[36:39], v232 offset:31744
    ds_read_b128 v[48:51], v232 offset:32768
    ds_read_b128 v[52:55], v232 offset:33792
    ds_read_b128 v[56:59], v232 offset:34816
    ds_read_b128 v[60:63], v232 offset:35840
    ds_read_b128 v[64:67], v232 offset:55296
    ds_read_b128 v[68:71], v232 offset:56320
    ds_read_b128 v[80:83], v232 offset:57344
    ds_read_b128 v[84:87], v232 offset:58368
    ds_read_b128 v[88:91], v232 offset:59392
    ds_read_b128 v[92:95], v232 offset:60416
    ds_read_b128 v[96:99], v233 offset:14336
    ds_read_b128 v[100:103], v233 offset:15360
    ds_read_b128 v[112:115], v233 offset:16384
    ds_read_b128 v[116:119], v233 offset:17408
    ds_read_b128 v[120:123], v233 offset:18432
    ds_read_b128 v[124:127], v233 offset:19456
    ds_read_b128 v[128:131], v233 offset:38912
    ds_read_b128 v[132:135], v233 offset:39936
    ds_read_b128 v[144:147], v233 offset:40960
    ds_read_b128 v[148:151], v233 offset:41984
    ds_read_b128 v[152:155], v233 offset:43008
    ds_read_b128 v[156:159], v233 offset:44032
    ds_read_b128 v[160:163], v233 offset:63488
    ds_read_b128 v[164:167], v233 offset:64512
    ds_read_b128 v[176:179], v234 offset:0
    ds_read_b128 v[180:183], v234 offset:1024
    ds_read_b128 v[184:187], v234 offset:2048
    ds_read_b128 v[188:191], v234 offset:3072
    ds_read_b128 v[192:195], v234 offset:22528
    ds_read_b128 v[196:199], v234 offset:23552
    ds_read_b128 v[208:211], v234 offset:24576
    ds_read_b128 v[212:215], v234 offset:25600
    ds_read_b128 v[216:219], v234 offset:26624
    ds_read_b128 v[220:223], v234 offset:27648
    s_waitcnt lgkmcnt(15)
    v_pk_add_f32 v[8:9], v[8:9], v[0:1]
    v_pk_add_f32 v[16:17], v[16:17], v[24:25]
    v_pk_add_f32 v[10:11], v[10:11], v[2:3]
    v_pk_add_f32 v[18:19], v[18:19], v[26:27]
    v_pk_add_f32 v[8:9], v[8:9], v[16:17]
    v_pk_add_f32 v[10:11], v[10:11], v[18:19]
    v_pk_add_f32 v[12:13], v[12:13], v[4:5]
    v_pk_add_f32 v[20:21], v[20:21], v[28:29]
    v_pk_add_f32 v[14:15], v[14:15], v[6:7]
    v_pk_add_f32 v[22:23], v[22:23], v[30:31]
    v_pk_add_f32 v[12:13], v[12:13], v[20:21]
    v_pk_add_f32 v[14:15], v[14:15], v[22:23]
    v_cvt_pk_bf16_f32 v8, v8, v9
    v_cvt_pk_bf16_f32 v9, v10, v11
    v_cvt_pk_bf16_f32 v10, v12, v13
    v_cvt_pk_bf16_f32 v11, v14, v15
    s_add_u32 s71, s70, 0
    s_add_u32 s71, s71, s68
    buffer_store_dwordx4 v[8:11], v235, s[88:91], s71 offen offset:64 sc0 sc1 nt
    v_pk_add_f32 v[40:41], v[40:41], v[32:33]
    v_pk_add_f32 v[48:49], v[48:49], v[56:57]
    v_pk_add_f32 v[42:43], v[42:43], v[34:35]
    v_pk_add_f32 v[50:51], v[50:51], v[58:59]
    v_pk_add_f32 v[40:41], v[40:41], v[48:49]
    v_pk_add_f32 v[42:43], v[42:43], v[50:51]
    v_pk_add_f32 v[44:45], v[44:45], v[36:37]
    v_pk_add_f32 v[52:53], v[52:53], v[60:61]
    v_pk_add_f32 v[46:47], v[46:47], v[38:39]
    v_pk_add_f32 v[54:55], v[54:55], v[62:63]
    v_pk_add_f32 v[44:45], v[44:45], v[52:53]
    v_pk_add_f32 v[46:47], v[46:47], v[54:55]
    v_cvt_pk_bf16_f32 v40, v40, v41
    v_cvt_pk_bf16_f32 v41, v42, v43
    v_cvt_pk_bf16_f32 v42, v44, v45
    v_cvt_pk_bf16_f32 v43, v46, v47
    s_add_u32 s71, s70, 32768
    s_add_u32 s71, s71, s68
    buffer_store_dwordx4 v[40:43], v235, s[88:91], s71 offen offset:64 sc0 sc1 nt
    v_pk_add_f32 v[72:73], v[72:73], v[64:65]
    v_pk_add_f32 v[80:81], v[80:81], v[88:89]
    v_pk_add_f32 v[74:75], v[74:75], v[66:67]
    v_pk_add_f32 v[82:83], v[82:83], v[90:91]
    v_pk_add_f32 v[72:73], v[72:73], v[80:81]
    v_pk_add_f32 v[74:75], v[74:75], v[82:83]
    v_pk_add_f32 v[76:77], v[76:77], v[68:69]
    v_pk_add_f32 v[84:85], v[84:85], v[92:93]
    v_pk_add_f32 v[78:79], v[78:79], v[70:71]
    v_pk_add_f32 v[86:87], v[86:87], v[94:95]
    v_pk_add_f32 v[76:77], v[76:77], v[84:85]
    v_pk_add_f32 v[78:79], v[78:79], v[86:87]
    v_cvt_pk_bf16_f32 v72, v72, v73
    v_cvt_pk_bf16_f32 v73, v74, v75
    v_cvt_pk_bf16_f32 v74, v76, v77
    v_cvt_pk_bf16_f32 v75, v78, v79
    s_add_u32 s71, s70, 65536
    s_add_u32 s71, s71, s68
    buffer_store_dwordx4 v[72:75], v235, s[88:91], s71 offen offset:64 sc0 sc1 nt
    v_pk_add_f32 v[104:105], v[104:105], v[96:97]
    v_pk_add_f32 v[112:113], v[112:113], v[120:121]
    v_pk_add_f32 v[106:107], v[106:107], v[98:99]
    v_pk_add_f32 v[114:115], v[114:115], v[122:123]
    v_pk_add_f32 v[104:105], v[104:105], v[112:113]
    v_pk_add_f32 v[106:107], v[106:107], v[114:115]
    v_pk_add_f32 v[108:109], v[108:109], v[100:101]
    v_pk_add_f32 v[116:117], v[116:117], v[124:125]
    v_pk_add_f32 v[110:111], v[110:111], v[102:103]
    v_pk_add_f32 v[118:119], v[118:119], v[126:127]
    v_pk_add_f32 v[108:109], v[108:109], v[116:117]
    v_pk_add_f32 v[110:111], v[110:111], v[118:119]
    v_cvt_pk_bf16_f32 v104, v104, v105
    v_cvt_pk_bf16_f32 v105, v106, v107
    v_cvt_pk_bf16_f32 v106, v108, v109
    v_cvt_pk_bf16_f32 v107, v110, v111
    s_add_u32 s71, s70, 98304
    s_add_u32 s71, s71, s68
    buffer_store_dwordx4 v[104:107], v235, s[88:91], s71 offen offset:64 sc0 sc1 nt
    v_pk_add_f32 v[136:137], v[136:137], v[128:129]
    s_waitcnt lgkmcnt(13)
    v_pk_add_f32 v[144:145], v[144:145], v[152:153]
    v_pk_add_f32 v[138:139], v[138:139], v[130:131]
    v_pk_add_f32 v[146:147], v[146:147], v[154:155]
    v_pk_add_f32 v[136:137], v[136:137], v[144:145]
    v_pk_add_f32 v[138:139], v[138:139], v[146:147]
    v_pk_add_f32 v[140:141], v[140:141], v[132:133]
    s_waitcnt lgkmcnt(12)
    v_pk_add_f32 v[148:149], v[148:149], v[156:157]
    v_pk_add_f32 v[142:143], v[142:143], v[134:135]
    v_pk_add_f32 v[150:151], v[150:151], v[158:159]
    v_pk_add_f32 v[140:141], v[140:141], v[148:149]
    v_pk_add_f32 v[142:143], v[142:143], v[150:151]
    v_cvt_pk_bf16_f32 v136, v136, v137
    v_cvt_pk_bf16_f32 v137, v138, v139
    v_cvt_pk_bf16_f32 v138, v140, v141
    v_cvt_pk_bf16_f32 v139, v142, v143
    s_add_u32 s71, s70, 131072
    s_add_u32 s71, s71, s68
    buffer_store_dwordx4 v[136:139], v235, s[88:91], s71 offen offset:64 sc0 sc1 nt
    s_waitcnt lgkmcnt(11)
    v_pk_add_f32 v[168:169], v[168:169], v[160:161]
    s_waitcnt lgkmcnt(7)
    v_pk_add_f32 v[176:177], v[176:177], v[184:185]
    v_pk_add_f32 v[170:171], v[170:171], v[162:163]
    v_pk_add_f32 v[178:179], v[178:179], v[186:187]
    v_pk_add_f32 v[168:169], v[168:169], v[176:177]
    v_pk_add_f32 v[170:171], v[170:171], v[178:179]
    v_pk_add_f32 v[172:173], v[172:173], v[164:165]
    s_waitcnt lgkmcnt(6)
    v_pk_add_f32 v[180:181], v[180:181], v[188:189]
    v_pk_add_f32 v[174:175], v[174:175], v[166:167]
    v_pk_add_f32 v[182:183], v[182:183], v[190:191]
    v_pk_add_f32 v[172:173], v[172:173], v[180:181]
    v_pk_add_f32 v[174:175], v[174:175], v[182:183]
    v_cvt_pk_bf16_f32 v168, v168, v169
    v_cvt_pk_bf16_f32 v169, v170, v171
    v_cvt_pk_bf16_f32 v170, v172, v173
    v_cvt_pk_bf16_f32 v171, v174, v175
    s_add_u32 s71, s70, 163840
    s_add_u32 s71, s71, s68
    buffer_store_dwordx4 v[168:171], v235, s[88:91], s71 offen offset:64 sc0 sc1 nt
    s_waitcnt lgkmcnt(5)
    v_pk_add_f32 v[200:201], v[200:201], v[192:193]
    s_waitcnt lgkmcnt(1)
    v_pk_add_f32 v[208:209], v[208:209], v[216:217]
    v_pk_add_f32 v[202:203], v[202:203], v[194:195]
    v_pk_add_f32 v[210:211], v[210:211], v[218:219]
    v_pk_add_f32 v[200:201], v[200:201], v[208:209]
    v_pk_add_f32 v[202:203], v[202:203], v[210:211]
    v_pk_add_f32 v[204:205], v[204:205], v[196:197]
    s_waitcnt lgkmcnt(0)
    v_pk_add_f32 v[212:213], v[212:213], v[220:221]
    v_pk_add_f32 v[206:207], v[206:207], v[198:199]
    v_pk_add_f32 v[214:215], v[214:215], v[222:223]
    v_pk_add_f32 v[204:205], v[204:205], v[212:213]
    v_pk_add_f32 v[206:207], v[206:207], v[214:215]
    v_cvt_pk_bf16_f32 v200, v200, v201
    v_cvt_pk_bf16_f32 v201, v202, v203
    v_cvt_pk_bf16_f32 v202, v204, v205
    v_cvt_pk_bf16_f32 v203, v206, v207
    s_add_u32 s71, s68, 393216
    buffer_store_dwordx4 v[200:203], v235, s[88:91], s71 offen offset:64 sc0 sc1 nt
    s_endpgm
L2_e2:
    v_mfma_f32_16x16x32_bf16 v[0:3], a[0:3], a[168:171], v[0:3]
    v_mfma_f32_16x16x32_bf16 v[0:3], a[64:67], a[196:199], v[0:3]
    v_mfma_f32_16x16x32_bf16 v[4:7], a[4:7], a[168:171], v[4:7]
    v_mfma_f32_16x16x32_bf16 v[4:7], a[68:71], a[196:199], v[4:7]
    v_mfma_f32_16x16x32_bf16 v[8:11], a[8:11], a[168:171], v[8:11]
    v_mfma_f32_16x16x32_bf16 v[8:11], a[72:75], a[196:199], v[8:11]
    v_mfma_f32_16x16x32_bf16 v[12:15], a[12:15], a[168:171], v[12:15]
    v_mfma_f32_16x16x32_bf16 v[12:15], a[76:79], a[196:199], v[12:15]
    s_nop 1
    ds_write_b128 v232, v[0:3] offset:2048
    v_mfma_f32_16x16x32_bf16 v[24:27], a[24:27], a[168:171], v[24:27]
    v_mfma_f32_16x16x32_bf16 v[24:27], a[88:91], a[196:199], v[24:27]
    ds_write_b128 v232, v[4:7] offset:3072
    v_mfma_f32_16x16x32_bf16 v[28:31], a[28:31], a[168:171], v[28:31]
    v_mfma_f32_16x16x32_bf16 v[28:31], a[92:95], a[196:199], v[28:31]
    ds_write_b128 v232, v[8:11] offset:6144
    v_mfma_f32_16x16x32_bf16 v[32:35], a[0:3], a[172:175], v[32:35]
    v_mfma_f32_16x16x32_bf16 v[32:35], a[64:67], a[200:203], v[32:35]
    ds_write_b128 v232, v[12:15] offset:7168
    v_mfma_f32_16x16x32_bf16 v[36:39], a[4:7], a[172:175], v[36:39]
    v_mfma_f32_16x16x32_bf16 v[36:39], a[68:71], a[200:203], v[36:39]
    ds_write_b128 v232, v[24:27] offset:22528
    v_mfma_f32_16x16x32_bf16 v[40:43], a[8:11], a[172:175], v[40:43]
    v_mfma_f32_16x16x32_bf16 v[40:43], a[72:75], a[200:203], v[40:43]
    ds_write_b128 v232, v[28:31] offset:23552
    v_mfma_f32_16x16x32_bf16 v[44:47], a[12:15], a[172:175], v[44:47]
    v_mfma_f32_16x16x32_bf16 v[44:47], a[76:79], a[200:203], v[44:47]
    ds_write_b128 v232, v[32:35] offset:26624
    v_mfma_f32_16x16x32_bf16 v[56:59], a[24:27], a[172:175], v[56:59]
    v_mfma_f32_16x16x32_bf16 v[56:59], a[88:91], a[200:203], v[56:59]
    ds_write_b128 v232, v[36:39] offset:27648
    v_mfma_f32_16x16x32_bf16 v[60:63], a[28:31], a[172:175], v[60:63]
    v_mfma_f32_16x16x32_bf16 v[60:63], a[92:95], a[200:203], v[60:63]
    ds_write_b128 v232, v[40:43] offset:30720
    v_mfma_f32_16x16x32_bf16 v[64:67], a[0:3], a[176:179], v[64:67]
    v_mfma_f32_16x16x32_bf16 v[64:67], a[64:67], a[204:207], v[64:67]
    ds_write_b128 v232, v[44:47] offset:31744
    v_mfma_f32_16x16x32_bf16 v[68:71], a[4:7], a[176:179], v[68:71]
    v_mfma_f32_16x16x32_bf16 v[68:71], a[68:71], a[204:207], v[68:71]
    ds_write_b128 v232, v[56:59] offset:47104
    v_mfma_f32_16x16x32_bf16 v[72:75], a[8:11], a[176:179], v[72:75]
    v_mfma_f32_16x16x32_bf16 v[72:75], a[72:75], a[204:207], v[72:75]
    ds_write_b128 v232, v[60:63] offset:48128
    v_mfma_f32_16x16x32_bf16 v[76:79], a[12:15], a[176:179], v[76:79]
    v_mfma_f32_16x16x32_bf16 v[76:79], a[76:79], a[204:207], v[76:79]
    ds_write_b128 v232, v[64:67] offset:51200
    v_mfma_f32_16x16x32_bf16 v[88:91], a[24:27], a[176:179], v[88:91]
    v_mfma_f32_16x16x32_bf16 v[88:91], a[88:91], a[204:207], v[88:91]
    ds_write_b128 v232, v[68:71] offset:52224
    v_mfma_f32_16x16x32_bf16 v[92:95], a[28:31], a[176:179], v[92:95]
    v_mfma_f32_16x16x32_bf16 v[92:95], a[92:95], a[204:207], v[92:95]
    ds_write_b128 v232, v[72:75] offset:55296
    v_mfma_f32_16x16x32_bf16 v[96:99], a[0:3], a[180:183], v[96:99]
    v_mfma_f32_16x16x32_bf16 v[96:99], a[64:67], a[208:211], v[96:99]
    ds_write_b128 v232, v[76:79] offset:56320
    v_mfma_f32_16x16x32_bf16 v[100:103], a[4:7], a[180:183], v[100:103]
    v_mfma_f32_16x16x32_bf16 v[100:103], a[68:71], a[208:211], v[100:103]
    ds_write_b128 v233, v[88:91] offset:6144
    v_mfma_f32_16x16x32_bf16 v[104:107], a[8:11], a[180:183], v[104:107]
    v_mfma_f32_16x16x32_bf16 v[104:107], a[72:75], a[208:211], v[104:107]
    ds_write_b128 v233, v[92:95] offset:7168
    v_mfma_f32_16x16x32_bf16 v[108:111], a[12:15], a[180:183], v[108:111]
    v_mfma_f32_16x16x32_bf16 v[108:111], a[76:79], a[208:211], v[108:111]
    ds_write_b128 v233, v[96:99] offset:10240
    v_mfma_f32_16x16x32_bf16 v[120:123], a[24:27], a[180:183], v[120:123]
    v_mfma_f32_16x16x32_bf16 v[120:123], a[88:91], a[208:211], v[120:123]
    ds_write_b128 v233, v[100:103] offset:11264
    v_mfma_f32_16x16x32_bf16 v[124:127], a[28:31], a[180:183], v[124:127]
    v_mfma_f32_16x16x32_bf16 v[124:127], a[92:95], a[208:211], v[124:127]
    ds_write_b128 v233, v[104:107] offset:14336
    v_mfma_f32_16x16x32_bf16 v[128:131], a[0:3], a[184:187], v[128:131]
    v_mfma_f32_16x16x32_bf16 v[128:131], a[64:67], a[212:215], v[128:131]
    ds_write_b128 v233, v[108:111] offset:15360
    v_mfma_f32_16x16x32_bf16 v[132:135], a[4:7], a[184:187], v[132:135]
    v_mfma_f32_16x16x32_bf16 v[132:135], a[68:71], a[212:215], v[132:135]
    ds_write_b128 v233, v[120:123] offset:30720
    v_mfma_f32_16x16x32_bf16 v[136:139], a[8:11], a[184:187], v[136:139]
    v_mfma_f32_16x16x32_bf16 v[136:139], a[72:75], a[212:215], v[136:139]
    ds_write_b128 v233, v[124:127] offset:31744
    v_mfma_f32_16x16x32_bf16 v[140:143], a[12:15], a[184:187], v[140:143]
    v_mfma_f32_16x16x32_bf16 v[140:143], a[76:79], a[212:215], v[140:143]
    ds_write_b128 v233, v[128:131] offset:34816
    v_mfma_f32_16x16x32_bf16 v[152:155], a[24:27], a[184:187], v[152:155]
    v_mfma_f32_16x16x32_bf16 v[152:155], a[88:91], a[212:215], v[152:155]
    ds_write_b128 v233, v[132:135] offset:35840
    v_mfma_f32_16x16x32_bf16 v[156:159], a[28:31], a[184:187], v[156:159]
    v_mfma_f32_16x16x32_bf16 v[156:159], a[92:95], a[212:215], v[156:159]
    ds_write_b128 v233, v[136:139] offset:38912
    v_mfma_f32_16x16x32_bf16 v[160:163], a[0:3], a[188:191], v[160:163]
    v_mfma_f32_16x16x32_bf16 v[160:163], a[64:67], a[216:219], v[160:163]
    ds_write_b128 v233, v[140:143] offset:39936
    v_mfma_f32_16x16x32_bf16 v[164:167], a[4:7], a[188:191], v[164:167]
    v_mfma_f32_16x16x32_bf16 v[164:167], a[68:71], a[216:219], v[164:167]
    ds_write_b128 v233, v[152:155] offset:55296
    v_mfma_f32_16x16x32_bf16 v[168:171], a[8:11], a[188:191], v[168:171]
    v_mfma_f32_16x16x32_bf16 v[168:171], a[72:75], a[216:219], v[168:171]
    ds_write_b128 v233, v[156:159] offset:56320
    v_mfma_f32_16x16x32_bf16 v[172:175], a[12:15], a[188:191], v[172:175]
    v_mfma_f32_16x16x32_bf16 v[172:175], a[76:79], a[216:219], v[172:175]
    ds_write_b128 v233, v[160:163] offset:59392
    v_mfma_f32_16x16x32_bf16 v[184:187], a[24:27], a[188:191], v[184:187]
    v_mfma_f32_16x16x32_bf16 v[184:187], a[88:91], a[216:219], v[184:187]
    ds_write_b128 v233, v[164:167] offset:60416
    v_mfma_f32_16x16x32_bf16 v[188:191], a[28:31], a[188:191], v[188:191]
    v_mfma_f32_16x16x32_bf16 v[188:191], a[92:95], a[216:219], v[188:191]
    ds_write_b128 v233, v[168:171] offset:63488
    v_mfma_f32_16x16x32_bf16 v[192:195], a[0:3], a[192:195], v[192:195]
    v_mfma_f32_16x16x32_bf16 v[192:195], a[64:67], a[220:223], v[192:195]
    ds_write_b128 v233, v[172:175] offset:64512
    v_mfma_f32_16x16x32_bf16 v[196:199], a[4:7], a[192:195], v[196:199]
    v_mfma_f32_16x16x32_bf16 v[196:199], a[68:71], a[220:223], v[196:199]
    ds_write_b128 v234, v[184:187] offset:14336
    v_mfma_f32_16x16x32_bf16 v[200:203], a[8:11], a[192:195], v[200:203]
    v_mfma_f32_16x16x32_bf16 v[200:203], a[72:75], a[220:223], v[200:203]
    ds_write_b128 v234, v[188:191] offset:15360
    v_mfma_f32_16x16x32_bf16 v[204:207], a[12:15], a[192:195], v[204:207]
    v_mfma_f32_16x16x32_bf16 v[204:207], a[76:79], a[220:223], v[204:207]
    ds_write_b128 v234, v[192:195] offset:18432
    v_mfma_f32_16x16x32_bf16 v[16:19], a[16:19], a[168:171], v[16:19]
    v_mfma_f32_16x16x32_bf16 v[16:19], a[80:83], a[196:199], v[16:19]
    ds_write_b128 v234, v[196:199] offset:19456
    v_mfma_f32_16x16x32_bf16 v[20:23], a[20:23], a[168:171], v[20:23]
    v_mfma_f32_16x16x32_bf16 v[20:23], a[84:87], a[196:199], v[20:23]
    ds_write_b128 v234, v[200:203] offset:22528
    v_mfma_f32_16x16x32_bf16 v[48:51], a[16:19], a[172:175], v[48:51]
    v_mfma_f32_16x16x32_bf16 v[48:51], a[80:83], a[200:203], v[48:51]
    ds_write_b128 v234, v[204:207] offset:23552
    v_mfma_f32_16x16x32_bf16 v[52:55], a[20:23], a[172:175], v[52:55]
    v_mfma_f32_16x16x32_bf16 v[52:55], a[84:87], a[200:203], v[52:55]
    v_mfma_f32_16x16x32_bf16 v[80:83], a[16:19], a[176:179], v[80:83]
    v_mfma_f32_16x16x32_bf16 v[80:83], a[80:83], a[204:207], v[80:83]
    v_mfma_f32_16x16x32_bf16 v[84:87], a[20:23], a[176:179], v[84:87]
    v_mfma_f32_16x16x32_bf16 v[84:87], a[84:87], a[204:207], v[84:87]
    v_mfma_f32_16x16x32_bf16 v[112:115], a[16:19], a[180:183], v[112:115]
    v_mfma_f32_16x16x32_bf16 v[112:115], a[80:83], a[208:211], v[112:115]
    v_mfma_f32_16x16x32_bf16 v[116:119], a[20:23], a[180:183], v[116:119]
    v_mfma_f32_16x16x32_bf16 v[116:119], a[84:87], a[208:211], v[116:119]
    v_mfma_f32_16x16x32_bf16 v[144:147], a[16:19], a[184:187], v[144:147]
    v_mfma_f32_16x16x32_bf16 v[144:147], a[80:83], a[212:215], v[144:147]
    v_mfma_f32_16x16x32_bf16 v[148:151], a[20:23], a[184:187], v[148:151]
    v_mfma_f32_16x16x32_bf16 v[148:151], a[84:87], a[212:215], v[148:151]
    v_mfma_f32_16x16x32_bf16 v[176:179], a[16:19], a[188:191], v[176:179]
    v_mfma_f32_16x16x32_bf16 v[176:179], a[80:83], a[216:219], v[176:179]
    v_mfma_f32_16x16x32_bf16 v[180:183], a[20:23], a[188:191], v[180:183]
    v_mfma_f32_16x16x32_bf16 v[180:183], a[84:87], a[216:219], v[180:183]
    s_waitcnt lgkmcnt(0)
    s_barrier
    ds_read_b128 v[0:3], v232 offset:12288
    ds_read_b128 v[4:7], v232 offset:13312
    ds_read_b128 v[8:11], v232 offset:14336
    ds_read_b128 v[12:15], v232 offset:15360
    ds_read_b128 v[24:27], v232 offset:16384
    ds_read_b128 v[28:31], v232 offset:17408
    ds_read_b128 v[32:35], v232 offset:36864
    ds_read_b128 v[36:39], v232 offset:37888
    ds_read_b128 v[40:43], v232 offset:38912
    ds_read_b128 v[44:47], v232 offset:39936
    ds_read_b128 v[56:59], v232 offset:40960
    ds_read_b128 v[60:63], v232 offset:41984
    ds_read_b128 v[64:67], v232 offset:61440
    ds_read_b128 v[68:71], v232 offset:62464
    ds_read_b128 v[72:75], v232 offset:63488
    ds_read_b128 v[76:79], v232 offset:64512
    ds_read_b128 v[88:91], v233 offset:0
    ds_read_b128 v[92:95], v233 offset:1024
    ds_read_b128 v[96:99], v233 offset:20480
    ds_read_b128 v[100:103], v233 offset:21504
    ds_read_b128 v[104:107], v233 offset:22528
    ds_read_b128 v[108:111], v233 offset:23552
    ds_read_b128 v[120:123], v233 offset:24576
    ds_read_b128 v[124:127], v233 offset:25600
    ds_read_b128 v[128:131], v233 offset:45056
    ds_read_b128 v[132:135], v233 offset:46080
    ds_read_b128 v[136:139], v233 offset:47104
    ds_read_b128 v[140:143], v233 offset:48128
    ds_read_b128 v[152:155], v233 offset:49152
    ds_read_b128 v[156:159], v233 offset:50176
    ds_read_b128 v[160:163], v234 offset:4096
    ds_read_b128 v[164:167], v234 offset:5120
    ds_read_b128 v[168:171], v234 offset:6144
    ds_read_b128 v[172:175], v234 offset:7168
    ds_read_b128 v[184:187], v234 offset:8192
    ds_read_b128 v[188:191], v234 offset:9216
    s_waitcnt lgkmcnt(15)
    v_pk_add_f32 v[16:17], v[16:17], v[0:1]
    v_pk_add_f32 v[8:9], v[8:9], v[24:25]
    v_pk_add_f32 v[18:19], v[18:19], v[2:3]
    v_pk_add_f32 v[10:11], v[10:11], v[26:27]
    v_pk_add_f32 v[16:17], v[16:17], v[8:9]
    v_pk_add_f32 v[18:19], v[18:19], v[10:11]
    v_pk_add_f32 v[20:21], v[20:21], v[4:5]
    v_pk_add_f32 v[12:13], v[12:13], v[28:29]
    v_pk_add_f32 v[22:23], v[22:23], v[6:7]
    v_pk_add_f32 v[14:15], v[14:15], v[30:31]
    v_pk_add_f32 v[20:21], v[20:21], v[12:13]
    v_pk_add_f32 v[22:23], v[22:23], v[14:15]
    v_cvt_pk_bf16_f32 v16, v16, v17
    v_cvt_pk_bf16_f32 v17, v18, v19
    v_cvt_pk_bf16_f32 v18, v20, v21
    v_cvt_pk_bf16_f32 v19, v22, v23
    s_add_u32 s71, s70, 0
    s_add_u32 s71, s71, s69
    buffer_store_dwordx4 v[16:19], v235, s[88:91], s71 offen offset:0 sc0 sc1 nt
    v_pk_add_f32 v[48:49], v[48:49], v[32:33]
    v_pk_add_f32 v[40:41], v[40:41], v[56:57]
    v_pk_add_f32 v[50:51], v[50:51], v[34:35]
    v_pk_add_f32 v[42:43], v[42:43], v[58:59]
    v_pk_add_f32 v[48:49], v[48:49], v[40:41]
    v_pk_add_f32 v[50:51], v[50:51], v[42:43]
    v_pk_add_f32 v[52:53], v[52:53], v[36:37]
    v_pk_add_f32 v[44:45], v[44:45], v[60:61]
    v_pk_add_f32 v[54:55], v[54:55], v[38:39]
    v_pk_add_f32 v[46:47], v[46:47], v[62:63]
    v_pk_add_f32 v[52:53], v[52:53], v[44:45]
    v_pk_add_f32 v[54:55], v[54:55], v[46:47]
    v_cvt_pk_bf16_f32 v48, v48, v49
    v_cvt_pk_bf16_f32 v49, v50, v51
    v_cvt_pk_bf16_f32 v50, v52, v53
    v_cvt_pk_bf16_f32 v51, v54, v55
    s_add_u32 s71, s70, 32768
    s_add_u32 s71, s71, s69
    buffer_store_dwordx4 v[48:51], v235, s[88:91], s71 offen offset:0 sc0 sc1 nt
    v_pk_add_f32 v[80:81], v[80:81], v[64:65]
    v_pk_add_f32 v[72:73], v[72:73], v[88:89]
    v_pk_add_f32 v[82:83], v[82:83], v[66:67]
    v_pk_add_f32 v[74:75], v[74:75], v[90:91]
    v_pk_add_f32 v[80:81], v[80:81], v[72:73]
    v_pk_add_f32 v[82:83], v[82:83], v[74:75]
    v_pk_add_f32 v[84:85], v[84:85], v[68:69]
    v_pk_add_f32 v[76:77], v[76:77], v[92:93]
    v_pk_add_f32 v[86:87], v[86:87], v[70:71]
    v_pk_add_f32 v[78:79], v[78:79], v[94:95]
    v_pk_add_f32 v[84:85], v[84:85], v[76:77]
    v_pk_add_f32 v[86:87], v[86:87], v[78:79]
    v_cvt_pk_bf16_f32 v80, v80, v81
    v_cvt_pk_bf16_f32 v81, v82, v83
    v_cvt_pk_bf16_f32 v82, v84, v85
    v_cvt_pk_bf16_f32 v83, v86, v87
    s_add_u32 s71, s70, 65536
    s_add_u32 s71, s71, s69
    buffer_store_dwordx4 v[80:83], v235, s[88:91], s71 offen offset:0 sc0 sc1 nt
    v_pk_add_f32 v[112:113], v[112:113], v[96:97]
    s_waitcnt lgkmcnt(13)
    v_pk_add_f32 v[104:105], v[104:105], v[120:121]
    v_pk_add_f32 v[114:115], v[114:115], v[98:99]
    v_pk_add_f32 v[106:107], v[106:107], v[122:123]
    v_pk_add_f32 v[112:113], v[112:113], v[104:105]
    v_pk_add_f32 v[114:115], v[114:115], v[106:107]
    v_pk_add_f32 v[116:117], v[116:117], v[100:101]
    s_waitcnt lgkmcnt(12)
    v_pk_add_f32 v[108:109], v[108:109], v[124:125]
    v_pk_add_f32 v[118:119], v[118:119], v[102:103]
    v_pk_add_f32 v[110:111], v[110:111], v[126:127]
    v_pk_add_f32 v[116:117], v[116:117], v[108:109]
    v_pk_add_f32 v[118:119], v[118:119], v[110:111]
    v_cvt_pk_bf16_f32 v112, v112, v113
    v_cvt_pk_bf16_f32 v113, v114, v115
    v_cvt_pk_bf16_f32 v114, v116, v117
    v_cvt_pk_bf16_f32 v115, v118, v119
    s_add_u32 s71, s70, 98304
    s_add_u32 s71, s71, s69
    buffer_store_dwordx4 v[112:115], v235, s[88:91], s71 offen offset:0 sc0 sc1 nt
    s_waitcnt lgkmcnt(11)
    v_pk_add_f32 v[144:145], v[144:145], v[128:129]
    s_waitcnt lgkmcnt(7)
    v_pk_add_f32 v[136:137], v[136:137], v[152:153]
    v_pk_add_f32 v[146:147], v[146:147], v[130:131]
    v_pk_add_f32 v[138:139], v[138:139], v[154:155]
    v_pk_add_f32 v[144:145], v[144:145], v[136:137]
    v_pk_add_f32 v[146:147], v[146:147], v[138:139]
    v_pk_add_f32 v[148:149], v[148:149], v[132:133]
    s_waitcnt lgkmcnt(6)
    v_pk_add_f32 v[140:141], v[140:141], v[156:157]
    v_pk_add_f32 v[150:151], v[150:151], v[134:135]
    v_pk_add_f32 v[142:143], v[142:143], v[158:159]
    v_pk_add_f32 v[148:149], v[148:149], v[140:141]
    v_pk_add_f32 v[150:151], v[150:151], v[142:143]
    v_cvt_pk_bf16_f32 v144, v144, v145
    v_cvt_pk_bf16_f32 v145, v146, v147
    v_cvt_pk_bf16_f32 v146, v148, v149
    v_cvt_pk_bf16_f32 v147, v150, v151
    s_add_u32 s71, s70, 131072
    s_add_u32 s71, s71, s69
    buffer_store_dwordx4 v[144:147], v235, s[88:91], s71 offen offset:0 sc0 sc1 nt
    s_waitcnt lgkmcnt(5)
    v_pk_add_f32 v[176:177], v[176:177], v[160:161]
    s_waitcnt lgkmcnt(1)
    v_pk_add_f32 v[168:169], v[168:169], v[184:185]
    v_pk_add_f32 v[178:179], v[178:179], v[162:163]
    v_pk_add_f32 v[170:171], v[170:171], v[186:187]
    v_pk_add_f32 v[176:177], v[176:177], v[168:169]
    v_pk_add_f32 v[178:179], v[178:179], v[170:171]
    v_pk_add_f32 v[180:181], v[180:181], v[164:165]
    s_waitcnt lgkmcnt(0)
    v_pk_add_f32 v[172:173], v[172:173], v[188:189]
    v_pk_add_f32 v[182:183], v[182:183], v[166:167]
    v_pk_add_f32 v[174:175], v[174:175], v[190:191]
    v_pk_add_f32 v[180:181], v[180:181], v[172:173]
    v_pk_add_f32 v[182:183], v[182:183], v[174:175]
    v_cvt_pk_bf16_f32 v176, v176, v177
    v_cvt_pk_bf16_f32 v177, v178, v179
    v_cvt_pk_bf16_f32 v178, v180, v181
    v_cvt_pk_bf16_f32 v179, v182, v183
    s_add_u32 s71, s70, 163840
    s_add_u32 s71, s71, s69
    buffer_store_dwordx4 v[176:179], v235, s[88:91], s71 offen offset:0 sc0 sc1 nt
    s_endpgm
L2_e3:
    v_mfma_f32_16x16x32_bf16 v[0:3], a[0:3], a[168:171], v[0:3]
    v_mfma_f32_16x16x32_bf16 v[0:3], a[64:67], a[196:199], v[0:3]
    v_mfma_f32_16x16x32_bf16 v[4:7], a[4:7], a[168:171], v[4:7]
    v_mfma_f32_16x16x32_bf16 v[4:7], a[68:71], a[196:199], v[4:7]
    v_mfma_f32_16x16x32_bf16 v[8:11], a[8:11], a[168:171], v[8:11]
    v_mfma_f32_16x16x32_bf16 v[8:11], a[72:75], a[196:199], v[8:11]
    v_mfma_f32_16x16x32_bf16 v[12:15], a[12:15], a[168:171], v[12:15]
    v_mfma_f32_16x16x32_bf16 v[12:15], a[76:79], a[196:199], v[12:15]
    s_nop 1
    ds_write_b128 v232, v[0:3] offset:4096
    v_mfma_f32_16x16x32_bf16 v[16:19], a[16:19], a[168:171], v[16:19]
    v_mfma_f32_16x16x32_bf16 v[16:19], a[80:83], a[196:199], v[16:19]
    ds_write_b128 v232, v[4:7] offset:5120
    v_mfma_f32_16x16x32_bf16 v[20:23], a[20:23], a[168:171], v[20:23]
    v_mfma_f32_16x16x32_bf16 v[20:23], a[84:87], a[196:199], v[20:23]
    ds_write_b128 v232, v[8:11] offset:8192
    v_mfma_f32_16x16x32_bf16 v[32:35], a[0:3], a[172:175], v[32:35]
    v_mfma_f32_16x16x32_bf16 v[32:35], a[64:67], a[200:203], v[32:35]
    ds_write_b128 v232, v[12:15] offset:9216
    v_mfma_f32_16x16x32_bf16 v[36:39], a[4:7], a[172:175], v[36:39]
    v_mfma_f32_16x16x32_bf16 v[36:39], a[68:71], a[200:203], v[36:39]
    ds_write_b128 v232, v[16:19] offset:12288
    v_mfma_f32_16x16x32_bf16 v[40:43], a[8:11], a[172:175], v[40:43]
    v_mfma_f32_16x16x32_bf16 v[40:43], a[72:75], a[200:203], v[40:43]
    ds_write_b128 v232, v[20:23] offset:13312
    v_mfma_f32_16x16x32_bf16 v[44:47], a[12:15], a[172:175], v[44:47]
    v_mfma_f32_16x16x32_bf16 v[44:47], a[76:79], a[200:203], v[44:47]
    ds_write_b128 v232, v[32:35] offset:28672
    v_mfma_f32_16x16x32_bf16 v[48:51], a[16:19], a[172:175], v[48:51]
    v_mfma_f32_16x16x32_bf16 v[48:51], a[80:83], a[200:203], v[48:51]
    ds_write_b128 v232, v[36:39] offset:29696
    v_mfma_f32_16x16x32_bf16 v[52:55], a[20:23], a[172:175], v[52:55]
    v_mfma_f32_16x16x32_bf16 v[52:55], a[84:87], a[200:203], v[52:55]
    ds_write_b128 v232, v[40:43] offset:32768
    v_mfma_f32_16x16x32_bf16 v[64:67], a[0:3], a[176:179], v[64:67]
    v_mfma_f32_16x16x32_bf16 v[64:67], a[64:67], a[204:207], v[64:67]
    ds_write_b128 v232, v[44:47] offset:33792
    v_mfma_f32_16x16x32_bf16 v[68:71], a[4:7], a[176:179], v[68:71]
    v_mfma_f32_16x16x32_bf16 v[68:71], a[68:71], a[204:207], v[68:71]
    ds_write_b128 v232, v[48:51] offset:36864
    v_mfma_f32_16x16x32_bf16 v[72:75], a[8:11], a[176:179], v[72:75]
    v_mfma_f32_16x16x32_bf16 v[72:75], a[72:75], a[204:207], v[72:75]
    ds_write_b128 v232, v[52:55] offset:37888
    v_mfma_f32_16x16x32_bf16 v[76:79], a[12:15], a[176:179], v[76:79]
    v_mfma_f32_16x16x32_bf16 v[76:79], a[76:79], a[204:207], v[76:79]
    ds_write_b128 v232, v[64:67] offset:53248
    v_mfma_f32_16x16x32_bf16 v[80:83], a[16:19], a[176:179], v[80:83]
    v_mfma_f32_16x16x32_bf16 v[80:83], a[80:83], a[204:207], v[80:83]
    ds_write_b128 v232, v[68:71] offset:54272
    v_mfma_f32_16x16x32_bf16 v[84:87], a[20:23], a[176:179], v[84:87]
    v_mfma_f32_16x16x32_bf16 v[84:87], a[84:87], a[204:207], v[84:87]
    ds_write_b128 v232, v[72:75] offset:57344
    v_mfma_f32_16x16x32_bf16 v[96:99], a[0:3], a[180:183], v[96:99]
    v_mfma_f32_16x16x32_bf16 v[96:99], a[64:67], a[208:211], v[96:99]
    ds_write_b128 v232, v[76:79] offset:58368
    v_mfma_f32_16x16x32_bf16 v[100:103], a[4:7], a[180:183], v[100:103]
    v_mfma_f32_16x16x32_bf16 v[100:103], a[68:71], a[208:211], v[100:103]
    ds_write_b128 v232, v[80:83] offset:61440
    v_mfma_f32_16x16x32_bf16 v[104:107], a[8:11], a[180:183], v[104:107]
    v_mfma_f32_16x16x32_bf16 v[104:107], a[72:75], a[208:211], v[104:107]
    ds_write_b128 v232, v[84:87] offset:62464
    v_mfma_f32_16x16x32_bf16 v[108:111], a[12:15], a[180:183], v[108:111]
    v_mfma_f32_16x16x32_bf16 v[108:111], a[76:79], a[208:211], v[108:111]
    ds_write_b128 v233, v[96:99] offset:12288
    v_mfma_f32_16x16x32_bf16 v[112:115], a[16:19], a[180:183], v[112:115]
    v_mfma_f32_16x16x32_bf16 v[112:115], a[80:83], a[208:211], v[112:115]
    ds_write_b128 v233, v[100:103] offset:13312
    v_mfma_f32_16x16x32_bf16 v[116:119], a[20:23], a[180:183], v[116:119]
    v_mfma_f32_16x16x32_bf16 v[116:119], a[84:87], a[208:211], v[116:119]
    ds_write_b128 v233, v[104:107] offset:16384
    v_mfma_f32_16x16x32_bf16 v[128:131], a[0:3], a[184:187], v[128:131]
    v_mfma_f32_16x16x32_bf16 v[128:131], a[64:67], a[212:215], v[128:131]
    ds_write_b128 v233, v[108:111] offset:17408
    v_mfma_f32_16x16x32_bf16 v[132:135], a[4:7], a[184:187], v[132:135]
    v_mfma_f32_16x16x32_bf16 v[132:135], a[68:71], a[212:215], v[132:135]
    ds_write_b128 v233, v[112:115] offset:20480
    v_mfma_f32_16x16x32_bf16 v[136:139], a[8:11], a[184:187], v[136:139]
    v_mfma_f32_16x16x32_bf16 v[136:139], a[72:75], a[212:215], v[136:139]
    ds_write_b128 v233, v[116:119] offset:21504
    v_mfma_f32_16x16x32_bf16 v[140:143], a[12:15], a[184:187], v[140:143]
    v_mfma_f32_16x16x32_bf16 v[140:143], a[76:79], a[212:215], v[140:143]
    ds_write_b128 v233, v[128:131] offset:36864
    v_mfma_f32_16x16x32_bf16 v[144:147], a[16:19], a[184:187], v[144:147]
    v_mfma_f32_16x16x32_bf16 v[144:147], a[80:83], a[212:215], v[144:147]
    ds_write_b128 v233, v[132:135] offset:37888
    v_mfma_f32_16x16x32_bf16 v[148:151], a[20:23], a[184:187], v[148:151]
    v_mfma_f32_16x16x32_bf16 v[148:151], a[84:87], a[212:215], v[148:151]
    ds_write_b128 v233, v[136:139] offset:40960
    v_mfma_f32_16x16x32_bf16 v[160:163], a[0:3], a[188:191], v[160:163]
    v_mfma_f32_16x16x32_bf16 v[160:163], a[64:67], a[216:219], v[160:163]
    ds_write_b128 v233, v[140:143] offset:41984
    v_mfma_f32_16x16x32_bf16 v[164:167], a[4:7], a[188:191], v[164:167]
    v_mfma_f32_16x16x32_bf16 v[164:167], a[68:71], a[216:219], v[164:167]
    ds_write_b128 v233, v[144:147] offset:45056
    v_mfma_f32_16x16x32_bf16 v[168:171], a[8:11], a[188:191], v[168:171]
    v_mfma_f32_16x16x32_bf16 v[168:171], a[72:75], a[216:219], v[168:171]
    ds_write_b128 v233, v[148:151] offset:46080
    v_mfma_f32_16x16x32_bf16 v[172:175], a[12:15], a[188:191], v[172:175]
    v_mfma_f32_16x16x32_bf16 v[172:175], a[76:79], a[216:219], v[172:175]
    ds_write_b128 v233, v[160:163] offset:61440
    v_mfma_f32_16x16x32_bf16 v[176:179], a[16:19], a[188:191], v[176:179]
    v_mfma_f32_16x16x32_bf16 v[176:179], a[80:83], a[216:219], v[176:179]
    ds_write_b128 v233, v[164:167] offset:62464
    v_mfma_f32_16x16x32_bf16 v[180:183], a[20:23], a[188:191], v[180:183]
    v_mfma_f32_16x16x32_bf16 v[180:183], a[84:87], a[216:219], v[180:183]
    ds_write_b128 v234, v[168:171] offset:0
    v_mfma_f32_16x16x32_bf16 v[192:195], a[0:3], a[192:195], v[192:195]
    v_mfma_f32_16x16x32_bf16 v[192:195], a[64:67], a[220:223], v[192:195]
    ds_write_b128 v234, v[172:175] offset:1024
    v_mfma_f32_16x16x32_bf16 v[196:199], a[4:7], a[192:195], v[196:199]
    v_mfma_f32_16x16x32_bf16 v[196:199], a[68:71], a[220:223], v[196:199]
    ds_write_b128 v234, v[176:179] offset:4096
    v_mfma_f32_16x16x32_bf16 v[200:203], a[8:11], a[192:195], v[200:203]
    v_mfma_f32_16x16x32_bf16 v[200:203], a[72:75], a[220:223], v[200:203]
    ds_write_b128 v234, v[180:183] offset:5120
    v_mfma_f32_16x16x32_bf16 v[204:207], a[12:15], a[192:195], v[204:207]
    v_mfma_f32_16x16x32_bf16 v[204:207], a[76:79], a[220:223], v[204:207]
    ds_write_b128 v234, v[192:195] offset:20480
    v_mfma_f32_16x16x32_bf16 v[24:27], a[24:27], a[168:171], v[24:27]
    v_mfma_f32_16x16x32_bf16 v[24:27], a[88:91], a[196:199], v[24:27]
    ds_write_b128 v234, v[196:199] offset:21504
    v_mfma_f32_16x16x32_bf16 v[28:31], a[28:31], a[168:171], v[28:31]
    v_mfma_f32_16x16x32_bf16 v[28:31], a[92:95], a[196:199], v[28:31]
    ds_write_b128 v234, v[200:203] offset:24576
    v_mfma_f32_16x16x32_bf16 v[56:59], a[24:27], a[172:175], v[56:59]
    v_mfma_f32_16x16x32_bf16 v[56:59], a[88:91], a[200:203], v[56:59]
    ds_write_b128 v234, v[204:207] offset:25600
    v_mfma_f32_16x16x32_bf16 v[60:63], a[28:31], a[172:175], v[60:63]
    v_mfma_f32_16x16x32_bf16 v[60:63], a[92:95], a[200:203], v[60:63]
    v_mfma_f32_16x16x32_bf16 v[88:91], a[24:27], a[176:179], v[88:91]
    v_mfma_f32_16x16x32_bf16 v[88:91], a[88:91], a[204:207], v[88:91]
    v_mfma_f32_16x16x32_bf16 v[92:95], a[28:31], a[176:179], v[92:95]
    v_mfma_f32_16x16x32_bf16 v[92:95], a[92:95], a[204:207], v[92:95]
    v_mfma_f32_16x16x32_bf16 v[120:123], a[24:27], a[180:183], v[120:123]
    v_mfma_f32_16x16x32_bf16 v[120:123], a[88:91], a[208:211], v[120:123]
    v_mfma_f32_16x16x32_bf16 v[124:127], a[28:31], a[180:183], v[124:127]
    v_mfma_f32_16x16x32_bf16 v[124:127], a[92:95], a[208:211], v[124:127]
    v_mfma_f32_16x16x32_bf16 v[152:155], a[24:27], a[184:187], v[152:155]
    v_mfma_f32_16x16x32_bf16 v[152:155], a[88:91], a[212:215], v[152:155]
    v_mfma_f32_16x16x32_bf16 v[156:159], a[28:31], a[184:187], v[156:159]
    v_mfma_f32_16x16x32_bf16 v[156:159], a[92:95], a[212:215], v[156:159]
    v_mfma_f32_16x16x32_bf16 v[184:187], a[24:27], a[188:191], v[184:187]
    v_mfma_f32_16x16x32_bf16 v[184:187], a[88:91], a[216:219], v[184:187]
    v_mfma_f32_16x16x32_bf16 v[188:191], a[28:31], a[188:191], v[188:191]
    v_mfma_f32_16x16x32_bf16 v[188:191], a[92:95], a[216:219], v[188:191]
    s_waitcnt lgkmcnt(0)
    s_barrier
    ds_read_b128 v[0:3], v232 offset:18432
    ds_read_b128 v[4:7], v232 offset:19456
    ds_read_b128 v[8:11], v232 offset:20480
    ds_read_b128 v[12:15], v232 offset:21504
    ds_read_b128 v[16:19], v232 offset:22528
    ds_read_b128 v[20:23], v232 offset:23552
    ds_read_b128 v[32:35], v232 offset:43008
    ds_read_b128 v[36:39], v232 offset:44032
    ds_read_b128 v[40:43], v232 offset:45056
    ds_read_b128 v[44:47], v232 offset:46080
    ds_read_b128 v[48:51], v232 offset:47104
    ds_read_b128 v[52:55], v232 offset:48128
    ds_read_b128 v[64:67], v233 offset:2048
    ds_read_b128 v[68:71], v233 offset:3072
    ds_read_b128 v[72:75], v233 offset:4096
    ds_read_b128 v[76:79], v233 offset:5120
    ds_read_b128 v[80:83], v233 offset:6144
    ds_read_b128 v[84:87], v233 offset:7168
    ds_read_b128 v[96:99], v233 offset:26624
    ds_read_b128 v[100:103], v233 offset:27648
    ds_read_b128 v[104:107], v233 offset:28672
    ds_read_b128 v[108:111], v233 offset:29696
    ds_read_b128 v[112:115], v233 offset:30720
    ds_read_b128 v[116:119], v233 offset:31744
    ds_read_b128 v[128:131], v233 offset:51200
    ds_read_b128 v[132:135], v233 offset:52224
    ds_read_b128 v[136:139], v233 offset:53248
    ds_read_b128 v[140:143], v233 offset:54272
    ds_read_b128 v[144:147], v233 offset:55296
    ds_read_b128 v[148:151], v233 offset:56320
    ds_read_b128 v[160:163], v234 offset:10240
    ds_read_b128 v[164:167], v234 offset:11264
    ds_read_b128 v[168:171], v234 offset:12288
    ds_read_b128 v[172:175], v234 offset:13312
    ds_read_b128 v[176:179], v234 offset:14336
    ds_read_b128 v[180:183], v234 offset:15360
    s_waitcnt lgkmcnt(15)
    v_pk_add_f32 v[24:25], v[24:25], v[0:1]
    v_pk_add_f32 v[8:9], v[8:9], v[16:17]
    v_pk_add_f32 v[26:27], v[26:27], v[2:3]
    v_pk_add_f32 v[10:11], v[10:11], v[18:19]
    v_pk_add_f32 v[24:25], v[24:25], v[8:9]
    v_pk_add_f32 v[26:27], v[26:27], v[10:11]
    v_pk_add_f32 v[28:29], v[28:29], v[4:5]
    v_pk_add_f32 v[12:13], v[12:13], v[20:21]
    v_pk_add_f32 v[30:31], v[30:31], v[6:7]
    v_pk_add_f32 v[14:15], v[14:15], v[22:23]
    v_pk_add_f32 v[28:29], v[28:29], v[12:13]
    v_pk_add_f32 v[30:31], v[30:31], v[14:15]
    v_cvt_pk_bf16_f32 v24, v24, v25
    v_cvt_pk_bf16_f32 v25, v26, v27
    v_cvt_pk_bf16_f32 v26, v28, v29
    v_cvt_pk_bf16_f32 v27, v30, v31
    s_add_u32 s71, s70, 0
    s_add_u32 s71, s71, s69
    buffer_store_dwordx4 v[24:27], v235, s[88:91], s71 offen offset:64 sc0 sc1 nt
    v_pk_add_f32 v[56:57], v[56:57], v[32:33]
    v_pk_add_f32 v[40:41], v[40:41], v[48:49]
    v_pk_add_f32 v[58:59], v[58:59], v[34:35]
    v_pk_add_f32 v[42:43], v[42:43], v[50:51]
    v_pk_add_f32 v[56:57], v[56:57], v[40:41]
    v_pk_add_f32 v[58:59], v[58:59], v[42:43]
    v_pk_add_f32 v[60:61], v[60:61], v[36:37]
    v_pk_add_f32 v[44:45], v[44:45], v[52:53]
    v_pk_add_f32 v[62:63], v[62:63], v[38:39]
    v_pk_add_f32 v[46:47], v[46:47], v[54:55]
    v_pk_add_f32 v[60:61], v[60:61], v[44:45]
    v_pk_add_f32 v[62:63], v[62:63], v[46:47]
    v_cvt_pk_bf16_f32 v56, v56, v57
    v_cvt_pk_bf16_f32 v57, v58, v59
    v_cvt_pk_bf16_f32 v58, v60, v61
    v_cvt_pk_bf16_f32 v59, v62, v63
    s_add_u32 s71, s70, 32768
    s_add_u32 s71, s71, s69
    buffer_store_dwordx4 v[56:59], v235, s[88:91], s71 offen offset:64 sc0 sc1 nt
    v_pk_add_f32 v[88:89], v[88:89], v[64:65]
    v_pk_add_f32 v[72:73], v[72:73], v[80:81]
    v_pk_add_f32 v[90:91], v[90:91], v[66:67]
    v_pk_add_f32 v[74:75], v[74:75], v[82:83]
    v_pk_add_f32 v[88:89], v[88:89], v[72:73]
    v_pk_add_f32 v[90:91], v[90:91], v[74:75]
    v_pk_add_f32 v[92:93], v[92:93], v[68:69]
    v_pk_add_f32 v[76:77], v[76:77], v[84:85]
    v_pk_add_f32 v[94:95], v[94:95], v[70:71]
    v_pk_add_f32 v[78:79], v[78:79], v[86:87]
    v_pk_add_f32 v[92:93], v[92:93], v[76:77]
    v_pk_add_f32 v[94:95], v[94:95], v[78:79]
    v_cvt_pk_bf16_f32 v88, v88, v89
    v_cvt_pk_bf16_f32 v89, v90, v91
    v_cvt_pk_bf16_f32 v90, v92, v93
    v_cvt_pk_bf16_f32 v91, v94, v95
    s_add_u32 s71, s70, 65536
    s_add_u32 s71, s71, s69
    buffer_store_dwordx4 v[88:91], v235, s[88:91], s71 offen offset:64 sc0 sc1 nt
    v_pk_add_f32 v[120:121], v[120:121], v[96:97]
    s_waitcnt lgkmcnt(13)
    v_pk_add_f32 v[104:105], v[104:105], v[112:113]
    v_pk_add_f32 v[122:123], v[122:123], v[98:99]
    v_pk_add_f32 v[106:107], v[106:107], v[114:115]
    v_pk_add_f32 v[120:121], v[120:121], v[104:105]
    v_pk_add_f32 v[122:123], v[122:123], v[106:107]
    v_pk_add_f32 v[124:125], v[124:125], v[100:101]
    s_waitcnt lgkmcnt(12)
    v_pk_add_f32 v[108:109], v[108:109], v[116:117]
    v_pk_add_f32 v[126:127], v[126:127], v[102:103]
    v_pk_add_f32 v[110:111], v[110:111], v[118:119]
    v_pk_add_f32 v[124:125], v[124:125], v[108:109]
    v_pk_add_f32 v[126:127], v[126:127], v[110:111]
    v_cvt_pk_bf16_f32 v120, v120, v121
    v_cvt_pk_bf16_f32 v121, v122, v123
    v_cvt_pk_bf16_f32 v122, v124, v125
    v_cvt_pk_bf16_f32 v123, v126, v127
    s_add_u32 s71, s70, 98304
    s_add_u32 s71, s71, s69
    buffer_store_dwordx4 v[120:123], v235, s[88:91], s71 offen offset:64 sc0 sc1 nt
    s_waitcnt lgkmcnt(11)
    v_pk_add_f32 v[152:153], v[152:153], v[128:129]
    s_waitcnt lgkmcnt(7)
    v_pk_add_f32 v[136:137], v[136:137], v[144:145]
    v_pk_add_f32 v[154:155], v[154:155], v[130:131]
    v_pk_add_f32 v[138:139], v[138:139], v[146:147]
    v_pk_add_f32 v[152:153], v[152:153], v[136:137]
    v_pk_add_f32 v[154:155], v[154:155], v[138:139]
    v_pk_add_f32 v[156:157], v[156:157], v[132:133]
    s_waitcnt lgkmcnt(6)
    v_pk_add_f32 v[140:141], v[140:141], v[148:149]
    v_pk_add_f32 v[158:159], v[158:159], v[134:135]
    v_pk_add_f32 v[142:143], v[142:143], v[150:151]
    v_pk_add_f32 v[156:157], v[156:157], v[140:141]
    v_pk_add_f32 v[158:159], v[158:159], v[142:143]
    v_cvt_pk_bf16_f32 v152, v152, v153
    v_cvt_pk_bf16_f32 v153, v154, v155
    v_cvt_pk_bf16_f32 v154, v156, v157
    v_cvt_pk_bf16_f32 v155, v158, v159
    s_add_u32 s71, s70, 131072
    s_add_u32 s71, s71, s69
    buffer_store_dwordx4 v[152:155], v235, s[88:91], s71 offen offset:64 sc0 sc1 nt
    s_waitcnt lgkmcnt(5)
    v_pk_add_f32 v[184:185], v[184:185], v[160:161]
    s_waitcnt lgkmcnt(1)
    v_pk_add_f32 v[168:169], v[168:169], v[176:177]
    v_pk_add_f32 v[186:187], v[186:187], v[162:163]
    v_pk_add_f32 v[170:171], v[170:171], v[178:179]
    v_pk_add_f32 v[184:185], v[184:185], v[168:169]
    v_pk_add_f32 v[186:187], v[186:187], v[170:171]
    v_pk_add_f32 v[188:189], v[188:189], v[164:165]
    s_waitcnt lgkmcnt(0)
    v_pk_add_f32 v[172:173], v[172:173], v[180:181]
    v_pk_add_f32 v[190:191], v[190:191], v[166:167]
    v_pk_add_f32 v[174:175], v[174:175], v[182:183]
    v_pk_add_f32 v[188:189], v[188:189], v[172:173]
    v_pk_add_f32 v[190:191], v[190:191], v[174:175]
    v_cvt_pk_bf16_f32 v184, v184, v185
    v_cvt_pk_bf16_f32 v185, v186, v187
    v_cvt_pk_bf16_f32 v186, v188, v189
    v_cvt_pk_bf16_f32 v187, v190, v191
    s_add_u32 s71, s70, 163840
    s_add_u32 s71, s71, s69
    buffer_store_dwordx4 v[184:187], v235, s[88:91], s71 offen offset:64 sc0 sc1 nt
    s_endpgm
L_code_end:
.section .rodata,"a"
.p2align 6
.amdhsa_kernel standalone__mha_block_cached__near_ridge_kernel
  .amdhsa_next_free_vgpr 512
  .amdhsa_next_free_sgpr 102
  .amdhsa_accum_offset 256
  .amdhsa_group_segment_fixed_size 0
  .amdhsa_kernarg_size 64
  .amdhsa_user_sgpr_count 2
  .amdhsa_user_sgpr_kernarg_segment_ptr 1
  .amdhsa_system_sgpr_workgroup_id_x 1
.end_amdhsa_kernel
```
